```python
import torch

def _softmax(x, axis=-1):
    return torch.softmax(x, dim=axis)

def _gelu(x):
    return torch.nn.functional.gelu(x, approximate='tanh')

def _silu(x):
    return torch.nn.functional.silu(x)

def _sigmoid(x):
    return torch.sigmoid(x)

def _layernorm(x, axis=-1, eps=1e-05):
    m = x.mean(dim=axis, keepdim=True)
    v = x.var(dim=axis, keepdim=True, unbiased=False)
    return (x - m) / torch.sqrt(v + eps)

def _scatter_add(tgt, idx, src, axis=0):
    return tgt.clone().index_add_(axis, idx, src)

def _segment_sum(src, seg, n):
    out = torch.zeros((n,) + src.shape[1:], dtype=src.dtype)
    return out.index_add_(0, seg, src)

def _pad(x, pw):
    flat = tuple((v for pair in reversed(pw) for v in pair))
    return torch.nn.functional.pad(x, flat)
kernel_name = 'concat_heads__grouped_kv_mqa__memory_aug_recurrent_mem_tr__prompt'

def setup_inputs():

    _w = lambda a: (lambda t: t.to(torch.bfloat16) if t.is_floating_point() else t)(torch.as_tensor(a))

    def _A_setup():
        B, S, D, H = (1, 2048, 1024, 32)
        Dh = D // H
        return {'x': _w((lambda *s: torch.randn(*s, dtype=torch.bfloat16) * 0.05)(B, S, D)), 'wq': _w((lambda *s: torch.randn(*s, dtype=torch.bfloat16) * 3.2)(D, H * Dh)), 'wk': _w((lambda *s: torch.randn(*s, dtype=torch.bfloat16) * 3.2)(D, Dh)), 'wv': _w((lambda *s: torch.randn(*s, dtype=torch.bfloat16) * 0.1)(D, Dh)), 'wo': _w((lambda *s: torch.randn(*s, dtype=torch.bfloat16) * 0.1)(H * Dh, D))}
    _A_in = _A_setup()

    def _B_setup():
        B, S, Dm = (1, 2048, 1024)
        H, Dh = (32, 128)
        M, seg = (8, 32)
        seg = min(seg, S)
        S = S // seg * seg
        return {'x': _w((lambda *s: torch.randn(*s, dtype=torch.bfloat16) * 0.05)(B, S, Dm)), 'mem0': _w((lambda *s: torch.randn(*s, dtype=torch.bfloat16) * 1.6)(B, M, Dm)), 'Wq': _w((lambda *s: torch.randn(*s, dtype=torch.bfloat16) * 0.8)(Dm, H, Dh) * Dm ** (-0.5)), 'Wk': _w((lambda *s: torch.randn(*s, dtype=torch.bfloat16) * 0.8)(Dm, H, Dh) * Dm ** (-0.5)), 'Wv': _w((lambda *s: torch.randn(*s, dtype=torch.bfloat16) * 1.6)(Dm, H, Dh) * Dm ** (-0.5)), 'Wo': _w((lambda *s: torch.randn(*s, dtype=torch.bfloat16) * 1.6)(H, Dh, Dm) * (H * Dh) ** (-0.5)), 'seg_len': seg}
    _B_in = _B_setup()
    return {'A_x': _A_in['x'], 'A_wq': _A_in['wq'], 'A_wk': _A_in['wk'], 'A_wv': _A_in['wv'], 'A_wo': _A_in['wo'], 'B_x': _B_in['x'], 'B_mem0': _B_in['mem0'], 'B_Wq': _B_in['Wq'], 'B_Wk': _B_in['Wk'], 'B_Wv': _B_in['Wv'], 'B_Wo': _B_in['Wo'], 'B_seg_len': _B_in['seg_len']}

def reference(A_x, A_wq, A_wk, A_wv, A_wo, B_x, B_mem0, B_Wq, B_Wk, B_Wv, B_Wo, B_seg_len):

    def _A_ref(x, wq, wk, wv, wo):
        B, S, D = x.shape
        H = 32
        Dh = D // H
        q = (lambda x, *d: x.permute(*d))((x @ wq).reshape(B, S, H, Dh), 0, 2, 1, 3)
        k = x @ wk
        v = x @ wv
        scores = torch.einsum('bhqd,bkd->bhqk', q, k) * Dh ** (-0.5)
        p = _softmax(scores, axis=-1)
        o = torch.einsum('bhqk,bkd->bhqd', p, v)
        return (lambda x, *d: x.permute(*d))(o, 0, 2, 1, 3).reshape(B, S, H * Dh) @ wo

    def _B_ref(x, mem0, Wq, Wk, Wv, Wo, seg_len):
        B, S, Dm = x.shape
        H, Dh = (Wq.shape[1], Wq.shape[2])
        M = mem0.shape[1]
        scale = Dh ** (-0.5)
        n_seg = S // seg_len
        L = M + seg_len
        idx = torch.arange(L)
        mask = (idx[:, None] < M) | (idx[:, None] >= idx[None, :])
        mem = mem0
        outs = []
        for s in range(n_seg):
            xs = x[:, s * seg_len:(s + 1) * seg_len, :].clone()
            h = torch.concatenate([mem, xs], axis=1)
            q = torch.einsum('btd,dhe->bhte', h, Wq)
            k = torch.einsum('btd,dhe->bhte', h, Wk)
            v = torch.einsum('btd,dhe->bhte', h, Wv)
            scores = torch.einsum('bhqe,bhke->bhqk', q, k) * scale
            scores = torch.where(mask[None, None], scores, -1000000000.0)
            p = _softmax(scores, axis=-1)
            o = torch.einsum('bhqk,bhke->bhqe', p, v)
            o = torch.einsum('bhte,hed->btd', o, Wo)
            mem = o[:, :M, :].clone()
            outs.append(o[:, M:, :])
        return torch.concatenate(outs, axis=1)
    a = _A_ref(A_x, A_wq, A_wk, A_wv, A_wo)
    b = _B_ref(B_x, B_mem0, B_Wq, B_Wk, B_Wv, B_Wo, B_seg_len)
    return torch.concatenate([a, b], axis=-1)
```

```asm
; @launch grid=(256,1,1) block=(512,1,1) lds=163840
.amdgcn_target "amdgcn-amd-amdhsa--gfx950"
.text
.globl concat_heads__grouped_kv_mqa__memory_aug_recurrent_mem_tr__prompt_kernel
.p2align 8
.type concat_heads__grouped_kv_mqa__memory_aug_recurrent_mem_tr__prompt_kernel,@function
concat_heads__grouped_kv_mqa__memory_aug_recurrent_mem_tr__prompt_kernel:
  s_cmp_ge_u32 s2, 256
  s_cbranch_scc1 L_exit
  s_load_dwordx2 s[8:9], s[0:1], 104
  s_load_dwordx2 s[4:5], s[0:1], 112
  v_lshrrev_b32 v1, 6, v0
  v_and_b32 v0, 63, v0
  v_readfirstlane_b32 s26, v1
  s_mov_b32 s27, 0
  s_mov_b32 s10, 256
  s_mov_b32 s11, 0x20000
  s_mov_b32 s6, 0x10000000
  s_mov_b32 s7, 0x20000
  s_waitcnt lgkmcnt(0)
  s_and_b32 s9, s9, 0xffff
  s_and_b32 s5, s5, 0xffff
  s_cmp_lg_u32 s26, 0
  s_cbranch_scc1 L_role_wait
  s_getreg_b32 s24, hwreg(HW_REG_XCC_ID, 0, 3)
  s_and_b32 s28, s24, 3
  s_lshl_b32 s28, s28, 4
  s_lshr_b32 s29, s24, 2
  s_add_u32 s28, s28, s29
  s_lshl_b32 s28, s28, 2
  v_mov_b32 v1, s28
  v_mov_b32 v2, 1
  v_mov_b32 v4, 0
  v_lshlrev_b32 v5, 2, v0
  s_mov_b64 exec, 1
  buffer_atomic_add v2, v1, s[8:11], 0 offen sc0 sc1
  s_waitcnt vmcnt(0)
  v_readfirstlane_b32 s25, v2
  s_nop 0
  s_cmp_lt_u32 s25, 32
  s_cbranch_scc1 L_role_ok
  v_mov_b32 v2, 1
  buffer_atomic_add v2, v4, s[8:11], 0 offen offset:36 sc0 sc1
  s_waitcnt vmcnt(0)
  v_readfirstlane_b32 s29, v2
  s_mov_b64 exec, -1
L_ovf_poll:
  buffer_load_dword v6, v5, s[8:11], 0 offen sc1
  s_waitcnt vmcnt(0)
  v_readlane_b32 s30, v6, 0
  v_readlane_b32 s31, v6, 16
  s_nop 0
  s_add_u32 s30, s30, s31
  v_readlane_b32 s31, v6, 32
  s_nop 0
  s_add_u32 s30, s30, s31
  v_readlane_b32 s31, v6, 48
  s_nop 0
  s_add_u32 s30, s30, s31
  v_readlane_b32 s31, v6, 1
  s_nop 0
  s_add_u32 s30, s30, s31
  v_readlane_b32 s31, v6, 17
  s_nop 0
  s_add_u32 s30, s30, s31
  v_readlane_b32 s31, v6, 33
  s_nop 0
  s_add_u32 s30, s30, s31
  v_readlane_b32 s31, v6, 49
  s_nop 0
  s_add_u32 s30, s30, s31
  s_cmp_ge_u32 s30, 256
  s_cbranch_scc1 L_ovf_go
  s_add_u32 s27, s27, 1
  s_cmp_lt_u32 s27, 0x80000
  s_cbranch_scc1 L_ovf_poll
L_ovf_go:
  v_readlane_b32 s30, v6, 0
  s_nop 0
  s_min_u32 s30, s30, 32
  s_sub_u32 s31, 32, s30
  s_mov_b32 s24, 0
  s_add_u32 s25, s30, s29
  s_cmp_lt_u32 s29, s31
  s_cbranch_scc1 L_role_ok
  s_sub_u32 s29, s29, s31
  v_readlane_b32 s30, v6, 16
  s_nop 0
  s_min_u32 s30, s30, 32
  s_sub_u32 s31, 32, s30
  s_mov_b32 s24, 1
  s_add_u32 s25, s30, s29
  s_cmp_lt_u32 s29, s31
  s_cbranch_scc1 L_role_ok
  s_sub_u32 s29, s29, s31
  v_readlane_b32 s30, v6, 32
  s_nop 0
  s_min_u32 s30, s30, 32
  s_sub_u32 s31, 32, s30
  s_mov_b32 s24, 2
  s_add_u32 s25, s30, s29
  s_cmp_lt_u32 s29, s31
  s_cbranch_scc1 L_role_ok
  s_sub_u32 s29, s29, s31
  v_readlane_b32 s30, v6, 48
  s_nop 0
  s_min_u32 s30, s30, 32
  s_sub_u32 s31, 32, s30
  s_mov_b32 s24, 3
  s_add_u32 s25, s30, s29
  s_cmp_lt_u32 s29, s31
  s_cbranch_scc1 L_role_ok
  s_sub_u32 s29, s29, s31
  v_readlane_b32 s30, v6, 1
  s_nop 0
  s_min_u32 s30, s30, 32
  s_sub_u32 s31, 32, s30
  s_mov_b32 s24, 4
  s_add_u32 s25, s30, s29
  s_cmp_lt_u32 s29, s31
  s_cbranch_scc1 L_role_ok
  s_sub_u32 s29, s29, s31
  v_readlane_b32 s30, v6, 17
  s_nop 0
  s_min_u32 s30, s30, 32
  s_sub_u32 s31, 32, s30
  s_mov_b32 s24, 5
  s_add_u32 s25, s30, s29
  s_cmp_lt_u32 s29, s31
  s_cbranch_scc1 L_role_ok
  s_sub_u32 s29, s29, s31
  v_readlane_b32 s30, v6, 33
  s_nop 0
  s_min_u32 s30, s30, 32
  s_sub_u32 s31, 32, s30
  s_mov_b32 s24, 6
  s_add_u32 s25, s30, s29
  s_cmp_lt_u32 s29, s31
  s_cbranch_scc1 L_role_ok
  s_sub_u32 s29, s29, s31
  v_readlane_b32 s30, v6, 49
  s_nop 0
  s_min_u32 s30, s30, 32
  s_sub_u32 s31, 32, s30
  s_mov_b32 s24, 7
  s_add_u32 s25, s30, s29
  s_cmp_lt_u32 s29, s31
  s_cbranch_scc1 L_role_ok
  s_sub_u32 s29, s29, s31
L_role_ok:
  s_mov_b64 exec, -1
  s_lshl_b32 s28, s24, 5
  s_and_b32 s25, s25, 31
  s_or_b32 s28, s28, s25
  v_mov_b32 v1, s28
  v_mov_b32 v4, 22536
  ds_write_b32 v4, v1
  s_waitcnt lgkmcnt(0)
L_role_wait:
  s_barrier
  v_mov_b32 v4, 22536
  ds_read_b32 v1, v4
  s_waitcnt lgkmcnt(0)
  v_readfirstlane_b32 s28, v1
  s_nop 0
  s_lshr_b32 s24, s28, 5
  s_and_b32 s24, s24, 7
  s_and_b32 s25, s28, 31
  s_cmp_lt_u32 s24, 4
  s_cbranch_scc1 L_R
  s_and_b32 s30, s28, 127
  v_lshlrev_b32 v1, 4, v0
  s_cmp_eq_u32 s26, 0
  s_cbranch_scc1 L_init_done
  s_cmp_eq_u32 s26, 7
  s_cselect_b32 s28, 0, -1
  v_mov_b32 v4, s28
  v_mov_b32 v5, s28
  v_mov_b32 v6, s28
  v_mov_b32 v7, s28
  s_cbranch_scc1 L_init_fl
  s_lshr_b32 s28, s30, 5
  s_lshl_b32 s28, s28, 19
  s_and_b32 s29, s30, 31
  s_lshl_b32 s29, s29, 13
  s_add_u32 s28, s28, s29
  s_add_u32 s28, s28, 85981184
  s_lshl_b32 s29, s30, 12
  s_add_u32 s29, s29, 88070144
  s_cmp_ge_u32 s26, 5
  s_cselect_b32 s28, s29, s28
  s_lshl_b32 s29, s26, 11
  s_add_u32 s28, s28, s29
  buffer_store_dwordx4 v[4:7], v1, s[4:7], s28 offen offset:1024 sc1
  s_branch L_init_go
L_init_fl:
  v_and_b32 v1, 0x70, v1
  s_lshl_b32 s28, s30, 7
  s_add_u32 s28, s28, 84934656
L_init_go:
  buffer_store_dwordx4 v[4:7], v1, s[4:7], s28 offen sc1
L_init_done:
  s_cmp_eq_u32 s26, 1
  s_cselect_b32 s67, 1, 0
  s_barrier
  s_cmp_lt_u32 s25, 28
  s_cbranch_scc1 L_init_nc
  s_waitcnt vmcnt(0)
  s_barrier
  s_cmp_eq_u32 s67, 0
  s_cbranch_scc1 L_init_nc
  s_mov_b32 s67, 0
  v_mov_b32 v62, 1
  v_mov_b32 v63, 0
  s_mov_b64 exec, 1
  buffer_atomic_add v62, v63, s[8:11], 0 offen offset:136 sc1
  s_mov_b64 exec, -1
L_init_nc:
L_B:
  s_mov_b32 s87, 0
L_B2:
  s_getpc_b64 s[28:29]
  s_add_u32 s28, s28, task_table@rel32@lo+4
  s_addc_u32 s29, s29, task_table@rel32@hi+12
  s_lshl_b32 s30, s24, 5
  s_add_u32 s30, s30, s25
  s_lshl_b32 s30, s30, 6
  s_add_u32 s94, s28, s30
  s_addc_u32 s95, s29, 0
  s_load_dwordx2 s[92:93], s[94:95], 0
  s_mov_b32 s57, 0
  s_mov_b32 s65, -1
  s_mov_b32 s66, 0
  s_mov_b32 s58, 0
  s_mov_b64 s[62:63], s[4:5]
  s_mov_b32 s91, 0
  s_mov_b64 s[12:13], s[4:5]
  s_mov_b32 s14, 0
  s_mov_b32 s15, 0x20000
  s_mov_b64 s[16:17], s[4:5]
  s_mov_b32 s18, 0
  s_mov_b32 s19, 0x20000
  s_mov_b64 s[20:21], s[4:5]
  s_mov_b32 s22, 0
  s_mov_b32 s23, 0x20000
  s_waitcnt lgkmcnt(0)
  s_branch L_disp
L_next:
  s_waitcnt lgkmcnt(0)
  s_mov_b32 s92, s93
  s_add_u32 s91, s91, 1
  s_lshl_b32 s28, s91, 2
  s_load_dword s93, s[94:95], s28 offset:4
L_disp:
  s_and_b32 s28, s92, 15
  s_cbranch_scc0 L_exit
  s_bfe_u32 s88, s92, 0x80004
  s_bfe_u32 s89, s92, 0x8000c
  s_bfe_u32 s90, s92, 0x80014
  s_and_b32 s28, s92, 15
  s_cmp_eq_u32 s28, 11
  s_cbranch_scc1 L_T_WARM
  s_cmp_eq_u32 s28, 1
  s_cbranch_scc1 L_T_QKV
  s_cmp_eq_u32 s28, 2
  s_cbranch_scc1 L_T_QA
  s_cmp_eq_u32 s28, 5
  s_cbranch_scc1 L_T_OUTA
  s_cmp_eq_u32 s28, 6
  s_cbranch_scc1 L_T_OUTB
  s_cmp_eq_u32 s28, 3
  s_cbranch_scc1 L_T_KVA
  s_cmp_eq_u32 s28, 4
  s_cbranch_scc1 L_T_ATT
  s_cmp_eq_u32 s28, 7
  s_cbranch_scc1 L_T_S3
  s_cmp_eq_u32 s28, 8
  s_cbranch_scc1 L_T_S4
  s_cmp_eq_u32 s28, 10
  s_cbranch_scc1 L_T_PROBE
L_exit:
  s_endpgm
L_T_PROBE:
  s_cmp_lg_u32 s26, 0
  s_cbranch_scc1 L_pr_end
  s_mov_b64 exec, 1
  v_mov_b32 v1, -1
  v_mov_b32 v2, 88080384
  s_mov_b32 s36, -1
  s_mov_b32 s37, -1
  s_memtime s[28:29]
  s_mov_b32 s32, 8192
  s_waitcnt lgkmcnt(0)
  buffer_store_dword v1, v2, s[4:7], s32 offen sc1
  s_waitcnt vmcnt(0)
  s_memtime s[30:31]
  s_waitcnt lgkmcnt(0)
  s_memtime s[28:29]
  s_mov_b32 s32, 0
  s_waitcnt lgkmcnt(0)
  buffer_store_dword v1, v2, s[4:7], s32 offen sc1
  s_waitcnt vmcnt(0)
  s_memtime s[30:31]
  s_waitcnt lgkmcnt(0)
  s_sub_u32 s30, s30, s28
  s_min_u32 s36, s36, s30
  s_memtime s[28:29]
  s_mov_b32 s32, 8192
  s_waitcnt lgkmcnt(0)
  buffer_store_dword v1, v2, s[4:7], s32 offen sc1
  s_waitcnt vmcnt(0)
  s_memtime s[30:31]
  s_waitcnt lgkmcnt(0)
  s_sub_u32 s30, s30, s28
  s_min_u32 s37, s37, s30
  s_memtime s[28:29]
  s_mov_b32 s32, 65536
  s_waitcnt lgkmcnt(0)
  buffer_store_dword v1, v2, s[4:7], s32 offen sc1
  s_waitcnt vmcnt(0)
  s_memtime s[30:31]
  s_waitcnt lgkmcnt(0)
  s_sub_u32 s30, s30, s28
  s_min_u32 s36, s36, s30
  s_memtime s[28:29]
  s_mov_b32 s32, 73728
  s_waitcnt lgkmcnt(0)
  buffer_store_dword v1, v2, s[4:7], s32 offen sc1
  s_waitcnt vmcnt(0)
  s_memtime s[30:31]
  s_waitcnt lgkmcnt(0)
  s_sub_u32 s30, s30, s28
  s_min_u32 s37, s37, s30
  s_memtime s[28:29]
  s_mov_b32 s32, 131072
  s_waitcnt lgkmcnt(0)
  buffer_store_dword v1, v2, s[4:7], s32 offen sc1
  s_waitcnt vmcnt(0)
  s_memtime s[30:31]
  s_waitcnt lgkmcnt(0)
  s_sub_u32 s30, s30, s28
  s_min_u32 s36, s36, s30
  s_memtime s[28:29]
  s_mov_b32 s32, 139264
  s_waitcnt lgkmcnt(0)
  buffer_store_dword v1, v2, s[4:7], s32 offen sc1
  s_waitcnt vmcnt(0)
  s_memtime s[30:31]
  s_waitcnt lgkmcnt(0)
  s_sub_u32 s30, s30, s28
  s_min_u32 s37, s37, s30
  s_memtime s[28:29]
  s_mov_b32 s32, 196608
  s_waitcnt lgkmcnt(0)
  buffer_store_dword v1, v2, s[4:7], s32 offen sc1
  s_waitcnt vmcnt(0)
  s_memtime s[30:31]
  s_waitcnt lgkmcnt(0)
  s_sub_u32 s30, s30, s28
  s_min_u32 s36, s36, s30
  s_memtime s[28:29]
  s_mov_b32 s32, 204800
  s_waitcnt lgkmcnt(0)
  buffer_store_dword v1, v2, s[4:7], s32 offen sc1
  s_waitcnt vmcnt(0)
  s_memtime s[30:31]
  s_waitcnt lgkmcnt(0)
  s_sub_u32 s30, s30, s28
  s_min_u32 s37, s37, s30
  s_cmp_lt_u32 s36, s37
  s_cselect_b32 s28, 2, 1
  v_mov_b32 v1, s28
  v_mov_b32 v2, 0
  buffer_store_dword v1, v2, s[8:11], 0 offen offset:140 sc1
  s_mov_b64 exec, -1
L_pr_end:
  s_barrier
  s_branch L_next
L_T_WARM:
  s_cmp_eq_u32 s89, 0
  s_cbranch_scc1 L_wm_x
  s_load_dwordx2 s[12:13], s[0:1], 32
  s_waitcnt lgkmcnt(0)
  s_and_b32 s13, s13, 0xffff
  s_mov_b32 s14, 0x200000
  s_mov_b32 s15, 0x20000
  s_branch L_wm_go
L_wm_x:
  s_load_dwordx2 s[12:13], s[0:1], 40
  s_waitcnt lgkmcnt(0)
  s_and_b32 s13, s13, 0xffff
  s_mov_b32 s14, 0x400000
  s_mov_b32 s15, 0x20000
L_wm_go:
  v_lshlrev_b32 v1, 7, v0
  s_lshl_b32 s28, s88, 16
  s_lshl_b32 s29, s26, 13
  s_add_u32 s28, s28, s29
L_wm_loop:
  buffer_load_dword v2, v1, s[12:15], s28 offen
  s_add_u32 s28, s28, 0x10000
  s_sub_u32 s90, s90, 1
  s_cmp_lg_u32 s90, 0
  s_cbranch_scc1 L_wm_loop
  s_waitcnt vmcnt(0)
  s_branch L_next
L_T_QKV:
  s_lshr_b32 s47, s90, 2
  s_and_b32 s90, s90, 3
  s_load_dwordx2 s[12:13], s[0:1], 40
  s_cmp_eq_u32 s90, 1
  s_cbranch_scc1 L_qkv_v
  s_cmp_eq_u32 s90, 2
  s_cbranch_scc1 L_qkv_q
  s_load_dwordx2 s[16:17], s[0:1], 64
  s_mov_b32 s48, 1.0
  s_branch L_qkv_c
L_qkv_q:
  s_load_dwordx2 s[16:17], s[0:1], 56
  s_mov_b32 s48, 0x3e0293ee
  s_branch L_qkv_c
L_qkv_v:
  s_load_dwordx2 s[16:17], s[0:1], 72
  s_mov_b32 s48, 1.0
L_qkv_c:
  s_mov_b32 s44, 8388608
  s_mov_b32 s39, 262144
  s_mov_b32 s28, 13
  s_mov_b32 s46, 8192
  s_mov_b32 s56, 524288
  s_lshl_b32 s45, s90, 24
  s_lshl_b32 s29, s88, 15
  s_add_u32 s45, s45, s29
  s_mul_i32 s50, s88, 192
  s_lshl_b32 s29, s90, 6
  s_add_u32 s50, s50, s29
  s_cmp_eq_u32 s47, 0
  s_cselect_b32 s34, 192, 0
  s_cmp_eq_u32 s90, 2
  s_cbranch_scc1 L_proj
  s_lshr_b32 s29, 8, s47
  s_cmp_ge_u32 s26, s29
  s_cbranch_scc1 L_proj
  s_lshl_b32 s29, s89, 1
  s_and_b32 s30, s26, 1
  s_add_u32 s29, s29, s30
  s_lshl_b32 s29, s29, 17
  s_lshl_b32 s30, s88, 13
  s_add_u32 s29, s29, s30
  s_lshr_b32 s30, s26, 1
  s_lshl_b32 s30, s30, 12
  s_add_u32 s29, s29, s30
  s_lshl_b32 s30, s90, 22
  s_add_u32 s29, s29, s30
  s_add_u32 s29, s29, 67108864
  v_lshlrev_b32 v1, 4, v0
  v_mov_b32 v4, -1
  v_mov_b32 v5, -1
  v_mov_b32 v6, -1
  v_mov_b32 v7, -1
  buffer_store_dwordx4 v[4:7], v1, s[4:7], s29 offen offset:0 sc1
  buffer_store_dwordx4 v[4:7], v1, s[4:7], s29 offen offset:1024 sc1
  buffer_store_dwordx4 v[4:7], v1, s[4:7], s29 offen offset:2048 sc1
  buffer_store_dwordx4 v[4:7], v1, s[4:7], s29 offen offset:3072 sc1
  s_nop 1
  s_branch L_proj
L_T_QA:
  s_load_dwordx2 s[12:13], s[0:1], 0
  s_load_dwordx2 s[16:17], s[0:1], 8
  s_mov_b32 s48, 0x3e8293ee
  s_mov_b32 s44, 2097152
  s_mov_b32 s39, 65536
  s_mov_b32 s28, 11
  s_mov_b32 s46, 65536
  s_mov_b32 s56, 8192
  s_lshl_b32 s45, s88, 18
  s_add_u32 s45, s45, 75497472
  s_lshl_b32 s50, s88, 4
  s_add_u32 s50, s50, 3072
  s_lshr_b32 s47, s90, 2
  s_mov_b32 s90, 0
  s_cmp_eq_u32 s47, 0
  s_cselect_b32 s34, 16, 0
L_proj:
  s_lshl_b32 s29, s89, 2
  s_add_u32 s50, s50, s29
  s_mul_i32 s29, s89, s56
  s_lshl_b32 s29, s29, 1
  s_add_u32 s45, s45, s29
  s_mov_b32 s49, s48
  s_mov_b32 s43, 4194304
  s_mov_b32 s38, 64
  s_lshl_b32 s36, s88, 18
  s_lshl_b32 s37, s89, 9
  s_mov_b32 s51, 32
  s_waitcnt lgkmcnt(0)
  s_and_b32 s13, s13, 0xffff
  s_mov_b32 s14, 0x0
  s_mov_b32 s15, 0x20000
  s_and_b32 s17, s17, 0xffff
  s_mov_b32 s18, 0x0
  s_mov_b32 s19, 0x20000
  s_mov_b32 s35, 0
  s_cmp_lg_u32 s47, 0
  s_cbranch_scc1 L_proj_h
  s_bfe_u32 s58, s92, 0x1001c
  s_cbranch_scc0 L_proj_nc
  s_bfe_u32 s60, s93, 0x80004
  s_lshl_b32 s60, s60, 18
  s_bfe_u32 s61, s93, 0x8000c
  s_lshl_b32 s61, s61, 9
  s_bfe_u32 s29, s93, 0x20014
  s_cmp_eq_u32 s29, 1
  s_cbranch_scc1 L_proj_nv
  s_cmp_eq_u32 s29, 2
  s_cbranch_scc1 L_proj_nq
  s_load_dwordx2 s[62:63], s[0:1], 64
  s_branch L_proj_nw
L_proj_nv:
  s_load_dwordx2 s[62:63], s[0:1], 72
  s_branch L_proj_nw
L_proj_nq:
  s_load_dwordx2 s[62:63], s[0:1], 56
L_proj_nw:
  s_waitcnt lgkmcnt(0)
  s_and_b32 s63, s63, 0xffff
L_proj_nc:
  s_cmp_eq_u32 s90, 1
  s_cbranch_scc1 L_proj_v4
  s_lshr_b32 s30, s26, 2
  s_and_b32 s31, s26, 3
  v_and_b32 v16, 15, v0
  v_lshrrev_b32 v17, 4, v0
  v_lshrrev_b32 v18, 3, v16
  v_and_b32 v19, 7, v16
  v_lshl_add_u32 v19, v18, 4, v19
  s_lshl_b32 s32, s30, 13
  v_lshlrev_b32 v20, 1, v18
  v_xor_b32 v20, v20, v17
  v_lshlrev_b32 v1, 6, v19
  v_lshl_add_u32 v1, v20, 4, v1
  v_add_u32 v1, s32, v1
  v_xor_b32 v2, 32, v1
  v_add_u32 v2, 512, v2
  v_lshrrev_b32 v20, 2, v0
  s_lshl_b32 s32, s26, 5
  v_add_u32 v20, s32, v20
  v_lshlrev_b32 v11, 11, v20
  v_lshrrev_b32 v21, 1, v20
  v_xor_b32 v21, v21, v20
  v_bfe_u32 v21, v21, 3, 1
  v_lshlrev_b32 v21, 1, v21
  v_xor_b32 v21, v21, v0
  v_and_b32 v21, 3, v21
  v_lshl_add_u32 v11, v21, 4, v11
  v_xor_b32 v12, 32, v11
  v_add_u32 v12, 0x8000, v12
  v_bfe_u32 v20, v0, 2, 2
  v_lshl_add_u32 v21, v17, 3, v20
  v_lshlrev_b32 v3, 9, v21
  v_bfe_u32 v21, v0, 1, 1
  v_lshlrev_b32 v21, 1, v21
  s_lshl_b32 s32, s31, 3
  v_or_b32 v21, s32, v21
  v_lshlrev_b32 v20, 2, v20
  v_xor_b32 v21, v21, v20
  v_and_b32 v22, 1, v17
  v_mul_u32_u24 v22, 3, v22
  v_xor_b32 v21, v21, v22
  v_lshl_add_u32 v3, v21, 4, v3
  v_and_b32 v21, 1, v0
  v_lshl_add_u32 v3, v21, 3, v3
  v_add_u32 v3, 0x10000, v3
  v_xor_b32 v4, 48, v3
  v_add_u32 v4, 2048, v4
  v_xor_b32 v5, 16, v3
  v_xor_b32 v6, 16, v4
  v_xor_b32 v7, 64, v3
  v_xor_b32 v8, 64, v4
  v_xor_b32 v9, 80, v3
  v_xor_b32 v10, 80, v4
  v_lshrrev_b32 v20, 5, v0
  s_lshl_b32 s32, s26, 2
  v_add_u32 v21, s32, v20
  v_lshlrev_b32 v13, s28, v21
  v_add_u32 v21, 2, v21
  v_lshlrev_b32 v14, s28, v21
  s_lshr_b32 s32, s26, 1
  s_xor_b32 s32, s32, s26
  s_and_b32 s32, s32, 1
  s_mul_i32 s32, s32, 3
  v_lshlrev_b32 v20, 2, v20
  v_and_b32 v21, 31, v0
  v_xor_b32 v21, v21, v20
  v_xor_b32 v21, s32, v21
  v_lshl_add_u32 v13, v21, 4, v13
  v_xor_b32 v21, 8, v21
  v_lshl_add_u32 v14, v21, 4, v14
  s_lshl_b32 s41, s26, 11
  s_lshl_b32 s42, s26, 11
  s_add_u32 s42, s42, 0x10000
  s_cmp_eq_u32 s57, 0
  s_cbranch_scc1 L_ci_1
  s_mov_b32 s14, s43
  s_mov_b32 s18, s44
  s_add_u32 s36, s36, 256
  s_add_u32 s37, s37, 1048576
  s_branch L_G_int4
L_ci_1:
L_gemm_t4:
  s_mov_b32 s14, s43
  s_mov_b32 s18, s44
  s_add_u32 m0, s41, 0
  s_nop 0
  buffer_load_dwordx4 v11, s[12:15], s36 offen lds
  s_add_u32 m0, s41, 1024
  s_nop 0
  buffer_load_dwordx4 v12, s[12:15], s36 offen lds
  s_add_u32 s36, s36, s38
  s_add_u32 m0, s42, 0
  s_nop 0
  buffer_load_dwordx4 v13, s[16:19], s37 offen lds
  s_add_u32 m0, s42, 1024
  s_nop 0
  buffer_load_dwordx4 v14, s[16:19], s37 offen lds
  s_add_u32 s37, s37, s39
  s_add_u32 m0, s41, 16384
  s_nop 0
  buffer_load_dwordx4 v11, s[12:15], s36 offen lds
  s_add_u32 m0, s41, 17408
  s_nop 0
  buffer_load_dwordx4 v12, s[12:15], s36 offen lds
  s_add_u32 s36, s36, s38
  s_add_u32 m0, s42, 16384
  s_nop 0
  buffer_load_dwordx4 v13, s[16:19], s37 offen lds
  s_add_u32 m0, s42, 17408
  s_nop 0
  buffer_load_dwordx4 v14, s[16:19], s37 offen lds
  s_add_u32 s37, s37, s39
  s_add_u32 m0, s41, 32768
  s_nop 0
  buffer_load_dwordx4 v11, s[12:15], s36 offen lds
  s_add_u32 m0, s41, 33792
  s_nop 0
  buffer_load_dwordx4 v12, s[12:15], s36 offen lds
  s_add_u32 s36, s36, s38
  s_add_u32 m0, s42, 32768
  s_nop 0
  buffer_load_dwordx4 v13, s[16:19], s37 offen lds
  s_add_u32 m0, s42, 33792
  s_nop 0
  buffer_load_dwordx4 v14, s[16:19], s37 offen lds
  s_add_u32 s37, s37, s39
  s_add_u32 m0, s41, 49152
  s_nop 0
  buffer_load_dwordx4 v11, s[12:15], s36 offen lds
  s_add_u32 m0, s41, 50176
  s_nop 0
  buffer_load_dwordx4 v12, s[12:15], s36 offen lds
  s_add_u32 s36, s36, s38
  s_add_u32 m0, s42, 49152
  s_nop 0
  buffer_load_dwordx4 v13, s[16:19], s37 offen lds
  s_add_u32 m0, s42, 50176
  s_nop 0
  buffer_load_dwordx4 v14, s[16:19], s37 offen lds
  s_add_u32 s37, s37, s39
  v_mov_b32 v128, 0
  v_mov_b32 v129, 0
  v_mov_b32 v130, 0
  v_mov_b32 v131, 0
  v_mov_b32 v132, 0
  v_mov_b32 v133, 0
  v_mov_b32 v134, 0
  v_mov_b32 v135, 0
  v_mov_b32 v136, 0
  v_mov_b32 v137, 0
  v_mov_b32 v138, 0
  v_mov_b32 v139, 0
  v_mov_b32 v140, 0
  v_mov_b32 v141, 0
  v_mov_b32 v142, 0
  v_mov_b32 v143, 0
  v_mov_b32 v144, 0
  v_mov_b32 v145, 0
  v_mov_b32 v146, 0
  v_mov_b32 v147, 0
  v_mov_b32 v148, 0
  v_mov_b32 v149, 0
  v_mov_b32 v150, 0
  v_mov_b32 v151, 0
  v_mov_b32 v152, 0
  v_mov_b32 v153, 0
  v_mov_b32 v154, 0
  v_mov_b32 v155, 0
  v_mov_b32 v156, 0
  v_mov_b32 v157, 0
  v_mov_b32 v158, 0
  v_mov_b32 v159, 0
  v_mov_b32 v160, 0
  v_mov_b32 v161, 0
  v_mov_b32 v162, 0
  v_mov_b32 v163, 0
  v_mov_b32 v164, 0
  v_mov_b32 v165, 0
  v_mov_b32 v166, 0
  v_mov_b32 v167, 0
  v_mov_b32 v168, 0
  v_mov_b32 v169, 0
  v_mov_b32 v170, 0
  v_mov_b32 v171, 0
  v_mov_b32 v172, 0
  v_mov_b32 v173, 0
  v_mov_b32 v174, 0
  v_mov_b32 v175, 0
  v_mov_b32 v176, 0
  v_mov_b32 v177, 0
  v_mov_b32 v178, 0
  v_mov_b32 v179, 0
  v_mov_b32 v180, 0
  v_mov_b32 v181, 0
  v_mov_b32 v182, 0
  v_mov_b32 v183, 0
  v_mov_b32 v184, 0
  v_mov_b32 v185, 0
  v_mov_b32 v186, 0
  v_mov_b32 v187, 0
  v_mov_b32 v188, 0
  v_mov_b32 v189, 0
  v_mov_b32 v190, 0
  v_mov_b32 v191, 0
  v_mov_b32 v192, 0
  v_mov_b32 v193, 0
  v_mov_b32 v194, 0
  v_mov_b32 v195, 0
  v_mov_b32 v196, 0
  v_mov_b32 v197, 0
  v_mov_b32 v198, 0
  v_mov_b32 v199, 0
  v_mov_b32 v200, 0
  v_mov_b32 v201, 0
  v_mov_b32 v202, 0
  v_mov_b32 v203, 0
  v_mov_b32 v204, 0
  v_mov_b32 v205, 0
  v_mov_b32 v206, 0
  v_mov_b32 v207, 0
  v_mov_b32 v208, 0
  v_mov_b32 v209, 0
  v_mov_b32 v210, 0
  v_mov_b32 v211, 0
  v_mov_b32 v212, 0
  v_mov_b32 v213, 0
  v_mov_b32 v214, 0
  v_mov_b32 v215, 0
  v_mov_b32 v216, 0
  v_mov_b32 v217, 0
  v_mov_b32 v218, 0
  v_mov_b32 v219, 0
  v_mov_b32 v220, 0
  v_mov_b32 v221, 0
  v_mov_b32 v222, 0
  v_mov_b32 v223, 0
  v_mov_b32 v224, 0
  v_mov_b32 v225, 0
  v_mov_b32 v226, 0
  v_mov_b32 v227, 0
  v_mov_b32 v228, 0
  v_mov_b32 v229, 0
  v_mov_b32 v230, 0
  v_mov_b32 v231, 0
  v_mov_b32 v232, 0
  v_mov_b32 v233, 0
  v_mov_b32 v234, 0
  v_mov_b32 v235, 0
  v_mov_b32 v236, 0
  v_mov_b32 v237, 0
  v_mov_b32 v238, 0
  v_mov_b32 v239, 0
  v_mov_b32 v240, 0
  v_mov_b32 v241, 0
  v_mov_b32 v242, 0
  v_mov_b32 v243, 0
  v_mov_b32 v244, 0
  v_mov_b32 v245, 0
  v_mov_b32 v246, 0
  v_mov_b32 v247, 0
  v_mov_b32 v248, 0
  v_mov_b32 v249, 0
  v_mov_b32 v250, 0
  v_mov_b32 v251, 0
  v_mov_b32 v252, 0
  v_mov_b32 v253, 0
  v_mov_b32 v254, 0
  v_mov_b32 v255, 0
  s_waitcnt vmcnt(12)
L_G_int4:
  s_cmp_lg_u32 s57, 0
  s_cselect_b64 vcc, -1, 0
  s_cselect_b32 s59, 8, s51
  s_mov_b32 s40, 4
  s_barrier
  s_cmp_eq_u32 s67, 0
  s_cbranch_scc1 L_G_rit4
  s_mov_b32 s67, 0
  v_mov_b32 v62, 1
  v_mov_b32 v63, 0
  s_mov_b64 exec, 1
  buffer_atomic_add v62, v63, s[8:11], 0 offen offset:136 sc1
  s_mov_b64 exec, -1
L_G_rit4:
  ds_read_b64_tr_b16 v[96:97], v3 offset:0
  ds_read_b64_tr_b16 v[98:99], v4 offset:0
  ds_read_b64_tr_b16 v[100:101], v5 offset:0
  ds_read_b64_tr_b16 v[102:103], v6 offset:0
  ds_read_b64_tr_b16 v[104:105], v7 offset:0
  ds_read_b64_tr_b16 v[106:107], v8 offset:0
  ds_read_b64_tr_b16 v[108:109], v9 offset:0
  ds_read_b64_tr_b16 v[110:111], v10 offset:0
  ds_read_b128 v[64:67], v1 offset:0
  ds_read_b128 v[68:71], v2 offset:0
  ds_read_b128 v[72:75], v1 offset:2048
  ds_read_b128 v[76:79], v2 offset:2048
.p2align 6
L_G_loopt4:
  s_cmp_eq_u32 s40, s59
  s_cbranch_scc1 L_G_evtt4
L_G_backt4:
  s_waitcnt lgkmcnt(0)
  v_mfma_f32_16x16x32_bf16 v[128:131], v[96:99], v[64:67], v[128:131]
  ds_read_b128 v[80:83], v1 offset:4096
  v_mfma_f32_16x16x32_bf16 v[132:135], v[100:103], v[64:67], v[132:135]
  ds_read_b128 v[84:87], v2 offset:4096
  v_mfma_f32_16x16x32_bf16 v[136:139], v[104:107], v[64:67], v[136:139]
  ds_read_b128 v[88:91], v1 offset:6144
  v_mfma_f32_16x16x32_bf16 v[140:143], v[108:111], v[64:67], v[140:143]
  ds_read_b128 v[92:95], v2 offset:6144
  v_mfma_f32_16x16x32_bf16 v[144:147], v[96:99], v[68:71], v[144:147]
  v_mfma_f32_16x16x32_bf16 v[148:151], v[100:103], v[68:71], v[148:151]
  v_mfma_f32_16x16x32_bf16 v[152:155], v[104:107], v[68:71], v[152:155]
  v_mfma_f32_16x16x32_bf16 v[156:159], v[108:111], v[68:71], v[156:159]
  v_mfma_f32_16x16x32_bf16 v[160:163], v[96:99], v[72:75], v[160:163]
  v_mfma_f32_16x16x32_bf16 v[164:167], v[100:103], v[72:75], v[164:167]
  v_mfma_f32_16x16x32_bf16 v[168:171], v[104:107], v[72:75], v[168:171]
  v_mfma_f32_16x16x32_bf16 v[172:175], v[108:111], v[72:75], v[172:175]
  v_mfma_f32_16x16x32_bf16 v[176:179], v[96:99], v[76:79], v[176:179]
  v_mfma_f32_16x16x32_bf16 v[180:183], v[100:103], v[76:79], v[180:183]
  v_mfma_f32_16x16x32_bf16 v[184:187], v[104:107], v[76:79], v[184:187]
  v_mfma_f32_16x16x32_bf16 v[188:191], v[108:111], v[76:79], v[188:191]
  s_cbranch_vccnz L_G_nwt40
  s_waitcnt vmcnt(8)
L_G_nwt40:
  s_waitcnt lgkmcnt(0)
  s_barrier
  v_mfma_f32_16x16x32_bf16 v[192:195], v[96:99], v[80:83], v[192:195]
  ds_read_b64_tr_b16 v[112:113], v3 offset:16384
  ds_read_b64_tr_b16 v[114:115], v4 offset:16384
  v_mfma_f32_16x16x32_bf16 v[196:199], v[100:103], v[80:83], v[196:199]
  ds_read_b128 v[64:67], v1 offset:16384
  v_mfma_f32_16x16x32_bf16 v[200:203], v[104:107], v[80:83], v[200:203]
  ds_read_b64_tr_b16 v[116:117], v5 offset:16384
  v_mfma_f32_16x16x32_bf16 v[204:207], v[108:111], v[80:83], v[204:207]
  ds_read_b64_tr_b16 v[118:119], v6 offset:16384
  v_mfma_f32_16x16x32_bf16 v[208:211], v[96:99], v[84:87], v[208:211]
  ds_read_b64_tr_b16 v[120:121], v7 offset:16384
  v_mfma_f32_16x16x32_bf16 v[212:215], v[100:103], v[84:87], v[212:215]
  ds_read_b64_tr_b16 v[122:123], v8 offset:16384
  ds_read_b64_tr_b16 v[124:125], v9 offset:16384
  s_add_u32 m0, s41, 0
  s_nop 0
  buffer_load_dwordx4 v11, s[12:15], s36 offen lds
  v_mfma_f32_16x16x32_bf16 v[216:219], v[104:107], v[84:87], v[216:219]
  ds_read_b64_tr_b16 v[126:127], v10 offset:16384
  v_mfma_f32_16x16x32_bf16 v[220:223], v[108:111], v[84:87], v[220:223]
  ds_read_b128 v[68:71], v2 offset:16384
  v_mfma_f32_16x16x32_bf16 v[224:227], v[96:99], v[88:91], v[224:227]
  ds_read_b128 v[72:75], v1 offset:18432
  v_mfma_f32_16x16x32_bf16 v[228:231], v[100:103], v[88:91], v[228:231]
  ds_read_b128 v[76:79], v2 offset:18432
  s_add_u32 m0, s41, 1024
  s_nop 0
  buffer_load_dwordx4 v12, s[12:15], s36 offen lds
  s_add_u32 s36, s36, s38
  v_mfma_f32_16x16x32_bf16 v[232:235], v[104:107], v[88:91], v[232:235]
  v_mfma_f32_16x16x32_bf16 v[236:239], v[108:111], v[88:91], v[236:239]
  v_mfma_f32_16x16x32_bf16 v[240:243], v[96:99], v[92:95], v[240:243]
  s_add_u32 m0, s42, 0
  s_nop 0
  buffer_load_dwordx4 v13, s[16:19], s37 offen lds
  v_mfma_f32_16x16x32_bf16 v[244:247], v[100:103], v[92:95], v[244:247]
  v_mfma_f32_16x16x32_bf16 v[248:251], v[104:107], v[92:95], v[248:251]
  s_add_u32 m0, s42, 1024
  s_nop 0
  buffer_load_dwordx4 v14, s[16:19], s37 offen lds
  s_add_u32 s37, s37, s39
  v_mfma_f32_16x16x32_bf16 v[252:255], v[108:111], v[92:95], v[252:255]
  s_waitcnt lgkmcnt(0)
  v_mfma_f32_16x16x32_bf16 v[128:131], v[112:115], v[64:67], v[128:131]
  ds_read_b128 v[80:83], v1 offset:20480
  v_mfma_f32_16x16x32_bf16 v[132:135], v[116:119], v[64:67], v[132:135]
  ds_read_b128 v[84:87], v2 offset:20480
  v_mfma_f32_16x16x32_bf16 v[136:139], v[120:123], v[64:67], v[136:139]
  ds_read_b128 v[88:91], v1 offset:22528
  v_mfma_f32_16x16x32_bf16 v[140:143], v[124:127], v[64:67], v[140:143]
  ds_read_b128 v[92:95], v2 offset:22528
  v_mfma_f32_16x16x32_bf16 v[144:147], v[112:115], v[68:71], v[144:147]
  v_mfma_f32_16x16x32_bf16 v[148:151], v[116:119], v[68:71], v[148:151]
  v_mfma_f32_16x16x32_bf16 v[152:155], v[120:123], v[68:71], v[152:155]
  v_mfma_f32_16x16x32_bf16 v[156:159], v[124:127], v[68:71], v[156:159]
  v_mfma_f32_16x16x32_bf16 v[160:163], v[112:115], v[72:75], v[160:163]
  v_mfma_f32_16x16x32_bf16 v[164:167], v[116:119], v[72:75], v[164:167]
  v_mfma_f32_16x16x32_bf16 v[168:171], v[120:123], v[72:75], v[168:171]
  v_mfma_f32_16x16x32_bf16 v[172:175], v[124:127], v[72:75], v[172:175]
  v_mfma_f32_16x16x32_bf16 v[176:179], v[112:115], v[76:79], v[176:179]
  v_mfma_f32_16x16x32_bf16 v[180:183], v[116:119], v[76:79], v[180:183]
  v_mfma_f32_16x16x32_bf16 v[184:187], v[120:123], v[76:79], v[184:187]
  v_mfma_f32_16x16x32_bf16 v[188:191], v[124:127], v[76:79], v[188:191]
  s_cbranch_vccnz L_G_nwt41
  s_waitcnt vmcnt(8)
L_G_nwt41:
  s_waitcnt lgkmcnt(0)
  s_barrier
  v_mfma_f32_16x16x32_bf16 v[192:195], v[112:115], v[80:83], v[192:195]
  ds_read_b64_tr_b16 v[96:97], v3 offset:32768
  ds_read_b64_tr_b16 v[98:99], v4 offset:32768
  v_mfma_f32_16x16x32_bf16 v[196:199], v[116:119], v[80:83], v[196:199]
  ds_read_b128 v[64:67], v1 offset:32768
  v_mfma_f32_16x16x32_bf16 v[200:203], v[120:123], v[80:83], v[200:203]
  ds_read_b64_tr_b16 v[100:101], v5 offset:32768
  v_mfma_f32_16x16x32_bf16 v[204:207], v[124:127], v[80:83], v[204:207]
  ds_read_b64_tr_b16 v[102:103], v6 offset:32768
  v_mfma_f32_16x16x32_bf16 v[208:211], v[112:115], v[84:87], v[208:211]
  ds_read_b64_tr_b16 v[104:105], v7 offset:32768
  v_mfma_f32_16x16x32_bf16 v[212:215], v[116:119], v[84:87], v[212:215]
  ds_read_b64_tr_b16 v[106:107], v8 offset:32768
  ds_read_b64_tr_b16 v[108:109], v9 offset:32768
  s_add_u32 m0, s41, 16384
  s_nop 0
  buffer_load_dwordx4 v11, s[12:15], s36 offen lds
  v_mfma_f32_16x16x32_bf16 v[216:219], v[120:123], v[84:87], v[216:219]
  ds_read_b64_tr_b16 v[110:111], v10 offset:32768
  v_mfma_f32_16x16x32_bf16 v[220:223], v[124:127], v[84:87], v[220:223]
  ds_read_b128 v[68:71], v2 offset:32768
  v_mfma_f32_16x16x32_bf16 v[224:227], v[112:115], v[88:91], v[224:227]
  ds_read_b128 v[72:75], v1 offset:34816
  v_mfma_f32_16x16x32_bf16 v[228:231], v[116:119], v[88:91], v[228:231]
  ds_read_b128 v[76:79], v2 offset:34816
  s_add_u32 m0, s41, 17408
  s_nop 0
  buffer_load_dwordx4 v12, s[12:15], s36 offen lds
  s_add_u32 s36, s36, s38
  v_mfma_f32_16x16x32_bf16 v[232:235], v[120:123], v[88:91], v[232:235]
  v_mfma_f32_16x16x32_bf16 v[236:239], v[124:127], v[88:91], v[236:239]
  v_mfma_f32_16x16x32_bf16 v[240:243], v[112:115], v[92:95], v[240:243]
  s_add_u32 m0, s42, 16384
  s_nop 0
  buffer_load_dwordx4 v13, s[16:19], s37 offen lds
  v_mfma_f32_16x16x32_bf16 v[244:247], v[116:119], v[92:95], v[244:247]
  v_mfma_f32_16x16x32_bf16 v[248:251], v[120:123], v[92:95], v[248:251]
  s_add_u32 m0, s42, 17408
  s_nop 0
  buffer_load_dwordx4 v14, s[16:19], s37 offen lds
  s_add_u32 s37, s37, s39
  v_mfma_f32_16x16x32_bf16 v[252:255], v[124:127], v[92:95], v[252:255]
  s_waitcnt lgkmcnt(0)
  v_mfma_f32_16x16x32_bf16 v[128:131], v[96:99], v[64:67], v[128:131]
  ds_read_b128 v[80:83], v1 offset:36864
  v_mfma_f32_16x16x32_bf16 v[132:135], v[100:103], v[64:67], v[132:135]
  ds_read_b128 v[84:87], v2 offset:36864
  v_mfma_f32_16x16x32_bf16 v[136:139], v[104:107], v[64:67], v[136:139]
  ds_read_b128 v[88:91], v1 offset:38912
  v_mfma_f32_16x16x32_bf16 v[140:143], v[108:111], v[64:67], v[140:143]
  ds_read_b128 v[92:95], v2 offset:38912
  v_mfma_f32_16x16x32_bf16 v[144:147], v[96:99], v[68:71], v[144:147]
  v_mfma_f32_16x16x32_bf16 v[148:151], v[100:103], v[68:71], v[148:151]
  v_mfma_f32_16x16x32_bf16 v[152:155], v[104:107], v[68:71], v[152:155]
  v_mfma_f32_16x16x32_bf16 v[156:159], v[108:111], v[68:71], v[156:159]
  v_mfma_f32_16x16x32_bf16 v[160:163], v[96:99], v[72:75], v[160:163]
  v_mfma_f32_16x16x32_bf16 v[164:167], v[100:103], v[72:75], v[164:167]
  v_mfma_f32_16x16x32_bf16 v[168:171], v[104:107], v[72:75], v[168:171]
  v_mfma_f32_16x16x32_bf16 v[172:175], v[108:111], v[72:75], v[172:175]
  v_mfma_f32_16x16x32_bf16 v[176:179], v[96:99], v[76:79], v[176:179]
  v_mfma_f32_16x16x32_bf16 v[180:183], v[100:103], v[76:79], v[180:183]
  v_mfma_f32_16x16x32_bf16 v[184:187], v[104:107], v[76:79], v[184:187]
  v_mfma_f32_16x16x32_bf16 v[188:191], v[108:111], v[76:79], v[188:191]
  s_cbranch_vccnz L_G_nwt42
  s_waitcnt vmcnt(8)
L_G_nwt42:
  s_waitcnt lgkmcnt(0)
  s_barrier
  v_mfma_f32_16x16x32_bf16 v[192:195], v[96:99], v[80:83], v[192:195]
  ds_read_b64_tr_b16 v[112:113], v3 offset:49152
  ds_read_b64_tr_b16 v[114:115], v4 offset:49152
  v_mfma_f32_16x16x32_bf16 v[196:199], v[100:103], v[80:83], v[196:199]
  ds_read_b128 v[64:67], v1 offset:49152
  v_mfma_f32_16x16x32_bf16 v[200:203], v[104:107], v[80:83], v[200:203]
  ds_read_b64_tr_b16 v[116:117], v5 offset:49152
  v_mfma_f32_16x16x32_bf16 v[204:207], v[108:111], v[80:83], v[204:207]
  ds_read_b64_tr_b16 v[118:119], v6 offset:49152
  v_mfma_f32_16x16x32_bf16 v[208:211], v[96:99], v[84:87], v[208:211]
  ds_read_b64_tr_b16 v[120:121], v7 offset:49152
  v_mfma_f32_16x16x32_bf16 v[212:215], v[100:103], v[84:87], v[212:215]
  ds_read_b64_tr_b16 v[122:123], v8 offset:49152
  ds_read_b64_tr_b16 v[124:125], v9 offset:49152
  s_add_u32 m0, s41, 32768
  s_nop 0
  buffer_load_dwordx4 v11, s[12:15], s36 offen lds
  v_mfma_f32_16x16x32_bf16 v[216:219], v[104:107], v[84:87], v[216:219]
  ds_read_b64_tr_b16 v[126:127], v10 offset:49152
  v_mfma_f32_16x16x32_bf16 v[220:223], v[108:111], v[84:87], v[220:223]
  ds_read_b128 v[68:71], v2 offset:49152
  v_mfma_f32_16x16x32_bf16 v[224:227], v[96:99], v[88:91], v[224:227]
  ds_read_b128 v[72:75], v1 offset:51200
  v_mfma_f32_16x16x32_bf16 v[228:231], v[100:103], v[88:91], v[228:231]
  ds_read_b128 v[76:79], v2 offset:51200
  s_add_u32 m0, s41, 33792
  s_nop 0
  buffer_load_dwordx4 v12, s[12:15], s36 offen lds
  s_add_u32 s36, s36, s38
  v_mfma_f32_16x16x32_bf16 v[232:235], v[104:107], v[88:91], v[232:235]
  v_mfma_f32_16x16x32_bf16 v[236:239], v[108:111], v[88:91], v[236:239]
  v_mfma_f32_16x16x32_bf16 v[240:243], v[96:99], v[92:95], v[240:243]
  s_add_u32 m0, s42, 32768
  s_nop 0
  buffer_load_dwordx4 v13, s[16:19], s37 offen lds
  v_mfma_f32_16x16x32_bf16 v[244:247], v[100:103], v[92:95], v[244:247]
  v_mfma_f32_16x16x32_bf16 v[248:251], v[104:107], v[92:95], v[248:251]
  s_add_u32 m0, s42, 33792
  s_nop 0
  buffer_load_dwordx4 v14, s[16:19], s37 offen lds
  s_add_u32 s37, s37, s39
  v_mfma_f32_16x16x32_bf16 v[252:255], v[108:111], v[92:95], v[252:255]
  s_waitcnt lgkmcnt(0)
  v_mfma_f32_16x16x32_bf16 v[128:131], v[112:115], v[64:67], v[128:131]
  ds_read_b128 v[80:83], v1 offset:53248
  v_mfma_f32_16x16x32_bf16 v[132:135], v[116:119], v[64:67], v[132:135]
  ds_read_b128 v[84:87], v2 offset:53248
  v_mfma_f32_16x16x32_bf16 v[136:139], v[120:123], v[64:67], v[136:139]
  ds_read_b128 v[88:91], v1 offset:55296
  v_mfma_f32_16x16x32_bf16 v[140:143], v[124:127], v[64:67], v[140:143]
  ds_read_b128 v[92:95], v2 offset:55296
  v_mfma_f32_16x16x32_bf16 v[144:147], v[112:115], v[68:71], v[144:147]
  v_mfma_f32_16x16x32_bf16 v[148:151], v[116:119], v[68:71], v[148:151]
  v_mfma_f32_16x16x32_bf16 v[152:155], v[120:123], v[68:71], v[152:155]
  v_mfma_f32_16x16x32_bf16 v[156:159], v[124:127], v[68:71], v[156:159]
  v_mfma_f32_16x16x32_bf16 v[160:163], v[112:115], v[72:75], v[160:163]
  v_mfma_f32_16x16x32_bf16 v[164:167], v[116:119], v[72:75], v[164:167]
  v_mfma_f32_16x16x32_bf16 v[168:171], v[120:123], v[72:75], v[168:171]
  v_mfma_f32_16x16x32_bf16 v[172:175], v[124:127], v[72:75], v[172:175]
  v_mfma_f32_16x16x32_bf16 v[176:179], v[112:115], v[76:79], v[176:179]
  v_mfma_f32_16x16x32_bf16 v[180:183], v[116:119], v[76:79], v[180:183]
  v_mfma_f32_16x16x32_bf16 v[184:187], v[120:123], v[76:79], v[184:187]
  v_mfma_f32_16x16x32_bf16 v[188:191], v[124:127], v[76:79], v[188:191]
  s_mov_b64 vcc, 0
  s_waitcnt vmcnt(8) lgkmcnt(0)
  s_barrier
  v_mfma_f32_16x16x32_bf16 v[192:195], v[112:115], v[80:83], v[192:195]
  ds_read_b64_tr_b16 v[96:97], v3 offset:0
  ds_read_b64_tr_b16 v[98:99], v4 offset:0
  v_mfma_f32_16x16x32_bf16 v[196:199], v[116:119], v[80:83], v[196:199]
  ds_read_b128 v[64:67], v1 offset:0
  v_mfma_f32_16x16x32_bf16 v[200:203], v[120:123], v[80:83], v[200:203]
  ds_read_b64_tr_b16 v[100:101], v5 offset:0
  v_mfma_f32_16x16x32_bf16 v[204:207], v[124:127], v[80:83], v[204:207]
  ds_read_b64_tr_b16 v[102:103], v6 offset:0
  v_mfma_f32_16x16x32_bf16 v[208:211], v[112:115], v[84:87], v[208:211]
  ds_read_b64_tr_b16 v[104:105], v7 offset:0
  v_mfma_f32_16x16x32_bf16 v[212:215], v[116:119], v[84:87], v[212:215]
  ds_read_b64_tr_b16 v[106:107], v8 offset:0
  ds_read_b64_tr_b16 v[108:109], v9 offset:0
  s_add_u32 m0, s41, 49152
  s_nop 0
  buffer_load_dwordx4 v11, s[12:15], s36 offen lds
  v_mfma_f32_16x16x32_bf16 v[216:219], v[120:123], v[84:87], v[216:219]
  ds_read_b64_tr_b16 v[110:111], v10 offset:0
  v_mfma_f32_16x16x32_bf16 v[220:223], v[124:127], v[84:87], v[220:223]
  ds_read_b128 v[68:71], v2 offset:0
  v_mfma_f32_16x16x32_bf16 v[224:227], v[112:115], v[88:91], v[224:227]
  ds_read_b128 v[72:75], v1 offset:2048
  v_mfma_f32_16x16x32_bf16 v[228:231], v[116:119], v[88:91], v[228:231]
  ds_read_b128 v[76:79], v2 offset:2048
  s_add_u32 m0, s41, 50176
  s_nop 0
  buffer_load_dwordx4 v12, s[12:15], s36 offen lds
  s_add_u32 s36, s36, s38
  v_mfma_f32_16x16x32_bf16 v[232:235], v[120:123], v[88:91], v[232:235]
  v_mfma_f32_16x16x32_bf16 v[236:239], v[124:127], v[88:91], v[236:239]
  v_mfma_f32_16x16x32_bf16 v[240:243], v[112:115], v[92:95], v[240:243]
  s_add_u32 m0, s42, 49152
  s_nop 0
  buffer_load_dwordx4 v13, s[16:19], s37 offen lds
  v_mfma_f32_16x16x32_bf16 v[244:247], v[116:119], v[92:95], v[244:247]
  v_mfma_f32_16x16x32_bf16 v[248:251], v[120:123], v[92:95], v[248:251]
  s_add_u32 m0, s42, 50176
  s_nop 0
  buffer_load_dwordx4 v14, s[16:19], s37 offen lds
  s_add_u32 s37, s37, s39
  v_mfma_f32_16x16x32_bf16 v[252:255], v[124:127], v[92:95], v[252:255]
  s_add_u32 s40, s40, 4
  s_cmp_le_u32 s40, s51
  s_cbranch_scc1 L_G_loopt4
  s_waitcnt lgkmcnt(0)
  s_cmp_lg_u32 s35, 0
  s_cbranch_scc1 L_out_epi4
  s_lshr_b32 s30, s26, 2
  s_and_b32 s31, s26, 3
  s_mul_i32 s30, s30, 4
  s_mul_i32 s30, s30, s46
  s_lshr_b32 s32, s31, 1
  s_mul_i32 s32, s32, s56
  s_and_b32 s31, s31, 1
  s_lshl_b32 s31, s31, 12
  s_add_u32 s30, s30, s31
  s_add_u32 s30, s30, s32
  s_add_u32 s30, s30, s45
  v_and_b32 v16, 15, v0
  v_lshrrev_b32 v17, 4, v0
  v_lshrrev_b32 v18, 3, v16
  v_and_b32 v16, 7, v16
  v_lshl_add_u32 v16, v18, 4, v16
  v_lshlrev_b32 v15, 9, v17
  v_lshl_add_u32 v15, v16, 4, v15
  v_pk_mul_f32 v[128:129], v[128:129], s[48:49]
  v_pk_mul_f32 v[130:131], v[130:131], s[48:49]
  v_pk_mul_f32 v[132:133], v[132:133], s[48:49]
  v_pk_mul_f32 v[134:135], v[134:135], s[48:49]
  v_cvt_pk_bf16_f32 v128, v128, v129
  v_cvt_pk_bf16_f32 v129, v130, v131
  v_cvt_pk_bf16_f32 v130, v132, v133
  v_cvt_pk_bf16_f32 v131, v134, v135
  v_pk_mul_f32 v[144:145], v[144:145], s[48:49]
  v_pk_mul_f32 v[146:147], v[146:147], s[48:49]
  v_pk_mul_f32 v[148:149], v[148:149], s[48:49]
  v_pk_mul_f32 v[150:151], v[150:151], s[48:49]
  v_cvt_pk_bf16_f32 v144, v144, v145
  v_cvt_pk_bf16_f32 v145, v146, v147
  v_cvt_pk_bf16_f32 v146, v148, v149
  v_cvt_pk_bf16_f32 v147, v150, v151
  v_pk_mul_f32 v[136:137], v[136:137], s[48:49]
  v_pk_mul_f32 v[138:139], v[138:139], s[48:49]
  v_pk_mul_f32 v[140:141], v[140:141], s[48:49]
  v_pk_mul_f32 v[142:143], v[142:143], s[48:49]
  v_cvt_pk_bf16_f32 v136, v136, v137
  v_cvt_pk_bf16_f32 v137, v138, v139
  v_cvt_pk_bf16_f32 v138, v140, v141
  v_cvt_pk_bf16_f32 v139, v142, v143
  v_pk_mul_f32 v[152:153], v[152:153], s[48:49]
  v_pk_mul_f32 v[154:155], v[154:155], s[48:49]
  v_pk_mul_f32 v[156:157], v[156:157], s[48:49]
  v_pk_mul_f32 v[158:159], v[158:159], s[48:49]
  v_cvt_pk_bf16_f32 v152, v152, v153
  v_cvt_pk_bf16_f32 v153, v154, v155
  v_cvt_pk_bf16_f32 v154, v156, v157
  v_cvt_pk_bf16_f32 v155, v158, v159
  v_pk_mul_f32 v[160:161], v[160:161], s[48:49]
  v_pk_mul_f32 v[162:163], v[162:163], s[48:49]
  v_pk_mul_f32 v[164:165], v[164:165], s[48:49]
  v_pk_mul_f32 v[166:167], v[166:167], s[48:49]
  v_cvt_pk_bf16_f32 v160, v160, v161
  v_cvt_pk_bf16_f32 v161, v162, v163
  v_cvt_pk_bf16_f32 v162, v164, v165
  v_cvt_pk_bf16_f32 v163, v166, v167
  v_pk_mul_f32 v[176:177], v[176:177], s[48:49]
  v_pk_mul_f32 v[178:179], v[178:179], s[48:49]
  v_pk_mul_f32 v[180:181], v[180:181], s[48:49]
  v_pk_mul_f32 v[182:183], v[182:183], s[48:49]
  v_cvt_pk_bf16_f32 v176, v176, v177
  v_cvt_pk_bf16_f32 v177, v178, v179
  v_cvt_pk_bf16_f32 v178, v180, v181
  v_cvt_pk_bf16_f32 v179, v182, v183
  v_pk_mul_f32 v[168:169], v[168:169], s[48:49]
  v_pk_mul_f32 v[170:171], v[170:171], s[48:49]
  v_pk_mul_f32 v[172:173], v[172:173], s[48:49]
  v_pk_mul_f32 v[174:175], v[174:175], s[48:49]
  v_cvt_pk_bf16_f32 v168, v168, v169
  v_cvt_pk_bf16_f32 v169, v170, v171
  v_cvt_pk_bf16_f32 v170, v172, v173
  v_cvt_pk_bf16_f32 v171, v174, v175
  v_pk_mul_f32 v[184:185], v[184:185], s[48:49]
  v_pk_mul_f32 v[186:187], v[186:187], s[48:49]
  v_pk_mul_f32 v[188:189], v[188:189], s[48:49]
  v_pk_mul_f32 v[190:191], v[190:191], s[48:49]
  v_cvt_pk_bf16_f32 v184, v184, v185
  v_cvt_pk_bf16_f32 v185, v186, v187
  v_cvt_pk_bf16_f32 v186, v188, v189
  v_cvt_pk_bf16_f32 v187, v190, v191
  v_pk_mul_f32 v[192:193], v[192:193], s[48:49]
  v_pk_mul_f32 v[194:195], v[194:195], s[48:49]
  v_pk_mul_f32 v[196:197], v[196:197], s[48:49]
  v_pk_mul_f32 v[198:199], v[198:199], s[48:49]
  v_cvt_pk_bf16_f32 v192, v192, v193
  v_cvt_pk_bf16_f32 v193, v194, v195
  v_cvt_pk_bf16_f32 v194, v196, v197
  v_cvt_pk_bf16_f32 v195, v198, v199
  v_pk_mul_f32 v[208:209], v[208:209], s[48:49]
  v_pk_mul_f32 v[210:211], v[210:211], s[48:49]
  v_pk_mul_f32 v[212:213], v[212:213], s[48:49]
  v_pk_mul_f32 v[214:215], v[214:215], s[48:49]
  v_cvt_pk_bf16_f32 v208, v208, v209
  v_cvt_pk_bf16_f32 v209, v210, v211
  v_cvt_pk_bf16_f32 v210, v212, v213
  v_cvt_pk_bf16_f32 v211, v214, v215
  v_pk_mul_f32 v[200:201], v[200:201], s[48:49]
  v_pk_mul_f32 v[202:203], v[202:203], s[48:49]
  v_pk_mul_f32 v[204:205], v[204:205], s[48:49]
  v_pk_mul_f32 v[206:207], v[206:207], s[48:49]
  v_cvt_pk_bf16_f32 v200, v200, v201
  v_cvt_pk_bf16_f32 v201, v202, v203
  v_cvt_pk_bf16_f32 v202, v204, v205
  v_cvt_pk_bf16_f32 v203, v206, v207
  v_pk_mul_f32 v[216:217], v[216:217], s[48:49]
  v_pk_mul_f32 v[218:219], v[218:219], s[48:49]
  v_pk_mul_f32 v[220:221], v[220:221], s[48:49]
  v_pk_mul_f32 v[222:223], v[222:223], s[48:49]
  v_cvt_pk_bf16_f32 v216, v216, v217
  v_cvt_pk_bf16_f32 v217, v218, v219
  v_cvt_pk_bf16_f32 v218, v220, v221
  v_cvt_pk_bf16_f32 v219, v222, v223
  v_pk_mul_f32 v[224:225], v[224:225], s[48:49]
  v_pk_mul_f32 v[226:227], v[226:227], s[48:49]
  v_pk_mul_f32 v[228:229], v[228:229], s[48:49]
  v_pk_mul_f32 v[230:231], v[230:231], s[48:49]
  v_cvt_pk_bf16_f32 v224, v224, v225
  v_cvt_pk_bf16_f32 v225, v226, v227
  v_cvt_pk_bf16_f32 v226, v228, v229
  v_cvt_pk_bf16_f32 v227, v230, v231
  v_pk_mul_f32 v[240:241], v[240:241], s[48:49]
  v_pk_mul_f32 v[242:243], v[242:243], s[48:49]
  v_pk_mul_f32 v[244:245], v[244:245], s[48:49]
  v_pk_mul_f32 v[246:247], v[246:247], s[48:49]
  v_cvt_pk_bf16_f32 v240, v240, v241
  v_cvt_pk_bf16_f32 v241, v242, v243
  v_cvt_pk_bf16_f32 v242, v244, v245
  v_cvt_pk_bf16_f32 v243, v246, v247
  v_pk_mul_f32 v[232:233], v[232:233], s[48:49]
  v_pk_mul_f32 v[234:235], v[234:235], s[48:49]
  v_pk_mul_f32 v[236:237], v[236:237], s[48:49]
  v_pk_mul_f32 v[238:239], v[238:239], s[48:49]
  v_cvt_pk_bf16_f32 v232, v232, v233
  v_cvt_pk_bf16_f32 v233, v234, v235
  v_cvt_pk_bf16_f32 v234, v236, v237
  v_cvt_pk_bf16_f32 v235, v238, v239
  v_pk_mul_f32 v[248:249], v[248:249], s[48:49]
  v_pk_mul_f32 v[250:251], v[250:251], s[48:49]
  v_pk_mul_f32 v[252:253], v[252:253], s[48:49]
  v_pk_mul_f32 v[254:255], v[254:255], s[48:49]
  v_cvt_pk_bf16_f32 v248, v248, v249
  v_cvt_pk_bf16_f32 v249, v250, v251
  v_cvt_pk_bf16_f32 v250, v252, v253
  v_cvt_pk_bf16_f32 v251, v254, v255
  s_waitcnt vmcnt(0)
  s_cmp_lg_u32 s26, 0
  s_cbranch_scc1 L_cm_2
  s_cmp_lg_u32 s87, 0
  s_cbranch_scc1 L_ei_3_ok
  v_mov_b32 v62, 0
L_ei_3:
  buffer_load_dword v63, v62, s[8:11], 0 offen offset:136 sc1
  s_waitcnt vmcnt(0)
  v_readfirstlane_b32 s28, v63
  s_nop 0
  s_cmp_ge_u32 s28, 128
  s_cbranch_scc1 L_ei_3_set
  s_sleep 8
  s_add_u32 s27, s27, 1
  s_cmp_lt_u32 s27, 0x80000
  s_cbranch_scc1 L_ei_3
L_ei_3_set:
  s_mov_b32 s87, 1
L_ei_3_ok:
L_cm_2:
  buffer_store_dwordx4 v[128:131], v15, s[4:7], s30 offen offset:0 sc1
  v_mov_b32 v132, 0
  v_mov_b32 v133, 0
  v_mov_b32 v134, 0
  v_mov_b32 v135, 0
  v_mov_b32 v128, 0
  v_mov_b32 v129, 0
  v_mov_b32 v130, 0
  v_mov_b32 v131, 0
  buffer_store_dwordx4 v[144:147], v15, s[4:7], s30 offen offset:128 sc1
  v_mov_b32 v148, 0
  v_mov_b32 v149, 0
  v_mov_b32 v150, 0
  v_mov_b32 v151, 0
  v_mov_b32 v144, 0
  v_mov_b32 v145, 0
  v_mov_b32 v146, 0
  v_mov_b32 v147, 0
  buffer_store_dwordx4 v[136:139], v15, s[4:7], s30 offen offset:2048 sc1
  v_mov_b32 v140, 0
  v_mov_b32 v141, 0
  v_mov_b32 v142, 0
  v_mov_b32 v143, 0
  v_mov_b32 v136, 0
  v_mov_b32 v137, 0
  v_mov_b32 v138, 0
  v_mov_b32 v139, 0
  buffer_store_dwordx4 v[152:155], v15, s[4:7], s30 offen offset:2176 sc1
  s_add_u32 s30, s30, s46
  v_mov_b32 v156, 0
  v_mov_b32 v157, 0
  v_mov_b32 v158, 0
  v_mov_b32 v159, 0
  v_mov_b32 v152, 0
  v_mov_b32 v153, 0
  v_mov_b32 v154, 0
  v_mov_b32 v155, 0
  buffer_store_dwordx4 v[160:163], v15, s[4:7], s30 offen offset:0 sc1
  v_mov_b32 v164, 0
  v_mov_b32 v165, 0
  v_mov_b32 v166, 0
  v_mov_b32 v167, 0
  v_mov_b32 v160, 0
  v_mov_b32 v161, 0
  v_mov_b32 v162, 0
  v_mov_b32 v163, 0
  buffer_store_dwordx4 v[176:179], v15, s[4:7], s30 offen offset:128 sc1
  v_mov_b32 v180, 0
  v_mov_b32 v181, 0
  v_mov_b32 v182, 0
  v_mov_b32 v183, 0
  v_mov_b32 v176, 0
  v_mov_b32 v177, 0
  v_mov_b32 v178, 0
  v_mov_b32 v179, 0
  buffer_store_dwordx4 v[168:171], v15, s[4:7], s30 offen offset:2048 sc1
  v_mov_b32 v172, 0
  v_mov_b32 v173, 0
  v_mov_b32 v174, 0
  v_mov_b32 v175, 0
  v_mov_b32 v168, 0
  v_mov_b32 v169, 0
  v_mov_b32 v170, 0
  v_mov_b32 v171, 0
  buffer_store_dwordx4 v[184:187], v15, s[4:7], s30 offen offset:2176 sc1
  s_add_u32 s30, s30, s46
  v_mov_b32 v188, 0
  v_mov_b32 v189, 0
  v_mov_b32 v190, 0
  v_mov_b32 v191, 0
  v_mov_b32 v184, 0
  v_mov_b32 v185, 0
  v_mov_b32 v186, 0
  v_mov_b32 v187, 0
  buffer_store_dwordx4 v[192:195], v15, s[4:7], s30 offen offset:0 sc1
  v_mov_b32 v196, 0
  v_mov_b32 v197, 0
  v_mov_b32 v198, 0
  v_mov_b32 v199, 0
  v_mov_b32 v192, 0
  v_mov_b32 v193, 0
  v_mov_b32 v194, 0
  v_mov_b32 v195, 0
  buffer_store_dwordx4 v[208:211], v15, s[4:7], s30 offen offset:128 sc1
  v_mov_b32 v212, 0
  v_mov_b32 v213, 0
  v_mov_b32 v214, 0
  v_mov_b32 v215, 0
  v_mov_b32 v208, 0
  v_mov_b32 v209, 0
  v_mov_b32 v210, 0
  v_mov_b32 v211, 0
  buffer_store_dwordx4 v[200:203], v15, s[4:7], s30 offen offset:2048 sc1
  v_mov_b32 v204, 0
  v_mov_b32 v205, 0
  v_mov_b32 v206, 0
  v_mov_b32 v207, 0
  v_mov_b32 v200, 0
  v_mov_b32 v201, 0
  v_mov_b32 v202, 0
  v_mov_b32 v203, 0
  buffer_store_dwordx4 v[216:219], v15, s[4:7], s30 offen offset:2176 sc1
  s_add_u32 s30, s30, s46
  v_mov_b32 v220, 0
  v_mov_b32 v221, 0
  v_mov_b32 v222, 0
  v_mov_b32 v223, 0
  v_mov_b32 v216, 0
  v_mov_b32 v217, 0
  v_mov_b32 v218, 0
  v_mov_b32 v219, 0
  buffer_store_dwordx4 v[224:227], v15, s[4:7], s30 offen offset:0 sc1
  v_mov_b32 v228, 0
  v_mov_b32 v229, 0
  v_mov_b32 v230, 0
  v_mov_b32 v231, 0
  v_mov_b32 v224, 0
  v_mov_b32 v225, 0
  v_mov_b32 v226, 0
  v_mov_b32 v227, 0
  buffer_store_dwordx4 v[240:243], v15, s[4:7], s30 offen offset:128 sc1
  v_mov_b32 v244, 0
  v_mov_b32 v245, 0
  v_mov_b32 v246, 0
  v_mov_b32 v247, 0
  v_mov_b32 v240, 0
  v_mov_b32 v241, 0
  v_mov_b32 v242, 0
  v_mov_b32 v243, 0
  buffer_store_dwordx4 v[232:235], v15, s[4:7], s30 offen offset:2048 sc1
  v_mov_b32 v236, 0
  v_mov_b32 v237, 0
  v_mov_b32 v238, 0
  v_mov_b32 v239, 0
  v_mov_b32 v232, 0
  v_mov_b32 v233, 0
  v_mov_b32 v234, 0
  v_mov_b32 v235, 0
  buffer_store_dwordx4 v[248:251], v15, s[4:7], s30 offen offset:2176 sc1
  v_mov_b32 v252, 0
  v_mov_b32 v253, 0
  v_mov_b32 v254, 0
  v_mov_b32 v255, 0
  v_mov_b32 v248, 0
  v_mov_b32 v249, 0
  v_mov_b32 v250, 0
  v_mov_b32 v251, 0
  s_branch L_proj_pub4
L_G_evtt4:
  s_cmp_eq_u32 s40, s51
  s_cbranch_scc1 L_G_lastt4
  s_mov_b32 s59, s51
  s_cmp_lg_u32 s26, 0
  s_cbranch_scc1 L_G_backt4
  v_mul_u32_u24 v62, 192, v0
  v_add_u32 v62, 84934656, v62
  v_mov_b32 v63, 1
  s_mov_b64 exec, 3
  buffer_store_dword v63, v62, s[4:7], s64 offen sc1
  s_mov_b64 exec, -1
  s_nop 3
  s_branch L_G_backt4
L_G_lastt4:
  s_cmp_lg_u32 s58, 0
  s_cselect_b32 s14, s43, 0
  s_cselect_b32 s18, s44, 0
  s_cbranch_scc0 L_G_backt4
  s_mov_b32 s36, s60
  s_mov_b32 s37, s61
  s_mov_b64 s[16:17], s[62:63]
  s_branch L_G_backt4
L_G_evtn4:
  s_cmp_eq_u32 s40, s51
  s_cbranch_scc1 L_G_lastn4
  s_mov_b32 s59, s51
  s_cmp_lg_u32 s26, 0
  s_cbranch_scc1 L_G_backn4
  v_mul_u32_u24 v62, 192, v0
  v_add_u32 v62, 84934656, v62
  v_mov_b32 v63, 1
  s_mov_b64 exec, 3
  buffer_store_dword v63, v62, s[4:7], s64 offen sc1
  s_mov_b64 exec, -1
  s_nop 3
  s_branch L_G_backn4
L_G_lastn4:
  s_cmp_lg_u32 s58, 0
  s_cselect_b32 s14, s43, 0
  s_cselect_b32 s18, s44, 0
  s_cbranch_scc0 L_G_backn4
  s_mov_b32 s36, s60
  s_mov_b32 s37, s61
  s_mov_b64 s[16:17], s[62:63]
  s_branch L_G_backn4
L_proj_v4:
  s_lshr_b32 s30, s26, 2
  s_and_b32 s31, s26, 3
  v_and_b32 v16, 15, v0
  v_lshrrev_b32 v17, 4, v0
  v_lshrrev_b32 v18, 3, v16
  v_and_b32 v19, 7, v16
  v_lshl_add_u32 v19, v18, 4, v19
  s_lshl_b32 s32, s30, 13
  v_lshlrev_b32 v20, 1, v18
  v_xor_b32 v20, v20, v17
  v_lshlrev_b32 v1, 6, v19
  v_lshl_add_u32 v1, v20, 4, v1
  v_add_u32 v1, s32, v1
  v_xor_b32 v2, 32, v1
  v_add_u32 v2, 512, v2
  v_lshrrev_b32 v20, 2, v0
  s_lshl_b32 s32, s26, 5
  v_add_u32 v20, s32, v20
  v_lshlrev_b32 v11, 11, v20
  v_lshrrev_b32 v21, 1, v20
  v_xor_b32 v21, v21, v20
  v_bfe_u32 v21, v21, 3, 1
  v_lshlrev_b32 v21, 1, v21
  v_xor_b32 v21, v21, v0
  v_and_b32 v21, 3, v21
  v_lshl_add_u32 v11, v21, 4, v11
  v_xor_b32 v12, 32, v11
  v_add_u32 v12, 0x8000, v12
  v_bfe_u32 v20, v0, 2, 2
  v_lshl_add_u32 v21, v17, 3, v20
  v_lshlrev_b32 v3, 9, v21
  v_bfe_u32 v21, v0, 1, 1
  s_lshl_b32 s32, s31, 3
  v_or_b32 v21, s32, v21
  v_lshlrev_b32 v20, 2, v20
  v_xor_b32 v21, v21, v20
  v_and_b32 v22, 1, v17
  v_mul_u32_u24 v22, 3, v22
  v_xor_b32 v21, v21, v22
  v_lshl_add_u32 v3, v21, 4, v3
  v_and_b32 v21, 1, v0
  v_lshl_add_u32 v3, v21, 3, v3
  v_add_u32 v3, 0x10000, v3
  v_xor_b32 v4, 48, v3
  v_add_u32 v4, 2048, v4
  v_xor_b32 v5, 32, v3
  v_xor_b32 v6, 32, v4
  v_xor_b32 v7, 64, v3
  v_xor_b32 v8, 64, v4
  v_xor_b32 v9, 96, v3
  v_xor_b32 v10, 96, v4
  v_lshrrev_b32 v20, 5, v0
  s_lshl_b32 s32, s26, 2
  v_add_u32 v21, s32, v20
  v_lshlrev_b32 v13, s28, v21
  v_add_u32 v21, 2, v21
  v_lshlrev_b32 v14, s28, v21
  s_lshr_b32 s32, s26, 1
  s_xor_b32 s32, s32, s26
  s_and_b32 s32, s32, 1
  s_mul_i32 s32, s32, 3
  v_lshlrev_b32 v20, 2, v20
  v_and_b32 v21, 31, v0
  v_xor_b32 v21, v21, v20
  v_xor_b32 v21, s32, v21
  v_lshl_add_u32 v13, v21, 4, v13
  v_xor_b32 v21, 8, v21
  v_lshl_add_u32 v14, v21, 4, v14
  s_lshl_b32 s41, s26, 11
  s_lshl_b32 s42, s26, 11
  s_add_u32 s42, s42, 0x10000
  s_cmp_eq_u32 s57, 0
  s_cbranch_scc1 L_ci_4
  s_mov_b32 s14, s43
  s_mov_b32 s18, s44
  s_add_u32 s36, s36, 256
  s_add_u32 s37, s37, 1048576
  s_branch L_G_inn4
L_ci_4:
  s_mov_b32 s14, s43
  s_mov_b32 s18, s44
  s_add_u32 m0, s41, 0
  s_nop 0
  buffer_load_dwordx4 v11, s[12:15], s36 offen lds
  s_add_u32 m0, s41, 1024
  s_nop 0
  buffer_load_dwordx4 v12, s[12:15], s36 offen lds
  s_add_u32 s36, s36, s38
  s_add_u32 m0, s42, 0
  s_nop 0
  buffer_load_dwordx4 v13, s[16:19], s37 offen lds
  s_add_u32 m0, s42, 1024
  s_nop 0
  buffer_load_dwordx4 v14, s[16:19], s37 offen lds
  s_add_u32 s37, s37, s39
  s_add_u32 m0, s41, 16384
  s_nop 0
  buffer_load_dwordx4 v11, s[12:15], s36 offen lds
  s_add_u32 m0, s41, 17408
  s_nop 0
  buffer_load_dwordx4 v12, s[12:15], s36 offen lds
  s_add_u32 s36, s36, s38
  s_add_u32 m0, s42, 16384
  s_nop 0
  buffer_load_dwordx4 v13, s[16:19], s37 offen lds
  s_add_u32 m0, s42, 17408
  s_nop 0
  buffer_load_dwordx4 v14, s[16:19], s37 offen lds
  s_add_u32 s37, s37, s39
  s_add_u32 m0, s41, 32768
  s_nop 0
  buffer_load_dwordx4 v11, s[12:15], s36 offen lds
  s_add_u32 m0, s41, 33792
  s_nop 0
  buffer_load_dwordx4 v12, s[12:15], s36 offen lds
  s_add_u32 s36, s36, s38
  s_add_u32 m0, s42, 32768
  s_nop 0
  buffer_load_dwordx4 v13, s[16:19], s37 offen lds
  s_add_u32 m0, s42, 33792
  s_nop 0
  buffer_load_dwordx4 v14, s[16:19], s37 offen lds
  s_add_u32 s37, s37, s39
  s_add_u32 m0, s41, 49152
  s_nop 0
  buffer_load_dwordx4 v11, s[12:15], s36 offen lds
  s_add_u32 m0, s41, 50176
  s_nop 0
  buffer_load_dwordx4 v12, s[12:15], s36 offen lds
  s_add_u32 s36, s36, s38
  s_add_u32 m0, s42, 49152
  s_nop 0
  buffer_load_dwordx4 v13, s[16:19], s37 offen lds
  s_add_u32 m0, s42, 50176
  s_nop 0
  buffer_load_dwordx4 v14, s[16:19], s37 offen lds
  s_add_u32 s37, s37, s39
  v_mov_b32 v128, 0
  v_mov_b32 v129, 0
  v_mov_b32 v130, 0
  v_mov_b32 v131, 0
  v_mov_b32 v132, 0
  v_mov_b32 v133, 0
  v_mov_b32 v134, 0
  v_mov_b32 v135, 0
  v_mov_b32 v136, 0
  v_mov_b32 v137, 0
  v_mov_b32 v138, 0
  v_mov_b32 v139, 0
  v_mov_b32 v140, 0
  v_mov_b32 v141, 0
  v_mov_b32 v142, 0
  v_mov_b32 v143, 0
  v_mov_b32 v144, 0
  v_mov_b32 v145, 0
  v_mov_b32 v146, 0
  v_mov_b32 v147, 0
  v_mov_b32 v148, 0
  v_mov_b32 v149, 0
  v_mov_b32 v150, 0
  v_mov_b32 v151, 0
  v_mov_b32 v152, 0
  v_mov_b32 v153, 0
  v_mov_b32 v154, 0
  v_mov_b32 v155, 0
  v_mov_b32 v156, 0
  v_mov_b32 v157, 0
  v_mov_b32 v158, 0
  v_mov_b32 v159, 0
  v_mov_b32 v160, 0
  v_mov_b32 v161, 0
  v_mov_b32 v162, 0
  v_mov_b32 v163, 0
  v_mov_b32 v164, 0
  v_mov_b32 v165, 0
  v_mov_b32 v166, 0
  v_mov_b32 v167, 0
  v_mov_b32 v168, 0
  v_mov_b32 v169, 0
  v_mov_b32 v170, 0
  v_mov_b32 v171, 0
  v_mov_b32 v172, 0
  v_mov_b32 v173, 0
  v_mov_b32 v174, 0
  v_mov_b32 v175, 0
  v_mov_b32 v176, 0
  v_mov_b32 v177, 0
  v_mov_b32 v178, 0
  v_mov_b32 v179, 0
  v_mov_b32 v180, 0
  v_mov_b32 v181, 0
  v_mov_b32 v182, 0
  v_mov_b32 v183, 0
  v_mov_b32 v184, 0
  v_mov_b32 v185, 0
  v_mov_b32 v186, 0
  v_mov_b32 v187, 0
  v_mov_b32 v188, 0
  v_mov_b32 v189, 0
  v_mov_b32 v190, 0
  v_mov_b32 v191, 0
  v_mov_b32 v192, 0
  v_mov_b32 v193, 0
  v_mov_b32 v194, 0
  v_mov_b32 v195, 0
  v_mov_b32 v196, 0
  v_mov_b32 v197, 0
  v_mov_b32 v198, 0
  v_mov_b32 v199, 0
  v_mov_b32 v200, 0
  v_mov_b32 v201, 0
  v_mov_b32 v202, 0
  v_mov_b32 v203, 0
  v_mov_b32 v204, 0
  v_mov_b32 v205, 0
  v_mov_b32 v206, 0
  v_mov_b32 v207, 0
  v_mov_b32 v208, 0
  v_mov_b32 v209, 0
  v_mov_b32 v210, 0
  v_mov_b32 v211, 0
  v_mov_b32 v212, 0
  v_mov_b32 v213, 0
  v_mov_b32 v214, 0
  v_mov_b32 v215, 0
  v_mov_b32 v216, 0
  v_mov_b32 v217, 0
  v_mov_b32 v218, 0
  v_mov_b32 v219, 0
  v_mov_b32 v220, 0
  v_mov_b32 v221, 0
  v_mov_b32 v222, 0
  v_mov_b32 v223, 0
  v_mov_b32 v224, 0
  v_mov_b32 v225, 0
  v_mov_b32 v226, 0
  v_mov_b32 v227, 0
  v_mov_b32 v228, 0
  v_mov_b32 v229, 0
  v_mov_b32 v230, 0
  v_mov_b32 v231, 0
  v_mov_b32 v232, 0
  v_mov_b32 v233, 0
  v_mov_b32 v234, 0
  v_mov_b32 v235, 0
  v_mov_b32 v236, 0
  v_mov_b32 v237, 0
  v_mov_b32 v238, 0
  v_mov_b32 v239, 0
  v_mov_b32 v240, 0
  v_mov_b32 v241, 0
  v_mov_b32 v242, 0
  v_mov_b32 v243, 0
  v_mov_b32 v244, 0
  v_mov_b32 v245, 0
  v_mov_b32 v246, 0
  v_mov_b32 v247, 0
  v_mov_b32 v248, 0
  v_mov_b32 v249, 0
  v_mov_b32 v250, 0
  v_mov_b32 v251, 0
  v_mov_b32 v252, 0
  v_mov_b32 v253, 0
  v_mov_b32 v254, 0
  v_mov_b32 v255, 0
  s_waitcnt vmcnt(12)
L_G_inn4:
  s_cmp_lg_u32 s57, 0
  s_cselect_b64 vcc, -1, 0
  s_cselect_b32 s59, 8, s51
  s_mov_b32 s40, 4
  s_barrier
  s_cmp_eq_u32 s67, 0
  s_cbranch_scc1 L_G_rin4
  s_mov_b32 s67, 0
  v_mov_b32 v62, 1
  v_mov_b32 v63, 0
  s_mov_b64 exec, 1
  buffer_atomic_add v62, v63, s[8:11], 0 offen offset:136 sc1
  s_mov_b64 exec, -1
L_G_rin4:
  ds_read_b64_tr_b16 v[96:97], v3 offset:0
  ds_read_b64_tr_b16 v[98:99], v4 offset:0
  ds_read_b64_tr_b16 v[100:101], v5 offset:0
  ds_read_b64_tr_b16 v[102:103], v6 offset:0
  ds_read_b64_tr_b16 v[104:105], v7 offset:0
  ds_read_b64_tr_b16 v[106:107], v8 offset:0
  ds_read_b64_tr_b16 v[108:109], v9 offset:0
  ds_read_b64_tr_b16 v[110:111], v10 offset:0
  ds_read_b128 v[64:67], v1 offset:0
  ds_read_b128 v[68:71], v2 offset:0
  ds_read_b128 v[72:75], v1 offset:2048
  ds_read_b128 v[76:79], v2 offset:2048
.p2align 6
L_G_loopn4:
  s_cmp_eq_u32 s40, s59
  s_cbranch_scc1 L_G_evtn4
L_G_backn4:
  s_waitcnt lgkmcnt(0)
  v_mfma_f32_16x16x32_bf16 v[128:131], v[64:67], v[96:99], v[128:131]
  ds_read_b128 v[80:83], v1 offset:4096
  v_mfma_f32_16x16x32_bf16 v[132:135], v[64:67], v[100:103], v[132:135]
  ds_read_b128 v[84:87], v2 offset:4096
  v_mfma_f32_16x16x32_bf16 v[136:139], v[64:67], v[104:107], v[136:139]
  ds_read_b128 v[88:91], v1 offset:6144
  v_mfma_f32_16x16x32_bf16 v[140:143], v[64:67], v[108:111], v[140:143]
  ds_read_b128 v[92:95], v2 offset:6144
  v_mfma_f32_16x16x32_bf16 v[144:147], v[68:71], v[96:99], v[144:147]
  v_mfma_f32_16x16x32_bf16 v[148:151], v[68:71], v[100:103], v[148:151]
  v_mfma_f32_16x16x32_bf16 v[152:155], v[68:71], v[104:107], v[152:155]
  v_mfma_f32_16x16x32_bf16 v[156:159], v[68:71], v[108:111], v[156:159]
  v_mfma_f32_16x16x32_bf16 v[160:163], v[72:75], v[96:99], v[160:163]
  v_mfma_f32_16x16x32_bf16 v[164:167], v[72:75], v[100:103], v[164:167]
  v_mfma_f32_16x16x32_bf16 v[168:171], v[72:75], v[104:107], v[168:171]
  v_mfma_f32_16x16x32_bf16 v[172:175], v[72:75], v[108:111], v[172:175]
  v_mfma_f32_16x16x32_bf16 v[176:179], v[76:79], v[96:99], v[176:179]
  v_mfma_f32_16x16x32_bf16 v[180:183], v[76:79], v[100:103], v[180:183]
  v_mfma_f32_16x16x32_bf16 v[184:187], v[76:79], v[104:107], v[184:187]
  v_mfma_f32_16x16x32_bf16 v[188:191], v[76:79], v[108:111], v[188:191]
  s_cbranch_vccnz L_G_nwn40
  s_waitcnt vmcnt(8)
L_G_nwn40:
  s_waitcnt lgkmcnt(0)
  s_barrier
  v_mfma_f32_16x16x32_bf16 v[192:195], v[80:83], v[96:99], v[192:195]
  ds_read_b64_tr_b16 v[112:113], v3 offset:16384
  ds_read_b64_tr_b16 v[114:115], v4 offset:16384
  v_mfma_f32_16x16x32_bf16 v[196:199], v[80:83], v[100:103], v[196:199]
  ds_read_b128 v[64:67], v1 offset:16384
  v_mfma_f32_16x16x32_bf16 v[200:203], v[80:83], v[104:107], v[200:203]
  ds_read_b64_tr_b16 v[116:117], v5 offset:16384
  v_mfma_f32_16x16x32_bf16 v[204:207], v[80:83], v[108:111], v[204:207]
  ds_read_b64_tr_b16 v[118:119], v6 offset:16384
  v_mfma_f32_16x16x32_bf16 v[208:211], v[84:87], v[96:99], v[208:211]
  ds_read_b64_tr_b16 v[120:121], v7 offset:16384
  v_mfma_f32_16x16x32_bf16 v[212:215], v[84:87], v[100:103], v[212:215]
  ds_read_b64_tr_b16 v[122:123], v8 offset:16384
  ds_read_b64_tr_b16 v[124:125], v9 offset:16384
  s_add_u32 m0, s41, 0
  s_nop 0
  buffer_load_dwordx4 v11, s[12:15], s36 offen lds
  v_mfma_f32_16x16x32_bf16 v[216:219], v[84:87], v[104:107], v[216:219]
  ds_read_b64_tr_b16 v[126:127], v10 offset:16384
  v_mfma_f32_16x16x32_bf16 v[220:223], v[84:87], v[108:111], v[220:223]
  ds_read_b128 v[68:71], v2 offset:16384
  v_mfma_f32_16x16x32_bf16 v[224:227], v[88:91], v[96:99], v[224:227]
  ds_read_b128 v[72:75], v1 offset:18432
  v_mfma_f32_16x16x32_bf16 v[228:231], v[88:91], v[100:103], v[228:231]
  ds_read_b128 v[76:79], v2 offset:18432
  s_add_u32 m0, s41, 1024
  s_nop 0
  buffer_load_dwordx4 v12, s[12:15], s36 offen lds
  s_add_u32 s36, s36, s38
  v_mfma_f32_16x16x32_bf16 v[232:235], v[88:91], v[104:107], v[232:235]
  v_mfma_f32_16x16x32_bf16 v[236:239], v[88:91], v[108:111], v[236:239]
  v_mfma_f32_16x16x32_bf16 v[240:243], v[92:95], v[96:99], v[240:243]
  s_add_u32 m0, s42, 0
  s_nop 0
  buffer_load_dwordx4 v13, s[16:19], s37 offen lds
  v_mfma_f32_16x16x32_bf16 v[244:247], v[92:95], v[100:103], v[244:247]
  v_mfma_f32_16x16x32_bf16 v[248:251], v[92:95], v[104:107], v[248:251]
  s_add_u32 m0, s42, 1024
  s_nop 0
  buffer_load_dwordx4 v14, s[16:19], s37 offen lds
  s_add_u32 s37, s37, s39
  v_mfma_f32_16x16x32_bf16 v[252:255], v[92:95], v[108:111], v[252:255]
  s_waitcnt lgkmcnt(0)
  v_mfma_f32_16x16x32_bf16 v[128:131], v[64:67], v[112:115], v[128:131]
  ds_read_b128 v[80:83], v1 offset:20480
  v_mfma_f32_16x16x32_bf16 v[132:135], v[64:67], v[116:119], v[132:135]
  ds_read_b128 v[84:87], v2 offset:20480
  v_mfma_f32_16x16x32_bf16 v[136:139], v[64:67], v[120:123], v[136:139]
  ds_read_b128 v[88:91], v1 offset:22528
  v_mfma_f32_16x16x32_bf16 v[140:143], v[64:67], v[124:127], v[140:143]
  ds_read_b128 v[92:95], v2 offset:22528
  v_mfma_f32_16x16x32_bf16 v[144:147], v[68:71], v[112:115], v[144:147]
  v_mfma_f32_16x16x32_bf16 v[148:151], v[68:71], v[116:119], v[148:151]
  v_mfma_f32_16x16x32_bf16 v[152:155], v[68:71], v[120:123], v[152:155]
  v_mfma_f32_16x16x32_bf16 v[156:159], v[68:71], v[124:127], v[156:159]
  v_mfma_f32_16x16x32_bf16 v[160:163], v[72:75], v[112:115], v[160:163]
  v_mfma_f32_16x16x32_bf16 v[164:167], v[72:75], v[116:119], v[164:167]
  v_mfma_f32_16x16x32_bf16 v[168:171], v[72:75], v[120:123], v[168:171]
  v_mfma_f32_16x16x32_bf16 v[172:175], v[72:75], v[124:127], v[172:175]
  v_mfma_f32_16x16x32_bf16 v[176:179], v[76:79], v[112:115], v[176:179]
  v_mfma_f32_16x16x32_bf16 v[180:183], v[76:79], v[116:119], v[180:183]
  v_mfma_f32_16x16x32_bf16 v[184:187], v[76:79], v[120:123], v[184:187]
  v_mfma_f32_16x16x32_bf16 v[188:191], v[76:79], v[124:127], v[188:191]
  s_cbranch_vccnz L_G_nwn41
  s_waitcnt vmcnt(8)
L_G_nwn41:
  s_waitcnt lgkmcnt(0)
  s_barrier
  v_mfma_f32_16x16x32_bf16 v[192:195], v[80:83], v[112:115], v[192:195]
  ds_read_b64_tr_b16 v[96:97], v3 offset:32768
  ds_read_b64_tr_b16 v[98:99], v4 offset:32768
  v_mfma_f32_16x16x32_bf16 v[196:199], v[80:83], v[116:119], v[196:199]
  ds_read_b128 v[64:67], v1 offset:32768
  v_mfma_f32_16x16x32_bf16 v[200:203], v[80:83], v[120:123], v[200:203]
  ds_read_b64_tr_b16 v[100:101], v5 offset:32768
  v_mfma_f32_16x16x32_bf16 v[204:207], v[80:83], v[124:127], v[204:207]
  ds_read_b64_tr_b16 v[102:103], v6 offset:32768
  v_mfma_f32_16x16x32_bf16 v[208:211], v[84:87], v[112:115], v[208:211]
  ds_read_b64_tr_b16 v[104:105], v7 offset:32768
  v_mfma_f32_16x16x32_bf16 v[212:215], v[84:87], v[116:119], v[212:215]
  ds_read_b64_tr_b16 v[106:107], v8 offset:32768
  ds_read_b64_tr_b16 v[108:109], v9 offset:32768
  s_add_u32 m0, s41, 16384
  s_nop 0
  buffer_load_dwordx4 v11, s[12:15], s36 offen lds
  v_mfma_f32_16x16x32_bf16 v[216:219], v[84:87], v[120:123], v[216:219]
  ds_read_b64_tr_b16 v[110:111], v10 offset:32768
  v_mfma_f32_16x16x32_bf16 v[220:223], v[84:87], v[124:127], v[220:223]
  ds_read_b128 v[68:71], v2 offset:32768
  v_mfma_f32_16x16x32_bf16 v[224:227], v[88:91], v[112:115], v[224:227]
  ds_read_b128 v[72:75], v1 offset:34816
  v_mfma_f32_16x16x32_bf16 v[228:231], v[88:91], v[116:119], v[228:231]
  ds_read_b128 v[76:79], v2 offset:34816
  s_add_u32 m0, s41, 17408
  s_nop 0
  buffer_load_dwordx4 v12, s[12:15], s36 offen lds
  s_add_u32 s36, s36, s38
  v_mfma_f32_16x16x32_bf16 v[232:235], v[88:91], v[120:123], v[232:235]
  v_mfma_f32_16x16x32_bf16 v[236:239], v[88:91], v[124:127], v[236:239]
  v_mfma_f32_16x16x32_bf16 v[240:243], v[92:95], v[112:115], v[240:243]
  s_add_u32 m0, s42, 16384
  s_nop 0
  buffer_load_dwordx4 v13, s[16:19], s37 offen lds
  v_mfma_f32_16x16x32_bf16 v[244:247], v[92:95], v[116:119], v[244:247]
  v_mfma_f32_16x16x32_bf16 v[248:251], v[92:95], v[120:123], v[248:251]
  s_add_u32 m0, s42, 17408
  s_nop 0
  buffer_load_dwordx4 v14, s[16:19], s37 offen lds
  s_add_u32 s37, s37, s39
  v_mfma_f32_16x16x32_bf16 v[252:255], v[92:95], v[124:127], v[252:255]
  s_waitcnt lgkmcnt(0)
  v_mfma_f32_16x16x32_bf16 v[128:131], v[64:67], v[96:99], v[128:131]
  ds_read_b128 v[80:83], v1 offset:36864
  v_mfma_f32_16x16x32_bf16 v[132:135], v[64:67], v[100:103], v[132:135]
  ds_read_b128 v[84:87], v2 offset:36864
  v_mfma_f32_16x16x32_bf16 v[136:139], v[64:67], v[104:107], v[136:139]
  ds_read_b128 v[88:91], v1 offset:38912
  v_mfma_f32_16x16x32_bf16 v[140:143], v[64:67], v[108:111], v[140:143]
  ds_read_b128 v[92:95], v2 offset:38912
  v_mfma_f32_16x16x32_bf16 v[144:147], v[68:71], v[96:99], v[144:147]
  v_mfma_f32_16x16x32_bf16 v[148:151], v[68:71], v[100:103], v[148:151]
  v_mfma_f32_16x16x32_bf16 v[152:155], v[68:71], v[104:107], v[152:155]
  v_mfma_f32_16x16x32_bf16 v[156:159], v[68:71], v[108:111], v[156:159]
  v_mfma_f32_16x16x32_bf16 v[160:163], v[72:75], v[96:99], v[160:163]
  v_mfma_f32_16x16x32_bf16 v[164:167], v[72:75], v[100:103], v[164:167]
  v_mfma_f32_16x16x32_bf16 v[168:171], v[72:75], v[104:107], v[168:171]
  v_mfma_f32_16x16x32_bf16 v[172:175], v[72:75], v[108:111], v[172:175]
  v_mfma_f32_16x16x32_bf16 v[176:179], v[76:79], v[96:99], v[176:179]
  v_mfma_f32_16x16x32_bf16 v[180:183], v[76:79], v[100:103], v[180:183]
  v_mfma_f32_16x16x32_bf16 v[184:187], v[76:79], v[104:107], v[184:187]
  v_mfma_f32_16x16x32_bf16 v[188:191], v[76:79], v[108:111], v[188:191]
  s_cbranch_vccnz L_G_nwn42
  s_waitcnt vmcnt(8)
L_G_nwn42:
  s_waitcnt lgkmcnt(0)
  s_barrier
  v_mfma_f32_16x16x32_bf16 v[192:195], v[80:83], v[96:99], v[192:195]
  ds_read_b64_tr_b16 v[112:113], v3 offset:49152
  ds_read_b64_tr_b16 v[114:115], v4 offset:49152
  v_mfma_f32_16x16x32_bf16 v[196:199], v[80:83], v[100:103], v[196:199]
  ds_read_b128 v[64:67], v1 offset:49152
  v_mfma_f32_16x16x32_bf16 v[200:203], v[80:83], v[104:107], v[200:203]
  ds_read_b64_tr_b16 v[116:117], v5 offset:49152
  v_mfma_f32_16x16x32_bf16 v[204:207], v[80:83], v[108:111], v[204:207]
  ds_read_b64_tr_b16 v[118:119], v6 offset:49152
  v_mfma_f32_16x16x32_bf16 v[208:211], v[84:87], v[96:99], v[208:211]
  ds_read_b64_tr_b16 v[120:121], v7 offset:49152
  v_mfma_f32_16x16x32_bf16 v[212:215], v[84:87], v[100:103], v[212:215]
  ds_read_b64_tr_b16 v[122:123], v8 offset:49152
  ds_read_b64_tr_b16 v[124:125], v9 offset:49152
  s_add_u32 m0, s41, 32768
  s_nop 0
  buffer_load_dwordx4 v11, s[12:15], s36 offen lds
  v_mfma_f32_16x16x32_bf16 v[216:219], v[84:87], v[104:107], v[216:219]
  ds_read_b64_tr_b16 v[126:127], v10 offset:49152
  v_mfma_f32_16x16x32_bf16 v[220:223], v[84:87], v[108:111], v[220:223]
  ds_read_b128 v[68:71], v2 offset:49152
  v_mfma_f32_16x16x32_bf16 v[224:227], v[88:91], v[96:99], v[224:227]
  ds_read_b128 v[72:75], v1 offset:51200
  v_mfma_f32_16x16x32_bf16 v[228:231], v[88:91], v[100:103], v[228:231]
  ds_read_b128 v[76:79], v2 offset:51200
  s_add_u32 m0, s41, 33792
  s_nop 0
  buffer_load_dwordx4 v12, s[12:15], s36 offen lds
  s_add_u32 s36, s36, s38
  v_mfma_f32_16x16x32_bf16 v[232:235], v[88:91], v[104:107], v[232:235]
  v_mfma_f32_16x16x32_bf16 v[236:239], v[88:91], v[108:111], v[236:239]
  v_mfma_f32_16x16x32_bf16 v[240:243], v[92:95], v[96:99], v[240:243]
  s_add_u32 m0, s42, 32768
  s_nop 0
  buffer_load_dwordx4 v13, s[16:19], s37 offen lds
  v_mfma_f32_16x16x32_bf16 v[244:247], v[92:95], v[100:103], v[244:247]
  v_mfma_f32_16x16x32_bf16 v[248:251], v[92:95], v[104:107], v[248:251]
  s_add_u32 m0, s42, 33792
  s_nop 0
  buffer_load_dwordx4 v14, s[16:19], s37 offen lds
  s_add_u32 s37, s37, s39
  v_mfma_f32_16x16x32_bf16 v[252:255], v[92:95], v[108:111], v[252:255]
  s_waitcnt lgkmcnt(0)
  v_mfma_f32_16x16x32_bf16 v[128:131], v[64:67], v[112:115], v[128:131]
  ds_read_b128 v[80:83], v1 offset:53248
  v_mfma_f32_16x16x32_bf16 v[132:135], v[64:67], v[116:119], v[132:135]
  ds_read_b128 v[84:87], v2 offset:53248
  v_mfma_f32_16x16x32_bf16 v[136:139], v[64:67], v[120:123], v[136:139]
  ds_read_b128 v[88:91], v1 offset:55296
  v_mfma_f32_16x16x32_bf16 v[140:143], v[64:67], v[124:127], v[140:143]
  ds_read_b128 v[92:95], v2 offset:55296
  v_mfma_f32_16x16x32_bf16 v[144:147], v[68:71], v[112:115], v[144:147]
  v_mfma_f32_16x16x32_bf16 v[148:151], v[68:71], v[116:119], v[148:151]
  v_mfma_f32_16x16x32_bf16 v[152:155], v[68:71], v[120:123], v[152:155]
  v_mfma_f32_16x16x32_bf16 v[156:159], v[68:71], v[124:127], v[156:159]
  v_mfma_f32_16x16x32_bf16 v[160:163], v[72:75], v[112:115], v[160:163]
  v_mfma_f32_16x16x32_bf16 v[164:167], v[72:75], v[116:119], v[164:167]
  v_mfma_f32_16x16x32_bf16 v[168:171], v[72:75], v[120:123], v[168:171]
  v_mfma_f32_16x16x32_bf16 v[172:175], v[72:75], v[124:127], v[172:175]
  v_mfma_f32_16x16x32_bf16 v[176:179], v[76:79], v[112:115], v[176:179]
  v_mfma_f32_16x16x32_bf16 v[180:183], v[76:79], v[116:119], v[180:183]
  v_mfma_f32_16x16x32_bf16 v[184:187], v[76:79], v[120:123], v[184:187]
  v_mfma_f32_16x16x32_bf16 v[188:191], v[76:79], v[124:127], v[188:191]
  s_mov_b64 vcc, 0
  s_waitcnt vmcnt(8) lgkmcnt(0)
  s_barrier
  v_mfma_f32_16x16x32_bf16 v[192:195], v[80:83], v[112:115], v[192:195]
  ds_read_b64_tr_b16 v[96:97], v3 offset:0
  ds_read_b64_tr_b16 v[98:99], v4 offset:0
  v_mfma_f32_16x16x32_bf16 v[196:199], v[80:83], v[116:119], v[196:199]
  ds_read_b128 v[64:67], v1 offset:0
  v_mfma_f32_16x16x32_bf16 v[200:203], v[80:83], v[120:123], v[200:203]
  ds_read_b64_tr_b16 v[100:101], v5 offset:0
  v_mfma_f32_16x16x32_bf16 v[204:207], v[80:83], v[124:127], v[204:207]
  ds_read_b64_tr_b16 v[102:103], v6 offset:0
  v_mfma_f32_16x16x32_bf16 v[208:211], v[84:87], v[112:115], v[208:211]
  ds_read_b64_tr_b16 v[104:105], v7 offset:0
  v_mfma_f32_16x16x32_bf16 v[212:215], v[84:87], v[116:119], v[212:215]
  ds_read_b64_tr_b16 v[106:107], v8 offset:0
  ds_read_b64_tr_b16 v[108:109], v9 offset:0
  s_add_u32 m0, s41, 49152
  s_nop 0
  buffer_load_dwordx4 v11, s[12:15], s36 offen lds
  v_mfma_f32_16x16x32_bf16 v[216:219], v[84:87], v[120:123], v[216:219]
  ds_read_b64_tr_b16 v[110:111], v10 offset:0
  v_mfma_f32_16x16x32_bf16 v[220:223], v[84:87], v[124:127], v[220:223]
  ds_read_b128 v[68:71], v2 offset:0
  v_mfma_f32_16x16x32_bf16 v[224:227], v[88:91], v[112:115], v[224:227]
  ds_read_b128 v[72:75], v1 offset:2048
  v_mfma_f32_16x16x32_bf16 v[228:231], v[88:91], v[116:119], v[228:231]
  ds_read_b128 v[76:79], v2 offset:2048
  s_add_u32 m0, s41, 50176
  s_nop 0
  buffer_load_dwordx4 v12, s[12:15], s36 offen lds
  s_add_u32 s36, s36, s38
  v_mfma_f32_16x16x32_bf16 v[232:235], v[88:91], v[120:123], v[232:235]
  v_mfma_f32_16x16x32_bf16 v[236:239], v[88:91], v[124:127], v[236:239]
  v_mfma_f32_16x16x32_bf16 v[240:243], v[92:95], v[112:115], v[240:243]
  s_add_u32 m0, s42, 49152
  s_nop 0
  buffer_load_dwordx4 v13, s[16:19], s37 offen lds
  v_mfma_f32_16x16x32_bf16 v[244:247], v[92:95], v[116:119], v[244:247]
  v_mfma_f32_16x16x32_bf16 v[248:251], v[92:95], v[120:123], v[248:251]
  s_add_u32 m0, s42, 50176
  s_nop 0
  buffer_load_dwordx4 v14, s[16:19], s37 offen lds
  s_add_u32 s37, s37, s39
  v_mfma_f32_16x16x32_bf16 v[252:255], v[92:95], v[124:127], v[252:255]
  s_add_u32 s40, s40, 4
  s_cmp_le_u32 s40, s51
  s_cbranch_scc1 L_G_loopn4
  s_waitcnt lgkmcnt(0)
  s_lshr_b32 s30, s26, 2
  s_and_b32 s31, s26, 3
  s_mul_i32 s30, s30, 4
  s_mul_i32 s30, s30, s46
  s_lshr_b32 s32, s31, 1
  s_mul_i32 s32, s32, s56
  s_and_b32 s31, s31, 1
  s_lshl_b32 s31, s31, 12
  s_add_u32 s30, s30, s31
  s_add_u32 s30, s30, s32
  s_add_u32 s30, s30, s45
  v_and_b32 v16, 15, v0
  v_lshrrev_b32 v17, 4, v0
  v_lshlrev_b32 v15, 9, v17
  v_lshl_add_u32 v15, v16, 4, v15
  v_cvt_pk_bf16_f32 v128, v128, v129
  v_cvt_pk_bf16_f32 v129, v130, v131
  v_cvt_pk_bf16_f32 v130, v144, v145
  v_cvt_pk_bf16_f32 v131, v146, v147
  v_cvt_pk_bf16_f32 v132, v132, v133
  v_cvt_pk_bf16_f32 v133, v134, v135
  v_cvt_pk_bf16_f32 v134, v148, v149
  v_cvt_pk_bf16_f32 v135, v150, v151
  v_cvt_pk_bf16_f32 v136, v136, v137
  v_cvt_pk_bf16_f32 v137, v138, v139
  v_cvt_pk_bf16_f32 v138, v152, v153
  v_cvt_pk_bf16_f32 v139, v154, v155
  v_cvt_pk_bf16_f32 v140, v140, v141
  v_cvt_pk_bf16_f32 v141, v142, v143
  v_cvt_pk_bf16_f32 v142, v156, v157
  v_cvt_pk_bf16_f32 v143, v158, v159
  v_cvt_pk_bf16_f32 v160, v160, v161
  v_cvt_pk_bf16_f32 v161, v162, v163
  v_cvt_pk_bf16_f32 v162, v176, v177
  v_cvt_pk_bf16_f32 v163, v178, v179
  v_cvt_pk_bf16_f32 v164, v164, v165
  v_cvt_pk_bf16_f32 v165, v166, v167
  v_cvt_pk_bf16_f32 v166, v180, v181
  v_cvt_pk_bf16_f32 v167, v182, v183
  v_cvt_pk_bf16_f32 v168, v168, v169
  v_cvt_pk_bf16_f32 v169, v170, v171
  v_cvt_pk_bf16_f32 v170, v184, v185
  v_cvt_pk_bf16_f32 v171, v186, v187
  v_cvt_pk_bf16_f32 v172, v172, v173
  v_cvt_pk_bf16_f32 v173, v174, v175
  v_cvt_pk_bf16_f32 v174, v188, v189
  v_cvt_pk_bf16_f32 v175, v190, v191
  v_cvt_pk_bf16_f32 v192, v192, v193
  v_cvt_pk_bf16_f32 v193, v194, v195
  v_cvt_pk_bf16_f32 v194, v208, v209
  v_cvt_pk_bf16_f32 v195, v210, v211
  v_cvt_pk_bf16_f32 v196, v196, v197
  v_cvt_pk_bf16_f32 v197, v198, v199
  v_cvt_pk_bf16_f32 v198, v212, v213
  v_cvt_pk_bf16_f32 v199, v214, v215
  v_cvt_pk_bf16_f32 v200, v200, v201
  v_cvt_pk_bf16_f32 v201, v202, v203
  v_cvt_pk_bf16_f32 v202, v216, v217
  v_cvt_pk_bf16_f32 v203, v218, v219
  v_cvt_pk_bf16_f32 v204, v204, v205
  v_cvt_pk_bf16_f32 v205, v206, v207
  v_cvt_pk_bf16_f32 v206, v220, v221
  v_cvt_pk_bf16_f32 v207, v222, v223
  v_cvt_pk_bf16_f32 v224, v224, v225
  v_cvt_pk_bf16_f32 v225, v226, v227
  v_cvt_pk_bf16_f32 v226, v240, v241
  v_cvt_pk_bf16_f32 v227, v242, v243
  v_cvt_pk_bf16_f32 v228, v228, v229
  v_cvt_pk_bf16_f32 v229, v230, v231
  v_cvt_pk_bf16_f32 v230, v244, v245
  v_cvt_pk_bf16_f32 v231, v246, v247
  v_cvt_pk_bf16_f32 v232, v232, v233
  v_cvt_pk_bf16_f32 v233, v234, v235
  v_cvt_pk_bf16_f32 v234, v248, v249
  v_cvt_pk_bf16_f32 v235, v250, v251
  v_cvt_pk_bf16_f32 v236, v236, v237
  v_cvt_pk_bf16_f32 v237, v238, v239
  v_cvt_pk_bf16_f32 v238, v252, v253
  v_cvt_pk_bf16_f32 v239, v254, v255
  s_waitcnt vmcnt(0)
  s_cmp_lg_u32 s26, 0
  s_cbranch_scc1 L_cm_5
  s_cmp_lg_u32 s87, 0
  s_cbranch_scc1 L_ei_6_ok
  v_mov_b32 v62, 0
L_ei_6:
  buffer_load_dword v63, v62, s[8:11], 0 offen offset:136 sc1
  s_waitcnt vmcnt(0)
  v_readfirstlane_b32 s28, v63
  s_nop 0
  s_cmp_ge_u32 s28, 128
  s_cbranch_scc1 L_ei_6_set
  s_sleep 8
  s_add_u32 s27, s27, 1
  s_cmp_lt_u32 s27, 0x80000
  s_cbranch_scc1 L_ei_6
L_ei_6_set:
  s_mov_b32 s87, 1
L_ei_6_ok:
L_cm_5:
  buffer_store_dwordx4 v[128:131], v15, s[4:7], s30 offen offset:0 sc1
  v_mov_b32 v144, 0
  v_mov_b32 v145, 0
  v_mov_b32 v146, 0
  v_mov_b32 v147, 0
  v_mov_b32 v128, 0
  v_mov_b32 v129, 0
  v_mov_b32 v130, 0
  v_mov_b32 v131, 0
  buffer_store_dwordx4 v[132:135], v15, s[4:7], s30 offen offset:256 sc1
  v_mov_b32 v148, 0
  v_mov_b32 v149, 0
  v_mov_b32 v150, 0
  v_mov_b32 v151, 0
  v_mov_b32 v132, 0
  v_mov_b32 v133, 0
  v_mov_b32 v134, 0
  v_mov_b32 v135, 0
  buffer_store_dwordx4 v[136:139], v15, s[4:7], s30 offen offset:2048 sc1
  v_mov_b32 v152, 0
  v_mov_b32 v153, 0
  v_mov_b32 v154, 0
  v_mov_b32 v155, 0
  v_mov_b32 v136, 0
  v_mov_b32 v137, 0
  v_mov_b32 v138, 0
  v_mov_b32 v139, 0
  buffer_store_dwordx4 v[140:143], v15, s[4:7], s30 offen offset:2304 sc1
  s_add_u32 s30, s30, s46
  v_mov_b32 v156, 0
  v_mov_b32 v157, 0
  v_mov_b32 v158, 0
  v_mov_b32 v159, 0
  v_mov_b32 v140, 0
  v_mov_b32 v141, 0
  v_mov_b32 v142, 0
  v_mov_b32 v143, 0
  buffer_store_dwordx4 v[160:163], v15, s[4:7], s30 offen offset:0 sc1
  v_mov_b32 v176, 0
  v_mov_b32 v177, 0
  v_mov_b32 v178, 0
  v_mov_b32 v179, 0
  v_mov_b32 v160, 0
  v_mov_b32 v161, 0
  v_mov_b32 v162, 0
  v_mov_b32 v163, 0
  buffer_store_dwordx4 v[164:167], v15, s[4:7], s30 offen offset:256 sc1
  v_mov_b32 v180, 0
  v_mov_b32 v181, 0
  v_mov_b32 v182, 0
  v_mov_b32 v183, 0
  v_mov_b32 v164, 0
  v_mov_b32 v165, 0
  v_mov_b32 v166, 0
  v_mov_b32 v167, 0
  buffer_store_dwordx4 v[168:171], v15, s[4:7], s30 offen offset:2048 sc1
  v_mov_b32 v184, 0
  v_mov_b32 v185, 0
  v_mov_b32 v186, 0
  v_mov_b32 v187, 0
  v_mov_b32 v168, 0
  v_mov_b32 v169, 0
  v_mov_b32 v170, 0
  v_mov_b32 v171, 0
  buffer_store_dwordx4 v[172:175], v15, s[4:7], s30 offen offset:2304 sc1
  s_add_u32 s30, s30, s46
  v_mov_b32 v188, 0
  v_mov_b32 v189, 0
  v_mov_b32 v190, 0
  v_mov_b32 v191, 0
  v_mov_b32 v172, 0
  v_mov_b32 v173, 0
  v_mov_b32 v174, 0
  v_mov_b32 v175, 0
  buffer_store_dwordx4 v[192:195], v15, s[4:7], s30 offen offset:0 sc1
  v_mov_b32 v208, 0
  v_mov_b32 v209, 0
  v_mov_b32 v210, 0
  v_mov_b32 v211, 0
  v_mov_b32 v192, 0
  v_mov_b32 v193, 0
  v_mov_b32 v194, 0
  v_mov_b32 v195, 0
  buffer_store_dwordx4 v[196:199], v15, s[4:7], s30 offen offset:256 sc1
  v_mov_b32 v212, 0
  v_mov_b32 v213, 0
  v_mov_b32 v214, 0
  v_mov_b32 v215, 0
  v_mov_b32 v196, 0
  v_mov_b32 v197, 0
  v_mov_b32 v198, 0
  v_mov_b32 v199, 0
  buffer_store_dwordx4 v[200:203], v15, s[4:7], s30 offen offset:2048 sc1
  v_mov_b32 v216, 0
  v_mov_b32 v217, 0
  v_mov_b32 v218, 0
  v_mov_b32 v219, 0
  v_mov_b32 v200, 0
  v_mov_b32 v201, 0
  v_mov_b32 v202, 0
  v_mov_b32 v203, 0
  buffer_store_dwordx4 v[204:207], v15, s[4:7], s30 offen offset:2304 sc1
  s_add_u32 s30, s30, s46
  v_mov_b32 v220, 0
  v_mov_b32 v221, 0
  v_mov_b32 v222, 0
  v_mov_b32 v223, 0
  v_mov_b32 v204, 0
  v_mov_b32 v205, 0
  v_mov_b32 v206, 0
  v_mov_b32 v207, 0
  buffer_store_dwordx4 v[224:227], v15, s[4:7], s30 offen offset:0 sc1
  v_mov_b32 v240, 0
  v_mov_b32 v241, 0
  v_mov_b32 v242, 0
  v_mov_b32 v243, 0
  v_mov_b32 v224, 0
  v_mov_b32 v225, 0
  v_mov_b32 v226, 0
  v_mov_b32 v227, 0
  buffer_store_dwordx4 v[228:231], v15, s[4:7], s30 offen offset:256 sc1
  v_mov_b32 v244, 0
  v_mov_b32 v245, 0
  v_mov_b32 v246, 0
  v_mov_b32 v247, 0
  v_mov_b32 v228, 0
  v_mov_b32 v229, 0
  v_mov_b32 v230, 0
  v_mov_b32 v231, 0
  buffer_store_dwordx4 v[232:235], v15, s[4:7], s30 offen offset:2048 sc1
  v_mov_b32 v248, 0
  v_mov_b32 v249, 0
  v_mov_b32 v250, 0
  v_mov_b32 v251, 0
  v_mov_b32 v232, 0
  v_mov_b32 v233, 0
  v_mov_b32 v234, 0
  v_mov_b32 v235, 0
  buffer_store_dwordx4 v[236:239], v15, s[4:7], s30 offen offset:2304 sc1
  v_mov_b32 v252, 0
  v_mov_b32 v253, 0
  v_mov_b32 v254, 0
  v_mov_b32 v255, 0
  v_mov_b32 v236, 0
  v_mov_b32 v237, 0
  v_mov_b32 v238, 0
  v_mov_b32 v239, 0
L_proj_pub4:
  s_mov_b32 s57, s58
  s_mov_b32 s64, s50
  s_cmp_lg_u32 s58, 0
  s_cbranch_scc1 L_next
  s_branch L_proj_pub2
L_proj_h:
  s_cmp_eq_u32 s90, 1
  s_cbranch_scc1 L_proj_v2
  s_lshr_b32 s30, s26, 2
  s_and_b32 s31, s26, 3
  v_and_b32 v16, 15, v0
  v_lshrrev_b32 v17, 4, v0
  v_lshrrev_b32 v18, 3, v16
  v_and_b32 v19, 7, v16
  v_lshl_add_u32 v19, v18, 4, v19
  s_lshl_b32 s32, s30, 12
  v_lshlrev_b32 v20, 1, v18
  v_xor_b32 v20, v20, v17
  v_lshlrev_b32 v1, 6, v19
  v_lshl_add_u32 v1, v20, 4, v1
  v_add_u32 v1, s32, v1
  v_xor_b32 v2, 32, v1
  v_add_u32 v2, 512, v2
  v_lshrrev_b32 v20, 2, v0
  s_lshl_b32 s32, s26, 4
  v_add_u32 v20, s32, v20
  v_lshlrev_b32 v11, 11, v20
  v_lshrrev_b32 v21, 1, v20
  v_xor_b32 v21, v21, v20
  v_bfe_u32 v21, v21, 3, 1
  v_lshlrev_b32 v21, 1, v21
  v_xor_b32 v21, v21, v0
  v_and_b32 v21, 3, v21
  v_lshl_add_u32 v11, v21, 4, v11
  v_xor_b32 v12, 32, v11
  v_add_u32 v12, 0x8000, v12
  v_bfe_u32 v20, v0, 2, 2
  v_lshl_add_u32 v21, v17, 3, v20
  v_lshlrev_b32 v3, 9, v21
  v_bfe_u32 v21, v0, 1, 1
  v_lshlrev_b32 v21, 1, v21
  s_lshl_b32 s32, s31, 3
  v_or_b32 v21, s32, v21
  v_lshlrev_b32 v20, 2, v20
  v_xor_b32 v21, v21, v20
  v_and_b32 v22, 1, v17
  v_mul_u32_u24 v22, 3, v22
  v_xor_b32 v21, v21, v22
  v_lshl_add_u32 v3, v21, 4, v3
  v_and_b32 v21, 1, v0
  v_lshl_add_u32 v3, v21, 3, v3
  v_add_u32 v3, 0x10000, v3
  v_xor_b32 v4, 48, v3
  v_add_u32 v4, 2048, v4
  v_xor_b32 v5, 16, v3
  v_xor_b32 v6, 16, v4
  v_xor_b32 v7, 64, v3
  v_xor_b32 v8, 64, v4
  v_xor_b32 v9, 80, v3
  v_xor_b32 v10, 80, v4
  v_lshrrev_b32 v20, 5, v0
  s_lshl_b32 s32, s26, 2
  v_add_u32 v21, s32, v20
  v_lshlrev_b32 v13, s28, v21
  v_add_u32 v21, 2, v21
  v_lshlrev_b32 v14, s28, v21
  s_lshr_b32 s32, s26, 1
  s_xor_b32 s32, s32, s26
  s_and_b32 s32, s32, 1
  s_mul_i32 s32, s32, 3
  v_lshlrev_b32 v20, 2, v20
  v_and_b32 v21, 31, v0
  v_xor_b32 v21, v21, v20
  v_xor_b32 v21, s32, v21
  v_lshl_add_u32 v13, v21, 4, v13
  v_xor_b32 v21, 8, v21
  v_lshl_add_u32 v14, v21, 4, v14
  s_lshl_b32 s41, s26, 10
  s_lshl_b32 s42, s26, 11
  s_add_u32 s42, s42, 0x10000
L_gemm_t2:
  s_mov_b32 s14, s43
  s_mov_b32 s18, s44
  s_add_u32 m0, s41, 0
  s_nop 0
  buffer_load_dwordx4 v11, s[12:15], s36 offen lds
  s_add_u32 s36, s36, s38
  s_add_u32 m0, s42, 0
  s_nop 0
  buffer_load_dwordx4 v13, s[16:19], s37 offen lds
  s_add_u32 m0, s42, 1024
  s_nop 0
  buffer_load_dwordx4 v14, s[16:19], s37 offen lds
  s_add_u32 s37, s37, s39
  s_add_u32 m0, s41, 16384
  s_nop 0
  buffer_load_dwordx4 v11, s[12:15], s36 offen lds
  s_add_u32 s36, s36, s38
  s_add_u32 m0, s42, 16384
  s_nop 0
  buffer_load_dwordx4 v13, s[16:19], s37 offen lds
  s_add_u32 m0, s42, 17408
  s_nop 0
  buffer_load_dwordx4 v14, s[16:19], s37 offen lds
  s_add_u32 s37, s37, s39
  s_add_u32 m0, s41, 32768
  s_nop 0
  buffer_load_dwordx4 v11, s[12:15], s36 offen lds
  s_add_u32 s36, s36, s38
  s_add_u32 m0, s42, 32768
  s_nop 0
  buffer_load_dwordx4 v13, s[16:19], s37 offen lds
  s_add_u32 m0, s42, 33792
  s_nop 0
  buffer_load_dwordx4 v14, s[16:19], s37 offen lds
  s_add_u32 s37, s37, s39
  s_add_u32 m0, s41, 49152
  s_nop 0
  buffer_load_dwordx4 v11, s[12:15], s36 offen lds
  s_add_u32 s36, s36, s38
  s_add_u32 m0, s42, 49152
  s_nop 0
  buffer_load_dwordx4 v13, s[16:19], s37 offen lds
  s_add_u32 m0, s42, 50176
  s_nop 0
  buffer_load_dwordx4 v14, s[16:19], s37 offen lds
  s_add_u32 s37, s37, s39
  v_mov_b32 v128, 0
  v_mov_b32 v129, 0
  v_mov_b32 v130, 0
  v_mov_b32 v131, 0
  v_mov_b32 v132, 0
  v_mov_b32 v133, 0
  v_mov_b32 v134, 0
  v_mov_b32 v135, 0
  v_mov_b32 v136, 0
  v_mov_b32 v137, 0
  v_mov_b32 v138, 0
  v_mov_b32 v139, 0
  v_mov_b32 v140, 0
  v_mov_b32 v141, 0
  v_mov_b32 v142, 0
  v_mov_b32 v143, 0
  v_mov_b32 v144, 0
  v_mov_b32 v145, 0
  v_mov_b32 v146, 0
  v_mov_b32 v147, 0
  v_mov_b32 v148, 0
  v_mov_b32 v149, 0
  v_mov_b32 v150, 0
  v_mov_b32 v151, 0
  v_mov_b32 v152, 0
  v_mov_b32 v153, 0
  v_mov_b32 v154, 0
  v_mov_b32 v155, 0
  v_mov_b32 v156, 0
  v_mov_b32 v157, 0
  v_mov_b32 v158, 0
  v_mov_b32 v159, 0
  v_mov_b32 v160, 0
  v_mov_b32 v161, 0
  v_mov_b32 v162, 0
  v_mov_b32 v163, 0
  v_mov_b32 v164, 0
  v_mov_b32 v165, 0
  v_mov_b32 v166, 0
  v_mov_b32 v167, 0
  v_mov_b32 v168, 0
  v_mov_b32 v169, 0
  v_mov_b32 v170, 0
  v_mov_b32 v171, 0
  v_mov_b32 v172, 0
  v_mov_b32 v173, 0
  v_mov_b32 v174, 0
  v_mov_b32 v175, 0
  v_mov_b32 v176, 0
  v_mov_b32 v177, 0
  v_mov_b32 v178, 0
  v_mov_b32 v179, 0
  v_mov_b32 v180, 0
  v_mov_b32 v181, 0
  v_mov_b32 v182, 0
  v_mov_b32 v183, 0
  v_mov_b32 v184, 0
  v_mov_b32 v185, 0
  v_mov_b32 v186, 0
  v_mov_b32 v187, 0
  v_mov_b32 v188, 0
  v_mov_b32 v189, 0
  v_mov_b32 v190, 0
  v_mov_b32 v191, 0
  s_waitcnt vmcnt(9)
  s_mov_b32 s40, 4
  s_barrier
  s_cmp_eq_u32 s67, 0
  s_cbranch_scc1 L_G_rit2
  s_mov_b32 s67, 0
  v_mov_b32 v62, 1
  v_mov_b32 v63, 0
  s_mov_b64 exec, 1
  buffer_atomic_add v62, v63, s[8:11], 0 offen offset:136 sc1
  s_mov_b64 exec, -1
L_G_rit2:
  ds_read_b64_tr_b16 v[96:97], v3 offset:0
  ds_read_b64_tr_b16 v[98:99], v4 offset:0
  ds_read_b64_tr_b16 v[100:101], v5 offset:0
  ds_read_b64_tr_b16 v[102:103], v6 offset:0
  ds_read_b64_tr_b16 v[104:105], v7 offset:0
  ds_read_b64_tr_b16 v[106:107], v8 offset:0
  ds_read_b64_tr_b16 v[108:109], v9 offset:0
  ds_read_b64_tr_b16 v[110:111], v10 offset:0
  ds_read_b128 v[64:67], v1 offset:0
  ds_read_b128 v[68:71], v2 offset:0
.p2align 6
L_G_loopt2:
  s_cmp_eq_u32 s40, s51
  s_cselect_b32 s14, 0, s43
  s_cselect_b32 s18, 0, s44
  s_waitcnt lgkmcnt(0)
  v_mfma_f32_16x16x32_bf16 v[128:131], v[96:99], v[64:67], v[128:131]
  ds_read_b128 v[80:83], v1 offset:2048
  v_mfma_f32_16x16x32_bf16 v[132:135], v[100:103], v[64:67], v[132:135]
  ds_read_b128 v[84:87], v2 offset:2048
  v_mfma_f32_16x16x32_bf16 v[136:139], v[104:107], v[64:67], v[136:139]
  v_mfma_f32_16x16x32_bf16 v[140:143], v[108:111], v[64:67], v[140:143]
  v_mfma_f32_16x16x32_bf16 v[144:147], v[96:99], v[68:71], v[144:147]
  v_mfma_f32_16x16x32_bf16 v[148:151], v[100:103], v[68:71], v[148:151]
  v_mfma_f32_16x16x32_bf16 v[152:155], v[104:107], v[68:71], v[152:155]
  v_mfma_f32_16x16x32_bf16 v[156:159], v[108:111], v[68:71], v[156:159]
  s_waitcnt vmcnt(6) lgkmcnt(0)
  s_barrier
  v_mfma_f32_16x16x32_bf16 v[160:163], v[96:99], v[80:83], v[160:163]
  ds_read_b64_tr_b16 v[112:113], v3 offset:16384
  ds_read_b64_tr_b16 v[114:115], v4 offset:16384
  v_mfma_f32_16x16x32_bf16 v[164:167], v[100:103], v[80:83], v[164:167]
  ds_read_b128 v[64:67], v1 offset:16384
  ds_read_b64_tr_b16 v[116:117], v5 offset:16384
  v_mfma_f32_16x16x32_bf16 v[168:171], v[104:107], v[80:83], v[168:171]
  ds_read_b64_tr_b16 v[118:119], v6 offset:16384
  ds_read_b64_tr_b16 v[120:121], v7 offset:16384
  v_mfma_f32_16x16x32_bf16 v[172:175], v[108:111], v[80:83], v[172:175]
  ds_read_b64_tr_b16 v[122:123], v8 offset:16384
  ds_read_b64_tr_b16 v[124:125], v9 offset:16384
  v_mfma_f32_16x16x32_bf16 v[176:179], v[96:99], v[84:87], v[176:179]
  ds_read_b64_tr_b16 v[126:127], v10 offset:16384
  ds_read_b128 v[68:71], v2 offset:16384
  v_mfma_f32_16x16x32_bf16 v[180:183], v[100:103], v[84:87], v[180:183]
  s_add_u32 m0, s41, 0
  s_nop 0
  buffer_load_dwordx4 v11, s[12:15], s36 offen lds
  s_add_u32 s36, s36, s38
  v_mfma_f32_16x16x32_bf16 v[184:187], v[104:107], v[84:87], v[184:187]
  s_add_u32 m0, s42, 0
  s_nop 0
  buffer_load_dwordx4 v13, s[16:19], s37 offen lds
  v_mfma_f32_16x16x32_bf16 v[188:191], v[108:111], v[84:87], v[188:191]
  s_add_u32 m0, s42, 1024
  s_nop 0
  buffer_load_dwordx4 v14, s[16:19], s37 offen lds
  s_add_u32 s37, s37, s39
  s_waitcnt lgkmcnt(0)
  v_mfma_f32_16x16x32_bf16 v[128:131], v[112:115], v[64:67], v[128:131]
  ds_read_b128 v[80:83], v1 offset:18432
  v_mfma_f32_16x16x32_bf16 v[132:135], v[116:119], v[64:67], v[132:135]
  ds_read_b128 v[84:87], v2 offset:18432
  v_mfma_f32_16x16x32_bf16 v[136:139], v[120:123], v[64:67], v[136:139]
  v_mfma_f32_16x16x32_bf16 v[140:143], v[124:127], v[64:67], v[140:143]
  v_mfma_f32_16x16x32_bf16 v[144:147], v[112:115], v[68:71], v[144:147]
  v_mfma_f32_16x16x32_bf16 v[148:151], v[116:119], v[68:71], v[148:151]
  v_mfma_f32_16x16x32_bf16 v[152:155], v[120:123], v[68:71], v[152:155]
  v_mfma_f32_16x16x32_bf16 v[156:159], v[124:127], v[68:71], v[156:159]
  s_waitcnt vmcnt(6) lgkmcnt(0)
  s_barrier
  v_mfma_f32_16x16x32_bf16 v[160:163], v[112:115], v[80:83], v[160:163]
  ds_read_b64_tr_b16 v[96:97], v3 offset:32768
  ds_read_b64_tr_b16 v[98:99], v4 offset:32768
  v_mfma_f32_16x16x32_bf16 v[164:167], v[116:119], v[80:83], v[164:167]
  ds_read_b128 v[64:67], v1 offset:32768
  ds_read_b64_tr_b16 v[100:101], v5 offset:32768
  v_mfma_f32_16x16x32_bf16 v[168:171], v[120:123], v[80:83], v[168:171]
  ds_read_b64_tr_b16 v[102:103], v6 offset:32768
  ds_read_b64_tr_b16 v[104:105], v7 offset:32768
  v_mfma_f32_16x16x32_bf16 v[172:175], v[124:127], v[80:83], v[172:175]
  ds_read_b64_tr_b16 v[106:107], v8 offset:32768
  ds_read_b64_tr_b16 v[108:109], v9 offset:32768
  v_mfma_f32_16x16x32_bf16 v[176:179], v[112:115], v[84:87], v[176:179]
  ds_read_b64_tr_b16 v[110:111], v10 offset:32768
  ds_read_b128 v[68:71], v2 offset:32768
  v_mfma_f32_16x16x32_bf16 v[180:183], v[116:119], v[84:87], v[180:183]
  s_add_u32 m0, s41, 16384
  s_nop 0
  buffer_load_dwordx4 v11, s[12:15], s36 offen lds
  s_add_u32 s36, s36, s38
  v_mfma_f32_16x16x32_bf16 v[184:187], v[120:123], v[84:87], v[184:187]
  s_add_u32 m0, s42, 16384
  s_nop 0
  buffer_load_dwordx4 v13, s[16:19], s37 offen lds
  v_mfma_f32_16x16x32_bf16 v[188:191], v[124:127], v[84:87], v[188:191]
  s_add_u32 m0, s42, 17408
  s_nop 0
  buffer_load_dwordx4 v14, s[16:19], s37 offen lds
  s_add_u32 s37, s37, s39
  s_waitcnt lgkmcnt(0)
  v_mfma_f32_16x16x32_bf16 v[128:131], v[96:99], v[64:67], v[128:131]
  ds_read_b128 v[80:83], v1 offset:34816
  v_mfma_f32_16x16x32_bf16 v[132:135], v[100:103], v[64:67], v[132:135]
  ds_read_b128 v[84:87], v2 offset:34816
  v_mfma_f32_16x16x32_bf16 v[136:139], v[104:107], v[64:67], v[136:139]
  v_mfma_f32_16x16x32_bf16 v[140:143], v[108:111], v[64:67], v[140:143]
  v_mfma_f32_16x16x32_bf16 v[144:147], v[96:99], v[68:71], v[144:147]
  v_mfma_f32_16x16x32_bf16 v[148:151], v[100:103], v[68:71], v[148:151]
  v_mfma_f32_16x16x32_bf16 v[152:155], v[104:107], v[68:71], v[152:155]
  v_mfma_f32_16x16x32_bf16 v[156:159], v[108:111], v[68:71], v[156:159]
  s_waitcnt vmcnt(6) lgkmcnt(0)
  s_barrier
  v_mfma_f32_16x16x32_bf16 v[160:163], v[96:99], v[80:83], v[160:163]
  ds_read_b64_tr_b16 v[112:113], v3 offset:49152
  ds_read_b64_tr_b16 v[114:115], v4 offset:49152
  v_mfma_f32_16x16x32_bf16 v[164:167], v[100:103], v[80:83], v[164:167]
  ds_read_b128 v[64:67], v1 offset:49152
  ds_read_b64_tr_b16 v[116:117], v5 offset:49152
  v_mfma_f32_16x16x32_bf16 v[168:171], v[104:107], v[80:83], v[168:171]
  ds_read_b64_tr_b16 v[118:119], v6 offset:49152
  ds_read_b64_tr_b16 v[120:121], v7 offset:49152
  v_mfma_f32_16x16x32_bf16 v[172:175], v[108:111], v[80:83], v[172:175]
  ds_read_b64_tr_b16 v[122:123], v8 offset:49152
  ds_read_b64_tr_b16 v[124:125], v9 offset:49152
  v_mfma_f32_16x16x32_bf16 v[176:179], v[96:99], v[84:87], v[176:179]
  ds_read_b64_tr_b16 v[126:127], v10 offset:49152
  ds_read_b128 v[68:71], v2 offset:49152
  v_mfma_f32_16x16x32_bf16 v[180:183], v[100:103], v[84:87], v[180:183]
  s_add_u32 m0, s41, 32768
  s_nop 0
  buffer_load_dwordx4 v11, s[12:15], s36 offen lds
  s_add_u32 s36, s36, s38
  v_mfma_f32_16x16x32_bf16 v[184:187], v[104:107], v[84:87], v[184:187]
  s_add_u32 m0, s42, 32768
  s_nop 0
  buffer_load_dwordx4 v13, s[16:19], s37 offen lds
  v_mfma_f32_16x16x32_bf16 v[188:191], v[108:111], v[84:87], v[188:191]
  s_add_u32 m0, s42, 33792
  s_nop 0
  buffer_load_dwordx4 v14, s[16:19], s37 offen lds
  s_add_u32 s37, s37, s39
  s_waitcnt lgkmcnt(0)
  v_mfma_f32_16x16x32_bf16 v[128:131], v[112:115], v[64:67], v[128:131]
  ds_read_b128 v[80:83], v1 offset:51200
  v_mfma_f32_16x16x32_bf16 v[132:135], v[116:119], v[64:67], v[132:135]
  ds_read_b128 v[84:87], v2 offset:51200
  v_mfma_f32_16x16x32_bf16 v[136:139], v[120:123], v[64:67], v[136:139]
  v_mfma_f32_16x16x32_bf16 v[140:143], v[124:127], v[64:67], v[140:143]
  v_mfma_f32_16x16x32_bf16 v[144:147], v[112:115], v[68:71], v[144:147]
  v_mfma_f32_16x16x32_bf16 v[148:151], v[116:119], v[68:71], v[148:151]
  v_mfma_f32_16x16x32_bf16 v[152:155], v[120:123], v[68:71], v[152:155]
  v_mfma_f32_16x16x32_bf16 v[156:159], v[124:127], v[68:71], v[156:159]
  s_waitcnt vmcnt(6) lgkmcnt(0)
  s_barrier
  v_mfma_f32_16x16x32_bf16 v[160:163], v[112:115], v[80:83], v[160:163]
  ds_read_b64_tr_b16 v[96:97], v3 offset:0
  ds_read_b64_tr_b16 v[98:99], v4 offset:0
  v_mfma_f32_16x16x32_bf16 v[164:167], v[116:119], v[80:83], v[164:167]
  ds_read_b128 v[64:67], v1 offset:0
  ds_read_b64_tr_b16 v[100:101], v5 offset:0
  v_mfma_f32_16x16x32_bf16 v[168:171], v[120:123], v[80:83], v[168:171]
  ds_read_b64_tr_b16 v[102:103], v6 offset:0
  ds_read_b64_tr_b16 v[104:105], v7 offset:0
  v_mfma_f32_16x16x32_bf16 v[172:175], v[124:127], v[80:83], v[172:175]
  ds_read_b64_tr_b16 v[106:107], v8 offset:0
  ds_read_b64_tr_b16 v[108:109], v9 offset:0
  v_mfma_f32_16x16x32_bf16 v[176:179], v[112:115], v[84:87], v[176:179]
  ds_read_b64_tr_b16 v[110:111], v10 offset:0
  ds_read_b128 v[68:71], v2 offset:0
  v_mfma_f32_16x16x32_bf16 v[180:183], v[116:119], v[84:87], v[180:183]
  s_add_u32 m0, s41, 49152
  s_nop 0
  buffer_load_dwordx4 v11, s[12:15], s36 offen lds
  s_add_u32 s36, s36, s38
  v_mfma_f32_16x16x32_bf16 v[184:187], v[120:123], v[84:87], v[184:187]
  s_add_u32 m0, s42, 49152
  s_nop 0
  buffer_load_dwordx4 v13, s[16:19], s37 offen lds
  v_mfma_f32_16x16x32_bf16 v[188:191], v[124:127], v[84:87], v[188:191]
  s_add_u32 m0, s42, 50176
  s_nop 0
  buffer_load_dwordx4 v14, s[16:19], s37 offen lds
  s_add_u32 s37, s37, s39
  s_add_u32 s40, s40, 4
  s_cmp_le_u32 s40, s51
  s_cbranch_scc1 L_G_loopt2
  s_waitcnt lgkmcnt(0) vmcnt(0)
  s_cmp_lg_u32 s35, 0
  s_cbranch_scc1 L_out_epi2
  s_lshr_b32 s30, s26, 2
  s_and_b32 s31, s26, 3
  s_mul_i32 s30, s30, 2
  s_mul_i32 s30, s30, s46
  s_lshr_b32 s32, s31, 1
  s_mul_i32 s32, s32, s56
  s_and_b32 s31, s31, 1
  s_lshl_b32 s31, s31, 12
  s_add_u32 s30, s30, s31
  s_add_u32 s30, s30, s32
  s_add_u32 s30, s30, s45
  v_and_b32 v16, 15, v0
  v_lshrrev_b32 v17, 4, v0
  v_lshrrev_b32 v18, 3, v16
  v_and_b32 v16, 7, v16
  v_lshl_add_u32 v16, v18, 4, v16
  v_lshlrev_b32 v15, 9, v17
  v_lshl_add_u32 v15, v16, 4, v15
  v_pk_mul_f32 v[128:129], v[128:129], s[48:49]
  v_pk_mul_f32 v[130:131], v[130:131], s[48:49]
  v_pk_mul_f32 v[132:133], v[132:133], s[48:49]
  v_pk_mul_f32 v[134:135], v[134:135], s[48:49]
  v_cvt_pk_bf16_f32 v128, v128, v129
  v_cvt_pk_bf16_f32 v129, v130, v131
  v_cvt_pk_bf16_f32 v130, v132, v133
  v_cvt_pk_bf16_f32 v131, v134, v135
  buffer_store_dwordx4 v[128:131], v15, s[4:7], s30 offen offset:0 sc1
  v_pk_mul_f32 v[144:145], v[144:145], s[48:49]
  v_pk_mul_f32 v[146:147], v[146:147], s[48:49]
  v_pk_mul_f32 v[148:149], v[148:149], s[48:49]
  v_pk_mul_f32 v[150:151], v[150:151], s[48:49]
  v_cvt_pk_bf16_f32 v144, v144, v145
  v_cvt_pk_bf16_f32 v145, v146, v147
  v_cvt_pk_bf16_f32 v146, v148, v149
  v_cvt_pk_bf16_f32 v147, v150, v151
  buffer_store_dwordx4 v[144:147], v15, s[4:7], s30 offen offset:128 sc1
  v_pk_mul_f32 v[136:137], v[136:137], s[48:49]
  v_pk_mul_f32 v[138:139], v[138:139], s[48:49]
  v_pk_mul_f32 v[140:141], v[140:141], s[48:49]
  v_pk_mul_f32 v[142:143], v[142:143], s[48:49]
  v_cvt_pk_bf16_f32 v136, v136, v137
  v_cvt_pk_bf16_f32 v137, v138, v139
  v_cvt_pk_bf16_f32 v138, v140, v141
  v_cvt_pk_bf16_f32 v139, v142, v143
  buffer_store_dwordx4 v[136:139], v15, s[4:7], s30 offen offset:2048 sc1
  v_pk_mul_f32 v[152:153], v[152:153], s[48:49]
  v_pk_mul_f32 v[154:155], v[154:155], s[48:49]
  v_pk_mul_f32 v[156:157], v[156:157], s[48:49]
  v_pk_mul_f32 v[158:159], v[158:159], s[48:49]
  v_cvt_pk_bf16_f32 v152, v152, v153
  v_cvt_pk_bf16_f32 v153, v154, v155
  v_cvt_pk_bf16_f32 v154, v156, v157
  v_cvt_pk_bf16_f32 v155, v158, v159
  buffer_store_dwordx4 v[152:155], v15, s[4:7], s30 offen offset:2176 sc1
  s_add_u32 s30, s30, s46
  v_pk_mul_f32 v[160:161], v[160:161], s[48:49]
  v_pk_mul_f32 v[162:163], v[162:163], s[48:49]
  v_pk_mul_f32 v[164:165], v[164:165], s[48:49]
  v_pk_mul_f32 v[166:167], v[166:167], s[48:49]
  v_cvt_pk_bf16_f32 v160, v160, v161
  v_cvt_pk_bf16_f32 v161, v162, v163
  v_cvt_pk_bf16_f32 v162, v164, v165
  v_cvt_pk_bf16_f32 v163, v166, v167
  buffer_store_dwordx4 v[160:163], v15, s[4:7], s30 offen offset:0 sc1
  v_pk_mul_f32 v[176:177], v[176:177], s[48:49]
  v_pk_mul_f32 v[178:179], v[178:179], s[48:49]
  v_pk_mul_f32 v[180:181], v[180:181], s[48:49]
  v_pk_mul_f32 v[182:183], v[182:183], s[48:49]
  v_cvt_pk_bf16_f32 v176, v176, v177
  v_cvt_pk_bf16_f32 v177, v178, v179
  v_cvt_pk_bf16_f32 v178, v180, v181
  v_cvt_pk_bf16_f32 v179, v182, v183
  buffer_store_dwordx4 v[176:179], v15, s[4:7], s30 offen offset:128 sc1
  v_pk_mul_f32 v[168:169], v[168:169], s[48:49]
  v_pk_mul_f32 v[170:171], v[170:171], s[48:49]
  v_pk_mul_f32 v[172:173], v[172:173], s[48:49]
  v_pk_mul_f32 v[174:175], v[174:175], s[48:49]
  v_cvt_pk_bf16_f32 v168, v168, v169
  v_cvt_pk_bf16_f32 v169, v170, v171
  v_cvt_pk_bf16_f32 v170, v172, v173
  v_cvt_pk_bf16_f32 v171, v174, v175
  buffer_store_dwordx4 v[168:171], v15, s[4:7], s30 offen offset:2048 sc1
  v_pk_mul_f32 v[184:185], v[184:185], s[48:49]
  v_pk_mul_f32 v[186:187], v[186:187], s[48:49]
  v_pk_mul_f32 v[188:189], v[188:189], s[48:49]
  v_pk_mul_f32 v[190:191], v[190:191], s[48:49]
  v_cvt_pk_bf16_f32 v184, v184, v185
  v_cvt_pk_bf16_f32 v185, v186, v187
  v_cvt_pk_bf16_f32 v186, v188, v189
  v_cvt_pk_bf16_f32 v187, v190, v191
  buffer_store_dwordx4 v[184:187], v15, s[4:7], s30 offen offset:2176 sc1
  s_branch L_proj_pub2
L_proj_v2:
  s_lshr_b32 s30, s26, 2
  s_and_b32 s31, s26, 3
  v_and_b32 v16, 15, v0
  v_lshrrev_b32 v17, 4, v0
  v_lshrrev_b32 v18, 3, v16
  v_and_b32 v19, 7, v16
  v_lshl_add_u32 v19, v18, 4, v19
  s_lshl_b32 s32, s30, 12
  v_lshlrev_b32 v20, 1, v18
  v_xor_b32 v20, v20, v17
  v_lshlrev_b32 v1, 6, v19
  v_lshl_add_u32 v1, v20, 4, v1
  v_add_u32 v1, s32, v1
  v_xor_b32 v2, 32, v1
  v_add_u32 v2, 512, v2
  v_lshrrev_b32 v20, 2, v0
  s_lshl_b32 s32, s26, 4
  v_add_u32 v20, s32, v20
  v_lshlrev_b32 v11, 11, v20
  v_lshrrev_b32 v21, 1, v20
  v_xor_b32 v21, v21, v20
  v_bfe_u32 v21, v21, 3, 1
  v_lshlrev_b32 v21, 1, v21
  v_xor_b32 v21, v21, v0
  v_and_b32 v21, 3, v21
  v_lshl_add_u32 v11, v21, 4, v11
  v_xor_b32 v12, 32, v11
  v_add_u32 v12, 0x8000, v12
  v_bfe_u32 v20, v0, 2, 2
  v_lshl_add_u32 v21, v17, 3, v20
  v_lshlrev_b32 v3, 9, v21
  v_bfe_u32 v21, v0, 1, 1
  s_lshl_b32 s32, s31, 3
  v_or_b32 v21, s32, v21
  v_lshlrev_b32 v20, 2, v20
  v_xor_b32 v21, v21, v20
  v_and_b32 v22, 1, v17
  v_mul_u32_u24 v22, 3, v22
  v_xor_b32 v21, v21, v22
  v_lshl_add_u32 v3, v21, 4, v3
  v_and_b32 v21, 1, v0
  v_lshl_add_u32 v3, v21, 3, v3
  v_add_u32 v3, 0x10000, v3
  v_xor_b32 v4, 48, v3
  v_add_u32 v4, 2048, v4
  v_xor_b32 v5, 32, v3
  v_xor_b32 v6, 32, v4
  v_xor_b32 v7, 64, v3
  v_xor_b32 v8, 64, v4
  v_xor_b32 v9, 96, v3
  v_xor_b32 v10, 96, v4
  v_lshrrev_b32 v20, 5, v0
  s_lshl_b32 s32, s26, 2
  v_add_u32 v21, s32, v20
  v_lshlrev_b32 v13, s28, v21
  v_add_u32 v21, 2, v21
  v_lshlrev_b32 v14, s28, v21
  s_lshr_b32 s32, s26, 1
  s_xor_b32 s32, s32, s26
  s_and_b32 s32, s32, 1
  s_mul_i32 s32, s32, 3
  v_lshlrev_b32 v20, 2, v20
  v_and_b32 v21, 31, v0
  v_xor_b32 v21, v21, v20
  v_xor_b32 v21, s32, v21
  v_lshl_add_u32 v13, v21, 4, v13
  v_xor_b32 v21, 8, v21
  v_lshl_add_u32 v14, v21, 4, v14
  s_lshl_b32 s41, s26, 10
  s_lshl_b32 s42, s26, 11
  s_add_u32 s42, s42, 0x10000
  s_mov_b32 s14, s43
  s_mov_b32 s18, s44
  s_add_u32 m0, s41, 0
  s_nop 0
  buffer_load_dwordx4 v11, s[12:15], s36 offen lds
  s_add_u32 s36, s36, s38
  s_add_u32 m0, s42, 0
  s_nop 0
  buffer_load_dwordx4 v13, s[16:19], s37 offen lds
  s_add_u32 m0, s42, 1024
  s_nop 0
  buffer_load_dwordx4 v14, s[16:19], s37 offen lds
  s_add_u32 s37, s37, s39
  s_add_u32 m0, s41, 16384
  s_nop 0
  buffer_load_dwordx4 v11, s[12:15], s36 offen lds
  s_add_u32 s36, s36, s38
  s_add_u32 m0, s42, 16384
  s_nop 0
  buffer_load_dwordx4 v13, s[16:19], s37 offen lds
  s_add_u32 m0, s42, 17408
  s_nop 0
  buffer_load_dwordx4 v14, s[16:19], s37 offen lds
  s_add_u32 s37, s37, s39
  s_add_u32 m0, s41, 32768
  s_nop 0
  buffer_load_dwordx4 v11, s[12:15], s36 offen lds
  s_add_u32 s36, s36, s38
  s_add_u32 m0, s42, 32768
  s_nop 0
  buffer_load_dwordx4 v13, s[16:19], s37 offen lds
  s_add_u32 m0, s42, 33792
  s_nop 0
  buffer_load_dwordx4 v14, s[16:19], s37 offen lds
  s_add_u32 s37, s37, s39
  s_add_u32 m0, s41, 49152
  s_nop 0
  buffer_load_dwordx4 v11, s[12:15], s36 offen lds
  s_add_u32 s36, s36, s38
  s_add_u32 m0, s42, 49152
  s_nop 0
  buffer_load_dwordx4 v13, s[16:19], s37 offen lds
  s_add_u32 m0, s42, 50176
  s_nop 0
  buffer_load_dwordx4 v14, s[16:19], s37 offen lds
  s_add_u32 s37, s37, s39
  v_mov_b32 v128, 0
  v_mov_b32 v129, 0
  v_mov_b32 v130, 0
  v_mov_b32 v131, 0
  v_mov_b32 v132, 0
  v_mov_b32 v133, 0
  v_mov_b32 v134, 0
  v_mov_b32 v135, 0
  v_mov_b32 v136, 0
  v_mov_b32 v137, 0
  v_mov_b32 v138, 0
  v_mov_b32 v139, 0
  v_mov_b32 v140, 0
  v_mov_b32 v141, 0
  v_mov_b32 v142, 0
  v_mov_b32 v143, 0
  v_mov_b32 v144, 0
  v_mov_b32 v145, 0
  v_mov_b32 v146, 0
  v_mov_b32 v147, 0
  v_mov_b32 v148, 0
  v_mov_b32 v149, 0
  v_mov_b32 v150, 0
  v_mov_b32 v151, 0
  v_mov_b32 v152, 0
  v_mov_b32 v153, 0
  v_mov_b32 v154, 0
  v_mov_b32 v155, 0
  v_mov_b32 v156, 0
  v_mov_b32 v157, 0
  v_mov_b32 v158, 0
  v_mov_b32 v159, 0
  v_mov_b32 v160, 0
  v_mov_b32 v161, 0
  v_mov_b32 v162, 0
  v_mov_b32 v163, 0
  v_mov_b32 v164, 0
  v_mov_b32 v165, 0
  v_mov_b32 v166, 0
  v_mov_b32 v167, 0
  v_mov_b32 v168, 0
  v_mov_b32 v169, 0
  v_mov_b32 v170, 0
  v_mov_b32 v171, 0
  v_mov_b32 v172, 0
  v_mov_b32 v173, 0
  v_mov_b32 v174, 0
  v_mov_b32 v175, 0
  v_mov_b32 v176, 0
  v_mov_b32 v177, 0
  v_mov_b32 v178, 0
  v_mov_b32 v179, 0
  v_mov_b32 v180, 0
  v_mov_b32 v181, 0
  v_mov_b32 v182, 0
  v_mov_b32 v183, 0
  v_mov_b32 v184, 0
  v_mov_b32 v185, 0
  v_mov_b32 v186, 0
  v_mov_b32 v187, 0
  v_mov_b32 v188, 0
  v_mov_b32 v189, 0
  v_mov_b32 v190, 0
  v_mov_b32 v191, 0
  s_waitcnt vmcnt(9)
  s_mov_b32 s40, 4
  s_barrier
  s_cmp_eq_u32 s67, 0
  s_cbranch_scc1 L_G_rin2
  s_mov_b32 s67, 0
  v_mov_b32 v62, 1
  v_mov_b32 v63, 0
  s_mov_b64 exec, 1
  buffer_atomic_add v62, v63, s[8:11], 0 offen offset:136 sc1
  s_mov_b64 exec, -1
L_G_rin2:
  ds_read_b64_tr_b16 v[96:97], v3 offset:0
  ds_read_b64_tr_b16 v[98:99], v4 offset:0
  ds_read_b64_tr_b16 v[100:101], v5 offset:0
  ds_read_b64_tr_b16 v[102:103], v6 offset:0
  ds_read_b64_tr_b16 v[104:105], v7 offset:0
  ds_read_b64_tr_b16 v[106:107], v8 offset:0
  ds_read_b64_tr_b16 v[108:109], v9 offset:0
  ds_read_b64_tr_b16 v[110:111], v10 offset:0
  ds_read_b128 v[64:67], v1 offset:0
  ds_read_b128 v[68:71], v2 offset:0
.p2align 6
L_G_loopn2:
  s_cmp_eq_u32 s40, s51
  s_cselect_b32 s14, 0, s43
  s_cselect_b32 s18, 0, s44
  s_waitcnt lgkmcnt(0)
  v_mfma_f32_16x16x32_bf16 v[128:131], v[64:67], v[96:99], v[128:131]
  ds_read_b128 v[80:83], v1 offset:2048
  v_mfma_f32_16x16x32_bf16 v[132:135], v[64:67], v[100:103], v[132:135]
  ds_read_b128 v[84:87], v2 offset:2048
  v_mfma_f32_16x16x32_bf16 v[136:139], v[64:67], v[104:107], v[136:139]
  v_mfma_f32_16x16x32_bf16 v[140:143], v[64:67], v[108:111], v[140:143]
  v_mfma_f32_16x16x32_bf16 v[144:147], v[68:71], v[96:99], v[144:147]
  v_mfma_f32_16x16x32_bf16 v[148:151], v[68:71], v[100:103], v[148:151]
  v_mfma_f32_16x16x32_bf16 v[152:155], v[68:71], v[104:107], v[152:155]
  v_mfma_f32_16x16x32_bf16 v[156:159], v[68:71], v[108:111], v[156:159]
  s_waitcnt vmcnt(6) lgkmcnt(0)
  s_barrier
  v_mfma_f32_16x16x32_bf16 v[160:163], v[80:83], v[96:99], v[160:163]
  ds_read_b64_tr_b16 v[112:113], v3 offset:16384
  ds_read_b64_tr_b16 v[114:115], v4 offset:16384
  v_mfma_f32_16x16x32_bf16 v[164:167], v[80:83], v[100:103], v[164:167]
  ds_read_b128 v[64:67], v1 offset:16384
  ds_read_b64_tr_b16 v[116:117], v5 offset:16384
  v_mfma_f32_16x16x32_bf16 v[168:171], v[80:83], v[104:107], v[168:171]
  ds_read_b64_tr_b16 v[118:119], v6 offset:16384
  ds_read_b64_tr_b16 v[120:121], v7 offset:16384
  v_mfma_f32_16x16x32_bf16 v[172:175], v[80:83], v[108:111], v[172:175]
  ds_read_b64_tr_b16 v[122:123], v8 offset:16384
  ds_read_b64_tr_b16 v[124:125], v9 offset:16384
  v_mfma_f32_16x16x32_bf16 v[176:179], v[84:87], v[96:99], v[176:179]
  ds_read_b64_tr_b16 v[126:127], v10 offset:16384
  ds_read_b128 v[68:71], v2 offset:16384
  v_mfma_f32_16x16x32_bf16 v[180:183], v[84:87], v[100:103], v[180:183]
  s_add_u32 m0, s41, 0
  s_nop 0
  buffer_load_dwordx4 v11, s[12:15], s36 offen lds
  s_add_u32 s36, s36, s38
  v_mfma_f32_16x16x32_bf16 v[184:187], v[84:87], v[104:107], v[184:187]
  s_add_u32 m0, s42, 0
  s_nop 0
  buffer_load_dwordx4 v13, s[16:19], s37 offen lds
  v_mfma_f32_16x16x32_bf16 v[188:191], v[84:87], v[108:111], v[188:191]
  s_add_u32 m0, s42, 1024
  s_nop 0
  buffer_load_dwordx4 v14, s[16:19], s37 offen lds
  s_add_u32 s37, s37, s39
  s_waitcnt lgkmcnt(0)
  v_mfma_f32_16x16x32_bf16 v[128:131], v[64:67], v[112:115], v[128:131]
  ds_read_b128 v[80:83], v1 offset:18432
  v_mfma_f32_16x16x32_bf16 v[132:135], v[64:67], v[116:119], v[132:135]
  ds_read_b128 v[84:87], v2 offset:18432
  v_mfma_f32_16x16x32_bf16 v[136:139], v[64:67], v[120:123], v[136:139]
  v_mfma_f32_16x16x32_bf16 v[140:143], v[64:67], v[124:127], v[140:143]
  v_mfma_f32_16x16x32_bf16 v[144:147], v[68:71], v[112:115], v[144:147]
  v_mfma_f32_16x16x32_bf16 v[148:151], v[68:71], v[116:119], v[148:151]
  v_mfma_f32_16x16x32_bf16 v[152:155], v[68:71], v[120:123], v[152:155]
  v_mfma_f32_16x16x32_bf16 v[156:159], v[68:71], v[124:127], v[156:159]
  s_waitcnt vmcnt(6) lgkmcnt(0)
  s_barrier
  v_mfma_f32_16x16x32_bf16 v[160:163], v[80:83], v[112:115], v[160:163]
  ds_read_b64_tr_b16 v[96:97], v3 offset:32768
  ds_read_b64_tr_b16 v[98:99], v4 offset:32768
  v_mfma_f32_16x16x32_bf16 v[164:167], v[80:83], v[116:119], v[164:167]
  ds_read_b128 v[64:67], v1 offset:32768
  ds_read_b64_tr_b16 v[100:101], v5 offset:32768
  v_mfma_f32_16x16x32_bf16 v[168:171], v[80:83], v[120:123], v[168:171]
  ds_read_b64_tr_b16 v[102:103], v6 offset:32768
  ds_read_b64_tr_b16 v[104:105], v7 offset:32768
  v_mfma_f32_16x16x32_bf16 v[172:175], v[80:83], v[124:127], v[172:175]
  ds_read_b64_tr_b16 v[106:107], v8 offset:32768
  ds_read_b64_tr_b16 v[108:109], v9 offset:32768
  v_mfma_f32_16x16x32_bf16 v[176:179], v[84:87], v[112:115], v[176:179]
  ds_read_b64_tr_b16 v[110:111], v10 offset:32768
  ds_read_b128 v[68:71], v2 offset:32768
  v_mfma_f32_16x16x32_bf16 v[180:183], v[84:87], v[116:119], v[180:183]
  s_add_u32 m0, s41, 16384
  s_nop 0
  buffer_load_dwordx4 v11, s[12:15], s36 offen lds
  s_add_u32 s36, s36, s38
  v_mfma_f32_16x16x32_bf16 v[184:187], v[84:87], v[120:123], v[184:187]
  s_add_u32 m0, s42, 16384
  s_nop 0
  buffer_load_dwordx4 v13, s[16:19], s37 offen lds
  v_mfma_f32_16x16x32_bf16 v[188:191], v[84:87], v[124:127], v[188:191]
  s_add_u32 m0, s42, 17408
  s_nop 0
  buffer_load_dwordx4 v14, s[16:19], s37 offen lds
  s_add_u32 s37, s37, s39
  s_waitcnt lgkmcnt(0)
  v_mfma_f32_16x16x32_bf16 v[128:131], v[64:67], v[96:99], v[128:131]
  ds_read_b128 v[80:83], v1 offset:34816
  v_mfma_f32_16x16x32_bf16 v[132:135], v[64:67], v[100:103], v[132:135]
  ds_read_b128 v[84:87], v2 offset:34816
  v_mfma_f32_16x16x32_bf16 v[136:139], v[64:67], v[104:107], v[136:139]
  v_mfma_f32_16x16x32_bf16 v[140:143], v[64:67], v[108:111], v[140:143]
  v_mfma_f32_16x16x32_bf16 v[144:147], v[68:71], v[96:99], v[144:147]
  v_mfma_f32_16x16x32_bf16 v[148:151], v[68:71], v[100:103], v[148:151]
  v_mfma_f32_16x16x32_bf16 v[152:155], v[68:71], v[104:107], v[152:155]
  v_mfma_f32_16x16x32_bf16 v[156:159], v[68:71], v[108:111], v[156:159]
  s_waitcnt vmcnt(6) lgkmcnt(0)
  s_barrier
  v_mfma_f32_16x16x32_bf16 v[160:163], v[80:83], v[96:99], v[160:163]
  ds_read_b64_tr_b16 v[112:113], v3 offset:49152
  ds_read_b64_tr_b16 v[114:115], v4 offset:49152
  v_mfma_f32_16x16x32_bf16 v[164:167], v[80:83], v[100:103], v[164:167]
  ds_read_b128 v[64:67], v1 offset:49152
  ds_read_b64_tr_b16 v[116:117], v5 offset:49152
  v_mfma_f32_16x16x32_bf16 v[168:171], v[80:83], v[104:107], v[168:171]
  ds_read_b64_tr_b16 v[118:119], v6 offset:49152
  ds_read_b64_tr_b16 v[120:121], v7 offset:49152
  v_mfma_f32_16x16x32_bf16 v[172:175], v[80:83], v[108:111], v[172:175]
  ds_read_b64_tr_b16 v[122:123], v8 offset:49152
  ds_read_b64_tr_b16 v[124:125], v9 offset:49152
  v_mfma_f32_16x16x32_bf16 v[176:179], v[84:87], v[96:99], v[176:179]
  ds_read_b64_tr_b16 v[126:127], v10 offset:49152
  ds_read_b128 v[68:71], v2 offset:49152
  v_mfma_f32_16x16x32_bf16 v[180:183], v[84:87], v[100:103], v[180:183]
  s_add_u32 m0, s41, 32768
  s_nop 0
  buffer_load_dwordx4 v11, s[12:15], s36 offen lds
  s_add_u32 s36, s36, s38
  v_mfma_f32_16x16x32_bf16 v[184:187], v[84:87], v[104:107], v[184:187]
  s_add_u32 m0, s42, 32768
  s_nop 0
  buffer_load_dwordx4 v13, s[16:19], s37 offen lds
  v_mfma_f32_16x16x32_bf16 v[188:191], v[84:87], v[108:111], v[188:191]
  s_add_u32 m0, s42, 33792
  s_nop 0
  buffer_load_dwordx4 v14, s[16:19], s37 offen lds
  s_add_u32 s37, s37, s39
  s_waitcnt lgkmcnt(0)
  v_mfma_f32_16x16x32_bf16 v[128:131], v[64:67], v[112:115], v[128:131]
  ds_read_b128 v[80:83], v1 offset:51200
  v_mfma_f32_16x16x32_bf16 v[132:135], v[64:67], v[116:119], v[132:135]
  ds_read_b128 v[84:87], v2 offset:51200
  v_mfma_f32_16x16x32_bf16 v[136:139], v[64:67], v[120:123], v[136:139]
  v_mfma_f32_16x16x32_bf16 v[140:143], v[64:67], v[124:127], v[140:143]
  v_mfma_f32_16x16x32_bf16 v[144:147], v[68:71], v[112:115], v[144:147]
  v_mfma_f32_16x16x32_bf16 v[148:151], v[68:71], v[116:119], v[148:151]
  v_mfma_f32_16x16x32_bf16 v[152:155], v[68:71], v[120:123], v[152:155]
  v_mfma_f32_16x16x32_bf16 v[156:159], v[68:71], v[124:127], v[156:159]
  s_waitcnt vmcnt(6) lgkmcnt(0)
  s_barrier
  v_mfma_f32_16x16x32_bf16 v[160:163], v[80:83], v[112:115], v[160:163]
  ds_read_b64_tr_b16 v[96:97], v3 offset:0
  ds_read_b64_tr_b16 v[98:99], v4 offset:0
  v_mfma_f32_16x16x32_bf16 v[164:167], v[80:83], v[116:119], v[164:167]
  ds_read_b128 v[64:67], v1 offset:0
  ds_read_b64_tr_b16 v[100:101], v5 offset:0
  v_mfma_f32_16x16x32_bf16 v[168:171], v[80:83], v[120:123], v[168:171]
  ds_read_b64_tr_b16 v[102:103], v6 offset:0
  ds_read_b64_tr_b16 v[104:105], v7 offset:0
  v_mfma_f32_16x16x32_bf16 v[172:175], v[80:83], v[124:127], v[172:175]
  ds_read_b64_tr_b16 v[106:107], v8 offset:0
  ds_read_b64_tr_b16 v[108:109], v9 offset:0
  v_mfma_f32_16x16x32_bf16 v[176:179], v[84:87], v[112:115], v[176:179]
  ds_read_b64_tr_b16 v[110:111], v10 offset:0
  ds_read_b128 v[68:71], v2 offset:0
  v_mfma_f32_16x16x32_bf16 v[180:183], v[84:87], v[116:119], v[180:183]
  s_add_u32 m0, s41, 49152
  s_nop 0
  buffer_load_dwordx4 v11, s[12:15], s36 offen lds
  s_add_u32 s36, s36, s38
  v_mfma_f32_16x16x32_bf16 v[184:187], v[84:87], v[120:123], v[184:187]
  s_add_u32 m0, s42, 49152
  s_nop 0
  buffer_load_dwordx4 v13, s[16:19], s37 offen lds
  v_mfma_f32_16x16x32_bf16 v[188:191], v[84:87], v[124:127], v[188:191]
  s_add_u32 m0, s42, 50176
  s_nop 0
  buffer_load_dwordx4 v14, s[16:19], s37 offen lds
  s_add_u32 s37, s37, s39
  s_add_u32 s40, s40, 4
  s_cmp_le_u32 s40, s51
  s_cbranch_scc1 L_G_loopn2
  s_waitcnt lgkmcnt(0) vmcnt(0)
  s_lshr_b32 s30, s26, 2
  s_and_b32 s31, s26, 3
  s_mul_i32 s30, s30, 2
  s_mul_i32 s30, s30, s46
  s_lshr_b32 s32, s31, 1
  s_mul_i32 s32, s32, s56
  s_and_b32 s31, s31, 1
  s_lshl_b32 s31, s31, 12
  s_add_u32 s30, s30, s31
  s_add_u32 s30, s30, s32
  s_add_u32 s30, s30, s45
  v_and_b32 v16, 15, v0
  v_lshrrev_b32 v17, 4, v0
  v_lshlrev_b32 v15, 9, v17
  v_lshl_add_u32 v15, v16, 4, v15
  v_cvt_pk_bf16_f32 v128, v128, v129
  v_cvt_pk_bf16_f32 v129, v130, v131
  v_cvt_pk_bf16_f32 v130, v144, v145
  v_cvt_pk_bf16_f32 v131, v146, v147
  buffer_store_dwordx4 v[128:131], v15, s[4:7], s30 offen offset:0 sc1
  v_cvt_pk_bf16_f32 v132, v132, v133
  v_cvt_pk_bf16_f32 v133, v134, v135
  v_cvt_pk_bf16_f32 v134, v148, v149
  v_cvt_pk_bf16_f32 v135, v150, v151
  buffer_store_dwordx4 v[132:135], v15, s[4:7], s30 offen offset:256 sc1
  v_cvt_pk_bf16_f32 v136, v136, v137
  v_cvt_pk_bf16_f32 v137, v138, v139
  v_cvt_pk_bf16_f32 v138, v152, v153
  v_cvt_pk_bf16_f32 v139, v154, v155
  buffer_store_dwordx4 v[136:139], v15, s[4:7], s30 offen offset:2048 sc1
  v_cvt_pk_bf16_f32 v140, v140, v141
  v_cvt_pk_bf16_f32 v141, v142, v143
  v_cvt_pk_bf16_f32 v142, v156, v157
  v_cvt_pk_bf16_f32 v143, v158, v159
  buffer_store_dwordx4 v[140:143], v15, s[4:7], s30 offen offset:2304 sc1
  s_add_u32 s30, s30, s46
  v_cvt_pk_bf16_f32 v160, v160, v161
  v_cvt_pk_bf16_f32 v161, v162, v163
  v_cvt_pk_bf16_f32 v162, v176, v177
  v_cvt_pk_bf16_f32 v163, v178, v179
  buffer_store_dwordx4 v[160:163], v15, s[4:7], s30 offen offset:0 sc1
  v_cvt_pk_bf16_f32 v164, v164, v165
  v_cvt_pk_bf16_f32 v165, v166, v167
  v_cvt_pk_bf16_f32 v166, v180, v181
  v_cvt_pk_bf16_f32 v167, v182, v183
  buffer_store_dwordx4 v[164:167], v15, s[4:7], s30 offen offset:256 sc1
  v_cvt_pk_bf16_f32 v168, v168, v169
  v_cvt_pk_bf16_f32 v169, v170, v171
  v_cvt_pk_bf16_f32 v170, v184, v185
  v_cvt_pk_bf16_f32 v171, v186, v187
  buffer_store_dwordx4 v[168:171], v15, s[4:7], s30 offen offset:2048 sc1
  v_cvt_pk_bf16_f32 v172, v172, v173
  v_cvt_pk_bf16_f32 v173, v174, v175
  v_cvt_pk_bf16_f32 v174, v188, v189
  v_cvt_pk_bf16_f32 v175, v190, v191
  buffer_store_dwordx4 v[172:175], v15, s[4:7], s30 offen offset:2304 sc1
L_proj_pub2:
  s_waitcnt lgkmcnt(0)
  s_and_b32 s28, s93, 15
  s_sub_u32 s28, s28, 4
  s_mov_b32 s66, s34
  s_cmp_lt_u32 s28, 3
  s_cselect_b32 s65, s50, -1
  s_cbranch_scc1 L_pb_7
  s_waitcnt vmcnt(0)
  s_barrier
  s_cmp_lg_u32 s26, 0
  s_cbranch_scc1 L_pb_7
  s_cmp_lg_u32 s87, 0
  s_cbranch_scc1 L_ei_8_ok
  v_mov_b32 v62, 0
L_ei_8:
  buffer_load_dword v63, v62, s[8:11], 0 offen offset:136 sc1
  s_waitcnt vmcnt(0)
  v_readfirstlane_b32 s28, v63
  s_nop 0
  s_cmp_ge_u32 s28, 128
  s_cbranch_scc1 L_ei_8_set
  s_sleep 8
  s_add_u32 s27, s27, 1
  s_cmp_lt_u32 s27, 0x80000
  s_cbranch_scc1 L_ei_8
L_ei_8_set:
  s_mov_b32 s87, 1
L_ei_8_ok:
  v_mul_lo_u32 v54, v0, s34
  v_add_u32 v54, 84934656, v54
  v_mov_b32 v55, 1
  s_mov_b64 exec, 3
  buffer_store_dword v55, v54, s[4:7], s50 offen sc1
  s_mov_b64 exec, -1
L_pb_7:
  s_branch L_next
L_T_OUTA:
  s_bfe_u32 s47, s90, 0x10002
  s_lshl_b32 s52, s88, 5
  s_add_u32 s52, s52, 3584
  s_cmp_eq_u32 s47, 0
  s_cselect_b32 s53, 32, 0
  s_add_u32 s53, s53, s52
  v_min_u32 v56, 7, v0
  v_lshlrev_b32 v56, 2, v56
  v_add_u32 v56, 84934656, v56
  v_min_u32 v57, 7, v0
  v_lshlrev_b32 v57, 2, v57
  v_add_u32 v57, 84934656, v57
  s_cmp_lg_u32 s26, 0
  s_cbranch_scc1 L_wf_9_x
  s_cmp_lg_u32 s87, 0
  s_cbranch_scc1 L_ei_10_ok
  v_mov_b32 v62, 0
L_ei_10:
  buffer_load_dword v63, v62, s[8:11], 0 offen offset:136 sc1
  s_waitcnt vmcnt(0)
  v_readfirstlane_b32 s28, v63
  s_nop 0
  s_cmp_ge_u32 s28, 128
  s_cbranch_scc1 L_ei_10_set
  s_sleep 8
  s_add_u32 s27, s27, 1
  s_cmp_lt_u32 s27, 0x80000
  s_cbranch_scc1 L_ei_10
L_ei_10_set:
  s_mov_b32 s87, 1
L_ei_10_ok:
  buffer_load_dword v60, v56, s[4:7], s52 offen sc1
  buffer_load_dword v61, v57, s[4:7], s53 offen sc1
L_wf_9_x:
  s_waitcnt vmcnt(0)
  s_barrier
  s_cmp_lg_u32 s26, 0
  s_cbranch_scc1 L_wf_9_done
  s_cmp_eq_u32 s65, -1
  s_cbranch_scc1 L_wf_9_c
  v_mul_lo_u32 v54, v0, s66
  v_add_u32 v54, 84934656, v54
  v_mov_b32 v55, 1
  s_mov_b64 exec, 3
  buffer_store_dword v55, v54, s[4:7], s65 offen sc1
  s_mov_b64 exec, -1
  s_branch L_wf_9_c
L_wf_9_p:
  buffer_load_dword v60, v56, s[4:7], s52 offen sc1
  buffer_load_dword v61, v57, s[4:7], s53 offen sc1
  s_waitcnt vmcnt(0)
L_wf_9_c:
  v_min_u32 v60, v60, v61
  v_cmp_eq_u32 vcc, 0, v60
  s_cbranch_vccz L_wf_9_done
  s_sleep 16
  s_add_u32 s27, s27, 1
  s_cmp_lt_u32 s27, 0x80000
  s_cbranch_scc1 L_wf_9_p
L_wf_9_done:
  s_mov_b32 s65, -1
  s_barrier
  s_load_dwordx2 s[16:17], s[0:1], 32
  s_mov_b32 s44, 2097152
  s_mov_b32 s29, 65536
  s_lshl_b32 s36, s88, 18
  s_add_u32 s36, s36, 79691776
  s_bitcmp1_b32 s90, 3
  s_cselect_b32 s51, 16, 32
  s_cselect_b32 s35, 2, 1
  s_bfe_u32 s33, s90, 0x10004
  s_lshl_b32 s30, s33, 15
  s_add_u32 s36, s36, s30
  s_lshl_b32 s33, s33, 20
  s_mov_b32 s45, 0
  s_branch L_out
L_T_OUTB:
  s_lshr_b32 s47, s90, 2
  s_lshl_b32 s52, s88, 9
  s_add_u32 s52, s52, 4096
  s_add_u32 s53, s52, 256
  s_cmp_eq_u32 s47, 0
  s_cselect_b32 s54, 512, 0
  s_add_u32 s55, s54, s53
  s_add_u32 s54, s54, s52
  v_min_u32 v56, 63, v0
  v_lshlrev_b32 v56, 2, v56
  v_add_u32 v56, 84934656, v56
  v_min_u32 v57, 63, v0
  v_lshlrev_b32 v57, 2, v57
  v_add_u32 v57, 84934656, v57
  v_min_u32 v58, 63, v0
  v_lshlrev_b32 v58, 2, v58
  v_add_u32 v58, 84934656, v58
  v_min_u32 v59, 63, v0
  v_lshlrev_b32 v59, 2, v59
  v_add_u32 v59, 84934656, v59
  s_cmp_lg_u32 s26, 0
  s_cbranch_scc1 L_wf_11_x
  s_cmp_lg_u32 s87, 0
  s_cbranch_scc1 L_ei_12_ok
  v_mov_b32 v62, 0
L_ei_12:
  buffer_load_dword v63, v62, s[8:11], 0 offen offset:136 sc1
  s_waitcnt vmcnt(0)
  v_readfirstlane_b32 s28, v63
  s_nop 0
  s_cmp_ge_u32 s28, 128
  s_cbranch_scc1 L_ei_12_set
  s_sleep 8
  s_add_u32 s27, s27, 1
  s_cmp_lt_u32 s27, 0x80000
  s_cbranch_scc1 L_ei_12
L_ei_12_set:
  s_mov_b32 s87, 1
L_ei_12_ok:
  buffer_load_dword v60, v56, s[4:7], s52 offen sc1
  buffer_load_dword v61, v57, s[4:7], s53 offen sc1
  buffer_load_dword v62, v58, s[4:7], s54 offen sc1
  buffer_load_dword v63, v59, s[4:7], s55 offen sc1
L_wf_11_x:
  s_waitcnt vmcnt(0)
  s_barrier
  s_cmp_lg_u32 s26, 0
  s_cbranch_scc1 L_wf_11_done
  s_cmp_eq_u32 s65, -1
  s_cbranch_scc1 L_wf_11_c
  v_mul_lo_u32 v54, v0, s66
  v_add_u32 v54, 84934656, v54
  v_mov_b32 v55, 1
  s_mov_b64 exec, 3
  buffer_store_dword v55, v54, s[4:7], s65 offen sc1
  s_mov_b64 exec, -1
  s_branch L_wf_11_c
L_wf_11_p:
  buffer_load_dword v60, v56, s[4:7], s52 offen sc1
  buffer_load_dword v61, v57, s[4:7], s53 offen sc1
  buffer_load_dword v62, v58, s[4:7], s54 offen sc1
  buffer_load_dword v63, v59, s[4:7], s55 offen sc1
  s_waitcnt vmcnt(0)
L_wf_11_c:
  v_min_u32 v60, v60, v61
  v_min_u32 v60, v60, v62
  v_min_u32 v60, v60, v63
  v_cmp_eq_u32 vcc, 0, v60
  s_cbranch_vccz L_wf_11_done
  s_sleep 32
  s_add_u32 s27, s27, 1
  s_cmp_lt_u32 s27, 0x80000
  s_cbranch_scc1 L_wf_11_p
L_wf_11_done:
  s_mov_b32 s65, -1
  s_barrier
  s_load_dwordx2 s[16:17], s[0:1], 80
  s_mov_b32 s44, 8388608
  s_mov_b32 s29, 262144
  s_lshl_b32 s36, s88, 20
  s_add_u32 s36, s36, 50331648
  s_mov_b32 s51, 128
  s_mov_b32 s45, 2048
  s_mov_b32 s35, 1
  s_mov_b32 s33, 0
L_out:
  s_load_dwordx2 s[12:13], s[0:1], 112
  s_load_dwordx2 s[20:21], s[0:1], 96
  s_mov_b32 s39, 65536
  s_mov_b32 s28, 11
  s_mov_b32 s43, 0x10000000
  s_mov_b32 s38, 2048
  s_lshl_b32 s37, s89, 9
  s_lshl_b32 s30, s88, 19
  s_add_u32 s45, s45, s30
  s_add_u32 s45, s45, s37
  s_add_u32 s37, s37, s33
  s_waitcnt lgkmcnt(0)
  s_and_b32 s13, s13, 0xffff
  s_mov_b32 s14, 0x0
  s_mov_b32 s15, 0x20000
  s_and_b32 s17, s17, 0xffff
  s_mov_b32 s18, 0x0
  s_mov_b32 s19, 0x20000
  s_and_b32 s21, s21, 0xffff
  s_mov_b32 s22, 0x800000
  s_mov_b32 s23, 0x20000
  s_cmp_lg_u32 s47, 0
  s_cbranch_scc1 L_out_h
  s_lshr_b32 s30, s26, 2
  s_and_b32 s31, s26, 3
  v_and_b32 v16, 15, v0
  v_lshrrev_b32 v17, 4, v0
  v_lshrrev_b32 v18, 3, v16
  v_and_b32 v19, 7, v16
  v_lshl_add_u32 v19, v18, 4, v19
  s_lshl_b32 s32, s30, 13
  v_lshlrev_b32 v1, 9, v17
  v_lshl_add_u32 v1, v19, 4, v1
  v_add_u32 v1, s32, v1
  v_add_u32 v2, 128, v1
  v_lshlrev_b32 v11, 4, v0
  s_mul_i32 s32, s26, s29
  v_add_u32 v11, s32, v11
  v_add_u32 v12, 1024, v11
  v_bfe_u32 v20, v0, 2, 2
  v_lshrrev_b32 v21, 1, v17
  v_lshl_add_u32 v21, v21, 4, v20
  v_and_b32 v22, 1, v17
  v_lshl_add_u32 v21, v22, 2, v21
  v_lshlrev_b32 v3, 9, v21
  v_bfe_u32 v21, v0, 1, 1
  v_lshlrev_b32 v21, 1, v21
  s_lshl_b32 s32, s31, 3
  v_or_b32 v21, s32, v21
  v_lshlrev_b32 v20, 2, v20
  v_xor_b32 v21, v21, v20
  v_and_b32 v22, 1, v17
  v_mul_u32_u24 v22, 3, v22
  v_xor_b32 v21, v21, v22
  v_lshl_add_u32 v3, v21, 4, v3
  v_and_b32 v21, 1, v0
  v_lshl_add_u32 v3, v21, 3, v3
  v_add_u32 v3, 0x10000, v3
  v_xor_b32 v4, 48, v3
  v_add_u32 v4, 4096, v4
  v_xor_b32 v5, 16, v3
  v_xor_b32 v6, 16, v4
  v_xor_b32 v7, 64, v3
  v_xor_b32 v8, 64, v4
  v_xor_b32 v9, 80, v3
  v_xor_b32 v10, 80, v4
  v_lshrrev_b32 v20, 5, v0
  s_lshl_b32 s32, s26, 2
  v_add_u32 v21, s32, v20
  v_lshlrev_b32 v13, s28, v21
  v_add_u32 v21, 2, v21
  v_lshlrev_b32 v14, s28, v21
  s_lshr_b32 s32, s26, 1
  s_xor_b32 s32, s32, s26
  s_and_b32 s32, s32, 1
  s_mul_i32 s32, s32, 3
  v_lshlrev_b32 v20, 2, v20
  v_and_b32 v21, 31, v0
  v_xor_b32 v21, v21, v20
  v_xor_b32 v21, s32, v21
  v_lshl_add_u32 v13, v21, 4, v13
  v_xor_b32 v21, 8, v21
  v_lshl_add_u32 v14, v21, 4, v14
  s_lshl_b32 s41, s26, 11
  s_lshl_b32 s42, s26, 11
  s_add_u32 s42, s42, 0x10000
  s_branch L_gemm_t4
L_out_epi4:
  s_lshr_b32 s30, s26, 2
  s_and_b32 s31, s26, 3
  s_lshl_b32 s30, s30, 19
  s_lshl_b32 s31, s31, 7
  s_add_u32 s30, s30, s31
  s_add_u32 s30, s30, s45
  s_lshl_b32 s31, s26, 14
  v_and_b32 v16, 15, v0
  v_lshrrev_b32 v17, 4, v0
  v_lshrrev_b32 v18, 3, v16
  v_and_b32 v16, 7, v16
  v_xor_b32 v17, v17, v16
  v_lshl_add_u32 v16, v18, 4, v16
  v_lshlrev_b32 v19, 7, v16
  v_lshl_add_u32 v19, v17, 4, v19
  v_add_u32 v19, s31, v19
  v_xor_b32 v20, 64, v19
  v_lshrrev_b32 v16, 3, v0
  v_and_b32 v17, 7, v0
  v_lshlrev_b32 v15, 12, v16
  v_lshl_add_u32 v15, v17, 4, v15
  v_xor_b32 v17, v17, v16
  v_lshlrev_b32 v21, 7, v16
  v_lshl_add_u32 v21, v17, 4, v21
  v_add_u32 v21, s31, v21
  v_cvt_pk_bf16_f32 v128, v128, v129
  v_cvt_pk_bf16_f32 v129, v130, v131
  v_cvt_pk_bf16_f32 v130, v132, v133
  v_cvt_pk_bf16_f32 v131, v134, v135
  v_cvt_pk_bf16_f32 v136, v136, v137
  v_cvt_pk_bf16_f32 v137, v138, v139
  v_cvt_pk_bf16_f32 v138, v140, v141
  v_cvt_pk_bf16_f32 v139, v142, v143
  v_permlane16_swap_b32 v128, v130
  v_permlane16_swap_b32 v129, v131
  v_permlane16_swap_b32 v136, v138
  v_permlane16_swap_b32 v137, v139
  s_waitcnt vmcnt(0)
  s_barrier
  ds_write_b128 v19, v[128:131] offset:0
  ds_write_b128 v20, v[136:139] offset:0
  v_cvt_pk_bf16_f32 v144, v144, v145
  v_cvt_pk_bf16_f32 v145, v146, v147
  v_cvt_pk_bf16_f32 v146, v148, v149
  v_cvt_pk_bf16_f32 v147, v150, v151
  v_cvt_pk_bf16_f32 v152, v152, v153
  v_cvt_pk_bf16_f32 v153, v154, v155
  v_cvt_pk_bf16_f32 v154, v156, v157
  v_cvt_pk_bf16_f32 v155, v158, v159
  v_permlane16_swap_b32 v144, v146
  v_permlane16_swap_b32 v145, v147
  v_permlane16_swap_b32 v152, v154
  v_permlane16_swap_b32 v153, v155
  ds_write_b128 v19, v[144:147] offset:1024
  ds_write_b128 v20, v[152:155] offset:1024
  ds_read_b128 v[24:27], v21 offset:0
  ds_read_b128 v[28:31], v21 offset:1024
  ds_read_b128 v[32:35], v21 offset:2048
  ds_read_b128 v[36:39], v21 offset:3072
  v_cvt_pk_bf16_f32 v160, v160, v161
  v_cvt_pk_bf16_f32 v161, v162, v163
  v_cvt_pk_bf16_f32 v162, v164, v165
  v_cvt_pk_bf16_f32 v163, v166, v167
  v_cvt_pk_bf16_f32 v168, v168, v169
  v_cvt_pk_bf16_f32 v169, v170, v171
  v_cvt_pk_bf16_f32 v170, v172, v173
  v_cvt_pk_bf16_f32 v171, v174, v175
  v_permlane16_swap_b32 v160, v162
  v_permlane16_swap_b32 v161, v163
  v_permlane16_swap_b32 v168, v170
  v_permlane16_swap_b32 v169, v171
  ds_write_b128 v19, v[160:163] offset:4096
  ds_write_b128 v20, v[168:171] offset:4096
  v_cvt_pk_bf16_f32 v176, v176, v177
  v_cvt_pk_bf16_f32 v177, v178, v179
  v_cvt_pk_bf16_f32 v178, v180, v181
  v_cvt_pk_bf16_f32 v179, v182, v183
  v_cvt_pk_bf16_f32 v184, v184, v185
  v_cvt_pk_bf16_f32 v185, v186, v187
  v_cvt_pk_bf16_f32 v186, v188, v189
  v_cvt_pk_bf16_f32 v187, v190, v191
  v_permlane16_swap_b32 v176, v178
  v_permlane16_swap_b32 v177, v179
  v_permlane16_swap_b32 v184, v186
  v_permlane16_swap_b32 v185, v187
  ds_write_b128 v19, v[176:179] offset:5120
  ds_write_b128 v20, v[184:187] offset:5120
  ds_read_b128 v[40:43], v21 offset:4096
  ds_read_b128 v[44:47], v21 offset:5120
  ds_read_b128 v[48:51], v21 offset:6144
  ds_read_b128 v[52:55], v21 offset:7168
  s_waitcnt lgkmcnt(8)
  buffer_store_dwordx4 v[24:27], v15, s[20:23], s30 offen sc1
  s_add_u32 s30, s30, 32768
  buffer_store_dwordx4 v[28:31], v15, s[20:23], s30 offen sc1
  s_add_u32 s30, s30, 32768
  buffer_store_dwordx4 v[32:35], v15, s[20:23], s30 offen sc1
  s_add_u32 s30, s30, 32768
  buffer_store_dwordx4 v[36:39], v15, s[20:23], s30 offen sc1
  s_add_u32 s30, s30, 32768
  v_cvt_pk_bf16_f32 v192, v192, v193
  v_cvt_pk_bf16_f32 v193, v194, v195
  v_cvt_pk_bf16_f32 v194, v196, v197
  v_cvt_pk_bf16_f32 v195, v198, v199
  v_cvt_pk_bf16_f32 v200, v200, v201
  v_cvt_pk_bf16_f32 v201, v202, v203
  v_cvt_pk_bf16_f32 v202, v204, v205
  v_cvt_pk_bf16_f32 v203, v206, v207
  v_permlane16_swap_b32 v192, v194
  v_permlane16_swap_b32 v193, v195
  v_permlane16_swap_b32 v200, v202
  v_permlane16_swap_b32 v201, v203
  ds_write_b128 v19, v[192:195] offset:8192
  ds_write_b128 v20, v[200:203] offset:8192
  v_cvt_pk_bf16_f32 v208, v208, v209
  v_cvt_pk_bf16_f32 v209, v210, v211
  v_cvt_pk_bf16_f32 v210, v212, v213
  v_cvt_pk_bf16_f32 v211, v214, v215
  v_cvt_pk_bf16_f32 v216, v216, v217
  v_cvt_pk_bf16_f32 v217, v218, v219
  v_cvt_pk_bf16_f32 v218, v220, v221
  v_cvt_pk_bf16_f32 v219, v222, v223
  v_permlane16_swap_b32 v208, v210
  v_permlane16_swap_b32 v209, v211
  v_permlane16_swap_b32 v216, v218
  v_permlane16_swap_b32 v217, v219
  ds_write_b128 v19, v[208:211] offset:9216
  ds_write_b128 v20, v[216:219] offset:9216
  ds_read_b128 v[24:27], v21 offset:8192
  ds_read_b128 v[28:31], v21 offset:9216
  ds_read_b128 v[32:35], v21 offset:10240
  ds_read_b128 v[36:39], v21 offset:11264
  s_waitcnt lgkmcnt(8)
  buffer_store_dwordx4 v[40:43], v15, s[20:23], s30 offen sc1
  s_add_u32 s30, s30, 32768
  buffer_store_dwordx4 v[44:47], v15, s[20:23], s30 offen sc1
  s_add_u32 s30, s30, 32768
  buffer_store_dwordx4 v[48:51], v15, s[20:23], s30 offen sc1
  s_add_u32 s30, s30, 32768
  buffer_store_dwordx4 v[52:55], v15, s[20:23], s30 offen sc1
  s_add_u32 s30, s30, 32768
  v_cvt_pk_bf16_f32 v224, v224, v225
  v_cvt_pk_bf16_f32 v225, v226, v227
  v_cvt_pk_bf16_f32 v226, v228, v229
  v_cvt_pk_bf16_f32 v227, v230, v231
  v_cvt_pk_bf16_f32 v232, v232, v233
  v_cvt_pk_bf16_f32 v233, v234, v235
  v_cvt_pk_bf16_f32 v234, v236, v237
  v_cvt_pk_bf16_f32 v235, v238, v239
  v_permlane16_swap_b32 v224, v226
  v_permlane16_swap_b32 v225, v227
  v_permlane16_swap_b32 v232, v234
  v_permlane16_swap_b32 v233, v235
  ds_write_b128 v19, v[224:227] offset:12288
  ds_write_b128 v20, v[232:235] offset:12288
  v_cvt_pk_bf16_f32 v240, v240, v241
  v_cvt_pk_bf16_f32 v241, v242, v243
  v_cvt_pk_bf16_f32 v242, v244, v245
  v_cvt_pk_bf16_f32 v243, v246, v247
  v_cvt_pk_bf16_f32 v248, v248, v249
  v_cvt_pk_bf16_f32 v249, v250, v251
  v_cvt_pk_bf16_f32 v250, v252, v253
  v_cvt_pk_bf16_f32 v251, v254, v255
  v_permlane16_swap_b32 v240, v242
  v_permlane16_swap_b32 v241, v243
  v_permlane16_swap_b32 v248, v250
  v_permlane16_swap_b32 v249, v251
  ds_write_b128 v19, v[240:243] offset:13312
  ds_write_b128 v20, v[248:251] offset:13312
  ds_read_b128 v[40:43], v21 offset:12288
  ds_read_b128 v[44:47], v21 offset:13312
  ds_read_b128 v[48:51], v21 offset:14336
  ds_read_b128 v[52:55], v21 offset:15360
  s_waitcnt lgkmcnt(8)
  buffer_store_dwordx4 v[24:27], v15, s[20:23], s30 offen sc1
  s_add_u32 s30, s30, 32768
  buffer_store_dwordx4 v[28:31], v15, s[20:23], s30 offen sc1
  s_add_u32 s30, s30, 32768
  buffer_store_dwordx4 v[32:35], v15, s[20:23], s30 offen sc1
  s_add_u32 s30, s30, 32768
  buffer_store_dwordx4 v[36:39], v15, s[20:23], s30 offen sc1
  s_add_u32 s30, s30, 32768
  s_waitcnt lgkmcnt(0)
  buffer_store_dwordx4 v[40:43], v15, s[20:23], s30 offen sc1
  s_add_u32 s30, s30, 32768
  buffer_store_dwordx4 v[44:47], v15, s[20:23], s30 offen sc1
  s_add_u32 s30, s30, 32768
  buffer_store_dwordx4 v[48:51], v15, s[20:23], s30 offen sc1
  s_add_u32 s30, s30, 32768
  buffer_store_dwordx4 v[52:55], v15, s[20:23], s30 offen sc1
  s_add_u32 s30, s30, 32768
  s_barrier
  s_branch L_next
L_out_h:
  s_lshr_b32 s30, s26, 2
  s_and_b32 s31, s26, 3
  v_and_b32 v16, 15, v0
  v_lshrrev_b32 v17, 4, v0
  v_lshrrev_b32 v18, 3, v16
  v_and_b32 v19, 7, v16
  v_lshl_add_u32 v19, v18, 4, v19
  s_lshl_b32 s32, s30, 12
  v_lshlrev_b32 v1, 9, v17
  v_lshl_add_u32 v1, v19, 4, v1
  v_add_u32 v1, s32, v1
  v_add_u32 v2, 128, v1
  v_lshlrev_b32 v11, 4, v0
  s_lshr_b32 s32, s26, 1
  s_mul_i32 s32, s32, s29
  s_and_b32 s33, s26, 1
  s_lshl_b32 s33, s33, 10
  s_add_u32 s32, s32, s33
  v_add_u32 v11, s32, v11
  v_add_u32 v12, 1024, v11
  v_bfe_u32 v20, v0, 2, 2
  v_lshrrev_b32 v21, 1, v17
  v_lshl_add_u32 v21, v21, 4, v20
  v_and_b32 v22, 1, v17
  v_lshl_add_u32 v21, v22, 2, v21
  v_lshlrev_b32 v3, 9, v21
  v_bfe_u32 v21, v0, 1, 1
  v_lshlrev_b32 v21, 1, v21
  s_lshl_b32 s32, s31, 3
  v_or_b32 v21, s32, v21
  v_lshlrev_b32 v20, 2, v20
  v_xor_b32 v21, v21, v20
  v_and_b32 v22, 1, v17
  v_mul_u32_u24 v22, 3, v22
  v_xor_b32 v21, v21, v22
  v_lshl_add_u32 v3, v21, 4, v3
  v_and_b32 v21, 1, v0
  v_lshl_add_u32 v3, v21, 3, v3
  v_add_u32 v3, 0x10000, v3
  v_xor_b32 v4, 48, v3
  v_add_u32 v4, 4096, v4
  v_xor_b32 v5, 16, v3
  v_xor_b32 v6, 16, v4
  v_xor_b32 v7, 64, v3
  v_xor_b32 v8, 64, v4
  v_xor_b32 v9, 80, v3
  v_xor_b32 v10, 80, v4
  v_lshrrev_b32 v20, 5, v0
  s_lshl_b32 s32, s26, 2
  v_add_u32 v21, s32, v20
  v_lshlrev_b32 v13, s28, v21
  v_add_u32 v21, 2, v21
  v_lshlrev_b32 v14, s28, v21
  s_lshr_b32 s32, s26, 1
  s_xor_b32 s32, s32, s26
  s_and_b32 s32, s32, 1
  s_mul_i32 s32, s32, 3
  v_lshlrev_b32 v20, 2, v20
  v_and_b32 v21, 31, v0
  v_xor_b32 v21, v21, v20
  v_xor_b32 v21, s32, v21
  v_lshl_add_u32 v13, v21, 4, v13
  v_xor_b32 v21, 8, v21
  v_lshl_add_u32 v14, v21, 4, v14
  s_lshl_b32 s41, s26, 10
  s_lshl_b32 s42, s26, 11
  s_add_u32 s42, s42, 0x10000
  s_branch L_gemm_t2
L_out_epi2:
  s_lshr_b32 s30, s26, 2
  s_and_b32 s31, s26, 3
  s_lshl_b32 s30, s30, 18
  s_lshl_b32 s31, s31, 7
  s_add_u32 s30, s30, s31
  s_add_u32 s30, s30, s45
  s_lshl_b32 s31, s26, 14
  v_and_b32 v16, 15, v0
  v_lshrrev_b32 v17, 4, v0
  v_lshrrev_b32 v18, 3, v16
  v_and_b32 v16, 7, v16
  v_xor_b32 v17, v17, v16
  v_lshl_add_u32 v16, v18, 4, v16
  v_lshlrev_b32 v19, 7, v16
  v_lshl_add_u32 v19, v17, 4, v19
  v_add_u32 v19, s31, v19
  v_xor_b32 v20, 64, v19
  v_lshrrev_b32 v16, 3, v0
  v_and_b32 v17, 7, v0
  v_lshlrev_b32 v15, 12, v16
  v_lshl_add_u32 v15, v17, 4, v15
  v_xor_b32 v17, v17, v16
  v_lshlrev_b32 v21, 7, v16
  v_lshl_add_u32 v21, v17, 4, v21
  v_add_u32 v21, s31, v21
  v_cvt_pk_bf16_f32 v128, v128, v129
  v_cvt_pk_bf16_f32 v129, v130, v131
  v_cvt_pk_bf16_f32 v130, v132, v133
  v_cvt_pk_bf16_f32 v131, v134, v135
  v_cvt_pk_bf16_f32 v136, v136, v137
  v_cvt_pk_bf16_f32 v137, v138, v139
  v_cvt_pk_bf16_f32 v138, v140, v141
  v_cvt_pk_bf16_f32 v139, v142, v143
  v_permlane16_swap_b32 v128, v130
  v_permlane16_swap_b32 v129, v131
  v_permlane16_swap_b32 v136, v138
  v_permlane16_swap_b32 v137, v139
  s_waitcnt vmcnt(0)
  s_barrier
  ds_write_b128 v19, v[128:131] offset:0
  ds_write_b128 v20, v[136:139] offset:0
  v_cvt_pk_bf16_f32 v144, v144, v145
  v_cvt_pk_bf16_f32 v145, v146, v147
  v_cvt_pk_bf16_f32 v146, v148, v149
  v_cvt_pk_bf16_f32 v147, v150, v151
  v_cvt_pk_bf16_f32 v152, v152, v153
  v_cvt_pk_bf16_f32 v153, v154, v155
  v_cvt_pk_bf16_f32 v154, v156, v157
  v_cvt_pk_bf16_f32 v155, v158, v159
  v_permlane16_swap_b32 v144, v146
  v_permlane16_swap_b32 v145, v147
  v_permlane16_swap_b32 v152, v154
  v_permlane16_swap_b32 v153, v155
  ds_write_b128 v19, v[144:147] offset:1024
  ds_write_b128 v20, v[152:155] offset:1024
  ds_read_b128 v[24:27], v21 offset:0
  ds_read_b128 v[28:31], v21 offset:1024
  ds_read_b128 v[32:35], v21 offset:2048
  ds_read_b128 v[36:39], v21 offset:3072
  v_cvt_pk_bf16_f32 v160, v160, v161
  v_cvt_pk_bf16_f32 v161, v162, v163
  v_cvt_pk_bf16_f32 v162, v164, v165
  v_cvt_pk_bf16_f32 v163, v166, v167
  v_cvt_pk_bf16_f32 v168, v168, v169
  v_cvt_pk_bf16_f32 v169, v170, v171
  v_cvt_pk_bf16_f32 v170, v172, v173
  v_cvt_pk_bf16_f32 v171, v174, v175
  v_permlane16_swap_b32 v160, v162
  v_permlane16_swap_b32 v161, v163
  v_permlane16_swap_b32 v168, v170
  v_permlane16_swap_b32 v169, v171
  ds_write_b128 v19, v[160:163] offset:4096
  ds_write_b128 v20, v[168:171] offset:4096
  v_cvt_pk_bf16_f32 v176, v176, v177
  v_cvt_pk_bf16_f32 v177, v178, v179
  v_cvt_pk_bf16_f32 v178, v180, v181
  v_cvt_pk_bf16_f32 v179, v182, v183
  v_cvt_pk_bf16_f32 v184, v184, v185
  v_cvt_pk_bf16_f32 v185, v186, v187
  v_cvt_pk_bf16_f32 v186, v188, v189
  v_cvt_pk_bf16_f32 v187, v190, v191
  v_permlane16_swap_b32 v176, v178
  v_permlane16_swap_b32 v177, v179
  v_permlane16_swap_b32 v184, v186
  v_permlane16_swap_b32 v185, v187
  ds_write_b128 v19, v[176:179] offset:5120
  ds_write_b128 v20, v[184:187] offset:5120
  ds_read_b128 v[40:43], v21 offset:4096
  ds_read_b128 v[44:47], v21 offset:5120
  ds_read_b128 v[48:51], v21 offset:6144
  ds_read_b128 v[52:55], v21 offset:7168
  s_waitcnt lgkmcnt(8)
  buffer_store_dwordx4 v[24:27], v15, s[20:23], s30 offen sc1
  s_add_u32 s30, s30, 32768
  buffer_store_dwordx4 v[28:31], v15, s[20:23], s30 offen sc1
  s_add_u32 s30, s30, 32768
  buffer_store_dwordx4 v[32:35], v15, s[20:23], s30 offen sc1
  s_add_u32 s30, s30, 32768
  buffer_store_dwordx4 v[36:39], v15, s[20:23], s30 offen sc1
  s_add_u32 s30, s30, 32768
  s_waitcnt lgkmcnt(0)
  buffer_store_dwordx4 v[40:43], v15, s[20:23], s30 offen sc1
  s_add_u32 s30, s30, 32768
  buffer_store_dwordx4 v[44:47], v15, s[20:23], s30 offen sc1
  s_add_u32 s30, s30, 32768
  buffer_store_dwordx4 v[48:51], v15, s[20:23], s30 offen sc1
  s_add_u32 s30, s30, 32768
  buffer_store_dwordx4 v[52:55], v15, s[20:23], s30 offen sc1
  s_add_u32 s30, s30, 32768
  s_barrier
  s_branch L_next
L_T_KVA:
  s_load_dwordx2 s[12:13], s[0:1], 0
  s_load_dwordx2 s[16:17], s[0:1], 16
  s_load_dwordx2 s[20:21], s[0:1], 24
  v_and_b32 v10, 15, v0
  v_lshrrev_b32 v11, 4, v0
  v_lshlrev_b32 v1, 4, v0
  v_lshlrev_b32 v2, 11, v10
  v_lshl_add_u32 v2, v11, 4, v2
  s_lshl_b32 s28, s88, 3
  s_add_u32 s28, s28, s26
  s_lshl_b32 s29, s28, 15
  s_lshl_b32 s30, s26, 13
  s_waitcnt lgkmcnt(0)
  s_and_b32 s13, s13, 0xffff
  s_mov_b32 s14, 0x400000
  s_mov_b32 s15, 0x20000
  s_and_b32 s17, s17, 0xffff
  s_mov_b32 s18, 0x10000
  s_mov_b32 s19, 0x20000
  s_and_b32 s21, s21, 0xffff
  s_mov_b32 s22, 0x10000
  s_mov_b32 s23, 0x20000
  s_add_u32 s31, s30, 0
  s_mov_b32 m0, s31
  s_nop 0
  buffer_load_dwordx4 v1, s[16:19], s31 offen lds
  s_add_u32 m0, s31, 0x10000
  s_nop 0
  buffer_load_dwordx4 v1, s[20:23], s31 offen lds
  s_add_u32 s31, s30, 1024
  s_mov_b32 m0, s31
  s_nop 0
  buffer_load_dwordx4 v1, s[16:19], s31 offen lds
  s_add_u32 m0, s31, 0x10000
  s_nop 0
  buffer_load_dwordx4 v1, s[20:23], s31 offen lds
  s_add_u32 s31, s30, 2048
  s_mov_b32 m0, s31
  s_nop 0
  buffer_load_dwordx4 v1, s[16:19], s31 offen lds
  s_add_u32 m0, s31, 0x10000
  s_nop 0
  buffer_load_dwordx4 v1, s[20:23], s31 offen lds
  s_add_u32 s31, s30, 3072
  s_mov_b32 m0, s31
  s_nop 0
  buffer_load_dwordx4 v1, s[16:19], s31 offen lds
  s_add_u32 m0, s31, 0x10000
  s_nop 0
  buffer_load_dwordx4 v1, s[20:23], s31 offen lds
  s_add_u32 s31, s30, 4096
  s_mov_b32 m0, s31
  s_nop 0
  buffer_load_dwordx4 v1, s[16:19], s31 offen lds
  s_add_u32 m0, s31, 0x10000
  s_nop 0
  buffer_load_dwordx4 v1, s[20:23], s31 offen lds
  s_add_u32 s31, s30, 5120
  s_mov_b32 m0, s31
  s_nop 0
  buffer_load_dwordx4 v1, s[16:19], s31 offen lds
  s_add_u32 m0, s31, 0x10000
  s_nop 0
  buffer_load_dwordx4 v1, s[20:23], s31 offen lds
  s_add_u32 s31, s30, 6144
  s_mov_b32 m0, s31
  s_nop 0
  buffer_load_dwordx4 v1, s[16:19], s31 offen lds
  s_add_u32 m0, s31, 0x10000
  s_nop 0
  buffer_load_dwordx4 v1, s[20:23], s31 offen lds
  s_add_u32 s31, s30, 7168
  s_mov_b32 m0, s31
  s_nop 0
  buffer_load_dwordx4 v1, s[16:19], s31 offen lds
  s_add_u32 m0, s31, 0x10000
  s_nop 0
  buffer_load_dwordx4 v1, s[20:23], s31 offen lds
  buffer_load_dwordx4 v[128:131], v2, s[12:15], s29 offen offset:0
  buffer_load_dwordx4 v[132:135], v2, s[12:15], s29 offen offset:64
  buffer_load_dwordx4 v[136:139], v2, s[12:15], s29 offen offset:128
  buffer_load_dwordx4 v[140:143], v2, s[12:15], s29 offen offset:192
  buffer_load_dwordx4 v[144:147], v2, s[12:15], s29 offen offset:256
  buffer_load_dwordx4 v[148:151], v2, s[12:15], s29 offen offset:320
  buffer_load_dwordx4 v[152:155], v2, s[12:15], s29 offen offset:384
  buffer_load_dwordx4 v[156:159], v2, s[12:15], s29 offen offset:448
  buffer_load_dwordx4 v[160:163], v2, s[12:15], s29 offen offset:512
  buffer_load_dwordx4 v[164:167], v2, s[12:15], s29 offen offset:576
  buffer_load_dwordx4 v[168:171], v2, s[12:15], s29 offen offset:640
  buffer_load_dwordx4 v[172:175], v2, s[12:15], s29 offen offset:704
  buffer_load_dwordx4 v[176:179], v2, s[12:15], s29 offen offset:768
  buffer_load_dwordx4 v[180:183], v2, s[12:15], s29 offen offset:832
  buffer_load_dwordx4 v[184:187], v2, s[12:15], s29 offen offset:896
  buffer_load_dwordx4 v[188:191], v2, s[12:15], s29 offen offset:960
  buffer_load_dwordx4 v[192:195], v2, s[12:15], s29 offen offset:1024
  buffer_load_dwordx4 v[196:199], v2, s[12:15], s29 offen offset:1088
  buffer_load_dwordx4 v[200:203], v2, s[12:15], s29 offen offset:1152
  buffer_load_dwordx4 v[204:207], v2, s[12:15], s29 offen offset:1216
  buffer_load_dwordx4 v[208:211], v2, s[12:15], s29 offen offset:1280
  buffer_load_dwordx4 v[212:215], v2, s[12:15], s29 offen offset:1344
  buffer_load_dwordx4 v[216:219], v2, s[12:15], s29 offen offset:1408
  buffer_load_dwordx4 v[220:223], v2, s[12:15], s29 offen offset:1472
  buffer_load_dwordx4 v[224:227], v2, s[12:15], s29 offen offset:1536
  buffer_load_dwordx4 v[228:231], v2, s[12:15], s29 offen offset:1600
  buffer_load_dwordx4 v[232:235], v2, s[12:15], s29 offen offset:1664
  buffer_load_dwordx4 v[236:239], v2, s[12:15], s29 offen offset:1728
  buffer_load_dwordx4 v[240:243], v2, s[12:15], s29 offen offset:1792
  buffer_load_dwordx4 v[244:247], v2, s[12:15], s29 offen offset:1856
  buffer_load_dwordx4 v[248:251], v2, s[12:15], s29 offen offset:1920
  buffer_load_dwordx4 v[252:255], v2, s[12:15], s29 offen offset:1984
  v_bfe_u32 v5, v0, 2, 2
  v_lshl_add_u32 v5, v11, 3, v5
  v_lshlrev_b32 v3, 6, v5
  v_and_b32 v5, 3, v0
  v_lshl_add_u32 v4, v5, 3, v3
  v_add_u32 v4, 0x10000, v4
  v_and_b32 v5, 1, v0
  v_lshl_add_u32 v3, v5, 3, v3
  v_bfe_u32 v5, v0, 1, 1
  v_lshl_add_u32 v3, v5, 5, v3
  v_mov_b32 v16, 0
  v_mov_b32 v17, 0
  v_mov_b32 v18, 0
  v_mov_b32 v19, 0
  v_mov_b32 v20, 0
  v_mov_b32 v21, 0
  v_mov_b32 v22, 0
  v_mov_b32 v23, 0
  v_mov_b32 v24, 0
  v_mov_b32 v25, 0
  v_mov_b32 v26, 0
  v_mov_b32 v27, 0
  v_mov_b32 v28, 0
  v_mov_b32 v29, 0
  v_mov_b32 v30, 0
  v_mov_b32 v31, 0
  s_waitcnt vmcnt(32)
  s_barrier
  ds_read_b64_tr_b16 v[32:33], v3 offset:0
  ds_read_b64_tr_b16 v[34:35], v3 offset:256
  ds_read_b64_tr_b16 v[36:37], v3 offset:16
  ds_read_b64_tr_b16 v[38:39], v3 offset:272
  ds_read_b64_tr_b16 v[40:41], v4 offset:0
  ds_read_b64_tr_b16 v[42:43], v4 offset:256
  ds_read_b64_tr_b16 v[44:45], v4 offset:32
  ds_read_b64_tr_b16 v[46:47], v4 offset:288
  ds_read_b64_tr_b16 v[48:49], v3 offset:2048
  ds_read_b64_tr_b16 v[50:51], v3 offset:2304
  ds_read_b64_tr_b16 v[52:53], v3 offset:2064
  ds_read_b64_tr_b16 v[54:55], v3 offset:2320
  ds_read_b64_tr_b16 v[56:57], v4 offset:2048
  ds_read_b64_tr_b16 v[58:59], v4 offset:2304
  ds_read_b64_tr_b16 v[60:61], v4 offset:2080
  ds_read_b64_tr_b16 v[62:63], v4 offset:2336
  s_waitcnt vmcnt(31) lgkmcnt(8)
  v_mfma_f32_16x16x32_bf16 v[16:19], v[32:35], v[128:131], v[16:19]
  v_mfma_f32_16x16x32_bf16 v[20:23], v[36:39], v[128:131], v[20:23]
  v_mfma_f32_16x16x32_bf16 v[24:27], v[128:131], v[40:43], v[24:27]
  v_mfma_f32_16x16x32_bf16 v[28:31], v[128:131], v[44:47], v[28:31]
  ds_read_b64_tr_b16 v[32:33], v3 offset:4096
  ds_read_b64_tr_b16 v[34:35], v3 offset:4352
  ds_read_b64_tr_b16 v[36:37], v3 offset:4112
  ds_read_b64_tr_b16 v[38:39], v3 offset:4368
  ds_read_b64_tr_b16 v[40:41], v4 offset:4096
  ds_read_b64_tr_b16 v[42:43], v4 offset:4352
  ds_read_b64_tr_b16 v[44:45], v4 offset:4128
  ds_read_b64_tr_b16 v[46:47], v4 offset:4384
  s_waitcnt vmcnt(30) lgkmcnt(8)
  v_mfma_f32_16x16x32_bf16 v[16:19], v[48:51], v[132:135], v[16:19]
  v_mfma_f32_16x16x32_bf16 v[20:23], v[52:55], v[132:135], v[20:23]
  v_mfma_f32_16x16x32_bf16 v[24:27], v[132:135], v[56:59], v[24:27]
  v_mfma_f32_16x16x32_bf16 v[28:31], v[132:135], v[60:63], v[28:31]
  ds_read_b64_tr_b16 v[48:49], v3 offset:6144
  ds_read_b64_tr_b16 v[50:51], v3 offset:6400
  ds_read_b64_tr_b16 v[52:53], v3 offset:6160
  ds_read_b64_tr_b16 v[54:55], v3 offset:6416
  ds_read_b64_tr_b16 v[56:57], v4 offset:6144
  ds_read_b64_tr_b16 v[58:59], v4 offset:6400
  ds_read_b64_tr_b16 v[60:61], v4 offset:6176
  ds_read_b64_tr_b16 v[62:63], v4 offset:6432
  s_waitcnt vmcnt(29) lgkmcnt(8)
  v_mfma_f32_16x16x32_bf16 v[16:19], v[32:35], v[136:139], v[16:19]
  v_mfma_f32_16x16x32_bf16 v[20:23], v[36:39], v[136:139], v[20:23]
  v_mfma_f32_16x16x32_bf16 v[24:27], v[136:139], v[40:43], v[24:27]
  v_mfma_f32_16x16x32_bf16 v[28:31], v[136:139], v[44:47], v[28:31]
  ds_read_b64_tr_b16 v[32:33], v3 offset:8192
  ds_read_b64_tr_b16 v[34:35], v3 offset:8448
  ds_read_b64_tr_b16 v[36:37], v3 offset:8208
  ds_read_b64_tr_b16 v[38:39], v3 offset:8464
  ds_read_b64_tr_b16 v[40:41], v4 offset:8192
  ds_read_b64_tr_b16 v[42:43], v4 offset:8448
  ds_read_b64_tr_b16 v[44:45], v4 offset:8224
  ds_read_b64_tr_b16 v[46:47], v4 offset:8480
  s_waitcnt vmcnt(28) lgkmcnt(8)
  v_mfma_f32_16x16x32_bf16 v[16:19], v[48:51], v[140:143], v[16:19]
  v_mfma_f32_16x16x32_bf16 v[20:23], v[52:55], v[140:143], v[20:23]
  v_mfma_f32_16x16x32_bf16 v[24:27], v[140:143], v[56:59], v[24:27]
  v_mfma_f32_16x16x32_bf16 v[28:31], v[140:143], v[60:63], v[28:31]
  ds_read_b64_tr_b16 v[48:49], v3 offset:10240
  ds_read_b64_tr_b16 v[50:51], v3 offset:10496
  ds_read_b64_tr_b16 v[52:53], v3 offset:10256
  ds_read_b64_tr_b16 v[54:55], v3 offset:10512
  ds_read_b64_tr_b16 v[56:57], v4 offset:10240
  ds_read_b64_tr_b16 v[58:59], v4 offset:10496
  ds_read_b64_tr_b16 v[60:61], v4 offset:10272
  ds_read_b64_tr_b16 v[62:63], v4 offset:10528
  s_waitcnt vmcnt(27) lgkmcnt(8)
  v_mfma_f32_16x16x32_bf16 v[16:19], v[32:35], v[144:147], v[16:19]
  v_mfma_f32_16x16x32_bf16 v[20:23], v[36:39], v[144:147], v[20:23]
  v_mfma_f32_16x16x32_bf16 v[24:27], v[144:147], v[40:43], v[24:27]
  v_mfma_f32_16x16x32_bf16 v[28:31], v[144:147], v[44:47], v[28:31]
  ds_read_b64_tr_b16 v[32:33], v3 offset:12288
  ds_read_b64_tr_b16 v[34:35], v3 offset:12544
  ds_read_b64_tr_b16 v[36:37], v3 offset:12304
  ds_read_b64_tr_b16 v[38:39], v3 offset:12560
  ds_read_b64_tr_b16 v[40:41], v4 offset:12288
  ds_read_b64_tr_b16 v[42:43], v4 offset:12544
  ds_read_b64_tr_b16 v[44:45], v4 offset:12320
  ds_read_b64_tr_b16 v[46:47], v4 offset:12576
  s_waitcnt vmcnt(26) lgkmcnt(8)
  v_mfma_f32_16x16x32_bf16 v[16:19], v[48:51], v[148:151], v[16:19]
  v_mfma_f32_16x16x32_bf16 v[20:23], v[52:55], v[148:151], v[20:23]
  v_mfma_f32_16x16x32_bf16 v[24:27], v[148:151], v[56:59], v[24:27]
  v_mfma_f32_16x16x32_bf16 v[28:31], v[148:151], v[60:63], v[28:31]
  ds_read_b64_tr_b16 v[48:49], v3 offset:14336
  ds_read_b64_tr_b16 v[50:51], v3 offset:14592
  ds_read_b64_tr_b16 v[52:53], v3 offset:14352
  ds_read_b64_tr_b16 v[54:55], v3 offset:14608
  ds_read_b64_tr_b16 v[56:57], v4 offset:14336
  ds_read_b64_tr_b16 v[58:59], v4 offset:14592
  ds_read_b64_tr_b16 v[60:61], v4 offset:14368
  ds_read_b64_tr_b16 v[62:63], v4 offset:14624
  s_waitcnt vmcnt(25) lgkmcnt(8)
  v_mfma_f32_16x16x32_bf16 v[16:19], v[32:35], v[152:155], v[16:19]
  v_mfma_f32_16x16x32_bf16 v[20:23], v[36:39], v[152:155], v[20:23]
  v_mfma_f32_16x16x32_bf16 v[24:27], v[152:155], v[40:43], v[24:27]
  v_mfma_f32_16x16x32_bf16 v[28:31], v[152:155], v[44:47], v[28:31]
  ds_read_b64_tr_b16 v[32:33], v3 offset:16384
  ds_read_b64_tr_b16 v[34:35], v3 offset:16640
  ds_read_b64_tr_b16 v[36:37], v3 offset:16400
  ds_read_b64_tr_b16 v[38:39], v3 offset:16656
  ds_read_b64_tr_b16 v[40:41], v4 offset:16384
  ds_read_b64_tr_b16 v[42:43], v4 offset:16640
  ds_read_b64_tr_b16 v[44:45], v4 offset:16416
  ds_read_b64_tr_b16 v[46:47], v4 offset:16672
  s_waitcnt vmcnt(24) lgkmcnt(8)
  v_mfma_f32_16x16x32_bf16 v[16:19], v[48:51], v[156:159], v[16:19]
  v_mfma_f32_16x16x32_bf16 v[20:23], v[52:55], v[156:159], v[20:23]
  v_mfma_f32_16x16x32_bf16 v[24:27], v[156:159], v[56:59], v[24:27]
  v_mfma_f32_16x16x32_bf16 v[28:31], v[156:159], v[60:63], v[28:31]
  ds_read_b64_tr_b16 v[48:49], v3 offset:18432
  ds_read_b64_tr_b16 v[50:51], v3 offset:18688
  ds_read_b64_tr_b16 v[52:53], v3 offset:18448
  ds_read_b64_tr_b16 v[54:55], v3 offset:18704
  ds_read_b64_tr_b16 v[56:57], v4 offset:18432
  ds_read_b64_tr_b16 v[58:59], v4 offset:18688
  ds_read_b64_tr_b16 v[60:61], v4 offset:18464
  ds_read_b64_tr_b16 v[62:63], v4 offset:18720
  s_waitcnt vmcnt(23) lgkmcnt(8)
  v_mfma_f32_16x16x32_bf16 v[16:19], v[32:35], v[160:163], v[16:19]
  v_mfma_f32_16x16x32_bf16 v[20:23], v[36:39], v[160:163], v[20:23]
  v_mfma_f32_16x16x32_bf16 v[24:27], v[160:163], v[40:43], v[24:27]
  v_mfma_f32_16x16x32_bf16 v[28:31], v[160:163], v[44:47], v[28:31]
  ds_read_b64_tr_b16 v[32:33], v3 offset:20480
  ds_read_b64_tr_b16 v[34:35], v3 offset:20736
  ds_read_b64_tr_b16 v[36:37], v3 offset:20496
  ds_read_b64_tr_b16 v[38:39], v3 offset:20752
  ds_read_b64_tr_b16 v[40:41], v4 offset:20480
  ds_read_b64_tr_b16 v[42:43], v4 offset:20736
  ds_read_b64_tr_b16 v[44:45], v4 offset:20512
  ds_read_b64_tr_b16 v[46:47], v4 offset:20768
  s_waitcnt vmcnt(22) lgkmcnt(8)
  v_mfma_f32_16x16x32_bf16 v[16:19], v[48:51], v[164:167], v[16:19]
  v_mfma_f32_16x16x32_bf16 v[20:23], v[52:55], v[164:167], v[20:23]
  v_mfma_f32_16x16x32_bf16 v[24:27], v[164:167], v[56:59], v[24:27]
  v_mfma_f32_16x16x32_bf16 v[28:31], v[164:167], v[60:63], v[28:31]
  ds_read_b64_tr_b16 v[48:49], v3 offset:22528
  ds_read_b64_tr_b16 v[50:51], v3 offset:22784
  ds_read_b64_tr_b16 v[52:53], v3 offset:22544
  ds_read_b64_tr_b16 v[54:55], v3 offset:22800
  ds_read_b64_tr_b16 v[56:57], v4 offset:22528
  ds_read_b64_tr_b16 v[58:59], v4 offset:22784
  ds_read_b64_tr_b16 v[60:61], v4 offset:22560
  ds_read_b64_tr_b16 v[62:63], v4 offset:22816
  s_waitcnt vmcnt(21) lgkmcnt(8)
  v_mfma_f32_16x16x32_bf16 v[16:19], v[32:35], v[168:171], v[16:19]
  v_mfma_f32_16x16x32_bf16 v[20:23], v[36:39], v[168:171], v[20:23]
  v_mfma_f32_16x16x32_bf16 v[24:27], v[168:171], v[40:43], v[24:27]
  v_mfma_f32_16x16x32_bf16 v[28:31], v[168:171], v[44:47], v[28:31]
  ds_read_b64_tr_b16 v[32:33], v3 offset:24576
  ds_read_b64_tr_b16 v[34:35], v3 offset:24832
  ds_read_b64_tr_b16 v[36:37], v3 offset:24592
  ds_read_b64_tr_b16 v[38:39], v3 offset:24848
  ds_read_b64_tr_b16 v[40:41], v4 offset:24576
  ds_read_b64_tr_b16 v[42:43], v4 offset:24832
  ds_read_b64_tr_b16 v[44:45], v4 offset:24608
  ds_read_b64_tr_b16 v[46:47], v4 offset:24864
  s_waitcnt vmcnt(20) lgkmcnt(8)
  v_mfma_f32_16x16x32_bf16 v[16:19], v[48:51], v[172:175], v[16:19]
  v_mfma_f32_16x16x32_bf16 v[20:23], v[52:55], v[172:175], v[20:23]
  v_mfma_f32_16x16x32_bf16 v[24:27], v[172:175], v[56:59], v[24:27]
  v_mfma_f32_16x16x32_bf16 v[28:31], v[172:175], v[60:63], v[28:31]
  ds_read_b64_tr_b16 v[48:49], v3 offset:26624
  ds_read_b64_tr_b16 v[50:51], v3 offset:26880
  ds_read_b64_tr_b16 v[52:53], v3 offset:26640
  ds_read_b64_tr_b16 v[54:55], v3 offset:26896
  ds_read_b64_tr_b16 v[56:57], v4 offset:26624
  ds_read_b64_tr_b16 v[58:59], v4 offset:26880
  ds_read_b64_tr_b16 v[60:61], v4 offset:26656
  ds_read_b64_tr_b16 v[62:63], v4 offset:26912
  s_waitcnt vmcnt(19) lgkmcnt(8)
  v_mfma_f32_16x16x32_bf16 v[16:19], v[32:35], v[176:179], v[16:19]
  v_mfma_f32_16x16x32_bf16 v[20:23], v[36:39], v[176:179], v[20:23]
  v_mfma_f32_16x16x32_bf16 v[24:27], v[176:179], v[40:43], v[24:27]
  v_mfma_f32_16x16x32_bf16 v[28:31], v[176:179], v[44:47], v[28:31]
  ds_read_b64_tr_b16 v[32:33], v3 offset:28672
  ds_read_b64_tr_b16 v[34:35], v3 offset:28928
  ds_read_b64_tr_b16 v[36:37], v3 offset:28688
  ds_read_b64_tr_b16 v[38:39], v3 offset:28944
  ds_read_b64_tr_b16 v[40:41], v4 offset:28672
  ds_read_b64_tr_b16 v[42:43], v4 offset:28928
  ds_read_b64_tr_b16 v[44:45], v4 offset:28704
  ds_read_b64_tr_b16 v[46:47], v4 offset:28960
  s_waitcnt vmcnt(18) lgkmcnt(8)
  v_mfma_f32_16x16x32_bf16 v[16:19], v[48:51], v[180:183], v[16:19]
  v_mfma_f32_16x16x32_bf16 v[20:23], v[52:55], v[180:183], v[20:23]
  v_mfma_f32_16x16x32_bf16 v[24:27], v[180:183], v[56:59], v[24:27]
  v_mfma_f32_16x16x32_bf16 v[28:31], v[180:183], v[60:63], v[28:31]
  ds_read_b64_tr_b16 v[48:49], v3 offset:30720
  ds_read_b64_tr_b16 v[50:51], v3 offset:30976
  ds_read_b64_tr_b16 v[52:53], v3 offset:30736
  ds_read_b64_tr_b16 v[54:55], v3 offset:30992
  ds_read_b64_tr_b16 v[56:57], v4 offset:30720
  ds_read_b64_tr_b16 v[58:59], v4 offset:30976
  ds_read_b64_tr_b16 v[60:61], v4 offset:30752
  ds_read_b64_tr_b16 v[62:63], v4 offset:31008
  s_waitcnt vmcnt(17) lgkmcnt(8)
  v_mfma_f32_16x16x32_bf16 v[16:19], v[32:35], v[184:187], v[16:19]
  v_mfma_f32_16x16x32_bf16 v[20:23], v[36:39], v[184:187], v[20:23]
  v_mfma_f32_16x16x32_bf16 v[24:27], v[184:187], v[40:43], v[24:27]
  v_mfma_f32_16x16x32_bf16 v[28:31], v[184:187], v[44:47], v[28:31]
  ds_read_b64_tr_b16 v[32:33], v3 offset:32768
  ds_read_b64_tr_b16 v[34:35], v3 offset:33024
  ds_read_b64_tr_b16 v[36:37], v3 offset:32784
  ds_read_b64_tr_b16 v[38:39], v3 offset:33040
  ds_read_b64_tr_b16 v[40:41], v4 offset:32768
  ds_read_b64_tr_b16 v[42:43], v4 offset:33024
  ds_read_b64_tr_b16 v[44:45], v4 offset:32800
  ds_read_b64_tr_b16 v[46:47], v4 offset:33056
  s_waitcnt vmcnt(16) lgkmcnt(8)
  v_mfma_f32_16x16x32_bf16 v[16:19], v[48:51], v[188:191], v[16:19]
  v_mfma_f32_16x16x32_bf16 v[20:23], v[52:55], v[188:191], v[20:23]
  v_mfma_f32_16x16x32_bf16 v[24:27], v[188:191], v[56:59], v[24:27]
  v_mfma_f32_16x16x32_bf16 v[28:31], v[188:191], v[60:63], v[28:31]
  ds_read_b64_tr_b16 v[48:49], v3 offset:34816
  ds_read_b64_tr_b16 v[50:51], v3 offset:35072
  ds_read_b64_tr_b16 v[52:53], v3 offset:34832
  ds_read_b64_tr_b16 v[54:55], v3 offset:35088
  ds_read_b64_tr_b16 v[56:57], v4 offset:34816
  ds_read_b64_tr_b16 v[58:59], v4 offset:35072
  ds_read_b64_tr_b16 v[60:61], v4 offset:34848
  ds_read_b64_tr_b16 v[62:63], v4 offset:35104
  s_waitcnt vmcnt(15) lgkmcnt(8)
  v_mfma_f32_16x16x32_bf16 v[16:19], v[32:35], v[192:195], v[16:19]
  v_mfma_f32_16x16x32_bf16 v[20:23], v[36:39], v[192:195], v[20:23]
  v_mfma_f32_16x16x32_bf16 v[24:27], v[192:195], v[40:43], v[24:27]
  v_mfma_f32_16x16x32_bf16 v[28:31], v[192:195], v[44:47], v[28:31]
  ds_read_b64_tr_b16 v[32:33], v3 offset:36864
  ds_read_b64_tr_b16 v[34:35], v3 offset:37120
  ds_read_b64_tr_b16 v[36:37], v3 offset:36880
  ds_read_b64_tr_b16 v[38:39], v3 offset:37136
  ds_read_b64_tr_b16 v[40:41], v4 offset:36864
  ds_read_b64_tr_b16 v[42:43], v4 offset:37120
  ds_read_b64_tr_b16 v[44:45], v4 offset:36896
  ds_read_b64_tr_b16 v[46:47], v4 offset:37152
  s_waitcnt vmcnt(14) lgkmcnt(8)
  v_mfma_f32_16x16x32_bf16 v[16:19], v[48:51], v[196:199], v[16:19]
  v_mfma_f32_16x16x32_bf16 v[20:23], v[52:55], v[196:199], v[20:23]
  v_mfma_f32_16x16x32_bf16 v[24:27], v[196:199], v[56:59], v[24:27]
  v_mfma_f32_16x16x32_bf16 v[28:31], v[196:199], v[60:63], v[28:31]
  ds_read_b64_tr_b16 v[48:49], v3 offset:38912
  ds_read_b64_tr_b16 v[50:51], v3 offset:39168
  ds_read_b64_tr_b16 v[52:53], v3 offset:38928
  ds_read_b64_tr_b16 v[54:55], v3 offset:39184
  ds_read_b64_tr_b16 v[56:57], v4 offset:38912
  ds_read_b64_tr_b16 v[58:59], v4 offset:39168
  ds_read_b64_tr_b16 v[60:61], v4 offset:38944
  ds_read_b64_tr_b16 v[62:63], v4 offset:39200
  s_waitcnt vmcnt(13) lgkmcnt(8)
  v_mfma_f32_16x16x32_bf16 v[16:19], v[32:35], v[200:203], v[16:19]
  v_mfma_f32_16x16x32_bf16 v[20:23], v[36:39], v[200:203], v[20:23]
  v_mfma_f32_16x16x32_bf16 v[24:27], v[200:203], v[40:43], v[24:27]
  v_mfma_f32_16x16x32_bf16 v[28:31], v[200:203], v[44:47], v[28:31]
  ds_read_b64_tr_b16 v[32:33], v3 offset:40960
  ds_read_b64_tr_b16 v[34:35], v3 offset:41216
  ds_read_b64_tr_b16 v[36:37], v3 offset:40976
  ds_read_b64_tr_b16 v[38:39], v3 offset:41232
  ds_read_b64_tr_b16 v[40:41], v4 offset:40960
  ds_read_b64_tr_b16 v[42:43], v4 offset:41216
  ds_read_b64_tr_b16 v[44:45], v4 offset:40992
  ds_read_b64_tr_b16 v[46:47], v4 offset:41248
  s_waitcnt vmcnt(12) lgkmcnt(8)
  v_mfma_f32_16x16x32_bf16 v[16:19], v[48:51], v[204:207], v[16:19]
  v_mfma_f32_16x16x32_bf16 v[20:23], v[52:55], v[204:207], v[20:23]
  v_mfma_f32_16x16x32_bf16 v[24:27], v[204:207], v[56:59], v[24:27]
  v_mfma_f32_16x16x32_bf16 v[28:31], v[204:207], v[60:63], v[28:31]
  ds_read_b64_tr_b16 v[48:49], v3 offset:43008
  ds_read_b64_tr_b16 v[50:51], v3 offset:43264
  ds_read_b64_tr_b16 v[52:53], v3 offset:43024
  ds_read_b64_tr_b16 v[54:55], v3 offset:43280
  ds_read_b64_tr_b16 v[56:57], v4 offset:43008
  ds_read_b64_tr_b16 v[58:59], v4 offset:43264
  ds_read_b64_tr_b16 v[60:61], v4 offset:43040
  ds_read_b64_tr_b16 v[62:63], v4 offset:43296
  s_waitcnt vmcnt(11) lgkmcnt(8)
  v_mfma_f32_16x16x32_bf16 v[16:19], v[32:35], v[208:211], v[16:19]
  v_mfma_f32_16x16x32_bf16 v[20:23], v[36:39], v[208:211], v[20:23]
  v_mfma_f32_16x16x32_bf16 v[24:27], v[208:211], v[40:43], v[24:27]
  v_mfma_f32_16x16x32_bf16 v[28:31], v[208:211], v[44:47], v[28:31]
  ds_read_b64_tr_b16 v[32:33], v3 offset:45056
  ds_read_b64_tr_b16 v[34:35], v3 offset:45312
  ds_read_b64_tr_b16 v[36:37], v3 offset:45072
  ds_read_b64_tr_b16 v[38:39], v3 offset:45328
  ds_read_b64_tr_b16 v[40:41], v4 offset:45056
  ds_read_b64_tr_b16 v[42:43], v4 offset:45312
  ds_read_b64_tr_b16 v[44:45], v4 offset:45088
  ds_read_b64_tr_b16 v[46:47], v4 offset:45344
  s_waitcnt vmcnt(10) lgkmcnt(8)
  v_mfma_f32_16x16x32_bf16 v[16:19], v[48:51], v[212:215], v[16:19]
  v_mfma_f32_16x16x32_bf16 v[20:23], v[52:55], v[212:215], v[20:23]
  v_mfma_f32_16x16x32_bf16 v[24:27], v[212:215], v[56:59], v[24:27]
  v_mfma_f32_16x16x32_bf16 v[28:31], v[212:215], v[60:63], v[28:31]
  ds_read_b64_tr_b16 v[48:49], v3 offset:47104
  ds_read_b64_tr_b16 v[50:51], v3 offset:47360
  ds_read_b64_tr_b16 v[52:53], v3 offset:47120
  ds_read_b64_tr_b16 v[54:55], v3 offset:47376
  ds_read_b64_tr_b16 v[56:57], v4 offset:47104
  ds_read_b64_tr_b16 v[58:59], v4 offset:47360
  ds_read_b64_tr_b16 v[60:61], v4 offset:47136
  ds_read_b64_tr_b16 v[62:63], v4 offset:47392
  s_waitcnt vmcnt(9) lgkmcnt(8)
  v_mfma_f32_16x16x32_bf16 v[16:19], v[32:35], v[216:219], v[16:19]
  v_mfma_f32_16x16x32_bf16 v[20:23], v[36:39], v[216:219], v[20:23]
  v_mfma_f32_16x16x32_bf16 v[24:27], v[216:219], v[40:43], v[24:27]
  v_mfma_f32_16x16x32_bf16 v[28:31], v[216:219], v[44:47], v[28:31]
  ds_read_b64_tr_b16 v[32:33], v3 offset:49152
  ds_read_b64_tr_b16 v[34:35], v3 offset:49408
  ds_read_b64_tr_b16 v[36:37], v3 offset:49168
  ds_read_b64_tr_b16 v[38:39], v3 offset:49424
  ds_read_b64_tr_b16 v[40:41], v4 offset:49152
  ds_read_b64_tr_b16 v[42:43], v4 offset:49408
  ds_read_b64_tr_b16 v[44:45], v4 offset:49184
  ds_read_b64_tr_b16 v[46:47], v4 offset:49440
  s_waitcnt vmcnt(8) lgkmcnt(8)
  v_mfma_f32_16x16x32_bf16 v[16:19], v[48:51], v[220:223], v[16:19]
  v_mfma_f32_16x16x32_bf16 v[20:23], v[52:55], v[220:223], v[20:23]
  v_mfma_f32_16x16x32_bf16 v[24:27], v[220:223], v[56:59], v[24:27]
  v_mfma_f32_16x16x32_bf16 v[28:31], v[220:223], v[60:63], v[28:31]
  ds_read_b64_tr_b16 v[48:49], v3 offset:51200
  ds_read_b64_tr_b16 v[50:51], v3 offset:51456
  ds_read_b64_tr_b16 v[52:53], v3 offset:51216
  ds_read_b64_tr_b16 v[54:55], v3 offset:51472
  ds_read_b64_tr_b16 v[56:57], v4 offset:51200
  ds_read_b64_tr_b16 v[58:59], v4 offset:51456
  ds_read_b64_tr_b16 v[60:61], v4 offset:51232
  ds_read_b64_tr_b16 v[62:63], v4 offset:51488
  s_waitcnt vmcnt(7) lgkmcnt(8)
  v_mfma_f32_16x16x32_bf16 v[16:19], v[32:35], v[224:227], v[16:19]
  v_mfma_f32_16x16x32_bf16 v[20:23], v[36:39], v[224:227], v[20:23]
  v_mfma_f32_16x16x32_bf16 v[24:27], v[224:227], v[40:43], v[24:27]
  v_mfma_f32_16x16x32_bf16 v[28:31], v[224:227], v[44:47], v[28:31]
  ds_read_b64_tr_b16 v[32:33], v3 offset:53248
  ds_read_b64_tr_b16 v[34:35], v3 offset:53504
  ds_read_b64_tr_b16 v[36:37], v3 offset:53264
  ds_read_b64_tr_b16 v[38:39], v3 offset:53520
  ds_read_b64_tr_b16 v[40:41], v4 offset:53248
  ds_read_b64_tr_b16 v[42:43], v4 offset:53504
  ds_read_b64_tr_b16 v[44:45], v4 offset:53280
  ds_read_b64_tr_b16 v[46:47], v4 offset:53536
  s_waitcnt vmcnt(6) lgkmcnt(8)
  v_mfma_f32_16x16x32_bf16 v[16:19], v[48:51], v[228:231], v[16:19]
  v_mfma_f32_16x16x32_bf16 v[20:23], v[52:55], v[228:231], v[20:23]
  v_mfma_f32_16x16x32_bf16 v[24:27], v[228:231], v[56:59], v[24:27]
  v_mfma_f32_16x16x32_bf16 v[28:31], v[228:231], v[60:63], v[28:31]
  ds_read_b64_tr_b16 v[48:49], v3 offset:55296
  ds_read_b64_tr_b16 v[50:51], v3 offset:55552
  ds_read_b64_tr_b16 v[52:53], v3 offset:55312
  ds_read_b64_tr_b16 v[54:55], v3 offset:55568
  ds_read_b64_tr_b16 v[56:57], v4 offset:55296
  ds_read_b64_tr_b16 v[58:59], v4 offset:55552
  ds_read_b64_tr_b16 v[60:61], v4 offset:55328
  ds_read_b64_tr_b16 v[62:63], v4 offset:55584
  s_waitcnt vmcnt(5) lgkmcnt(8)
  v_mfma_f32_16x16x32_bf16 v[16:19], v[32:35], v[232:235], v[16:19]
  v_mfma_f32_16x16x32_bf16 v[20:23], v[36:39], v[232:235], v[20:23]
  v_mfma_f32_16x16x32_bf16 v[24:27], v[232:235], v[40:43], v[24:27]
  v_mfma_f32_16x16x32_bf16 v[28:31], v[232:235], v[44:47], v[28:31]
  ds_read_b64_tr_b16 v[32:33], v3 offset:57344
  ds_read_b64_tr_b16 v[34:35], v3 offset:57600
  ds_read_b64_tr_b16 v[36:37], v3 offset:57360
  ds_read_b64_tr_b16 v[38:39], v3 offset:57616
  ds_read_b64_tr_b16 v[40:41], v4 offset:57344
  ds_read_b64_tr_b16 v[42:43], v4 offset:57600
  ds_read_b64_tr_b16 v[44:45], v4 offset:57376
  ds_read_b64_tr_b16 v[46:47], v4 offset:57632
  s_waitcnt vmcnt(4) lgkmcnt(8)
  v_mfma_f32_16x16x32_bf16 v[16:19], v[48:51], v[236:239], v[16:19]
  v_mfma_f32_16x16x32_bf16 v[20:23], v[52:55], v[236:239], v[20:23]
  v_mfma_f32_16x16x32_bf16 v[24:27], v[236:239], v[56:59], v[24:27]
  v_mfma_f32_16x16x32_bf16 v[28:31], v[236:239], v[60:63], v[28:31]
  ds_read_b64_tr_b16 v[48:49], v3 offset:59392
  ds_read_b64_tr_b16 v[50:51], v3 offset:59648
  ds_read_b64_tr_b16 v[52:53], v3 offset:59408
  ds_read_b64_tr_b16 v[54:55], v3 offset:59664
  ds_read_b64_tr_b16 v[56:57], v4 offset:59392
  ds_read_b64_tr_b16 v[58:59], v4 offset:59648
  ds_read_b64_tr_b16 v[60:61], v4 offset:59424
  ds_read_b64_tr_b16 v[62:63], v4 offset:59680
  s_waitcnt vmcnt(3) lgkmcnt(8)
  v_mfma_f32_16x16x32_bf16 v[16:19], v[32:35], v[240:243], v[16:19]
  v_mfma_f32_16x16x32_bf16 v[20:23], v[36:39], v[240:243], v[20:23]
  v_mfma_f32_16x16x32_bf16 v[24:27], v[240:243], v[40:43], v[24:27]
  v_mfma_f32_16x16x32_bf16 v[28:31], v[240:243], v[44:47], v[28:31]
  ds_read_b64_tr_b16 v[32:33], v3 offset:61440
  ds_read_b64_tr_b16 v[34:35], v3 offset:61696
  ds_read_b64_tr_b16 v[36:37], v3 offset:61456
  ds_read_b64_tr_b16 v[38:39], v3 offset:61712
  ds_read_b64_tr_b16 v[40:41], v4 offset:61440
  ds_read_b64_tr_b16 v[42:43], v4 offset:61696
  ds_read_b64_tr_b16 v[44:45], v4 offset:61472
  ds_read_b64_tr_b16 v[46:47], v4 offset:61728
  s_waitcnt vmcnt(2) lgkmcnt(8)
  v_mfma_f32_16x16x32_bf16 v[16:19], v[48:51], v[244:247], v[16:19]
  v_mfma_f32_16x16x32_bf16 v[20:23], v[52:55], v[244:247], v[20:23]
  v_mfma_f32_16x16x32_bf16 v[24:27], v[244:247], v[56:59], v[24:27]
  v_mfma_f32_16x16x32_bf16 v[28:31], v[244:247], v[60:63], v[28:31]
  ds_read_b64_tr_b16 v[48:49], v3 offset:63488
  ds_read_b64_tr_b16 v[50:51], v3 offset:63744
  ds_read_b64_tr_b16 v[52:53], v3 offset:63504
  ds_read_b64_tr_b16 v[54:55], v3 offset:63760
  ds_read_b64_tr_b16 v[56:57], v4 offset:63488
  ds_read_b64_tr_b16 v[58:59], v4 offset:63744
  ds_read_b64_tr_b16 v[60:61], v4 offset:63520
  ds_read_b64_tr_b16 v[62:63], v4 offset:63776
  s_waitcnt vmcnt(1) lgkmcnt(8)
  v_mfma_f32_16x16x32_bf16 v[16:19], v[32:35], v[248:251], v[16:19]
  v_mfma_f32_16x16x32_bf16 v[20:23], v[36:39], v[248:251], v[20:23]
  v_mfma_f32_16x16x32_bf16 v[24:27], v[248:251], v[40:43], v[24:27]
  v_mfma_f32_16x16x32_bf16 v[28:31], v[248:251], v[44:47], v[28:31]
  s_waitcnt vmcnt(0) lgkmcnt(0)
  v_mfma_f32_16x16x32_bf16 v[16:19], v[48:51], v[252:255], v[16:19]
  v_mfma_f32_16x16x32_bf16 v[20:23], v[52:55], v[252:255], v[20:23]
  v_mfma_f32_16x16x32_bf16 v[24:27], v[252:255], v[56:59], v[24:27]
  v_mfma_f32_16x16x32_bf16 v[28:31], v[252:255], v[60:63], v[28:31]
  s_lshr_b32 s29, s28, 1
  s_lshl_b32 s29, s29, 11
  s_and_b32 s30, s28, 1
  s_lshl_b32 s31, s30, 8
  s_add_u32 s31, s31, s29
  s_add_u32 s31, s31, 83886080
  s_lshl_b32 s30, s30, 10
  s_add_u32 s30, s30, s29
  s_add_u32 s30, s30, 84017152
  v_lshlrev_b32 v5, 4, v10
  v_lshl_add_u32 v6, v11, 9, v5
  v_lshrrev_b32 v7, 1, v11
  v_lshl_add_u32 v7, v7, 9, v5
  v_and_b32 v8, 1, v11
  v_lshl_add_u32 v7, v8, 3, v7
  v_cvt_pk_bf16_f32 v32, v16, v17
  v_cvt_pk_bf16_f32 v33, v18, v19
  v_cvt_pk_bf16_f32 v34, v20, v21
  v_cvt_pk_bf16_f32 v35, v22, v23
  v_cvt_pk_bf16_f32 v36, v24, v25
  v_cvt_pk_bf16_f32 v37, v26, v27
  v_cvt_pk_bf16_f32 v38, v28, v29
  v_cvt_pk_bf16_f32 v39, v30, v31
  buffer_store_dwordx4 v[32:35], v6, s[4:7], s31 offen sc1
  buffer_store_dwordx2 v[36:37], v7, s[4:7], s30 offen sc1
  buffer_store_dwordx2 v[38:39], v7, s[4:7], s30 offen offset:256 sc1
  s_lshl_b32 s50, s88, 2
  s_add_u32 s50, s50, 3328
  s_waitcnt lgkmcnt(0)
  s_and_b32 s28, s93, 15
  s_sub_u32 s28, s28, 4
  s_mov_b32 s66, 0
  s_cmp_lt_u32 s28, 3
  s_cselect_b32 s65, s50, -1
  s_cbranch_scc1 L_pb_13
  s_waitcnt vmcnt(0)
  s_barrier
  s_cmp_lg_u32 s26, 0
  s_cbranch_scc1 L_pb_13
  s_cmp_lg_u32 s87, 0
  s_cbranch_scc1 L_ei_14_ok
  v_mov_b32 v62, 0
L_ei_14:
  buffer_load_dword v63, v62, s[8:11], 0 offen offset:136 sc1
  s_waitcnt vmcnt(0)
  v_readfirstlane_b32 s28, v63
  s_nop 0
  s_cmp_ge_u32 s28, 128
  s_cbranch_scc1 L_ei_14_set
  s_sleep 8
  s_add_u32 s27, s27, 1
  s_cmp_lt_u32 s27, 0x80000
  s_cbranch_scc1 L_ei_14
L_ei_14_set:
  s_mov_b32 s87, 1
L_ei_14_ok:
  v_mov_b32 v54, 0
  v_add_u32 v54, 84934656, v54
  v_mov_b32 v55, 1
  s_mov_b64 exec, 3
  buffer_store_dword v55, v54, s[4:7], s50 offen sc1
  s_mov_b64 exec, -1
L_pb_13:
  s_branch L_next
L_T_ATT:
  s_lshr_b32 s52, s88, 2
  s_lshl_b32 s52, s52, 4
  s_lshl_b32 s53, s89, 3
  s_add_u32 s52, s52, s53
  s_add_u32 s52, s52, 3072
  s_mov_b32 s53, 3328
  v_min_u32 v56, 1, v0
  v_lshlrev_b32 v56, 2, v56
  v_add_u32 v56, 84934656, v56
  v_min_u32 v57, 15, v0
  v_lshlrev_b32 v57, 2, v57
  v_add_u32 v57, 84934656, v57
  s_cmp_lg_u32 s26, 0
  s_cbranch_scc1 L_wf_15_x
  s_cmp_lg_u32 s87, 0
  s_cbranch_scc1 L_ei_16_ok
  v_mov_b32 v62, 0
L_ei_16:
  buffer_load_dword v63, v62, s[8:11], 0 offen offset:136 sc1
  s_waitcnt vmcnt(0)
  v_readfirstlane_b32 s28, v63
  s_nop 0
  s_cmp_ge_u32 s28, 128
  s_cbranch_scc1 L_ei_16_set
  s_sleep 8
  s_add_u32 s27, s27, 1
  s_cmp_lt_u32 s27, 0x80000
  s_cbranch_scc1 L_ei_16
L_ei_16_set:
  s_mov_b32 s87, 1
L_ei_16_ok:
  buffer_load_dword v60, v56, s[4:7], s52 offen sc1
  buffer_load_dword v61, v57, s[4:7], s53 offen sc1
L_wf_15_x:
  s_waitcnt vmcnt(0)
  s_barrier
  s_cmp_lg_u32 s26, 0
  s_cbranch_scc1 L_wf_15_done
  s_cmp_eq_u32 s65, -1
  s_cbranch_scc1 L_wf_15_c
  v_mul_lo_u32 v54, v0, s66
  v_add_u32 v54, 84934656, v54
  v_mov_b32 v55, 1
  s_mov_b64 exec, 3
  buffer_store_dword v55, v54, s[4:7], s65 offen sc1
  s_mov_b64 exec, -1
  s_branch L_wf_15_c
L_wf_15_p:
  buffer_load_dword v60, v56, s[4:7], s52 offen sc1
  buffer_load_dword v61, v57, s[4:7], s53 offen sc1
  s_waitcnt vmcnt(0)
L_wf_15_c:
  v_min_u32 v60, v60, v61
  v_cmp_eq_u32 vcc, 0, v60
  s_cbranch_vccz L_wf_15_done
  s_sleep 16
  s_add_u32 s27, s27, 1
  s_cmp_lt_u32 s27, 0x80000
  s_cbranch_scc1 L_wf_15_p
L_wf_15_done:
  s_mov_b32 s65, -1
  s_barrier
  s_lshl_b32 s36, s88, 16
  s_lshl_b32 s28, s89, 15
  s_add_u32 s36, s36, s28
  s_lshl_b32 s28, s26, 12
  s_add_u32 s36, s36, s28
  v_lshlrev_b32 v1, 4, v0
  s_add_u32 s28, s36, 75497472
  buffer_load_dwordx4 v[16:19], v1, s[4:7], s28 offen offset:0 sc1
  buffer_load_dwordx4 v[20:23], v1, s[4:7], s28 offen offset:1024 sc1
  buffer_load_dwordx4 v[24:27], v1, s[4:7], s28 offen offset:2048 sc1
  buffer_load_dwordx4 v[28:31], v1, s[4:7], s28 offen offset:3072 sc1
  v_mov_b32 v3, 0xdddd
  v_bfe_u32 v4, v0, 2, 1
  v_cmp_eq_u32 vcc, 0, v4
  v_mov_b32 v4, 0x3f803f80
  s_nop 0
  v_cndmask_b32 v192, 0, v4, vcc
  v_mov_b32 v193, v192
  v_xor_b32 v194, v192, v4
  v_mov_b32 v195, v194
  s_lshl_b32 s41, s26, 11
  s_mov_b32 s37, 1
  s_mov_b32 s38, 0x42700000
  s_mov_b64 s[12:13], s[4:5]
  s_mov_b32 s15, 0x20000
L_att_again:
  s_mov_b32 s14, 0x10000000
  v_mov_b32 v32, 0xff800000
  v_mov_b32 v48, 0xff800000
  s_mov_b32 s39, 83886080
  s_mov_b32 s40, 0
  s_add_u32 s42, s41, 83886080
  s_add_u32 s43, s41, 84017152
  s_add_u32 m0, s41, 0
  s_nop 0
  buffer_load_dwordx4 v1, s[12:15], s42 offen offset:0 sc1 lds
  s_add_u32 m0, s41, 0
  s_nop 0
  buffer_load_dwordx4 v1, s[12:15], s42 offen offset:1024 sc1 lds
  s_add_u32 s42, s42, 16384
  s_add_u32 m0, s41, 16384
  s_nop 0
  buffer_load_dwordx4 v1, s[12:15], s43 offen offset:0 sc1 lds
  s_add_u32 m0, s41, 16384
  s_nop 0
  buffer_load_dwordx4 v1, s[12:15], s43 offen offset:1024 sc1 lds
  s_add_u32 s43, s43, 16384
  s_waitcnt vmcnt(0)
  s_barrier
  ds_read_b128 v[196:199], v1 offset:0
  ds_read_b128 v[200:203], v1 offset:1024
  ds_read_b128 v[204:207], v1 offset:2048
  ds_read_b128 v[208:211], v1 offset:3072
  ds_read_b128 v[212:215], v1 offset:4096
  ds_read_b128 v[216:219], v1 offset:5120
  ds_read_b128 v[220:223], v1 offset:6144
  ds_read_b128 v[224:227], v1 offset:7168
  s_add_u32 m0, s41, 32768
  s_nop 0
  buffer_load_dwordx4 v1, s[12:15], s42 offen offset:0 sc1 lds
  s_add_u32 m0, s41, 32768
  s_nop 0
  buffer_load_dwordx4 v1, s[12:15], s42 offen offset:1024 sc1 lds
  s_add_u32 s42, s42, 16384
  s_add_u32 m0, s41, 49152
  s_nop 0
  buffer_load_dwordx4 v1, s[12:15], s43 offen offset:0 sc1 lds
  s_add_u32 m0, s41, 49152
  s_nop 0
  buffer_load_dwordx4 v1, s[12:15], s43 offen offset:1024 sc1 lds
  s_add_u32 s43, s43, 16384
  s_add_u32 m0, s41, 65536
  s_nop 0
  buffer_load_dwordx4 v1, s[12:15], s42 offen offset:0 sc1 lds
  s_add_u32 m0, s41, 65536
  s_nop 0
  buffer_load_dwordx4 v1, s[12:15], s42 offen offset:1024 sc1 lds
  s_add_u32 s42, s42, 16384
  s_add_u32 m0, s41, 81920
  s_nop 0
  buffer_load_dwordx4 v1, s[12:15], s43 offen offset:0 sc1 lds
  s_add_u32 m0, s41, 81920
  s_nop 0
  buffer_load_dwordx4 v1, s[12:15], s43 offen offset:1024 sc1 lds
  s_add_u32 s43, s43, 16384
  s_add_u32 m0, s41, 98304
  s_nop 0
  buffer_load_dwordx4 v1, s[12:15], s42 offen offset:0 sc1 lds
  s_add_u32 m0, s41, 98304
  s_nop 0
  buffer_load_dwordx4 v1, s[12:15], s42 offen offset:1024 sc1 lds
  s_add_u32 s42, s42, 16384
  s_add_u32 m0, s41, 114688
  s_nop 0
  buffer_load_dwordx4 v1, s[12:15], s43 offen offset:0 sc1 lds
  s_add_u32 m0, s41, 114688
  s_nop 0
  buffer_load_dwordx4 v1, s[12:15], s43 offen offset:1024 sc1 lds
  s_add_u32 s43, s43, 16384
  s_add_u32 s39, s39, 8192
  s_waitcnt lgkmcnt(0)
  s_branch L_att_m2
L_att_max:
  s_add_u32 s28, s39, 4096
  buffer_load_dwordx4 v[196:199], v1, s[4:7], s39 offen offset:0 sc1
  buffer_load_dwordx4 v[200:203], v1, s[4:7], s39 offen offset:1024 sc1
  buffer_load_dwordx4 v[204:207], v1, s[4:7], s39 offen offset:2048 sc1
  buffer_load_dwordx4 v[208:211], v1, s[4:7], s39 offen offset:3072 sc1
  buffer_load_dwordx4 v[212:215], v1, s[4:7], s28 offen offset:0 sc1
  buffer_load_dwordx4 v[216:219], v1, s[4:7], s28 offen offset:1024 sc1
  buffer_load_dwordx4 v[220:223], v1, s[4:7], s28 offen offset:2048 sc1
  buffer_load_dwordx4 v[224:227], v1, s[4:7], s28 offen offset:3072 sc1
  s_add_u32 s39, s39, 8192
  s_waitcnt vmcnt(0)
L_att_m2:
  v_mfma_f32_32x32x16_bf16 v[128:143], v[196:199], v[16:19], 0
  v_mfma_f32_32x32x16_bf16 v[128:143], v[200:203], v[20:23], v[128:143]
  v_mfma_f32_32x32x16_bf16 v[144:159], v[196:199], v[24:27], 0
  v_mfma_f32_32x32x16_bf16 v[144:159], v[200:203], v[28:31], v[144:159]
  v_mfma_f32_32x32x16_bf16 v[160:175], v[204:207], v[16:19], 0
  v_mfma_f32_32x32x16_bf16 v[160:175], v[208:211], v[20:23], v[160:175]
  v_mfma_f32_32x32x16_bf16 v[176:191], v[204:207], v[24:27], 0
  v_mfma_f32_32x32x16_bf16 v[176:191], v[208:211], v[28:31], v[176:191]
  s_nop 5
  v_max3_f32 v32, v32, v128, v129
  v_max3_f32 v32, v32, v130, v131
  v_max3_f32 v32, v32, v132, v133
  v_max3_f32 v32, v32, v134, v135
  v_max3_f32 v32, v32, v136, v137
  v_max3_f32 v32, v32, v138, v139
  v_max3_f32 v32, v32, v140, v141
  v_max3_f32 v32, v32, v142, v143
  v_max3_f32 v48, v48, v144, v145
  v_max3_f32 v48, v48, v146, v147
  v_max3_f32 v48, v48, v148, v149
  v_max3_f32 v48, v48, v150, v151
  v_max3_f32 v48, v48, v152, v153
  v_max3_f32 v48, v48, v154, v155
  v_max3_f32 v48, v48, v156, v157
  v_max3_f32 v48, v48, v158, v159
  v_max3_f32 v32, v32, v160, v161
  v_max3_f32 v32, v32, v162, v163
  v_max3_f32 v32, v32, v164, v165
  v_max3_f32 v32, v32, v166, v167
  v_max3_f32 v32, v32, v168, v169
  v_max3_f32 v32, v32, v170, v171
  v_max3_f32 v32, v32, v172, v173
  v_max3_f32 v32, v32, v174, v175
  v_max3_f32 v48, v48, v176, v177
  v_max3_f32 v48, v48, v178, v179
  v_max3_f32 v48, v48, v180, v181
  v_max3_f32 v48, v48, v182, v183
  v_max3_f32 v48, v48, v184, v185
  v_max3_f32 v48, v48, v186, v187
  v_max3_f32 v48, v48, v188, v189
  v_max3_f32 v48, v48, v190, v191
  v_mfma_f32_32x32x16_bf16 v[128:143], v[212:215], v[16:19], 0
  v_mfma_f32_32x32x16_bf16 v[128:143], v[216:219], v[20:23], v[128:143]
  v_mfma_f32_32x32x16_bf16 v[144:159], v[212:215], v[24:27], 0
  v_mfma_f32_32x32x16_bf16 v[144:159], v[216:219], v[28:31], v[144:159]
  v_mfma_f32_32x32x16_bf16 v[160:175], v[220:223], v[16:19], 0
  v_mfma_f32_32x32x16_bf16 v[160:175], v[224:227], v[20:23], v[160:175]
  v_mfma_f32_32x32x16_bf16 v[176:191], v[220:223], v[24:27], 0
  v_mfma_f32_32x32x16_bf16 v[176:191], v[224:227], v[28:31], v[176:191]
  s_nop 5
  v_max3_f32 v32, v32, v128, v129
  v_max3_f32 v32, v32, v130, v131
  v_max3_f32 v32, v32, v132, v133
  v_max3_f32 v32, v32, v134, v135
  v_max3_f32 v32, v32, v136, v137
  v_max3_f32 v32, v32, v138, v139
  v_max3_f32 v32, v32, v140, v141
  v_max3_f32 v32, v32, v142, v143
  v_max3_f32 v48, v48, v144, v145
  v_max3_f32 v48, v48, v146, v147
  v_max3_f32 v48, v48, v148, v149
  v_max3_f32 v48, v48, v150, v151
  v_max3_f32 v48, v48, v152, v153
  v_max3_f32 v48, v48, v154, v155
  v_max3_f32 v48, v48, v156, v157
  v_max3_f32 v48, v48, v158, v159
  v_max3_f32 v32, v32, v160, v161
  v_max3_f32 v32, v32, v162, v163
  v_max3_f32 v32, v32, v164, v165
  v_max3_f32 v32, v32, v166, v167
  v_max3_f32 v32, v32, v168, v169
  v_max3_f32 v32, v32, v170, v171
  v_max3_f32 v32, v32, v172, v173
  v_max3_f32 v32, v32, v174, v175
  v_max3_f32 v48, v48, v176, v177
  v_max3_f32 v48, v48, v178, v179
  v_max3_f32 v48, v48, v180, v181
  v_max3_f32 v48, v48, v182, v183
  v_max3_f32 v48, v48, v184, v185
  v_max3_f32 v48, v48, v186, v187
  v_max3_f32 v48, v48, v188, v189
  v_max3_f32 v48, v48, v190, v191
  s_add_u32 s40, s40, 1
  s_cmp_lt_u32 s40, s37
  s_cbranch_scc1 L_att_max
  v_mov_b32 v4, v32
  s_nop 1
  v_permlane32_swap_b32 v32, v4
  v_max_f32 v32, v32, v4
  v_add_f32 v32, s38, v32
  v_xor_b32 v32, 0x80000000, v32
  v_mov_b32 v33, v32
  v_mov_b32 v34, v32
  v_mov_b32 v35, v32
  v_mov_b32 v36, v32
  v_mov_b32 v37, v32
  v_mov_b32 v38, v32
  v_mov_b32 v39, v32
  v_mov_b32 v40, v32
  v_mov_b32 v41, v32
  v_mov_b32 v42, v32
  v_mov_b32 v43, v32
  v_mov_b32 v44, v32
  v_mov_b32 v45, v32
  v_mov_b32 v46, v32
  v_mov_b32 v47, v32
  v_mov_b32 v4, v48
  s_nop 1
  v_permlane32_swap_b32 v48, v4
  v_max_f32 v48, v48, v4
  v_add_f32 v48, s38, v48
  v_xor_b32 v48, 0x80000000, v48
  v_mov_b32 v49, v48
  v_mov_b32 v50, v48
  v_mov_b32 v51, v48
  v_mov_b32 v52, v48
  v_mov_b32 v53, v48
  v_mov_b32 v54, v48
  v_mov_b32 v55, v48
  v_mov_b32 v56, v48
  v_mov_b32 v57, v48
  v_mov_b32 v58, v48
  v_mov_b32 v59, v48
  v_mov_b32 v60, v48
  v_mov_b32 v61, v48
  v_mov_b32 v62, v48
  v_mov_b32 v63, v48
  v_mov_b32 v64, 0
  v_mov_b32 v65, 0
  v_mov_b32 v66, 0
  v_mov_b32 v67, 0
  v_mov_b32 v68, 0
  v_mov_b32 v69, 0
  v_mov_b32 v70, 0
  v_mov_b32 v71, 0
  v_mov_b32 v72, 0
  v_mov_b32 v73, 0
  v_mov_b32 v74, 0
  v_mov_b32 v75, 0
  v_mov_b32 v76, 0
  v_mov_b32 v77, 0
  v_mov_b32 v78, 0
  v_mov_b32 v79, 0
  v_mov_b32 v80, 0
  v_mov_b32 v81, 0
  v_mov_b32 v82, 0
  v_mov_b32 v83, 0
  v_mov_b32 v84, 0
  v_mov_b32 v85, 0
  v_mov_b32 v86, 0
  v_mov_b32 v87, 0
  v_mov_b32 v88, 0
  v_mov_b32 v89, 0
  v_mov_b32 v90, 0
  v_mov_b32 v91, 0
  v_mov_b32 v92, 0
  v_mov_b32 v93, 0
  v_mov_b32 v94, 0
  v_mov_b32 v95, 0
  v_mov_b32 v96, 0
  v_mov_b32 v97, 0
  v_mov_b32 v98, 0
  v_mov_b32 v99, 0
  v_mov_b32 v100, 0
  v_mov_b32 v101, 0
  v_mov_b32 v102, 0
  v_mov_b32 v103, 0
  v_mov_b32 v176, 0
  v_mov_b32 v177, 0
  v_mov_b32 v178, 0
  v_mov_b32 v179, 0
  v_mov_b32 v180, 0
  v_mov_b32 v181, 0
  v_mov_b32 v182, 0
  v_mov_b32 v183, 0
  v_mov_b32 v184, 0
  v_mov_b32 v185, 0
  v_mov_b32 v186, 0
  v_mov_b32 v187, 0
  v_mov_b32 v188, 0
  v_mov_b32 v189, 0
  v_mov_b32 v190, 0
  v_mov_b32 v191, 0
  v_mov_b32 v120, 0
  v_mov_b32 v121, 0
  v_mov_b32 v122, 0
  v_mov_b32 v123, 0
  v_mov_b32 v124, 0
  v_mov_b32 v125, 0
  v_mov_b32 v126, 0
  v_mov_b32 v127, 0
  v_mov_b32 v2, v1
  v_add_u32 v5, 0x8000, v1
  s_mov_b32 s44, s41
  s_mov_b32 s40, 0
  s_waitcnt vmcnt(12)
  s_barrier
  ds_read_b128 v[104:107], v2 offset:0
  ds_read_b128 v[108:111], v2 offset:1024
  ds_read_b128 v[112:115], v2 offset:16384
  ds_read_b128 v[116:119], v2 offset:17408
  s_waitcnt lgkmcnt(0)
  v_mfma_f32_32x32x16_bf16 v[128:143], v[104:107], v[16:19], v[32:47]
  v_mfma_f32_32x32x16_bf16 v[128:143], v[108:111], v[20:23], v[128:143]
  s_nop 7
  s_nop 3
.p2align 6
L_att_loop:
  v_mfma_f32_32x32x16_bf16 v[144:159], v[104:107], v[24:27], v[48:63]
  v_exp_f32 v128, v128
  v_exp_f32 v129, v129
  v_exp_f32 v130, v130
  v_mfma_f32_32x32x16_bf16 v[144:159], v[108:111], v[28:31], v[144:159]
  v_exp_f32 v131, v131
  ds_read_b128 v[104:107], v2 offset:2048
  ds_read_b128 v[108:111], v2 offset:3072
  v_exp_f32 v132, v132
  v_exp_f32 v133, v133
  v_smfmac_f32_32x32x32_bf16 v[80:95], v[120:123], v[176:183], v3
  v_exp_f32 v134, v134
  v_exp_f32 v135, v135
  v_exp_f32 v136, v136
  v_smfmac_f32_16x16x64_bf16 v[100:103], v[192:195], v[176:183], v3
  v_exp_f32 v137, v137
  v_exp_f32 v138, v138
  v_smfmac_f32_32x32x32_bf16 v[80:95], v[124:127], v[184:191], v3
  v_exp_f32 v139, v139
  v_exp_f32 v140, v140
  v_exp_f32 v141, v141
  v_smfmac_f32_16x16x64_bf16 v[100:103], v[192:195], v[184:191], v3
  v_exp_f32 v142, v142
  v_exp_f32 v143, v143
  s_waitcnt lgkmcnt(0)
  v_mfma_f32_32x32x16_bf16 v[160:175], v[104:107], v[16:19], v[32:47]
  v_exp_f32 v144, v144
  v_exp_f32 v145, v145
  v_exp_f32 v146, v146
  v_mfma_f32_32x32x16_bf16 v[160:175], v[108:111], v[20:23], v[160:175]
  v_exp_f32 v147, v147
  ds_read_b128 v[120:123], v2 offset:18432
  ds_read_b128 v[124:127], v2 offset:19456
  v_exp_f32 v148, v148
  v_exp_f32 v149, v149
  v_smfmac_f32_32x32x32_bf16 v[64:79], v[112:115], v[128:135], v3
  v_exp_f32 v150, v150
  v_exp_f32 v151, v151
  v_exp_f32 v152, v152
  v_smfmac_f32_16x16x64_bf16 v[96:99], v[192:195], v[128:135], v3
  v_exp_f32 v153, v153
  v_exp_f32 v154, v154
  v_smfmac_f32_32x32x32_bf16 v[64:79], v[116:119], v[136:143], v3
  v_exp_f32 v155, v155
  v_exp_f32 v156, v156
  v_exp_f32 v157, v157
  v_smfmac_f32_16x16x64_bf16 v[96:99], v[192:195], v[136:143], v3
  v_exp_f32 v158, v158
  v_exp_f32 v159, v159
  v_mfma_f32_32x32x16_bf16 v[176:191], v[104:107], v[24:27], v[48:63]
  v_exp_f32 v160, v160
  v_exp_f32 v161, v161
  v_exp_f32 v162, v162
  v_mfma_f32_32x32x16_bf16 v[176:191], v[108:111], v[28:31], v[176:191]
  v_exp_f32 v163, v163
  ds_read_b128 v[104:107], v2 offset:4096
  ds_read_b128 v[108:111], v2 offset:5120
  v_exp_f32 v164, v164
  v_exp_f32 v165, v165
  v_smfmac_f32_32x32x32_bf16 v[80:95], v[112:115], v[144:151], v3
  v_exp_f32 v166, v166
  v_exp_f32 v167, v167
  v_exp_f32 v168, v168
  v_smfmac_f32_16x16x64_bf16 v[100:103], v[192:195], v[144:151], v3
  v_exp_f32 v169, v169
  v_exp_f32 v170, v170
  v_smfmac_f32_32x32x32_bf16 v[80:95], v[116:119], v[152:159], v3
  v_exp_f32 v171, v171
  v_exp_f32 v172, v172
  v_exp_f32 v173, v173
  v_smfmac_f32_16x16x64_bf16 v[100:103], v[192:195], v[152:159], v3
  v_exp_f32 v174, v174
  v_exp_f32 v175, v175
  s_waitcnt lgkmcnt(0)
  v_mfma_f32_32x32x16_bf16 v[128:143], v[104:107], v[16:19], v[32:47]
  v_exp_f32 v176, v176
  v_exp_f32 v177, v177
  v_exp_f32 v178, v178
  v_mfma_f32_32x32x16_bf16 v[128:143], v[108:111], v[20:23], v[128:143]
  v_exp_f32 v179, v179
  ds_read_b128 v[112:115], v2 offset:20480
  ds_read_b128 v[116:119], v2 offset:21504
  v_exp_f32 v180, v180
  v_exp_f32 v181, v181
  v_smfmac_f32_32x32x32_bf16 v[64:79], v[120:123], v[160:167], v3
  v_exp_f32 v182, v182
  v_exp_f32 v183, v183
  v_exp_f32 v184, v184
  v_smfmac_f32_16x16x64_bf16 v[96:99], v[192:195], v[160:167], v3
  v_exp_f32 v185, v185
  v_exp_f32 v186, v186
  v_smfmac_f32_32x32x32_bf16 v[64:79], v[124:127], v[168:175], v3
  v_exp_f32 v187, v187
  v_exp_f32 v188, v188
  v_exp_f32 v189, v189
  v_smfmac_f32_16x16x64_bf16 v[96:99], v[192:195], v[168:175], v3
  v_exp_f32 v190, v190
  v_exp_f32 v191, v191
  v_mfma_f32_32x32x16_bf16 v[144:159], v[104:107], v[24:27], v[48:63]
  v_exp_f32 v128, v128
  v_exp_f32 v129, v129
  v_exp_f32 v130, v130
  v_mfma_f32_32x32x16_bf16 v[144:159], v[108:111], v[28:31], v[144:159]
  v_exp_f32 v131, v131
  ds_read_b128 v[104:107], v2 offset:6144
  ds_read_b128 v[108:111], v2 offset:7168
  v_exp_f32 v132, v132
  v_exp_f32 v133, v133
  v_smfmac_f32_32x32x32_bf16 v[80:95], v[120:123], v[176:183], v3
  v_exp_f32 v134, v134
  v_exp_f32 v135, v135
  v_exp_f32 v136, v136
  v_smfmac_f32_16x16x64_bf16 v[100:103], v[192:195], v[176:183], v3
  v_exp_f32 v137, v137
  v_exp_f32 v138, v138
  v_smfmac_f32_32x32x32_bf16 v[80:95], v[124:127], v[184:191], v3
  v_exp_f32 v139, v139
  v_exp_f32 v140, v140
  v_exp_f32 v141, v141
  v_smfmac_f32_16x16x64_bf16 v[100:103], v[192:195], v[184:191], v3
  v_exp_f32 v142, v142
  v_exp_f32 v143, v143
  s_waitcnt lgkmcnt(0)
  v_mfma_f32_32x32x16_bf16 v[160:175], v[104:107], v[16:19], v[32:47]
  v_exp_f32 v144, v144
  v_exp_f32 v145, v145
  v_exp_f32 v146, v146
  v_mfma_f32_32x32x16_bf16 v[160:175], v[108:111], v[20:23], v[160:175]
  v_exp_f32 v147, v147
  ds_read_b128 v[120:123], v2 offset:22528
  ds_read_b128 v[124:127], v2 offset:23552
  v_exp_f32 v148, v148
  v_exp_f32 v149, v149
  v_smfmac_f32_32x32x32_bf16 v[64:79], v[112:115], v[128:135], v3
  v_exp_f32 v150, v150
  v_exp_f32 v151, v151
  v_exp_f32 v152, v152
  v_smfmac_f32_16x16x64_bf16 v[96:99], v[192:195], v[128:135], v3
  v_exp_f32 v153, v153
  v_exp_f32 v154, v154
  v_smfmac_f32_32x32x32_bf16 v[64:79], v[116:119], v[136:143], v3
  v_exp_f32 v155, v155
  v_exp_f32 v156, v156
  v_exp_f32 v157, v157
  v_smfmac_f32_16x16x64_bf16 v[96:99], v[192:195], v[136:143], v3
  v_exp_f32 v158, v158
  v_exp_f32 v159, v159
  v_mfma_f32_32x32x16_bf16 v[176:191], v[104:107], v[24:27], v[48:63]
  v_exp_f32 v160, v160
  v_exp_f32 v161, v161
  v_exp_f32 v162, v162
  v_mfma_f32_32x32x16_bf16 v[176:191], v[108:111], v[28:31], v[176:191]
  v_exp_f32 v163, v163
  ds_read_b128 v[104:107], v2 offset:8192
  ds_read_b128 v[108:111], v2 offset:9216
  v_exp_f32 v164, v164
  v_exp_f32 v165, v165
  v_smfmac_f32_32x32x32_bf16 v[80:95], v[112:115], v[144:151], v3
  v_exp_f32 v166, v166
  v_exp_f32 v167, v167
  v_exp_f32 v168, v168
  v_smfmac_f32_16x16x64_bf16 v[100:103], v[192:195], v[144:151], v3
  v_exp_f32 v169, v169
  v_exp_f32 v170, v170
  v_smfmac_f32_32x32x32_bf16 v[80:95], v[116:119], v[152:159], v3
  v_exp_f32 v171, v171
  v_exp_f32 v172, v172
  v_exp_f32 v173, v173
  v_smfmac_f32_16x16x64_bf16 v[100:103], v[192:195], v[152:159], v3
  v_exp_f32 v174, v174
  v_exp_f32 v175, v175
  s_waitcnt lgkmcnt(0)
  v_mfma_f32_32x32x16_bf16 v[128:143], v[104:107], v[16:19], v[32:47]
  v_exp_f32 v176, v176
  v_exp_f32 v177, v177
  v_exp_f32 v178, v178
  v_mfma_f32_32x32x16_bf16 v[128:143], v[108:111], v[20:23], v[128:143]
  v_exp_f32 v179, v179
  ds_read_b128 v[112:115], v2 offset:24576
  ds_read_b128 v[116:119], v2 offset:25600
  v_exp_f32 v180, v180
  v_exp_f32 v181, v181
  v_smfmac_f32_32x32x32_bf16 v[64:79], v[120:123], v[160:167], v3
  v_exp_f32 v182, v182
  v_exp_f32 v183, v183
  v_exp_f32 v184, v184
  v_smfmac_f32_16x16x64_bf16 v[96:99], v[192:195], v[160:167], v3
  v_exp_f32 v185, v185
  v_exp_f32 v186, v186
  v_smfmac_f32_32x32x32_bf16 v[64:79], v[124:127], v[168:175], v3
  v_exp_f32 v187, v187
  v_exp_f32 v188, v188
  v_exp_f32 v189, v189
  v_smfmac_f32_16x16x64_bf16 v[96:99], v[192:195], v[168:175], v3
  v_exp_f32 v190, v190
  v_exp_f32 v191, v191
  v_mfma_f32_32x32x16_bf16 v[144:159], v[104:107], v[24:27], v[48:63]
  v_exp_f32 v128, v128
  v_exp_f32 v129, v129
  v_exp_f32 v130, v130
  v_mfma_f32_32x32x16_bf16 v[144:159], v[108:111], v[28:31], v[144:159]
  v_exp_f32 v131, v131
  ds_read_b128 v[104:107], v2 offset:10240
  ds_read_b128 v[108:111], v2 offset:11264
  v_exp_f32 v132, v132
  v_exp_f32 v133, v133
  v_smfmac_f32_32x32x32_bf16 v[80:95], v[120:123], v[176:183], v3
  v_exp_f32 v134, v134
  v_exp_f32 v135, v135
  v_exp_f32 v136, v136
  v_smfmac_f32_16x16x64_bf16 v[100:103], v[192:195], v[176:183], v3
  v_exp_f32 v137, v137
  v_exp_f32 v138, v138
  v_smfmac_f32_32x32x32_bf16 v[80:95], v[124:127], v[184:191], v3
  v_exp_f32 v139, v139
  v_exp_f32 v140, v140
  v_exp_f32 v141, v141
  v_smfmac_f32_16x16x64_bf16 v[100:103], v[192:195], v[184:191], v3
  v_exp_f32 v142, v142
  v_exp_f32 v143, v143
  s_waitcnt lgkmcnt(0)
  v_mfma_f32_32x32x16_bf16 v[160:175], v[104:107], v[16:19], v[32:47]
  v_exp_f32 v144, v144
  v_exp_f32 v145, v145
  v_exp_f32 v146, v146
  v_mfma_f32_32x32x16_bf16 v[160:175], v[108:111], v[20:23], v[160:175]
  v_exp_f32 v147, v147
  ds_read_b128 v[120:123], v2 offset:26624
  ds_read_b128 v[124:127], v2 offset:27648
  v_exp_f32 v148, v148
  v_exp_f32 v149, v149
  v_smfmac_f32_32x32x32_bf16 v[64:79], v[112:115], v[128:135], v3
  v_exp_f32 v150, v150
  v_exp_f32 v151, v151
  v_exp_f32 v152, v152
  v_smfmac_f32_16x16x64_bf16 v[96:99], v[192:195], v[128:135], v3
  v_exp_f32 v153, v153
  v_exp_f32 v154, v154
  v_smfmac_f32_32x32x32_bf16 v[64:79], v[116:119], v[136:143], v3
  v_exp_f32 v155, v155
  v_exp_f32 v156, v156
  v_exp_f32 v157, v157
  v_smfmac_f32_16x16x64_bf16 v[96:99], v[192:195], v[136:143], v3
  v_exp_f32 v158, v158
  v_exp_f32 v159, v159
  v_mfma_f32_32x32x16_bf16 v[176:191], v[104:107], v[24:27], v[48:63]
  v_exp_f32 v160, v160
  v_exp_f32 v161, v161
  v_exp_f32 v162, v162
  v_mfma_f32_32x32x16_bf16 v[176:191], v[108:111], v[28:31], v[176:191]
  v_exp_f32 v163, v163
  ds_read_b128 v[104:107], v2 offset:12288
  ds_read_b128 v[108:111], v2 offset:13312
  v_exp_f32 v164, v164
  v_exp_f32 v165, v165
  v_smfmac_f32_32x32x32_bf16 v[80:95], v[112:115], v[144:151], v3
  v_exp_f32 v166, v166
  v_exp_f32 v167, v167
  v_exp_f32 v168, v168
  v_smfmac_f32_16x16x64_bf16 v[100:103], v[192:195], v[144:151], v3
  v_exp_f32 v169, v169
  v_exp_f32 v170, v170
  v_smfmac_f32_32x32x32_bf16 v[80:95], v[116:119], v[152:159], v3
  v_exp_f32 v171, v171
  v_exp_f32 v172, v172
  v_exp_f32 v173, v173
  v_smfmac_f32_16x16x64_bf16 v[100:103], v[192:195], v[152:159], v3
  v_exp_f32 v174, v174
  v_exp_f32 v175, v175
  s_waitcnt lgkmcnt(0)
  v_mfma_f32_32x32x16_bf16 v[128:143], v[104:107], v[16:19], v[32:47]
  v_exp_f32 v176, v176
  v_exp_f32 v177, v177
  v_exp_f32 v178, v178
  v_mfma_f32_32x32x16_bf16 v[128:143], v[108:111], v[20:23], v[128:143]
  v_exp_f32 v179, v179
  ds_read_b128 v[112:115], v2 offset:28672
  ds_read_b128 v[116:119], v2 offset:29696
  v_exp_f32 v180, v180
  v_exp_f32 v181, v181
  v_smfmac_f32_32x32x32_bf16 v[64:79], v[120:123], v[160:167], v3
  v_exp_f32 v182, v182
  v_exp_f32 v183, v183
  v_exp_f32 v184, v184
  v_smfmac_f32_16x16x64_bf16 v[96:99], v[192:195], v[160:167], v3
  v_exp_f32 v185, v185
  v_exp_f32 v186, v186
  v_smfmac_f32_32x32x32_bf16 v[64:79], v[124:127], v[168:175], v3
  v_exp_f32 v187, v187
  v_exp_f32 v188, v188
  v_exp_f32 v189, v189
  v_smfmac_f32_16x16x64_bf16 v[96:99], v[192:195], v[168:175], v3
  v_exp_f32 v190, v190
  v_exp_f32 v191, v191
  v_mfma_f32_32x32x16_bf16 v[144:159], v[104:107], v[24:27], v[48:63]
  v_exp_f32 v128, v128
  v_exp_f32 v129, v129
  v_exp_f32 v130, v130
  v_mfma_f32_32x32x16_bf16 v[144:159], v[108:111], v[28:31], v[144:159]
  v_exp_f32 v131, v131
  ds_read_b128 v[104:107], v2 offset:14336
  ds_read_b128 v[108:111], v2 offset:15360
  v_exp_f32 v132, v132
  v_exp_f32 v133, v133
  v_smfmac_f32_32x32x32_bf16 v[80:95], v[120:123], v[176:183], v3
  v_exp_f32 v134, v134
  v_exp_f32 v135, v135
  v_exp_f32 v136, v136
  v_smfmac_f32_16x16x64_bf16 v[100:103], v[192:195], v[176:183], v3
  v_exp_f32 v137, v137
  v_exp_f32 v138, v138
  v_smfmac_f32_32x32x32_bf16 v[80:95], v[124:127], v[184:191], v3
  v_exp_f32 v139, v139
  v_exp_f32 v140, v140
  v_exp_f32 v141, v141
  v_smfmac_f32_16x16x64_bf16 v[100:103], v[192:195], v[184:191], v3
  v_exp_f32 v142, v142
  v_exp_f32 v143, v143
  s_waitcnt lgkmcnt(0)
  v_mfma_f32_32x32x16_bf16 v[160:175], v[104:107], v[16:19], v[32:47]
  v_exp_f32 v144, v144
  v_exp_f32 v145, v145
  v_exp_f32 v146, v146
  v_mfma_f32_32x32x16_bf16 v[160:175], v[108:111], v[20:23], v[160:175]
  v_exp_f32 v147, v147
  ds_read_b128 v[120:123], v2 offset:30720
  ds_read_b128 v[124:127], v2 offset:31744
  v_exp_f32 v148, v148
  v_exp_f32 v149, v149
  v_smfmac_f32_32x32x32_bf16 v[64:79], v[112:115], v[128:135], v3
  v_exp_f32 v150, v150
  v_exp_f32 v151, v151
  v_exp_f32 v152, v152
  v_smfmac_f32_16x16x64_bf16 v[96:99], v[192:195], v[128:135], v3
  v_exp_f32 v153, v153
  v_exp_f32 v154, v154
  v_smfmac_f32_32x32x32_bf16 v[64:79], v[116:119], v[136:143], v3
  v_exp_f32 v155, v155
  v_exp_f32 v156, v156
  v_exp_f32 v157, v157
  v_smfmac_f32_16x16x64_bf16 v[96:99], v[192:195], v[136:143], v3
  v_exp_f32 v158, v158
  v_exp_f32 v159, v159
  s_waitcnt vmcnt(8) lgkmcnt(0)
  s_barrier
  s_cmp_lt_u32 s40, 4
  s_cselect_b32 s14, s6, 0
  v_mfma_f32_32x32x16_bf16 v[176:191], v[104:107], v[24:27], v[48:63]
  v_exp_f32 v160, v160
  v_exp_f32 v161, v161
  v_exp_f32 v162, v162
  v_mfma_f32_32x32x16_bf16 v[176:191], v[108:111], v[28:31], v[176:191]
  v_exp_f32 v163, v163
  ds_read_b128 v[104:107], v5 offset:0
  ds_read_b128 v[108:111], v5 offset:1024
  v_exp_f32 v164, v164
  v_exp_f32 v165, v165
  v_smfmac_f32_32x32x32_bf16 v[80:95], v[112:115], v[144:151], v3
  v_exp_f32 v166, v166
  s_add_u32 m0, s44, 0
  s_nop 0
  buffer_load_dwordx4 v1, s[12:15], s42 offen offset:0 sc1 lds
  v_exp_f32 v167, v167
  v_exp_f32 v168, v168
  v_smfmac_f32_16x16x64_bf16 v[100:103], v[192:195], v[144:151], v3
  v_exp_f32 v169, v169
  v_exp_f32 v170, v170
  v_smfmac_f32_32x32x32_bf16 v[80:95], v[116:119], v[152:159], v3
  v_exp_f32 v171, v171
  s_add_u32 m0, s44, 0
  s_nop 0
  buffer_load_dwordx4 v1, s[12:15], s42 offen offset:1024 sc1 lds
  s_add_u32 s42, s42, 16384
  v_exp_f32 v172, v172
  v_exp_f32 v173, v173
  v_smfmac_f32_16x16x64_bf16 v[100:103], v[192:195], v[152:159], v3
  v_exp_f32 v174, v174
  v_exp_f32 v175, v175
  s_waitcnt lgkmcnt(0)
  v_mfma_f32_32x32x16_bf16 v[128:143], v[104:107], v[16:19], v[32:47]
  v_exp_f32 v176, v176
  v_exp_f32 v177, v177
  v_exp_f32 v178, v178
  v_mfma_f32_32x32x16_bf16 v[128:143], v[108:111], v[20:23], v[128:143]
  v_exp_f32 v179, v179
  ds_read_b128 v[112:115], v5 offset:16384
  ds_read_b128 v[116:119], v5 offset:17408
  v_exp_f32 v180, v180
  v_exp_f32 v181, v181
  v_smfmac_f32_32x32x32_bf16 v[64:79], v[120:123], v[160:167], v3
  v_exp_f32 v182, v182
  s_add_u32 m0, s44, 16384
  s_nop 0
  buffer_load_dwordx4 v1, s[12:15], s43 offen offset:0 sc1 lds
  v_exp_f32 v183, v183
  v_exp_f32 v184, v184
  v_smfmac_f32_16x16x64_bf16 v[96:99], v[192:195], v[160:167], v3
  v_exp_f32 v185, v185
  v_exp_f32 v186, v186
  v_smfmac_f32_32x32x32_bf16 v[64:79], v[124:127], v[168:175], v3
  v_exp_f32 v187, v187
  s_add_u32 m0, s44, 16384
  s_nop 0
  buffer_load_dwordx4 v1, s[12:15], s43 offen offset:1024 sc1 lds
  s_add_u32 s43, s43, 16384
  v_exp_f32 v188, v188
  v_exp_f32 v189, v189
  v_smfmac_f32_16x16x64_bf16 v[96:99], v[192:195], v[168:175], v3
  v_exp_f32 v190, v190
  v_exp_f32 v191, v191
  v_mov_b32 v2, v5
  v_add_u32 v5, 0x8000, v5
  v_and_b32 v5, 0x1ffff, v5
  s_add_u32 s44, s44, 0x8000
  s_and_b32 s44, s44, 0x1ffff
  s_add_u32 s40, s40, 1
  s_cmp_lt_u32 s40, 8
  s_cbranch_scc1 L_att_loop
  v_smfmac_f32_32x32x32_bf16 v[80:95], v[120:123], v[176:183], v3
  v_smfmac_f32_16x16x64_bf16 v[100:103], v[192:195], v[176:183], v3
  v_smfmac_f32_32x32x32_bf16 v[80:95], v[124:127], v[184:191], v3
  v_smfmac_f32_16x16x64_bf16 v[100:103], v[192:195], v[184:191], v3
  s_waitcnt vmcnt(0) lgkmcnt(0)
  s_cmp_lg_u32 s37, 1
  s_cbranch_scc1 L_att_fin
  v_maximum3_f32 v8, |v64|, |v65|, |v66|
  v_maximum3_f32 v8, v8, |v67|, |v68|
  v_maximum3_f32 v8, v8, |v69|, |v70|
  v_maximum3_f32 v8, v8, |v71|, |v72|
  v_maximum3_f32 v8, v8, |v73|, |v74|
  v_maximum3_f32 v8, v8, |v75|, |v76|
  v_maximum3_f32 v8, v8, |v77|, |v78|
  v_maximum3_f32 v8, v8, |v79|, |v79|
  v_maximum3_f32 v9, |v80|, |v81|, |v82|
  v_maximum3_f32 v9, v9, |v83|, |v84|
  v_maximum3_f32 v9, v9, |v85|, |v86|
  v_maximum3_f32 v9, v9, |v87|, |v88|
  v_maximum3_f32 v9, v9, |v89|, |v90|
  v_maximum3_f32 v9, v9, |v91|, |v92|
  v_maximum3_f32 v9, v9, |v93|, |v94|
  v_maximum3_f32 v9, v9, |v95|, |v95|
  v_maximum3_f32 v6, v96, v100, v100
  v_mul_f32 v6, 0x43000000, v6
  v_maximum3_f32 v6, v6, v8, v9
  v_mov_b32 v7, 0x7f000000
  v_cmp_nle_f32 s[28:29], v6, v7
  v_min_f32 v8, v8, v9
  v_cmp_gt_f32 vcc, 0xd800000, v8
  s_nop 0
  s_or_b64 vcc, vcc, s[28:29]
  v_mov_b32 v7, 131072
  s_lshl_b32 s28, s26, 2
  v_add_u32 v8, s28, v7
  s_cmp_lg_u64 vcc, 0
  s_cselect_b32 s28, 1, 0
  v_mov_b32 v9, s28
  ds_write_b32 v8, v9
  s_waitcnt lgkmcnt(0)
  s_barrier
  v_and_b32 v8, 7, v0
  v_lshl_add_u32 v8, v8, 2, v7
  ds_read_b32 v9, v8
  s_waitcnt lgkmcnt(0)
  v_cmp_ne_u32 vcc, 0, v9
  s_cbranch_vccz L_att_fin
  s_mov_b32 s37, 16
  s_mov_b32 s38, 0
  s_branch L_att_again
L_att_fin:
  s_add_u32 s28, s36, 79691776
  v_rcp_f32 v6, v96
  s_nop 0
  v_pk_mul_f32 v[64:65], v[64:65], v[6:7] op_sel_hi:[1,0]
  v_pk_mul_f32 v[66:67], v[66:67], v[6:7] op_sel_hi:[1,0]
  v_pk_mul_f32 v[68:69], v[68:69], v[6:7] op_sel_hi:[1,0]
  v_pk_mul_f32 v[70:71], v[70:71], v[6:7] op_sel_hi:[1,0]
  v_pk_mul_f32 v[72:73], v[72:73], v[6:7] op_sel_hi:[1,0]
  v_pk_mul_f32 v[74:75], v[74:75], v[6:7] op_sel_hi:[1,0]
  v_pk_mul_f32 v[76:77], v[76:77], v[6:7] op_sel_hi:[1,0]
  v_pk_mul_f32 v[78:79], v[78:79], v[6:7] op_sel_hi:[1,0]
  v_cvt_pk_bf16_f32 v64, v64, v65
  v_cvt_pk_bf16_f32 v65, v66, v67
  v_cvt_pk_bf16_f32 v66, v68, v69
  v_cvt_pk_bf16_f32 v67, v70, v71
  v_cvt_pk_bf16_f32 v68, v72, v73
  v_cvt_pk_bf16_f32 v69, v74, v75
  v_cvt_pk_bf16_f32 v70, v76, v77
  v_cvt_pk_bf16_f32 v71, v78, v79
  buffer_store_dwordx4 v[64:67], v1, s[4:7], s28 offen offset:0 sc1
  buffer_store_dwordx4 v[68:71], v1, s[4:7], s28 offen offset:1024 sc1
  v_rcp_f32 v6, v100
  s_nop 0
  v_pk_mul_f32 v[80:81], v[80:81], v[6:7] op_sel_hi:[1,0]
  v_pk_mul_f32 v[82:83], v[82:83], v[6:7] op_sel_hi:[1,0]
  v_pk_mul_f32 v[84:85], v[84:85], v[6:7] op_sel_hi:[1,0]
  v_pk_mul_f32 v[86:87], v[86:87], v[6:7] op_sel_hi:[1,0]
  v_pk_mul_f32 v[88:89], v[88:89], v[6:7] op_sel_hi:[1,0]
  v_pk_mul_f32 v[90:91], v[90:91], v[6:7] op_sel_hi:[1,0]
  v_pk_mul_f32 v[92:93], v[92:93], v[6:7] op_sel_hi:[1,0]
  v_pk_mul_f32 v[94:95], v[94:95], v[6:7] op_sel_hi:[1,0]
  v_cvt_pk_bf16_f32 v80, v80, v81
  v_cvt_pk_bf16_f32 v81, v82, v83
  v_cvt_pk_bf16_f32 v82, v84, v85
  v_cvt_pk_bf16_f32 v83, v86, v87
  v_cvt_pk_bf16_f32 v84, v88, v89
  v_cvt_pk_bf16_f32 v85, v90, v91
  v_cvt_pk_bf16_f32 v86, v92, v93
  v_cvt_pk_bf16_f32 v87, v94, v95
  buffer_store_dwordx4 v[80:83], v1, s[4:7], s28 offen offset:2048 sc1
  buffer_store_dwordx4 v[84:87], v1, s[4:7], s28 offen offset:3072 sc1
  s_lshl_b32 s50, s88, 1
  s_add_u32 s50, s50, s89
  s_lshl_b32 s50, s50, 2
  s_add_u32 s50, s50, 3584
  s_waitcnt lgkmcnt(0)
  s_and_b32 s28, s93, 15
  s_sub_u32 s28, s28, 4
  s_mov_b32 s66, 0
  s_cmp_lt_u32 s28, 3
  s_cselect_b32 s65, s50, -1
  s_cbranch_scc1 L_pb_17
  s_waitcnt vmcnt(0)
  s_barrier
  s_cmp_lg_u32 s26, 0
  s_cbranch_scc1 L_pb_17
  s_cmp_lg_u32 s87, 0
  s_cbranch_scc1 L_ei_18_ok
  v_mov_b32 v62, 0
L_ei_18:
  buffer_load_dword v63, v62, s[8:11], 0 offen offset:136 sc1
  s_waitcnt vmcnt(0)
  v_readfirstlane_b32 s28, v63
  s_nop 0
  s_cmp_ge_u32 s28, 128
  s_cbranch_scc1 L_ei_18_set
  s_sleep 8
  s_add_u32 s27, s27, 1
  s_cmp_lt_u32 s27, 0x80000
  s_cbranch_scc1 L_ei_18
L_ei_18_set:
  s_mov_b32 s87, 1
L_ei_18_ok:
  v_mov_b32 v54, 0
  v_add_u32 v54, 84934656, v54
  v_mov_b32 v55, 1
  s_mov_b64 exec, 3
  buffer_store_dword v55, v54, s[4:7], s50 offen sc1
  s_mov_b64 exec, -1
L_pb_17:
  s_branch L_next
L_T_S3:
  s_cmp_lg_u32 s87, 0
  s_cbranch_scc1 L_ei_19_ok
  v_mov_b32 v62, 0
L_ei_19:
  buffer_load_dword v63, v62, s[8:11], 0 offen offset:136 sc1
  s_waitcnt vmcnt(0)
  v_readfirstlane_b32 s28, v63
  s_nop 0
  s_cmp_ge_u32 s28, 128
  s_cbranch_scc1 L_ei_19_set
  s_sleep 8
  s_add_u32 s27, s27, 1
  s_cmp_lt_u32 s27, 0x80000
  s_cbranch_scc1 L_ei_19
L_ei_19_set:
  s_mov_b32 s87, 1
L_ei_19_ok:
  s_load_dwordx2 s[20:21], s[0:1], 96
  s_lshl_b32 s36, s89, 3
  s_add_u32 s36, s36, s26
  s_mov_b32 s37, s88
  s_bfe_u32 s38, s92, 0x3001c
  v_lshlrev_b32 v1, 4, v0
  v_and_b32 v10, 31, v0
  v_lshrrev_b32 v11, 5, v0
  v_and_b32 v2, 7, v0
  v_lshlrev_b32 v2, 4, v2
  v_lshl_add_u32 v2, v11, 7, v2
  v_add_u32 v2, 67108864, v2
  v_lshlrev_b32 v3, 4, v10
  v_lshl_add_u32 v3, v11, 3, v3
  v_add_u32 v3, 71303168, v3
  v_lshlrev_b32 v4, 2, v11
  v_sub_u32 v4, v10, v4
  v_and_b32 v5, 7, v0
  v_lshlrev_b32 v5, 2, v5
  s_lshl_b32 s28, s36, 7
  s_add_u32 s28, s28, 84946944
  v_add_u32 v5, s28, v5
  v_min_u32 v12, 2, v0
  v_lshlrev_b32 v12, 6, v12
  v_add_u32 v12, 84934656, v12
  v_mov_b32 v6, 0xceabfb8f
  v_mov_b32 v7, 84938752
  v_lshlrev_b32 v13, 9, v0
  v_add_u32 v13, 71303232, v13
  v_mov_b32 v146, 0
  v_mov_b32 v147, 0
  v_mov_b32 v150, 0
  v_mov_b32 v151, 0
  v_mov_b32 v154, 0
  v_mov_b32 v155, 0
  v_mov_b32 v158, 0
  v_mov_b32 v159, 0
  v_mov_b32 v202, 0
  v_mov_b32 v203, 0
  v_lshrrev_b32 v14, 2, v0
  v_lshlrev_b32 v14, 12, v14
  v_and_b32 v8, 3, v0
  v_lshl_add_u32 v14, v8, 4, v14
  s_lshl_b32 s28, s36, 6
  s_add_u32 s28, s28, 2048
  v_add_u32 v14, s28, v14
  v_mov_b32 v208, 0
  v_mov_b32 v209, 0
  v_mov_b32 v210, 0
  v_mov_b32 v211, 0
  s_waitcnt lgkmcnt(0)
  s_and_b32 s21, s21, 0xffff
  s_mov_b32 s22, 0x800000
  s_mov_b32 s23, 0x20000
  s_mov_b32 s44, 0xff
  s_mov_b32 s45, 0xff
L_s3_loop:
  s_cmp_lt_u32 s37, 40
  s_cbranch_scc1 L_s3_nz
  s_lshl_b32 s28, s37, 17
  s_add_u32 s29, s28, 0x10000
  buffer_store_dwordx4 v[208:211], v14, s[20:23], s28 offen sc1
  buffer_store_dwordx4 v[208:211], v14, s[20:23], s29 offen sc1
L_s3_nz:
  s_lshr_b32 s28, s37, 2
  s_mul_i32 s28, s28, 192
  s_lshr_b32 s29, s36, 1
  s_lshl_b32 s29, s29, 2
  s_add_u32 s39, s28, s29
L_s3_w:
  buffer_load_dword v8, v12, s[4:7], s39 offen sc1
  buffer_load_dword v9, v5, s[4:7], 0 offen sc1
  s_waitcnt vmcnt(0)
  v_cmp_eq_u32 s[28:29], 0, v8
  v_cmp_ge_u32 vcc, s37, v9
  s_cmp_lt_u32 s37, 12
  s_cselect_b32 s30, vcc_lo, 0
  s_cselect_b32 s31, -4, -1
  s_and_b32 s28, s28, s31
  s_or_b32 s28, s28, s30
  s_cbranch_scc0 L_s3_wk
  s_sleep 16
  s_add_u32 s27, s27, 1
  s_cmp_lt_u32 s27, 0x80000
  s_cbranch_scc1 L_s3_w
L_s3_wk:
  s_lshl_b32 s40, s37, 5
  s_add_u32 s40, s40, s36
  s_lshl_b32 s41, s40, 13
  s_lshl_b32 s42, s36, 6
  s_add_u32 s42, s42, s37
  s_lshl_b32 s43, s42, 13
  s_add_u32 s28, s43, 33554432
  s_add_u32 s29, s43, 33558528
  buffer_load_dwordx4 v[16:19], v1, s[4:7], s28 offen offset:0
  buffer_load_dwordx4 v[20:23], v1, s[4:7], s28 offen offset:1024
  buffer_load_dwordx4 v[24:27], v1, s[4:7], s28 offen offset:2048
  buffer_load_dwordx4 v[28:31], v1, s[4:7], s28 offen offset:3072
  buffer_load_dwordx4 v[32:35], v1, s[4:7], s29 offen offset:0
  buffer_load_dwordx4 v[36:39], v1, s[4:7], s29 offen offset:1024
  buffer_load_dwordx4 v[40:43], v1, s[4:7], s29 offen offset:2048
  buffer_load_dwordx4 v[44:47], v1, s[4:7], s29 offen offset:3072
  s_add_u32 s28, s43, 0
  s_add_u32 s29, s43, 4096
  buffer_load_dwordx4 v[48:51], v1, s[4:7], s28 offen offset:0
  buffer_load_dwordx4 v[52:55], v1, s[4:7], s28 offen offset:1024
  buffer_load_dwordx4 v[56:59], v1, s[4:7], s28 offen offset:2048
  buffer_load_dwordx4 v[60:63], v1, s[4:7], s28 offen offset:3072
  buffer_load_dwordx4 v[64:67], v1, s[4:7], s29 offen offset:0
  buffer_load_dwordx4 v[68:71], v1, s[4:7], s29 offen offset:1024
  buffer_load_dwordx4 v[72:75], v1, s[4:7], s29 offen offset:2048
  buffer_load_dwordx4 v[76:79], v1, s[4:7], s29 offen offset:3072
  s_add_u32 s28, s43, 16777216
  s_add_u32 s29, s43, 16781312
  buffer_load_dwordx4 v[80:83], v1, s[4:7], s28 offen offset:0
  buffer_load_dwordx4 v[84:87], v1, s[4:7], s28 offen offset:1024
  buffer_load_dwordx4 v[88:91], v1, s[4:7], s28 offen offset:2048
  buffer_load_dwordx4 v[92:95], v1, s[4:7], s28 offen offset:3072
  buffer_load_dwordx4 v[96:99], v1, s[4:7], s29 offen offset:0
  buffer_load_dwordx4 v[100:103], v1, s[4:7], s29 offen offset:1024
  buffer_load_dwordx4 v[104:107], v1, s[4:7], s29 offen offset:2048
  buffer_load_dwordx4 v[108:111], v1, s[4:7], s29 offen offset:3072
  s_lshl_b32 s42, s42, 11
  s_mov_b64 exec, s[44:45]
  buffer_load_dwordx4 v[112:115], v2, s[4:7], s42 offen offset:0 sc1
  buffer_load_dwordx4 v[116:119], v2, s[4:7], s42 offen offset:256 sc1
  buffer_load_dwordx4 v[120:123], v2, s[4:7], s42 offen offset:512 sc1
  buffer_load_dwordx4 v[124:127], v2, s[4:7], s42 offen offset:768 sc1
  buffer_load_dwordx4 v[128:131], v2, s[4:7], s42 offen offset:1024 sc1
  buffer_load_dwordx4 v[132:135], v2, s[4:7], s42 offen offset:1280 sc1
  buffer_load_dwordx4 v[136:139], v2, s[4:7], s42 offen offset:1536 sc1
  buffer_load_dwordx4 v[140:143], v2, s[4:7], s42 offen offset:1792 sc1
  s_mov_b64 exec, -1
  buffer_load_dwordx2 v[144:145], v3, s[4:7], s42 offen offset:0 sc1
  buffer_load_dwordx2 v[148:149], v3, s[4:7], s42 offen offset:512 sc1
  buffer_load_dwordx2 v[152:153], v3, s[4:7], s42 offen offset:1024 sc1
  buffer_load_dwordx2 v[156:157], v3, s[4:7], s42 offen offset:1536 sc1
  s_waitcnt vmcnt(20)
  v_mfma_f32_32x32x16_bf16 v[160:175], v[48:51], v[16:19], 0
  v_mfma_f32_32x32x16_bf16 v[160:175], v[52:55], v[20:23], v[160:175]
  v_mfma_f32_32x32x16_bf16 v[160:175], v[56:59], v[24:27], v[160:175]
  v_mfma_f32_32x32x16_bf16 v[160:175], v[60:63], v[28:31], v[160:175]
  v_mfma_f32_32x32x16_bf16 v[160:175], v[64:67], v[32:35], v[160:175]
  v_mfma_f32_32x32x16_bf16 v[160:175], v[68:71], v[36:39], v[160:175]
  v_mfma_f32_32x32x16_bf16 v[160:175], v[72:75], v[40:43], v[160:175]
  v_mfma_f32_32x32x16_bf16 v[160:175], v[76:79], v[44:47], v[160:175]
  v_cmp_le_i32 vcc, 0, v4
  s_nop 10
  v_cndmask_b32 v160, v6, v160, vcc
  v_cmp_le_i32 vcc, 1, v4
  s_nop 1
  v_cndmask_b32 v161, v6, v161, vcc
  v_cmp_le_i32 vcc, 2, v4
  s_nop 1
  v_cndmask_b32 v162, v6, v162, vcc
  v_cmp_le_i32 vcc, 3, v4
  s_nop 1
  v_cndmask_b32 v163, v6, v163, vcc
  v_cmp_le_i32 vcc, 8, v4
  s_nop 1
  v_cndmask_b32 v164, v6, v164, vcc
  v_cmp_le_i32 vcc, 9, v4
  s_nop 1
  v_cndmask_b32 v165, v6, v165, vcc
  v_cmp_le_i32 vcc, 10, v4
  s_nop 1
  v_cndmask_b32 v166, v6, v166, vcc
  v_cmp_le_i32 vcc, 11, v4
  s_nop 1
  v_cndmask_b32 v167, v6, v167, vcc
  v_cmp_le_i32 vcc, 16, v4
  s_nop 1
  v_cndmask_b32 v168, v6, v168, vcc
  v_cmp_le_i32 vcc, 17, v4
  s_nop 1
  v_cndmask_b32 v169, v6, v169, vcc
  v_cmp_le_i32 vcc, 18, v4
  s_nop 1
  v_cndmask_b32 v170, v6, v170, vcc
  v_cmp_le_i32 vcc, 19, v4
  s_nop 1
  v_cndmask_b32 v171, v6, v171, vcc
  v_cmp_le_i32 vcc, 24, v4
  s_nop 1
  v_cndmask_b32 v172, v6, v172, vcc
  v_cmp_le_i32 vcc, 25, v4
  s_nop 1
  v_cndmask_b32 v173, v6, v173, vcc
  v_cmp_le_i32 vcc, 26, v4
  s_nop 1
  v_cndmask_b32 v174, v6, v174, vcc
  v_cmp_le_i32 vcc, 27, v4
  s_nop 1
  v_cndmask_b32 v175, v6, v175, vcc
  v_max3_f32 v15, v160, v161, v162
  v_max3_f32 v15, v15, v163, v164
  v_max3_f32 v15, v15, v165, v166
  v_max3_f32 v15, v15, v167, v168
  v_max3_f32 v15, v15, v169, v170
  v_max3_f32 v15, v15, v171, v172
  v_max3_f32 v15, v15, v173, v174
  v_max_f32 v15, v15, v175
  v_mov_b32 v8, v15
  s_nop 1
  v_permlane32_swap_b32 v15, v8
  v_max_f32 v15, v15, v8
  v_sub_f32 v160, v160, v15
  v_sub_f32 v161, v161, v15
  v_sub_f32 v162, v162, v15
  v_sub_f32 v163, v163, v15
  v_sub_f32 v164, v164, v15
  v_sub_f32 v165, v165, v15
  v_sub_f32 v166, v166, v15
  v_sub_f32 v167, v167, v15
  v_sub_f32 v168, v168, v15
  v_sub_f32 v169, v169, v15
  v_sub_f32 v170, v170, v15
  v_sub_f32 v171, v171, v15
  v_sub_f32 v172, v172, v15
  v_sub_f32 v173, v173, v15
  v_sub_f32 v174, v174, v15
  v_sub_f32 v175, v175, v15
  v_exp_f32 v160, v160
  v_exp_f32 v161, v161
  v_exp_f32 v162, v162
  v_exp_f32 v163, v163
  v_exp_f32 v164, v164
  v_exp_f32 v165, v165
  v_exp_f32 v166, v166
  v_exp_f32 v167, v167
  v_exp_f32 v168, v168
  v_exp_f32 v169, v169
  v_exp_f32 v170, v170
  v_exp_f32 v171, v171
  v_exp_f32 v172, v172
  v_exp_f32 v173, v173
  v_exp_f32 v174, v174
  v_exp_f32 v175, v175
  v_cvt_pk_bf16_f32 v192, v160, v161
  v_cvt_pk_bf16_f32 v193, v162, v163
  v_cvt_pk_bf16_f32 v194, v164, v165
  v_cvt_pk_bf16_f32 v195, v166, v167
  v_cvt_pk_bf16_f32 v196, v168, v169
  v_cvt_pk_bf16_f32 v197, v170, v171
  v_cvt_pk_bf16_f32 v198, v172, v173
  v_cvt_pk_bf16_f32 v199, v174, v175
  s_waitcnt vmcnt(12)
  v_mfma_f32_32x32x16_bf16 v[48:63], v[80:83], v[192:195], 0
  v_mfma_f32_32x32x16_bf16 v[64:79], v[88:91], v[192:195], 0
  v_mfma_f32_32x32x16_bf16 v[212:227], v[96:99], v[192:195], 0
  v_mfma_f32_32x32x16_bf16 v[228:243], v[104:107], v[192:195], 0
  v_mfma_f32_32x32x16_bf16 v[48:63], v[84:87], v[196:199], v[48:63]
  v_mfma_f32_32x32x16_bf16 v[64:79], v[92:95], v[196:199], v[64:79]
  v_mfma_f32_32x32x16_bf16 v[212:227], v[100:103], v[196:199], v[212:227]
  v_mfma_f32_32x32x16_bf16 v[228:243], v[108:111], v[196:199], v[228:243]
  v_pk_add_f32 v[160:161], v[160:161], v[162:163]
  v_pk_add_f32 v[160:161], v[160:161], v[164:165]
  v_pk_add_f32 v[160:161], v[160:161], v[166:167]
  v_pk_add_f32 v[160:161], v[160:161], v[168:169]
  v_pk_add_f32 v[160:161], v[160:161], v[170:171]
  v_pk_add_f32 v[160:161], v[160:161], v[172:173]
  v_pk_add_f32 v[160:161], v[160:161], v[174:175]
  s_mov_b32 s46, 0
L_s3_poll:
  s_waitcnt vmcnt(0)
  v_max3_u32 v8, v144, v145, v148
  v_max3_u32 v8, v8, v149, v152
  v_max3_u32 v8, v8, v153, v156
  v_max_u32 v8, v8, v157
  s_mov_b64 exec, s[44:45]
  v_max3_u32 v8, v8, v112, v116
  v_max3_u32 v8, v8, v120, v124
  v_max3_u32 v8, v8, v128, v132
  v_max3_u32 v8, v8, v136, v140
  s_mov_b64 exec, -1
  v_cmp_eq_u32 vcc, -1, v8
  s_cbranch_vccz L_s3_go
  s_cmp_lg_u32 s46, 0
  s_cbranch_scc1 L_s3_re
  s_cmp_ge_u32 s37, 60
  s_cselect_b32 s46, 2048, 0
  s_sub_u32 s47, s42, s46
L_s3_lt:
  s_sleep 12
  s_mov_b64 exec, 15
  buffer_load_dword v8, v13, s[4:7], s47 offen sc1
  s_waitcnt vmcnt(0)
  v_cmp_eq_u32 vcc, -1, v8
  s_mov_b64 exec, -1
  s_cbranch_vccz L_s3_re
  s_add_u32 s27, s27, 1
  s_cmp_lt_u32 s27, 0x80000
  s_cbranch_scc1 L_s3_lt
L_s3_re:
  s_mov_b64 exec, s[44:45]
  buffer_load_dwordx4 v[112:115], v2, s[4:7], s42 offen offset:0 sc1
  buffer_load_dwordx4 v[116:119], v2, s[4:7], s42 offen offset:256 sc1
  buffer_load_dwordx4 v[120:123], v2, s[4:7], s42 offen offset:512 sc1
  buffer_load_dwordx4 v[124:127], v2, s[4:7], s42 offen offset:768 sc1
  buffer_load_dwordx4 v[128:131], v2, s[4:7], s42 offen offset:1024 sc1
  buffer_load_dwordx4 v[132:135], v2, s[4:7], s42 offen offset:1280 sc1
  buffer_load_dwordx4 v[136:139], v2, s[4:7], s42 offen offset:1536 sc1
  buffer_load_dwordx4 v[140:143], v2, s[4:7], s42 offen offset:1792 sc1
  s_mov_b64 exec, -1
  buffer_load_dwordx2 v[144:145], v3, s[4:7], s42 offen offset:0 sc1
  buffer_load_dwordx2 v[148:149], v3, s[4:7], s42 offen offset:512 sc1
  buffer_load_dwordx2 v[152:153], v3, s[4:7], s42 offen offset:1024 sc1
  buffer_load_dwordx2 v[156:157], v3, s[4:7], s42 offen offset:1536 sc1
  s_add_u32 s27, s27, 1
  s_cmp_lt_u32 s27, 0x80000
  s_cbranch_scc1 L_s3_poll
  s_waitcnt vmcnt(0)
L_s3_go:
  v_mfma_f32_32x32x16_bf16 v[176:191], v[112:115], v[16:19], 0
  v_mfma_f32_32x32x16_bf16 v[80:95], v[116:119], v[20:23], 0
  v_mfma_f32_32x32x16_bf16 v[176:191], v[120:123], v[24:27], v[176:191]
  v_mfma_f32_32x32x16_bf16 v[80:95], v[124:127], v[28:31], v[80:95]
  v_mfma_f32_32x32x16_bf16 v[176:191], v[128:131], v[32:35], v[176:191]
  v_mfma_f32_32x32x16_bf16 v[80:95], v[132:135], v[36:39], v[80:95]
  v_mfma_f32_32x32x16_bf16 v[176:191], v[136:139], v[40:43], v[176:191]
  v_mfma_f32_32x32x16_bf16 v[80:95], v[140:143], v[44:47], v[80:95]
  s_add_u32 s28, s41, 50331648
  s_add_u32 s29, s41, 50335744
  s_nop 8
  v_sub_f32 v176, v176, v15
  v_sub_f32 v177, v177, v15
  v_sub_f32 v178, v178, v15
  v_sub_f32 v179, v179, v15
  v_pk_add_f32 v[176:177], v[176:177], v[80:81]
  v_pk_add_f32 v[178:179], v[178:179], v[82:83]
  v_max3_f32 v9, v176, v177, v178
  v_max3_f32 v9, v9, v179, 0
  v_cmp_lt_f32 vcc, 0x41c00000, v9
  s_cbranch_vccz L_s3_nr
  v_mov_b32 v8, v9
  s_nop 1
  v_permlane32_swap_b32 v9, v8
  v_max_f32 v9, v9, v8
  v_sub_f32 v176, v176, v9
  v_sub_f32 v177, v177, v9
  v_sub_f32 v178, v178, v9
  v_sub_f32 v179, v179, v9
  v_exp_f32 v8, -v9
  s_nop 0
  v_pk_mul_f32 v[48:49], v[48:49], v[8:9] op_sel_hi:[1,0]
  v_pk_mul_f32 v[50:51], v[50:51], v[8:9] op_sel_hi:[1,0]
  v_pk_mul_f32 v[52:53], v[52:53], v[8:9] op_sel_hi:[1,0]
  v_pk_mul_f32 v[54:55], v[54:55], v[8:9] op_sel_hi:[1,0]
  v_pk_mul_f32 v[56:57], v[56:57], v[8:9] op_sel_hi:[1,0]
  v_pk_mul_f32 v[58:59], v[58:59], v[8:9] op_sel_hi:[1,0]
  v_pk_mul_f32 v[60:61], v[60:61], v[8:9] op_sel_hi:[1,0]
  v_pk_mul_f32 v[62:63], v[62:63], v[8:9] op_sel_hi:[1,0]
  v_pk_mul_f32 v[64:65], v[64:65], v[8:9] op_sel_hi:[1,0]
  v_pk_mul_f32 v[66:67], v[66:67], v[8:9] op_sel_hi:[1,0]
  v_pk_mul_f32 v[68:69], v[68:69], v[8:9] op_sel_hi:[1,0]
  v_pk_mul_f32 v[70:71], v[70:71], v[8:9] op_sel_hi:[1,0]
  v_pk_mul_f32 v[72:73], v[72:73], v[8:9] op_sel_hi:[1,0]
  v_pk_mul_f32 v[74:75], v[74:75], v[8:9] op_sel_hi:[1,0]
  v_pk_mul_f32 v[76:77], v[76:77], v[8:9] op_sel_hi:[1,0]
  v_pk_mul_f32 v[78:79], v[78:79], v[8:9] op_sel_hi:[1,0]
  v_pk_mul_f32 v[212:213], v[212:213], v[8:9] op_sel_hi:[1,0]
  v_pk_mul_f32 v[214:215], v[214:215], v[8:9] op_sel_hi:[1,0]
  v_pk_mul_f32 v[216:217], v[216:217], v[8:9] op_sel_hi:[1,0]
  v_pk_mul_f32 v[218:219], v[218:219], v[8:9] op_sel_hi:[1,0]
  v_pk_mul_f32 v[220:221], v[220:221], v[8:9] op_sel_hi:[1,0]
  v_pk_mul_f32 v[222:223], v[222:223], v[8:9] op_sel_hi:[1,0]
  v_pk_mul_f32 v[224:225], v[224:225], v[8:9] op_sel_hi:[1,0]
  v_pk_mul_f32 v[226:227], v[226:227], v[8:9] op_sel_hi:[1,0]
  v_pk_mul_f32 v[228:229], v[228:229], v[8:9] op_sel_hi:[1,0]
  v_pk_mul_f32 v[230:231], v[230:231], v[8:9] op_sel_hi:[1,0]
  v_pk_mul_f32 v[232:233], v[232:233], v[8:9] op_sel_hi:[1,0]
  v_pk_mul_f32 v[234:235], v[234:235], v[8:9] op_sel_hi:[1,0]
  v_pk_mul_f32 v[236:237], v[236:237], v[8:9] op_sel_hi:[1,0]
  v_pk_mul_f32 v[238:239], v[238:239], v[8:9] op_sel_hi:[1,0]
  v_pk_mul_f32 v[240:241], v[240:241], v[8:9] op_sel_hi:[1,0]
  v_pk_mul_f32 v[242:243], v[242:243], v[8:9] op_sel_hi:[1,0]
  v_pk_mul_f32 v[160:161], v[160:161], v[8:9] op_sel_hi:[1,0]
L_s3_nr:
  v_exp_f32 v176, v176
  v_exp_f32 v177, v177
  v_exp_f32 v178, v178
  v_exp_f32 v179, v179
  v_cvt_pk_bf16_f32 v200, v176, v177
  v_cvt_pk_bf16_f32 v201, v178, v179
  s_nop 1
  v_mfma_f32_32x32x16_bf16 v[48:63], v[144:147], v[200:203], v[48:63]
  v_pk_add_f32 v[160:161], v[160:161], v[176:177]
  v_pk_add_f32 v[160:161], v[160:161], v[178:179]
  v_add_f32 v8, v160, v161
  v_mfma_f32_32x32x16_bf16 v[64:79], v[148:151], v[200:203], v[64:79]
  v_mov_b32 v9, v8
  s_nop 1
  v_permlane32_swap_b32 v9, v8
  v_mfma_f32_32x32x16_bf16 v[212:227], v[152:155], v[200:203], v[212:227]
  v_add_f32 v8, v9, v8
  v_rcp_f32 v8, v8
  v_mfma_f32_32x32x16_bf16 v[228:243], v[156:159], v[200:203], v[228:243]
  v_pk_mul_f32 v[48:49], v[48:49], v[8:9] op_sel_hi:[1,0]
  v_pk_mul_f32 v[50:51], v[50:51], v[8:9] op_sel_hi:[1,0]
  v_pk_mul_f32 v[52:53], v[52:53], v[8:9] op_sel_hi:[1,0]
  v_pk_mul_f32 v[54:55], v[54:55], v[8:9] op_sel_hi:[1,0]
  v_pk_mul_f32 v[56:57], v[56:57], v[8:9] op_sel_hi:[1,0]
  v_pk_mul_f32 v[58:59], v[58:59], v[8:9] op_sel_hi:[1,0]
  v_pk_mul_f32 v[60:61], v[60:61], v[8:9] op_sel_hi:[1,0]
  v_pk_mul_f32 v[62:63], v[62:63], v[8:9] op_sel_hi:[1,0]
  v_cvt_pk_bf16_f32 v48, v48, v49
  v_cvt_pk_bf16_f32 v49, v50, v51
  v_cvt_pk_bf16_f32 v50, v52, v53
  v_cvt_pk_bf16_f32 v51, v54, v55
  v_cvt_pk_bf16_f32 v52, v56, v57
  v_cvt_pk_bf16_f32 v53, v58, v59
  v_cvt_pk_bf16_f32 v54, v60, v61
  v_cvt_pk_bf16_f32 v55, v62, v63
  buffer_store_dwordx4 v[48:51], v1, s[4:7], s28 offen offset:0 sc1
  buffer_store_dwordx4 v[52:55], v1, s[4:7], s28 offen offset:1024 sc1
  v_pk_mul_f32 v[64:65], v[64:65], v[8:9] op_sel_hi:[1,0]
  v_pk_mul_f32 v[66:67], v[66:67], v[8:9] op_sel_hi:[1,0]
  v_pk_mul_f32 v[68:69], v[68:69], v[8:9] op_sel_hi:[1,0]
  v_pk_mul_f32 v[70:71], v[70:71], v[8:9] op_sel_hi:[1,0]
  v_pk_mul_f32 v[72:73], v[72:73], v[8:9] op_sel_hi:[1,0]
  v_pk_mul_f32 v[74:75], v[74:75], v[8:9] op_sel_hi:[1,0]
  v_pk_mul_f32 v[76:77], v[76:77], v[8:9] op_sel_hi:[1,0]
  v_pk_mul_f32 v[78:79], v[78:79], v[8:9] op_sel_hi:[1,0]
  v_cvt_pk_bf16_f32 v64, v64, v65
  v_cvt_pk_bf16_f32 v65, v66, v67
  v_cvt_pk_bf16_f32 v66, v68, v69
  v_cvt_pk_bf16_f32 v67, v70, v71
  v_cvt_pk_bf16_f32 v68, v72, v73
  v_cvt_pk_bf16_f32 v69, v74, v75
  v_cvt_pk_bf16_f32 v70, v76, v77
  v_cvt_pk_bf16_f32 v71, v78, v79
  buffer_store_dwordx4 v[64:67], v1, s[4:7], s28 offen offset:2048 sc1
  buffer_store_dwordx4 v[68:71], v1, s[4:7], s28 offen offset:3072 sc1
  v_pk_mul_f32 v[212:213], v[212:213], v[8:9] op_sel_hi:[1,0]
  v_pk_mul_f32 v[214:215], v[214:215], v[8:9] op_sel_hi:[1,0]
  v_pk_mul_f32 v[216:217], v[216:217], v[8:9] op_sel_hi:[1,0]
  v_pk_mul_f32 v[218:219], v[218:219], v[8:9] op_sel_hi:[1,0]
  v_pk_mul_f32 v[220:221], v[220:221], v[8:9] op_sel_hi:[1,0]
  v_pk_mul_f32 v[222:223], v[222:223], v[8:9] op_sel_hi:[1,0]
  v_pk_mul_f32 v[224:225], v[224:225], v[8:9] op_sel_hi:[1,0]
  v_pk_mul_f32 v[226:227], v[226:227], v[8:9] op_sel_hi:[1,0]
  v_cvt_pk_bf16_f32 v212, v212, v213
  v_cvt_pk_bf16_f32 v213, v214, v215
  v_cvt_pk_bf16_f32 v214, v216, v217
  v_cvt_pk_bf16_f32 v215, v218, v219
  v_cvt_pk_bf16_f32 v216, v220, v221
  v_cvt_pk_bf16_f32 v217, v222, v223
  v_cvt_pk_bf16_f32 v218, v224, v225
  v_cvt_pk_bf16_f32 v219, v226, v227
  buffer_store_dwordx4 v[212:215], v1, s[4:7], s29 offen offset:0 sc1
  buffer_store_dwordx4 v[216:219], v1, s[4:7], s29 offen offset:1024 sc1
  v_pk_mul_f32 v[228:229], v[228:229], v[8:9] op_sel_hi:[1,0]
  v_pk_mul_f32 v[230:231], v[230:231], v[8:9] op_sel_hi:[1,0]
  v_pk_mul_f32 v[232:233], v[232:233], v[8:9] op_sel_hi:[1,0]
  v_pk_mul_f32 v[234:235], v[234:235], v[8:9] op_sel_hi:[1,0]
  v_pk_mul_f32 v[236:237], v[236:237], v[8:9] op_sel_hi:[1,0]
  v_pk_mul_f32 v[238:239], v[238:239], v[8:9] op_sel_hi:[1,0]
  v_pk_mul_f32 v[240:241], v[240:241], v[8:9] op_sel_hi:[1,0]
  v_pk_mul_f32 v[242:243], v[242:243], v[8:9] op_sel_hi:[1,0]
  v_cvt_pk_bf16_f32 v228, v228, v229
  v_cvt_pk_bf16_f32 v229, v230, v231
  v_cvt_pk_bf16_f32 v230, v232, v233
  v_cvt_pk_bf16_f32 v231, v234, v235
  v_cvt_pk_bf16_f32 v232, v236, v237
  v_cvt_pk_bf16_f32 v233, v238, v239
  v_cvt_pk_bf16_f32 v234, v240, v241
  v_cvt_pk_bf16_f32 v235, v242, v243
  buffer_store_dwordx4 v[228:231], v1, s[4:7], s29 offen offset:2048 sc1
  buffer_store_dwordx4 v[232:235], v1, s[4:7], s29 offen offset:3072 sc1
  s_lshl_b32 s28, s40, 2
  v_mov_b32 v8, 1
  s_waitcnt vmcnt(0)
  s_mov_b64 exec, 1
  buffer_store_dword v8, v7, s[4:7], s28 offen sc1
  s_mov_b64 exec, -1
  s_add_u32 s37, s37, s38
  s_cmp_lt_u32 s37, s90
  s_cbranch_scc1 L_s3_loop
  s_barrier
  s_branch L_next
L_T_S4:
  s_cmp_lg_u32 s87, 0
  s_cbranch_scc1 L_ei_20_ok
  v_mov_b32 v62, 0
L_ei_20:
  buffer_load_dword v63, v62, s[8:11], 0 offen offset:136 sc1
  s_waitcnt vmcnt(0)
  v_readfirstlane_b32 s28, v63
  s_nop 0
  s_cmp_ge_u32 s28, 128
  s_cbranch_scc1 L_ei_20_set
  s_sleep 8
  s_add_u32 s27, s27, 1
  s_cmp_lt_u32 s27, 0x80000
  s_cbranch_scc1 L_ei_20
L_ei_20_set:
  s_mov_b32 s87, 1
L_ei_20_ok:
  s_lshr_b32 s42, s89, 4
  s_lshl_b32 s42, s42, 3
  s_add_u32 s42, s42, s26
  s_and_b32 s89, s89, 15
  s_and_b32 s43, s89, 7
  v_lshrrev_b32 v11, 5, v0
  s_bitcmp1_b32 s92, 31
  s_cbranch_scc1 L_s4_kept
  s_load_dwordx2 s[12:13], s[0:1], 80
  s_load_dwordx2 s[20:21], s[0:1], 96
  v_lshrrev_b32 v2, 3, v0
  v_lshlrev_b32 v2, 11, v2
  v_and_b32 v3, 7, v0
  v_lshl_add_u32 v2, v3, 4, v2
  s_lshl_b32 s28, s42, 19
  s_lshl_b32 s29, s89, 7
  s_add_u32 s28, s28, s29
  s_lshl_b32 s30, s43, 16
  s_waitcnt lgkmcnt(0)
  s_and_b32 s13, s13, 0xffff
  s_mov_b32 s14, 0x800000
  s_mov_b32 s15, 0x20000
  s_and_b32 s21, s21, 0xffff
  s_mov_b32 s22, 0x800000
  s_mov_b32 s23, 0x20000
  s_add_u32 s31, s28, s30
  buffer_load_dwordx4 v[128:131], v2, s[12:15], s31 offen
  s_add_u32 s30, s30, 16384
  s_and_b32 s30, s30, 0x7ffff
  s_add_u32 s31, s28, s30
  buffer_load_dwordx4 v[132:135], v2, s[12:15], s31 offen
  s_add_u32 s30, s30, 16384
  s_and_b32 s30, s30, 0x7ffff
  s_add_u32 s31, s28, s30
  buffer_load_dwordx4 v[136:139], v2, s[12:15], s31 offen
  s_add_u32 s30, s30, 16384
  s_and_b32 s30, s30, 0x7ffff
  s_add_u32 s31, s28, s30
  buffer_load_dwordx4 v[140:143], v2, s[12:15], s31 offen
  s_add_u32 s30, s30, 16384
  s_and_b32 s30, s30, 0x7ffff
  s_add_u32 s31, s28, s30
  buffer_load_dwordx4 v[144:147], v2, s[12:15], s31 offen
  s_add_u32 s30, s30, 16384
  s_and_b32 s30, s30, 0x7ffff
  s_add_u32 s31, s28, s30
  buffer_load_dwordx4 v[148:151], v2, s[12:15], s31 offen
  s_add_u32 s30, s30, 16384
  s_and_b32 s30, s30, 0x7ffff
  s_add_u32 s31, s28, s30
  buffer_load_dwordx4 v[152:155], v2, s[12:15], s31 offen
  s_add_u32 s30, s30, 16384
  s_and_b32 s30, s30, 0x7ffff
  s_add_u32 s31, s28, s30
  buffer_load_dwordx4 v[156:159], v2, s[12:15], s31 offen
  s_add_u32 s30, s30, 16384
  s_and_b32 s30, s30, 0x7ffff
  s_add_u32 s31, s28, s30
  buffer_load_dwordx4 v[160:163], v2, s[12:15], s31 offen
  s_add_u32 s30, s30, 16384
  s_and_b32 s30, s30, 0x7ffff
  s_add_u32 s31, s28, s30
  buffer_load_dwordx4 v[164:167], v2, s[12:15], s31 offen
  s_add_u32 s30, s30, 16384
  s_and_b32 s30, s30, 0x7ffff
  s_add_u32 s31, s28, s30
  buffer_load_dwordx4 v[168:171], v2, s[12:15], s31 offen
  s_add_u32 s30, s30, 16384
  s_and_b32 s30, s30, 0x7ffff
  s_add_u32 s31, s28, s30
  buffer_load_dwordx4 v[172:175], v2, s[12:15], s31 offen
  s_add_u32 s30, s30, 16384
  s_and_b32 s30, s30, 0x7ffff
  s_add_u32 s31, s28, s30
  buffer_load_dwordx4 v[176:179], v2, s[12:15], s31 offen
  s_add_u32 s30, s30, 16384
  s_and_b32 s30, s30, 0x7ffff
  s_add_u32 s31, s28, s30
  buffer_load_dwordx4 v[180:183], v2, s[12:15], s31 offen
  s_add_u32 s30, s30, 16384
  s_and_b32 s30, s30, 0x7ffff
  s_add_u32 s31, s28, s30
  buffer_load_dwordx4 v[184:187], v2, s[12:15], s31 offen
  s_add_u32 s30, s30, 16384
  s_and_b32 s30, s30, 0x7ffff
  s_add_u32 s31, s28, s30
  buffer_load_dwordx4 v[188:191], v2, s[12:15], s31 offen
  s_add_u32 s30, s30, 16384
  s_and_b32 s30, s30, 0x7ffff
  s_add_u32 s31, s28, s30
  buffer_load_dwordx4 v[192:195], v2, s[12:15], s31 offen
  s_add_u32 s30, s30, 16384
  s_and_b32 s30, s30, 0x7ffff
  s_add_u32 s31, s28, s30
  buffer_load_dwordx4 v[196:199], v2, s[12:15], s31 offen
  s_add_u32 s30, s30, 16384
  s_and_b32 s30, s30, 0x7ffff
  s_add_u32 s31, s28, s30
  buffer_load_dwordx4 v[200:203], v2, s[12:15], s31 offen
  s_add_u32 s30, s30, 16384
  s_and_b32 s30, s30, 0x7ffff
  s_add_u32 s31, s28, s30
  buffer_load_dwordx4 v[204:207], v2, s[12:15], s31 offen
  s_add_u32 s30, s30, 16384
  s_and_b32 s30, s30, 0x7ffff
  s_add_u32 s31, s28, s30
  buffer_load_dwordx4 v[208:211], v2, s[12:15], s31 offen
  s_add_u32 s30, s30, 16384
  s_and_b32 s30, s30, 0x7ffff
  s_add_u32 s31, s28, s30
  buffer_load_dwordx4 v[212:215], v2, s[12:15], s31 offen
  s_add_u32 s30, s30, 16384
  s_and_b32 s30, s30, 0x7ffff
  s_add_u32 s31, s28, s30
  buffer_load_dwordx4 v[216:219], v2, s[12:15], s31 offen
  s_add_u32 s30, s30, 16384
  s_and_b32 s30, s30, 0x7ffff
  s_add_u32 s31, s28, s30
  buffer_load_dwordx4 v[220:223], v2, s[12:15], s31 offen
  s_add_u32 s30, s30, 16384
  s_and_b32 s30, s30, 0x7ffff
  s_add_u32 s31, s28, s30
  buffer_load_dwordx4 v[224:227], v2, s[12:15], s31 offen
  s_add_u32 s30, s30, 16384
  s_and_b32 s30, s30, 0x7ffff
  s_add_u32 s31, s28, s30
  buffer_load_dwordx4 v[228:231], v2, s[12:15], s31 offen
  s_add_u32 s30, s30, 16384
  s_and_b32 s30, s30, 0x7ffff
  s_add_u32 s31, s28, s30
  buffer_load_dwordx4 v[232:235], v2, s[12:15], s31 offen
  s_add_u32 s30, s30, 16384
  s_and_b32 s30, s30, 0x7ffff
  s_add_u32 s31, s28, s30
  buffer_load_dwordx4 v[236:239], v2, s[12:15], s31 offen
  s_add_u32 s30, s30, 16384
  s_and_b32 s30, s30, 0x7ffff
  s_add_u32 s31, s28, s30
  buffer_load_dwordx4 v[240:243], v2, s[12:15], s31 offen
  s_add_u32 s30, s30, 16384
  s_and_b32 s30, s30, 0x7ffff
  s_add_u32 s31, s28, s30
  buffer_load_dwordx4 v[244:247], v2, s[12:15], s31 offen
  s_add_u32 s30, s30, 16384
  s_and_b32 s30, s30, 0x7ffff
  s_add_u32 s31, s28, s30
  buffer_load_dwordx4 v[248:251], v2, s[12:15], s31 offen
  s_add_u32 s30, s30, 16384
  s_and_b32 s30, s30, 0x7ffff
  s_add_u32 s31, s28, s30
  buffer_load_dwordx4 v[252:255], v2, s[12:15], s31 offen
  s_add_u32 s30, s30, 16384
  s_and_b32 s30, s30, 0x7ffff
  v_lshlrev_b32 v1, 4, v0
  s_lshl_b32 s30, s26, 14
  v_add_u32 v3, s30, v1
  v_lshrrev_b32 v11, 5, v0
  v_bfe_u32 v4, v0, 2, 2
  v_lshl_add_u32 v4, v11, 2, v4
  v_lshlrev_b32 v4, 7, v4
  v_bfe_u32 v5, v0, 4, 1
  v_lshl_add_u32 v4, v5, 5, v4
  v_and_b32 v5, 3, v0
  v_lshl_add_u32 v4, v5, 3, v4
  v_add_u32 v4, s30, v4
  s_waitcnt vmcnt(24)
  ds_write_b128 v3, v[128:131] offset:0
  ds_write_b128 v3, v[132:135] offset:1024
  ds_read_b64_tr_b16 v[128:129], v4 offset:0
  ds_read_b64_tr_b16 v[130:131], v4 offset:1024
  ds_read_b64_tr_b16 v[132:133], v4 offset:64
  ds_read_b64_tr_b16 v[134:135], v4 offset:1088
  ds_write_b128 v3, v[136:139] offset:2048
  ds_write_b128 v3, v[140:143] offset:3072
  ds_read_b64_tr_b16 v[136:137], v4 offset:2048
  ds_read_b64_tr_b16 v[138:139], v4 offset:3072
  ds_read_b64_tr_b16 v[140:141], v4 offset:2112
  ds_read_b64_tr_b16 v[142:143], v4 offset:3136
  ds_write_b128 v3, v[144:147] offset:4096
  ds_write_b128 v3, v[148:151] offset:5120
  ds_read_b64_tr_b16 v[144:145], v4 offset:4096
  ds_read_b64_tr_b16 v[146:147], v4 offset:5120
  ds_read_b64_tr_b16 v[148:149], v4 offset:4160
  ds_read_b64_tr_b16 v[150:151], v4 offset:5184
  ds_write_b128 v3, v[152:155] offset:6144
  ds_write_b128 v3, v[156:159] offset:7168
  ds_read_b64_tr_b16 v[152:153], v4 offset:6144
  ds_read_b64_tr_b16 v[154:155], v4 offset:7168
  ds_read_b64_tr_b16 v[156:157], v4 offset:6208
  ds_read_b64_tr_b16 v[158:159], v4 offset:7232
  s_waitcnt vmcnt(16)
  ds_write_b128 v3, v[160:163] offset:8192
  ds_write_b128 v3, v[164:167] offset:9216
  ds_read_b64_tr_b16 v[160:161], v4 offset:8192
  ds_read_b64_tr_b16 v[162:163], v4 offset:9216
  ds_read_b64_tr_b16 v[164:165], v4 offset:8256
  ds_read_b64_tr_b16 v[166:167], v4 offset:9280
  ds_write_b128 v3, v[168:171] offset:10240
  ds_write_b128 v3, v[172:175] offset:11264
  ds_read_b64_tr_b16 v[168:169], v4 offset:10240
  ds_read_b64_tr_b16 v[170:171], v4 offset:11264
  ds_read_b64_tr_b16 v[172:173], v4 offset:10304
  ds_read_b64_tr_b16 v[174:175], v4 offset:11328
  ds_write_b128 v3, v[176:179] offset:12288
  ds_write_b128 v3, v[180:183] offset:13312
  ds_read_b64_tr_b16 v[176:177], v4 offset:12288
  ds_read_b64_tr_b16 v[178:179], v4 offset:13312
  ds_read_b64_tr_b16 v[180:181], v4 offset:12352
  ds_read_b64_tr_b16 v[182:183], v4 offset:13376
  ds_write_b128 v3, v[184:187] offset:14336
  ds_write_b128 v3, v[188:191] offset:15360
  ds_read_b64_tr_b16 v[184:185], v4 offset:14336
  ds_read_b64_tr_b16 v[186:187], v4 offset:15360
  ds_read_b64_tr_b16 v[188:189], v4 offset:14400
  ds_read_b64_tr_b16 v[190:191], v4 offset:15424
  s_waitcnt vmcnt(8)
  ds_write_b128 v3, v[192:195] offset:0
  ds_write_b128 v3, v[196:199] offset:1024
  ds_read_b64_tr_b16 v[192:193], v4 offset:0
  ds_read_b64_tr_b16 v[194:195], v4 offset:1024
  ds_read_b64_tr_b16 v[196:197], v4 offset:64
  ds_read_b64_tr_b16 v[198:199], v4 offset:1088
  ds_write_b128 v3, v[200:203] offset:2048
  ds_write_b128 v3, v[204:207] offset:3072
  ds_read_b64_tr_b16 v[200:201], v4 offset:2048
  ds_read_b64_tr_b16 v[202:203], v4 offset:3072
  ds_read_b64_tr_b16 v[204:205], v4 offset:2112
  ds_read_b64_tr_b16 v[206:207], v4 offset:3136
  ds_write_b128 v3, v[208:211] offset:4096
  ds_write_b128 v3, v[212:215] offset:5120
  ds_read_b64_tr_b16 v[208:209], v4 offset:4096
  ds_read_b64_tr_b16 v[210:211], v4 offset:5120
  ds_read_b64_tr_b16 v[212:213], v4 offset:4160
  ds_read_b64_tr_b16 v[214:215], v4 offset:5184
  ds_write_b128 v3, v[216:219] offset:6144
  ds_write_b128 v3, v[220:223] offset:7168
  ds_read_b64_tr_b16 v[216:217], v4 offset:6144
  ds_read_b64_tr_b16 v[218:219], v4 offset:7168
  ds_read_b64_tr_b16 v[220:221], v4 offset:6208
  ds_read_b64_tr_b16 v[222:223], v4 offset:7232
  s_waitcnt vmcnt(0)
  ds_write_b128 v3, v[224:227] offset:8192
  ds_write_b128 v3, v[228:231] offset:9216
  ds_read_b64_tr_b16 v[224:225], v4 offset:8192
  ds_read_b64_tr_b16 v[226:227], v4 offset:9216
  ds_read_b64_tr_b16 v[228:229], v4 offset:8256
  ds_read_b64_tr_b16 v[230:231], v4 offset:9280
  ds_write_b128 v3, v[232:235] offset:10240
  ds_write_b128 v3, v[236:239] offset:11264
  ds_read_b64_tr_b16 v[232:233], v4 offset:10240
  ds_read_b64_tr_b16 v[234:235], v4 offset:11264
  ds_read_b64_tr_b16 v[236:237], v4 offset:10304
  ds_read_b64_tr_b16 v[238:239], v4 offset:11328
  ds_write_b128 v3, v[240:243] offset:12288
  ds_write_b128 v3, v[244:247] offset:13312
  ds_read_b64_tr_b16 v[240:241], v4 offset:12288
  ds_read_b64_tr_b16 v[242:243], v4 offset:13312
  ds_read_b64_tr_b16 v[244:245], v4 offset:12352
  ds_read_b64_tr_b16 v[246:247], v4 offset:13376
  ds_write_b128 v3, v[248:251] offset:14336
  ds_write_b128 v3, v[252:255] offset:15360
  ds_read_b64_tr_b16 v[248:249], v4 offset:14336
  ds_read_b64_tr_b16 v[250:251], v4 offset:15360
  ds_read_b64_tr_b16 v[252:253], v4 offset:14400
  ds_read_b64_tr_b16 v[254:255], v4 offset:15424
  s_waitcnt lgkmcnt(0)
  s_barrier
L_s4_kept:
  s_lshl_b32 s30, s26, 13
  v_add_u32 v3, s30, v1
  s_lshr_b32 s30, s26, 1
  s_and_b32 s31, s26, 1
  s_lshl_b32 s28, s30, 10
  s_lshl_b32 s29, s31, 3
  s_add_u32 s28, s28, s29
  v_add_u32 v4, s28, v1
  v_and_b32 v5, 30, v0
  v_lshlrev_b32 v5, 1, v5
  v_and_b32 v6, 1, v0
  v_lshl_add_u32 v5, v6, 6, v5
  v_lshl_add_u32 v5, v11, 14, v5
  s_lshl_b32 s30, s30, 15
  s_lshl_b32 s31, s31, 13
  s_add_u32 s30, s30, s31
  s_lshl_b32 s31, s89, 7
  s_add_u32 s30, s30, s31
  s_add_u32 s30, s30, 2048
  v_add_u32 v5, s30, v5
  s_bfe_u32 s38, s92, 0x3001c
  s_lshl_b32 s30, s38, 7
  v_lshrrev_b32 v6, 4, v0
  v_mul_lo_u32 v6, v6, s30
  v_and_b32 v2, 15, v0
  v_lshl_add_u32 v6, v2, 3, v6
  v_add_u32 v6, 84938752, v6
  s_mov_b32 s46, 0x20000
  s_mov_b32 s44, 0xaaaaaaaa
  s_mov_b32 s45, 0xaaaaaaaa
  s_mov_b32 s37, s88
  s_mov_b64 s[12:13], s[4:5]
  s_lshl_b32 s40, s42, 14
  s_add_u32 s40, s40, 50331648
  s_lshl_b32 s30, s43, 11
L_s4_cold:
  s_xor_b32 s46, s46, 4
  v_mov_b32 v10, s46
  s_cmp_lg_u32 s26, 0
  s_cbranch_scc1 L_s4_wk
  s_lshl_b32 s39, s37, 7
  s_mov_b32 s41, s37
  buffer_load_dwordx2 v[8:9], v6, s[4:7], s39 offen sc1
  s_waitcnt vmcnt(0)
  v_min_u32 v8, v8, v9
  v_cmp_eq_u32 vcc, 0, v8
  s_nop 0
  s_ff1_i32_b64 s32, vcc
  s_min_u32 s32, s32, 64
  s_lshr_b32 s32, s32, 4
  s_mul_i32 s32, s32, s38
  s_add_u32 s41, s41, s32
  v_mov_b32 v8, 0
  s_cmp_lg_u32 s41, s37
  s_cbranch_scc1 L_s4_wj
  s_mov_b64 exec, 0xffff
  s_cmp_ge_u32 s37, 62
  s_cbranch_scc1 L_s4_hot
L_s4_v:
  s_sleep 10
  buffer_load_dwordx2 v[12:13], v6, s[4:7], s39 offen sc1
  s_waitcnt vmcnt(0)
  v_min_u32 v14, v12, v13
  v_cmp_eq_u32 vcc, 0, v14
  s_cbranch_vccz L_s4_wi
  s_add_u32 s27, s27, 1
  s_cmp_lt_u32 s27, 0x80000
  s_cbranch_scc1 L_s4_v
L_s4_hot:
  buffer_load_dwordx2 v[12:13], v6, s[4:7], s39 offen sc1
  s_sleep 5
  buffer_load_dwordx2 v[12:13], v6, s[4:7], s39 offen sc1
  s_sleep 5
L_s4_w:
  buffer_load_dwordx2 v[12:13], v6, s[4:7], s39 offen sc1
  s_waitcnt vmcnt(2)
  v_min_u32 v14, v12, v13
  v_cmp_eq_u32 vcc, 0, v14
  s_cbranch_vccz L_s4_wi
  s_add_u32 s27, s27, 1
  s_cmp_lt_u32 s27, 0x80000
  s_cbranch_scc1 L_s4_w
L_s4_wi:
  s_mov_b64 exec, -1
  s_add_u32 s41, s41, s38
L_s4_wj:
  v_mov_b32 v11, s41
  ds_write_b32 v10, v11
  s_waitcnt lgkmcnt(0)
L_s4_wk:
  s_barrier
  ds_read_b32 v11, v10
  s_mov_b32 s14, 0x10000000
  s_lshl_b32 s28, s37, 18
  s_add_u32 s28, s28, s40
  s_add_u32 s31, s28, s30
  buffer_load_dwordx4 v[64:67], v1, s[12:15], s31 offen
  s_add_u32 s30, s30, 1024
  s_and_b32 s30, s30, 0x3fff
  s_add_u32 s31, s28, s30
  buffer_load_dwordx4 v[68:71], v1, s[12:15], s31 offen
  s_add_u32 s30, s30, 1024
  s_and_b32 s30, s30, 0x3fff
  s_add_u32 s31, s28, s30
  buffer_load_dwordx4 v[72:75], v1, s[12:15], s31 offen
  s_add_u32 s30, s30, 1024
  s_and_b32 s30, s30, 0x3fff
  s_add_u32 s31, s28, s30
  buffer_load_dwordx4 v[76:79], v1, s[12:15], s31 offen
  s_add_u32 s30, s30, 1024
  s_and_b32 s30, s30, 0x3fff
  s_add_u32 s31, s28, s30
  buffer_load_dwordx4 v[80:83], v1, s[12:15], s31 offen
  s_add_u32 s30, s30, 1024
  s_and_b32 s30, s30, 0x3fff
  s_add_u32 s31, s28, s30
  buffer_load_dwordx4 v[84:87], v1, s[12:15], s31 offen
  s_add_u32 s30, s30, 1024
  s_and_b32 s30, s30, 0x3fff
  s_add_u32 s31, s28, s30
  buffer_load_dwordx4 v[88:91], v1, s[12:15], s31 offen
  s_add_u32 s30, s30, 1024
  s_and_b32 s30, s30, 0x3fff
  s_add_u32 s31, s28, s30
  buffer_load_dwordx4 v[92:95], v1, s[12:15], s31 offen
  s_add_u32 s30, s30, 1024
  s_and_b32 s30, s30, 0x3fff
  s_add_u32 s31, s28, s30
  buffer_load_dwordx4 v[96:99], v1, s[12:15], s31 offen
  s_add_u32 s30, s30, 1024
  s_and_b32 s30, s30, 0x3fff
  s_add_u32 s31, s28, s30
  buffer_load_dwordx4 v[100:103], v1, s[12:15], s31 offen
  s_add_u32 s30, s30, 1024
  s_and_b32 s30, s30, 0x3fff
  s_add_u32 s31, s28, s30
  buffer_load_dwordx4 v[104:107], v1, s[12:15], s31 offen
  s_add_u32 s30, s30, 1024
  s_and_b32 s30, s30, 0x3fff
  s_add_u32 s31, s28, s30
  buffer_load_dwordx4 v[108:111], v1, s[12:15], s31 offen
  s_add_u32 s30, s30, 1024
  s_and_b32 s30, s30, 0x3fff
  s_add_u32 s31, s28, s30
  buffer_load_dwordx4 v[112:115], v1, s[12:15], s31 offen
  s_add_u32 s30, s30, 1024
  s_and_b32 s30, s30, 0x3fff
  s_add_u32 s31, s28, s30
  buffer_load_dwordx4 v[116:119], v1, s[12:15], s31 offen
  s_add_u32 s30, s30, 1024
  s_and_b32 s30, s30, 0x3fff
  s_add_u32 s31, s28, s30
  buffer_load_dwordx4 v[120:123], v1, s[12:15], s31 offen
  s_add_u32 s30, s30, 1024
  s_and_b32 s30, s30, 0x3fff
  s_add_u32 s31, s28, s30
  buffer_load_dwordx4 v[124:127], v1, s[12:15], s31 offen
  s_add_u32 s30, s30, 1024
  s_and_b32 s30, s30, 0x3fff
  buffer_load_dword v7, v1, s[12:15], s31 offen
  buffer_load_dword v7, v1, s[12:15], s31 offen
  s_waitcnt lgkmcnt(0)
  v_readfirstlane_b32 s47, v11
L_s4_first:
  s_add_u32 s36, s37, s38
  s_waitcnt vmcnt(17)
  v_mfma_f32_32x32x16_bf16 v[16:31], v[64:67], v[128:131], 0
  s_cmp_lg_u32 s26, 0
  s_cbranch_scc1 L_s4_k_21
  v_min_u32 v8, v8, v9
  v_cmp_eq_u32 vcc, 0, v8
  s_nop 0
  s_ff1_i32_b64 s32, vcc
  s_min_u32 s32, s32, 64
  s_lshr_b32 s32, s32, 4
  s_mul_i32 s32, s32, s38
  s_add_u32 s41, s41, s32
  v_mov_b32 v8, 0
  s_lshl_b32 s39, s41, 7
  s_lshl_b32 s32, s38, 2
  s_add_u32 s32, s32, s37
  s_min_u32 s32, s32, s90
  s_cmp_lt_u32 s41, s32
  s_cbranch_scc0 L_s4_k_21
  buffer_load_dwordx2 v[8:9], v6, s[4:7], s39 offen sc1
L_s4_k_21:
  s_waitcnt vmcnt(16)
  v_mfma_f32_32x32x16_bf16 v[16:31], v[68:71], v[136:139], v[16:31]
  s_waitcnt vmcnt(15)
  v_mfma_f32_32x32x16_bf16 v[16:31], v[72:75], v[144:147], v[16:31]
  s_waitcnt vmcnt(14)
  v_mfma_f32_32x32x16_bf16 v[16:31], v[76:79], v[152:155], v[16:31]
  s_waitcnt vmcnt(13)
  v_mfma_f32_32x32x16_bf16 v[16:31], v[80:83], v[160:163], v[16:31]
  s_waitcnt vmcnt(12)
  v_mfma_f32_32x32x16_bf16 v[16:31], v[84:87], v[168:171], v[16:31]
  s_waitcnt vmcnt(11)
  v_mfma_f32_32x32x16_bf16 v[16:31], v[88:91], v[176:179], v[16:31]
  v_mfma_f32_32x32x16_bf16 v[32:47], v[64:67], v[132:135], 0
  s_lshl_b32 s28, s36, 18
  s_add_u32 s28, s28, s40
  s_min_u32 s34, s47, s90
  s_cmp_lt_u32 s36, s34
  s_cselect_b32 s14, s6, 0
  s_add_u32 s31, s28, s30
  buffer_load_dwordx4 v[64:67], v1, s[12:15], s31 offen
  s_add_u32 s30, s30, 1024
  s_and_b32 s30, s30, 0x3fff
  s_waitcnt vmcnt(11)
  v_mfma_f32_32x32x16_bf16 v[16:31], v[92:95], v[184:187], v[16:31]
  v_mfma_f32_32x32x16_bf16 v[32:47], v[68:71], v[140:143], v[32:47]
  s_add_u32 s31, s28, s30
  buffer_load_dwordx4 v[68:71], v1, s[12:15], s31 offen
  s_add_u32 s30, s30, 1024
  s_and_b32 s30, s30, 0x3fff
  s_waitcnt vmcnt(11)
  v_mfma_f32_32x32x16_bf16 v[16:31], v[96:99], v[192:195], v[16:31]
  v_mfma_f32_32x32x16_bf16 v[32:47], v[72:75], v[148:151], v[32:47]
  s_add_u32 s31, s28, s30
  buffer_load_dwordx4 v[72:75], v1, s[12:15], s31 offen
  s_add_u32 s30, s30, 1024
  s_and_b32 s30, s30, 0x3fff
  s_waitcnt vmcnt(11)
  v_mfma_f32_32x32x16_bf16 v[16:31], v[100:103], v[200:203], v[16:31]
  v_mfma_f32_32x32x16_bf16 v[32:47], v[76:79], v[156:159], v[32:47]
  s_add_u32 s31, s28, s30
  buffer_load_dwordx4 v[76:79], v1, s[12:15], s31 offen
  s_add_u32 s30, s30, 1024
  s_and_b32 s30, s30, 0x3fff
  s_waitcnt vmcnt(11)
  v_mfma_f32_32x32x16_bf16 v[16:31], v[104:107], v[208:211], v[16:31]
  v_mfma_f32_32x32x16_bf16 v[32:47], v[80:83], v[164:167], v[32:47]
  s_add_u32 s31, s28, s30
  buffer_load_dwordx4 v[80:83], v1, s[12:15], s31 offen
  s_add_u32 s30, s30, 1024
  s_and_b32 s30, s30, 0x3fff
  s_waitcnt vmcnt(11)
  v_mfma_f32_32x32x16_bf16 v[16:31], v[108:111], v[216:219], v[16:31]
  v_mfma_f32_32x32x16_bf16 v[32:47], v[84:87], v[172:175], v[32:47]
  s_add_u32 s31, s28, s30
  buffer_load_dwordx4 v[84:87], v1, s[12:15], s31 offen
  s_add_u32 s30, s30, 1024
  s_and_b32 s30, s30, 0x3fff
  s_waitcnt vmcnt(11)
  v_mfma_f32_32x32x16_bf16 v[16:31], v[112:115], v[224:227], v[16:31]
  v_mfma_f32_32x32x16_bf16 v[32:47], v[88:91], v[180:183], v[32:47]
  s_add_u32 s31, s28, s30
  buffer_load_dwordx4 v[88:91], v1, s[12:15], s31 offen
  s_add_u32 s30, s30, 1024
  s_and_b32 s30, s30, 0x3fff
  s_waitcnt vmcnt(11)
  v_mfma_f32_32x32x16_bf16 v[16:31], v[116:119], v[232:235], v[16:31]
  s_or_b32 s32, s26, s14
  s_cbranch_scc1 L_s4_m_22
  buffer_load_dwordx2 v[8:9], v6, s[4:7], s39 offen sc1
L_s4_m_22:
  v_mfma_f32_32x32x16_bf16 v[32:47], v[92:95], v[188:191], v[32:47]
  s_add_u32 s31, s28, s30
  buffer_load_dwordx4 v[92:95], v1, s[12:15], s31 offen
  s_add_u32 s30, s30, 1024
  s_and_b32 s30, s30, 0x3fff
  s_waitcnt vmcnt(11)
  v_mfma_f32_32x32x16_bf16 v[16:31], v[120:123], v[240:243], v[16:31]
  v_mfma_f32_32x32x16_bf16 v[32:47], v[96:99], v[196:199], v[32:47]
  s_add_u32 s31, s28, s30
  buffer_load_dwordx4 v[96:99], v1, s[12:15], s31 offen
  s_add_u32 s30, s30, 1024
  s_and_b32 s30, s30, 0x3fff
  s_waitcnt vmcnt(11)
  v_mfma_f32_32x32x16_bf16 v[16:31], v[124:127], v[248:251], v[16:31]
  v_mfma_f32_32x32x16_bf16 v[32:47], v[100:103], v[204:207], v[32:47]
  s_add_u32 s31, s28, s30
  buffer_load_dwordx4 v[100:103], v1, s[12:15], s31 offen
  s_add_u32 s30, s30, 1024
  s_and_b32 s30, s30, 0x3fff
  v_mfma_f32_32x32x16_bf16 v[32:47], v[104:107], v[212:215], v[32:47]
  s_add_u32 s31, s28, s30
  buffer_load_dwordx4 v[104:107], v1, s[12:15], s31 offen
  s_add_u32 s30, s30, 1024
  s_and_b32 s30, s30, 0x3fff
  v_mfma_f32_32x32x16_bf16 v[32:47], v[108:111], v[220:223], v[32:47]
  s_add_u32 s31, s28, s30
  buffer_load_dwordx4 v[108:111], v1, s[12:15], s31 offen
  s_add_u32 s30, s30, 1024
  s_and_b32 s30, s30, 0x3fff
  ds_write_b128 v3, v[16:19] offset:0
  v_mfma_f32_32x32x16_bf16 v[32:47], v[112:115], v[228:231], v[32:47]
  s_add_u32 s31, s28, s30
  buffer_load_dwordx4 v[112:115], v1, s[12:15], s31 offen
  s_add_u32 s30, s30, 1024
  s_and_b32 s30, s30, 0x3fff
  ds_write_b128 v3, v[20:23] offset:1024
  v_mfma_f32_32x32x16_bf16 v[32:47], v[116:119], v[236:239], v[32:47]
  s_add_u32 s31, s28, s30
  buffer_load_dwordx4 v[116:119], v1, s[12:15], s31 offen
  s_add_u32 s30, s30, 1024
  s_and_b32 s30, s30, 0x3fff
  ds_write_b128 v3, v[24:27] offset:2048
  v_mfma_f32_32x32x16_bf16 v[32:47], v[120:123], v[244:247], v[32:47]
  s_add_u32 s31, s28, s30
  buffer_load_dwordx4 v[120:123], v1, s[12:15], s31 offen
  s_add_u32 s30, s30, 1024
  s_and_b32 s30, s30, 0x3fff
  ds_write_b128 v3, v[28:31] offset:3072
  v_mfma_f32_32x32x16_bf16 v[32:47], v[124:127], v[252:255], v[32:47]
  s_add_u32 s31, s28, s30
  buffer_load_dwordx4 v[124:127], v1, s[12:15], s31 offen
  s_add_u32 s30, s30, 1024
  s_and_b32 s30, s30, 0x3fff
  buffer_load_dword v7, v1, s[12:15], s31 offen
  buffer_load_dword v7, v1, s[12:15], s31 offen
  s_lshl_b32 s29, s37, 17
  s_mov_b32 s37, s36
  s_cmp_lt_u32 s37, s34
  s_cbranch_scc0 L_s4_flush
.p2align 6
L_s4_loop:
  s_add_u32 s36, s37, s38
  s_waitcnt vmcnt(17)
  v_mfma_f32_32x32x16_bf16 v[16:31], v[64:67], v[128:131], 0
  ds_write_b128 v3, v[32:35] offset:4096
  ds_write_b128 v3, v[36:39] offset:5120
  s_xor_b32 s46, s46, 4
  v_mov_b32 v10, s46
  s_cmp_lg_u32 s26, 0
  s_cbranch_scc1 L_s4_k_23
  v_min_u32 v8, v8, v9
  v_cmp_eq_u32 vcc, 0, v8
  s_nop 0
  s_ff1_i32_b64 s32, vcc
  s_min_u32 s32, s32, 64
  s_lshr_b32 s32, s32, 4
  s_mul_i32 s32, s32, s38
  s_add_u32 s41, s41, s32
  v_mov_b32 v8, 0
  v_mov_b32 v11, s41
  ds_write_b32 v10, v11
  s_lshl_b32 s39, s41, 7
  s_lshl_b32 s32, s38, 2
  s_add_u32 s32, s32, s37
  s_min_u32 s32, s32, s90
  s_cmp_lt_u32 s41, s32
  s_cbranch_scc0 L_s4_k_23
  buffer_load_dwordx2 v[8:9], v6, s[4:7], s39 offen sc1
L_s4_k_23:
  s_waitcnt vmcnt(16)
  v_mfma_f32_32x32x16_bf16 v[16:31], v[68:71], v[136:139], v[16:31]
  ds_write_b128 v3, v[40:43] offset:6144
  ds_write_b128 v3, v[44:47] offset:7168
  s_waitcnt vmcnt(15)
  v_mfma_f32_32x32x16_bf16 v[16:31], v[72:75], v[144:147], v[16:31]
  v_xor_b32 v3, 0x10000, v3
  s_waitcnt vmcnt(14)
  v_mfma_f32_32x32x16_bf16 v[16:31], v[76:79], v[152:155], v[16:31]
  s_waitcnt vmcnt(13)
  v_mfma_f32_32x32x16_bf16 v[16:31], v[80:83], v[160:163], v[16:31]
  s_waitcnt lgkmcnt(0)
  s_barrier
  ds_read_b32 v11, v10
  ds_read_b64 v[48:49], v4 offset:0
  ds_read_b64 v[50:51], v4 offset:8192
  ds_read_b64 v[52:53], v4 offset:16384
  ds_read_b64 v[54:55], v4 offset:24576
  ds_read_b64 v[56:57], v4 offset:32768
  ds_read_b64 v[58:59], v4 offset:40960
  ds_read_b64 v[60:61], v4 offset:49152
  ds_read_b64 v[62:63], v4 offset:57344
  s_waitcnt vmcnt(12)
  v_mfma_f32_32x32x16_bf16 v[16:31], v[84:87], v[168:171], v[16:31]
  s_waitcnt vmcnt(11)
  v_mfma_f32_32x32x16_bf16 v[16:31], v[88:91], v[176:179], v[16:31]
  s_waitcnt lgkmcnt(8)
  v_readfirstlane_b32 s47, v11
  v_mfma_f32_32x32x16_bf16 v[32:47], v[64:67], v[132:135], 0
  s_lshl_b32 s28, s36, 18
  s_add_u32 s28, s28, s40
  s_min_u32 s34, s47, s90
  s_cmp_lt_u32 s36, s34
  s_cselect_b32 s14, s6, 0
  s_add_u32 s31, s28, s30
  buffer_load_dwordx4 v[64:67], v1, s[12:15], s31 offen
  s_add_u32 s30, s30, 1024
  s_and_b32 s30, s30, 0x3fff
  s_waitcnt vmcnt(11)
  v_mfma_f32_32x32x16_bf16 v[16:31], v[92:95], v[184:187], v[16:31]
  v_mfma_f32_32x32x16_bf16 v[32:47], v[68:71], v[140:143], v[32:47]
  s_add_u32 s31, s28, s30
  buffer_load_dwordx4 v[68:71], v1, s[12:15], s31 offen
  s_add_u32 s30, s30, 1024
  s_and_b32 s30, s30, 0x3fff
  s_waitcnt vmcnt(11)
  v_mfma_f32_32x32x16_bf16 v[16:31], v[96:99], v[192:195], v[16:31]
  v_mfma_f32_32x32x16_bf16 v[32:47], v[72:75], v[148:151], v[32:47]
  s_add_u32 s31, s28, s30
  buffer_load_dwordx4 v[72:75], v1, s[12:15], s31 offen
  s_add_u32 s30, s30, 1024
  s_and_b32 s30, s30, 0x3fff
  s_waitcnt vmcnt(11)
  v_mfma_f32_32x32x16_bf16 v[16:31], v[100:103], v[200:203], v[16:31]
  s_waitcnt lgkmcnt(0)
  v_pk_add_f32 v[48:49], v[48:49], v[56:57]
  v_pk_add_f32 v[50:51], v[50:51], v[58:59]
  v_pk_add_f32 v[52:53], v[52:53], v[60:61]
  v_pk_add_f32 v[54:55], v[54:55], v[62:63]
  v_mfma_f32_32x32x16_bf16 v[32:47], v[76:79], v[156:159], v[32:47]
  s_add_u32 s31, s28, s30
  buffer_load_dwordx4 v[76:79], v1, s[12:15], s31 offen
  s_add_u32 s30, s30, 1024
  s_and_b32 s30, s30, 0x3fff
  v_pk_add_f32 v[48:49], v[48:49], v[52:53]
  v_pk_add_f32 v[50:51], v[50:51], v[54:55]
  v_pk_add_f32 v[12:13], v[48:49], v[50:51]
  ds_read_b64 v[48:49], v4 offset:4096
  ds_read_b64 v[50:51], v4 offset:12288
  ds_read_b64 v[52:53], v4 offset:20480
  ds_read_b64 v[54:55], v4 offset:28672
  ds_read_b64 v[56:57], v4 offset:36864
  ds_read_b64 v[58:59], v4 offset:45056
  ds_read_b64 v[60:61], v4 offset:53248
  ds_read_b64 v[62:63], v4 offset:61440
  s_waitcnt vmcnt(11)
  v_mfma_f32_32x32x16_bf16 v[16:31], v[104:107], v[208:211], v[16:31]
  v_mfma_f32_32x32x16_bf16 v[32:47], v[80:83], v[164:167], v[32:47]
  s_add_u32 s31, s28, s30
  buffer_load_dwordx4 v[80:83], v1, s[12:15], s31 offen
  s_add_u32 s30, s30, 1024
  s_and_b32 s30, s30, 0x3fff
  s_waitcnt vmcnt(11)
  v_mfma_f32_32x32x16_bf16 v[16:31], v[108:111], v[216:219], v[16:31]
  v_mfma_f32_32x32x16_bf16 v[32:47], v[84:87], v[172:175], v[32:47]
  s_add_u32 s31, s28, s30
  buffer_load_dwordx4 v[84:87], v1, s[12:15], s31 offen
  s_add_u32 s30, s30, 1024
  s_and_b32 s30, s30, 0x3fff
  s_waitcnt vmcnt(11)
  v_mfma_f32_32x32x16_bf16 v[16:31], v[112:115], v[224:227], v[16:31]
  s_waitcnt lgkmcnt(0)
  v_pk_add_f32 v[48:49], v[48:49], v[56:57]
  v_pk_add_f32 v[50:51], v[50:51], v[58:59]
  v_pk_add_f32 v[52:53], v[52:53], v[60:61]
  v_pk_add_f32 v[54:55], v[54:55], v[62:63]
  v_mfma_f32_32x32x16_bf16 v[32:47], v[88:91], v[180:183], v[32:47]
  s_add_u32 s31, s28, s30
  buffer_load_dwordx4 v[88:91], v1, s[12:15], s31 offen
  s_add_u32 s30, s30, 1024
  s_and_b32 s30, s30, 0x3fff
  v_pk_add_f32 v[48:49], v[48:49], v[52:53]
  v_pk_add_f32 v[50:51], v[50:51], v[54:55]
  v_pk_add_f32 v[14:15], v[48:49], v[50:51]
  s_waitcnt vmcnt(11)
  v_mfma_f32_32x32x16_bf16 v[16:31], v[116:119], v[232:235], v[16:31]
  s_or_b32 s32, s26, s14
  s_cbranch_scc1 L_s4_m_24
  buffer_load_dwordx2 v[8:9], v6, s[4:7], s39 offen sc1
L_s4_m_24:
  v_mfma_f32_32x32x16_bf16 v[32:47], v[92:95], v[188:191], v[32:47]
  s_add_u32 s31, s28, s30
  buffer_load_dwordx4 v[92:95], v1, s[12:15], s31 offen
  s_add_u32 s30, s30, 1024
  s_and_b32 s30, s30, 0x3fff
  s_mov_b64 vcc, s[44:45]
  v_xor_b32 v4, 0x10000, v4
  v_mov_b32_dpp v48, v14 quad_perm:[1,0,3,2] row_mask:0xf bank_mask:0xf
  v_cndmask_b32_dpp v50, v12, v14, vcc quad_perm:[1,0,3,2] row_mask:0xf bank_mask:0xf
  v_mov_b32_dpp v49, v15 quad_perm:[1,0,3,2] row_mask:0xf bank_mask:0xf
  v_cndmask_b32_dpp v51, v13, v15, vcc quad_perm:[1,0,3,2] row_mask:0xf bank_mask:0xf
  s_waitcnt vmcnt(11)
  v_mfma_f32_32x32x16_bf16 v[16:31], v[120:123], v[240:243], v[16:31]
  v_cndmask_b32 v48, v12, v48, vcc
  v_cndmask_b32 v49, v13, v49, vcc
  v_cvt_pk_bf16_f32 v10, v48, v50
  v_cvt_pk_bf16_f32 v11, v49, v51
  v_mfma_f32_32x32x16_bf16 v[32:47], v[96:99], v[196:199], v[32:47]
  s_add_u32 s31, s28, s30
  buffer_load_dwordx4 v[96:99], v1, s[12:15], s31 offen
  s_add_u32 s30, s30, 1024
  s_and_b32 s30, s30, 0x3fff
  s_waitcnt vmcnt(11)
  v_mfma_f32_32x32x16_bf16 v[16:31], v[124:127], v[248:251], v[16:31]
  v_mfma_f32_32x32x16_bf16 v[32:47], v[100:103], v[204:207], v[32:47]
  s_add_u32 s31, s28, s30
  buffer_load_dwordx4 v[100:103], v1, s[12:15], s31 offen
  s_add_u32 s30, s30, 1024
  s_and_b32 s30, s30, 0x3fff
  v_mfma_f32_32x32x16_bf16 v[32:47], v[104:107], v[212:215], v[32:47]
  s_add_u32 s31, s28, s30
  buffer_load_dwordx4 v[104:107], v1, s[12:15], s31 offen
  s_add_u32 s30, s30, 1024
  s_and_b32 s30, s30, 0x3fff
  v_mfma_f32_32x32x16_bf16 v[32:47], v[108:111], v[220:223], v[32:47]
  s_add_u32 s31, s28, s30
  buffer_load_dwordx4 v[108:111], v1, s[12:15], s31 offen
  s_add_u32 s30, s30, 1024
  s_and_b32 s30, s30, 0x3fff
  ds_write_b128 v3, v[16:19] offset:0
  v_mfma_f32_32x32x16_bf16 v[32:47], v[112:115], v[228:231], v[32:47]
  s_add_u32 s31, s28, s30
  buffer_load_dwordx4 v[112:115], v1, s[12:15], s31 offen
  s_add_u32 s30, s30, 1024
  s_and_b32 s30, s30, 0x3fff
  ds_write_b128 v3, v[20:23] offset:1024
  v_mfma_f32_32x32x16_bf16 v[32:47], v[116:119], v[236:239], v[32:47]
  s_add_u32 s31, s28, s30
  buffer_load_dwordx4 v[116:119], v1, s[12:15], s31 offen
  s_add_u32 s30, s30, 1024
  s_and_b32 s30, s30, 0x3fff
  ds_write_b128 v3, v[24:27] offset:2048
  v_mfma_f32_32x32x16_bf16 v[32:47], v[120:123], v[244:247], v[32:47]
  s_add_u32 s31, s28, s30
  buffer_load_dwordx4 v[120:123], v1, s[12:15], s31 offen
  s_add_u32 s30, s30, 1024
  s_and_b32 s30, s30, 0x3fff
  ds_write_b128 v3, v[28:31] offset:3072
  v_mfma_f32_32x32x16_bf16 v[32:47], v[124:127], v[252:255], v[32:47]
  s_add_u32 s31, s28, s30
  buffer_load_dwordx4 v[124:127], v1, s[12:15], s31 offen
  s_add_u32 s30, s30, 1024
  s_and_b32 s30, s30, 0x3fff
  buffer_atomic_pk_add_bf16 v10, v5, s[20:23], s29 offen
  s_add_u32 s29, s29, 0x1000
  buffer_atomic_pk_add_bf16 v11, v5, s[20:23], s29 offen
  s_lshl_b32 s29, s37, 17
  s_mov_b32 s37, s36
  s_cmp_lt_u32 s37, s34
  s_cbranch_scc1 L_s4_loop
L_s4_flush:
  s_xor_b32 s46, s46, 4
  v_mov_b32 v10, s46
  s_nop 5
  ds_write_b128 v3, v[32:35] offset:4096
  ds_write_b128 v3, v[36:39] offset:5120
  ds_write_b128 v3, v[40:43] offset:6144
  ds_write_b128 v3, v[44:47] offset:7168
  v_xor_b32 v3, 0x10000, v3
  s_cmp_lg_u32 s26, 0
  s_cbranch_scc1 L_s4_f1
  s_waitcnt vmcnt(2)
  v_min_u32 v8, v8, v9
  v_cmp_eq_u32 vcc, 0, v8
  s_nop 0
  s_ff1_i32_b64 s32, vcc
  s_min_u32 s32, s32, 64
  s_lshr_b32 s32, s32, 4
  s_mul_i32 s32, s32, s38
  s_add_u32 s41, s41, s32
  v_mov_b32 v8, 0
  v_mov_b32 v11, s41
  ds_write_b32 v10, v11
L_s4_f1:
  s_waitcnt lgkmcnt(0)
  s_barrier
  ds_read_b32 v11, v10
  ds_read_b64 v[48:49], v4 offset:0
  ds_read_b64 v[50:51], v4 offset:8192
  ds_read_b64 v[52:53], v4 offset:16384
  ds_read_b64 v[54:55], v4 offset:24576
  ds_read_b64 v[56:57], v4 offset:32768
  ds_read_b64 v[58:59], v4 offset:40960
  ds_read_b64 v[60:61], v4 offset:49152
  ds_read_b64 v[62:63], v4 offset:57344
  s_waitcnt lgkmcnt(8)
  v_readfirstlane_b32 s47, v11
  s_nop 0
  s_min_u32 s34, s47, s90
  s_cmp_lt_u32 s37, s34
  s_cbranch_scc0 L_s4_f2
  s_mov_b32 s14, 0x10000000
  s_add_u32 s31, s28, s30
  buffer_load_dwordx4 v[64:67], v1, s[12:15], s31 offen
  s_add_u32 s30, s30, 1024
  s_and_b32 s30, s30, 0x3fff
  s_add_u32 s31, s28, s30
  buffer_load_dwordx4 v[68:71], v1, s[12:15], s31 offen
  s_add_u32 s30, s30, 1024
  s_and_b32 s30, s30, 0x3fff
  s_add_u32 s31, s28, s30
  buffer_load_dwordx4 v[72:75], v1, s[12:15], s31 offen
  s_add_u32 s30, s30, 1024
  s_and_b32 s30, s30, 0x3fff
  s_add_u32 s31, s28, s30
  buffer_load_dwordx4 v[76:79], v1, s[12:15], s31 offen
  s_add_u32 s30, s30, 1024
  s_and_b32 s30, s30, 0x3fff
  s_add_u32 s31, s28, s30
  buffer_load_dwordx4 v[80:83], v1, s[12:15], s31 offen
  s_add_u32 s30, s30, 1024
  s_and_b32 s30, s30, 0x3fff
  s_add_u32 s31, s28, s30
  buffer_load_dwordx4 v[84:87], v1, s[12:15], s31 offen
  s_add_u32 s30, s30, 1024
  s_and_b32 s30, s30, 0x3fff
  s_add_u32 s31, s28, s30
  buffer_load_dwordx4 v[88:91], v1, s[12:15], s31 offen
  s_add_u32 s30, s30, 1024
  s_and_b32 s30, s30, 0x3fff
  s_add_u32 s31, s28, s30
  buffer_load_dwordx4 v[92:95], v1, s[12:15], s31 offen
  s_add_u32 s30, s30, 1024
  s_and_b32 s30, s30, 0x3fff
  s_add_u32 s31, s28, s30
  buffer_load_dwordx4 v[96:99], v1, s[12:15], s31 offen
  s_add_u32 s30, s30, 1024
  s_and_b32 s30, s30, 0x3fff
  s_add_u32 s31, s28, s30
  buffer_load_dwordx4 v[100:103], v1, s[12:15], s31 offen
  s_add_u32 s30, s30, 1024
  s_and_b32 s30, s30, 0x3fff
  s_add_u32 s31, s28, s30
  buffer_load_dwordx4 v[104:107], v1, s[12:15], s31 offen
  s_add_u32 s30, s30, 1024
  s_and_b32 s30, s30, 0x3fff
  s_add_u32 s31, s28, s30
  buffer_load_dwordx4 v[108:111], v1, s[12:15], s31 offen
  s_add_u32 s30, s30, 1024
  s_and_b32 s30, s30, 0x3fff
  s_add_u32 s31, s28, s30
  buffer_load_dwordx4 v[112:115], v1, s[12:15], s31 offen
  s_add_u32 s30, s30, 1024
  s_and_b32 s30, s30, 0x3fff
  s_add_u32 s31, s28, s30
  buffer_load_dwordx4 v[116:119], v1, s[12:15], s31 offen
  s_add_u32 s30, s30, 1024
  s_and_b32 s30, s30, 0x3fff
  s_add_u32 s31, s28, s30
  buffer_load_dwordx4 v[120:123], v1, s[12:15], s31 offen
  s_add_u32 s30, s30, 1024
  s_and_b32 s30, s30, 0x3fff
  s_add_u32 s31, s28, s30
  buffer_load_dwordx4 v[124:127], v1, s[12:15], s31 offen
  s_add_u32 s30, s30, 1024
  s_and_b32 s30, s30, 0x3fff
L_s4_f2:
  s_waitcnt lgkmcnt(0)
  v_pk_add_f32 v[48:49], v[48:49], v[56:57]
  v_pk_add_f32 v[50:51], v[50:51], v[58:59]
  v_pk_add_f32 v[52:53], v[52:53], v[60:61]
  v_pk_add_f32 v[54:55], v[54:55], v[62:63]
  v_pk_add_f32 v[48:49], v[48:49], v[52:53]
  v_pk_add_f32 v[50:51], v[50:51], v[54:55]
  v_pk_add_f32 v[12:13], v[48:49], v[50:51]
  ds_read_b64 v[48:49], v4 offset:4096
  ds_read_b64 v[50:51], v4 offset:12288
  ds_read_b64 v[52:53], v4 offset:20480
  ds_read_b64 v[54:55], v4 offset:28672
  ds_read_b64 v[56:57], v4 offset:36864
  ds_read_b64 v[58:59], v4 offset:45056
  ds_read_b64 v[60:61], v4 offset:53248
  ds_read_b64 v[62:63], v4 offset:61440
  s_waitcnt lgkmcnt(0)
  v_pk_add_f32 v[48:49], v[48:49], v[56:57]
  v_pk_add_f32 v[50:51], v[50:51], v[58:59]
  v_pk_add_f32 v[52:53], v[52:53], v[60:61]
  v_pk_add_f32 v[54:55], v[54:55], v[62:63]
  v_pk_add_f32 v[48:49], v[48:49], v[52:53]
  v_pk_add_f32 v[50:51], v[50:51], v[54:55]
  v_pk_add_f32 v[14:15], v[48:49], v[50:51]
  s_mov_b64 vcc, s[44:45]
  v_xor_b32 v4, 0x10000, v4
  v_mov_b32_dpp v48, v14 quad_perm:[1,0,3,2] row_mask:0xf bank_mask:0xf
  v_cndmask_b32_dpp v50, v12, v14, vcc quad_perm:[1,0,3,2] row_mask:0xf bank_mask:0xf
  v_mov_b32_dpp v49, v15 quad_perm:[1,0,3,2] row_mask:0xf bank_mask:0xf
  v_cndmask_b32_dpp v51, v13, v15, vcc quad_perm:[1,0,3,2] row_mask:0xf bank_mask:0xf
  v_cndmask_b32 v48, v12, v48, vcc
  v_cndmask_b32 v49, v13, v49, vcc
  v_cvt_pk_bf16_f32 v10, v48, v50
  v_cvt_pk_bf16_f32 v11, v49, v51
  buffer_atomic_pk_add_bf16 v10, v5, s[20:23], s29 offen
  s_add_u32 s29, s29, 0x1000
  buffer_atomic_pk_add_bf16 v11, v5, s[20:23], s29 offen
  s_cmp_lt_u32 s37, s34
  s_cbranch_scc1 L_s4_first
  s_cmp_lt_u32 s37, s90
  s_cbranch_scc1 L_s4_cold
  s_waitcnt vmcnt(0)
  s_barrier
  s_branch L_next
L_R:
  s_lshl_b32 s46, s24, 3
  s_lshr_b32 s28, s25, 2
  s_add_u32 s46, s46, s28
  s_and_b32 s47, s25, 3
  s_lshl_b32 s44, s24, 19
  s_add_u32 s44, s44, 85983232
  s_mov_b32 s45, 88080384
  s_mov_b32 s48, 0xcccccccc
  s_mov_b32 s49, 0xcccccccc
  s_mov_b32 s50, 0x33333333
  s_mov_b32 s51, 0x33333333
  s_mov_b32 s52, 0x3e0293ee
  s_mov_b32 s36, 0
  s_cmp_ge_u32 s26, 4
  s_cbranch_scc1 L_R_O
  s_load_dwordx2 s[16:17], s[0:1], 40
  s_load_dwordx2 s[96:97], s[0:1], 48
  s_load_dwordx2 s[12:13], s[0:1], 64
  s_load_dwordx2 s[20:21], s[0:1], 72
  s_load_dwordx2 s[92:93], s[0:1], 56
  v_lshrrev_b32 v6, 5, v0
  v_and_b32 v8, 31, v0
  v_xor_b32 v8, v8, v6
  v_lshlrev_b32 v8, 4, v8
  v_lshl_add_u32 v8, v6, 11, v8
  s_lshl_b32 s28, s26, 9
  v_add_u32 v8, s28, v8
  s_lshl_b32 s55, s26, 14
  s_add_u32 s55, s55, 65536
  v_lshrrev_b32 v2, 3, v0
  v_lshlrev_b32 v2, 11, v2
  v_and_b32 v3, 7, v0
  v_lshl_add_u32 v2, v3, 4, v2
  s_cmp_ge_u32 s26, 2
  s_cselect_b32 s34, 35840, 0
  s_lshl_b32 s28, s26, 12
  s_add_u32 s34, s34, s28
  s_add_u32 s34, s34, 13312
  v_lshrrev_b32 v1, 2, v0
  s_lshl_b32 s28, s26, 8
  v_add_u32 v1, s28, v1
  v_lshlrev_b32 v1, 13, v1
  v_and_b32 v3, 3, v0
  v_lshl_add_u32 v1, v3, 4, v1
  s_lshl_b32 s28, s46, 8
  s_lshl_b32 s29, s47, 6
  s_add_u32 s28, s28, s29
  v_add_u32 v1, s28, v1
  v_xor_b32 v3, 0x80, v1
  s_waitcnt lgkmcnt(0)
  s_and_b32 s17, s17, 0xffff
  s_mov_b32 s18, 0x400000
  s_mov_b32 s19, 0x20000
  s_and_b32 s97, s97, 0xffff
  s_mov_b32 s98, 0x4000
  s_mov_b32 s99, 0x20000
  s_and_b32 s13, s13, 0xffff
  s_mov_b32 s14, 0x800000
  s_mov_b32 s15, 0x20000
  s_and_b32 s21, s21, 0xffff
  s_mov_b32 s22, 0x800000
  s_mov_b32 s23, 0x20000
  s_and_b32 s93, s93, 0xffff
  s_mov_b32 s94, 0x800000
  s_mov_b32 s95, 0x20000
  s_bitcmp1_b32 s25, 0
  s_cbranch_scc1 L_wlP1
  s_mov_b32 s28, 0
  buffer_load_dwordx4 v[128:131], v1, s[12:15], s28 offen
  buffer_load_dwordx4 v[192:195], v3, s[20:23], s28 offen
  buffer_load_dwordx4 v[64:67], v1, s[92:95], s28 offen
  s_mov_b32 s28, 131072
  buffer_load_dwordx4 v[132:135], v1, s[12:15], s28 offen
  buffer_load_dwordx4 v[196:199], v3, s[20:23], s28 offen
  buffer_load_dwordx4 v[68:71], v1, s[92:95], s28 offen
  s_mov_b32 s28, 262144
  buffer_load_dwordx4 v[160:163], v1, s[12:15], s28 offen
  buffer_load_dwordx4 v[224:227], v3, s[20:23], s28 offen
  buffer_load_dwordx4 v[96:99], v1, s[92:95], s28 offen
  s_mov_b32 s28, 393216
  buffer_load_dwordx4 v[164:167], v1, s[12:15], s28 offen
  buffer_load_dwordx4 v[228:231], v3, s[20:23], s28 offen
  buffer_load_dwordx4 v[100:103], v1, s[92:95], s28 offen
  v_xor_b32 v9, 0x0, v8
  s_add_u32 m0, s55, 0
  s_nop 0
  buffer_load_dwordx4 v9, s[16:19], 0 offen lds
  v_xor_b32 v9, 0x1020, v8
  s_add_u32 m0, s55, 1024
  s_nop 0
  buffer_load_dwordx4 v9, s[16:19], 0 offen lds
  v_xor_b32 v9, 0x2040, v8
  s_add_u32 m0, s55, 2048
  s_nop 0
  buffer_load_dwordx4 v9, s[16:19], 0 offen lds
  v_xor_b32 v9, 0x3060, v8
  s_add_u32 m0, s55, 3072
  s_nop 0
  buffer_load_dwordx4 v9, s[16:19], 0 offen lds
  v_xor_b32 v9, 0x4080, v8
  s_add_u32 m0, s55, 4096
  s_nop 0
  buffer_load_dwordx4 v9, s[16:19], 0 offen lds
  v_xor_b32 v9, 0x50a0, v8
  s_add_u32 m0, s55, 5120
  s_nop 0
  buffer_load_dwordx4 v9, s[16:19], 0 offen lds
  v_xor_b32 v9, 0x60c0, v8
  s_add_u32 m0, s55, 6144
  s_nop 0
  buffer_load_dwordx4 v9, s[16:19], 0 offen lds
  v_xor_b32 v9, 0x70e0, v8
  s_add_u32 m0, s55, 7168
  s_nop 0
  buffer_load_dwordx4 v9, s[16:19], 0 offen lds
  v_xor_b32 v9, 0x8000, v8
  s_add_u32 m0, s55, 8192
  s_nop 0
  buffer_load_dwordx4 v9, s[16:19], 0 offen lds
  v_xor_b32 v9, 0x9020, v8
  s_add_u32 m0, s55, 9216
  s_nop 0
  buffer_load_dwordx4 v9, s[16:19], 0 offen lds
  v_xor_b32 v9, 0xa040, v8
  s_add_u32 m0, s55, 10240
  s_nop 0
  buffer_load_dwordx4 v9, s[16:19], 0 offen lds
  v_xor_b32 v9, 0xb060, v8
  s_add_u32 m0, s55, 11264
  s_nop 0
  buffer_load_dwordx4 v9, s[16:19], 0 offen lds
  v_xor_b32 v9, 0xc080, v8
  s_add_u32 m0, s55, 12288
  s_nop 0
  buffer_load_dwordx4 v9, s[16:19], 0 offen lds
  v_xor_b32 v9, 0xd0a0, v8
  s_add_u32 m0, s55, 13312
  s_nop 0
  buffer_load_dwordx4 v9, s[16:19], 0 offen lds
  v_xor_b32 v9, 0xe0c0, v8
  s_add_u32 m0, s55, 14336
  s_nop 0
  buffer_load_dwordx4 v9, s[16:19], 0 offen lds
  v_xor_b32 v9, 0xf0e0, v8
  s_add_u32 m0, s55, 15360
  s_nop 0
  buffer_load_dwordx4 v9, s[16:19], 0 offen lds
  s_lshl_b32 s28, s26, 9
  s_add_u32 m0, s34, 0
  s_nop 0
  buffer_load_dwordx4 v2, s[96:99], s28 offen offset:0 lds
  s_add_u32 m0, s34, 896
  s_nop 0
  buffer_load_dwordx4 v2, s[96:99], s28 offen offset:128 lds
  s_add_u32 m0, s34, 1792
  s_nop 0
  buffer_load_dwordx4 v2, s[96:99], s28 offen offset:256 lds
  s_add_u32 m0, s34, 2688
  s_nop 0
  buffer_load_dwordx4 v2, s[96:99], s28 offen offset:384 lds
  s_mov_b32 s28, 524288
  buffer_load_dwordx4 v[136:139], v1, s[12:15], s28 offen
  buffer_load_dwordx4 v[200:203], v3, s[20:23], s28 offen
  buffer_load_dwordx4 v[72:75], v1, s[92:95], s28 offen
  s_mov_b32 s28, 655360
  buffer_load_dwordx4 v[140:143], v1, s[12:15], s28 offen
  buffer_load_dwordx4 v[204:207], v3, s[20:23], s28 offen
  buffer_load_dwordx4 v[76:79], v1, s[92:95], s28 offen
  s_mov_b32 s28, 786432
  buffer_load_dwordx4 v[168:171], v1, s[12:15], s28 offen
  buffer_load_dwordx4 v[232:235], v3, s[20:23], s28 offen
  buffer_load_dwordx4 v[104:107], v1, s[92:95], s28 offen
  s_mov_b32 s28, 917504
  buffer_load_dwordx4 v[172:175], v1, s[12:15], s28 offen
  buffer_load_dwordx4 v[236:239], v3, s[20:23], s28 offen
  buffer_load_dwordx4 v[108:111], v1, s[92:95], s28 offen
  s_mov_b32 s28, 1048576
  buffer_load_dwordx4 v[144:147], v1, s[12:15], s28 offen
  buffer_load_dwordx4 v[208:211], v3, s[20:23], s28 offen
  buffer_load_dwordx4 v[80:83], v1, s[92:95], s28 offen
  s_mov_b32 s28, 1179648
  buffer_load_dwordx4 v[148:151], v1, s[12:15], s28 offen
  buffer_load_dwordx4 v[212:215], v3, s[20:23], s28 offen
  buffer_load_dwordx4 v[84:87], v1, s[92:95], s28 offen
  s_mov_b32 s28, 1310720
  buffer_load_dwordx4 v[176:179], v1, s[12:15], s28 offen
  buffer_load_dwordx4 v[240:243], v3, s[20:23], s28 offen
  buffer_load_dwordx4 v[112:115], v1, s[92:95], s28 offen
  s_mov_b32 s28, 1441792
  buffer_load_dwordx4 v[180:183], v1, s[12:15], s28 offen
  buffer_load_dwordx4 v[244:247], v3, s[20:23], s28 offen
  buffer_load_dwordx4 v[116:119], v1, s[92:95], s28 offen
  s_mov_b32 s28, 1572864
  buffer_load_dwordx4 v[152:155], v1, s[12:15], s28 offen
  buffer_load_dwordx4 v[216:219], v3, s[20:23], s28 offen
  buffer_load_dwordx4 v[88:91], v1, s[92:95], s28 offen
  s_mov_b32 s28, 1703936
  buffer_load_dwordx4 v[156:159], v1, s[12:15], s28 offen
  buffer_load_dwordx4 v[220:223], v3, s[20:23], s28 offen
  buffer_load_dwordx4 v[92:95], v1, s[92:95], s28 offen
  s_mov_b32 s28, 1835008
  buffer_load_dwordx4 v[184:187], v1, s[12:15], s28 offen
  buffer_load_dwordx4 v[248:251], v3, s[20:23], s28 offen
  buffer_load_dwordx4 v[120:123], v1, s[92:95], s28 offen
  s_mov_b32 s28, 1966080
  buffer_load_dwordx4 v[188:191], v1, s[12:15], s28 offen
  buffer_load_dwordx4 v[252:255], v3, s[20:23], s28 offen
  buffer_load_dwordx4 v[124:127], v1, s[92:95], s28 offen
  s_branch L_wlP2
L_wlP1:
  s_mov_b32 s28, 262144
  buffer_load_dwordx4 v[160:163], v1, s[12:15], s28 offen
  buffer_load_dwordx4 v[224:227], v3, s[20:23], s28 offen
  buffer_load_dwordx4 v[96:99], v1, s[92:95], s28 offen
  s_mov_b32 s28, 393216
  buffer_load_dwordx4 v[164:167], v1, s[12:15], s28 offen
  buffer_load_dwordx4 v[228:231], v3, s[20:23], s28 offen
  buffer_load_dwordx4 v[100:103], v1, s[92:95], s28 offen
  s_mov_b32 s28, 0
  buffer_load_dwordx4 v[128:131], v1, s[12:15], s28 offen
  buffer_load_dwordx4 v[192:195], v3, s[20:23], s28 offen
  buffer_load_dwordx4 v[64:67], v1, s[92:95], s28 offen
  s_mov_b32 s28, 131072
  buffer_load_dwordx4 v[132:135], v1, s[12:15], s28 offen
  buffer_load_dwordx4 v[196:199], v3, s[20:23], s28 offen
  buffer_load_dwordx4 v[68:71], v1, s[92:95], s28 offen
  v_xor_b32 v9, 0x0, v8
  s_add_u32 m0, s55, 0
  s_nop 0
  buffer_load_dwordx4 v9, s[16:19], 0 offen lds
  v_xor_b32 v9, 0x1020, v8
  s_add_u32 m0, s55, 1024
  s_nop 0
  buffer_load_dwordx4 v9, s[16:19], 0 offen lds
  v_xor_b32 v9, 0x2040, v8
  s_add_u32 m0, s55, 2048
  s_nop 0
  buffer_load_dwordx4 v9, s[16:19], 0 offen lds
  v_xor_b32 v9, 0x3060, v8
  s_add_u32 m0, s55, 3072
  s_nop 0
  buffer_load_dwordx4 v9, s[16:19], 0 offen lds
  v_xor_b32 v9, 0x4080, v8
  s_add_u32 m0, s55, 4096
  s_nop 0
  buffer_load_dwordx4 v9, s[16:19], 0 offen lds
  v_xor_b32 v9, 0x50a0, v8
  s_add_u32 m0, s55, 5120
  s_nop 0
  buffer_load_dwordx4 v9, s[16:19], 0 offen lds
  v_xor_b32 v9, 0x60c0, v8
  s_add_u32 m0, s55, 6144
  s_nop 0
  buffer_load_dwordx4 v9, s[16:19], 0 offen lds
  v_xor_b32 v9, 0x70e0, v8
  s_add_u32 m0, s55, 7168
  s_nop 0
  buffer_load_dwordx4 v9, s[16:19], 0 offen lds
  v_xor_b32 v9, 0x8000, v8
  s_add_u32 m0, s55, 8192
  s_nop 0
  buffer_load_dwordx4 v9, s[16:19], 0 offen lds
  v_xor_b32 v9, 0x9020, v8
  s_add_u32 m0, s55, 9216
  s_nop 0
  buffer_load_dwordx4 v9, s[16:19], 0 offen lds
  v_xor_b32 v9, 0xa040, v8
  s_add_u32 m0, s55, 10240
  s_nop 0
  buffer_load_dwordx4 v9, s[16:19], 0 offen lds
  v_xor_b32 v9, 0xb060, v8
  s_add_u32 m0, s55, 11264
  s_nop 0
  buffer_load_dwordx4 v9, s[16:19], 0 offen lds
  v_xor_b32 v9, 0xc080, v8
  s_add_u32 m0, s55, 12288
  s_nop 0
  buffer_load_dwordx4 v9, s[16:19], 0 offen lds
  v_xor_b32 v9, 0xd0a0, v8
  s_add_u32 m0, s55, 13312
  s_nop 0
  buffer_load_dwordx4 v9, s[16:19], 0 offen lds
  v_xor_b32 v9, 0xe0c0, v8
  s_add_u32 m0, s55, 14336
  s_nop 0
  buffer_load_dwordx4 v9, s[16:19], 0 offen lds
  v_xor_b32 v9, 0xf0e0, v8
  s_add_u32 m0, s55, 15360
  s_nop 0
  buffer_load_dwordx4 v9, s[16:19], 0 offen lds
  s_lshl_b32 s28, s26, 9
  s_add_u32 m0, s34, 0
  s_nop 0
  buffer_load_dwordx4 v2, s[96:99], s28 offen offset:0 lds
  s_add_u32 m0, s34, 896
  s_nop 0
  buffer_load_dwordx4 v2, s[96:99], s28 offen offset:128 lds
  s_add_u32 m0, s34, 1792
  s_nop 0
  buffer_load_dwordx4 v2, s[96:99], s28 offen offset:256 lds
  s_add_u32 m0, s34, 2688
  s_nop 0
  buffer_load_dwordx4 v2, s[96:99], s28 offen offset:384 lds
  s_mov_b32 s28, 786432
  buffer_load_dwordx4 v[168:171], v1, s[12:15], s28 offen
  buffer_load_dwordx4 v[232:235], v3, s[20:23], s28 offen
  buffer_load_dwordx4 v[104:107], v1, s[92:95], s28 offen
  s_mov_b32 s28, 917504
  buffer_load_dwordx4 v[172:175], v1, s[12:15], s28 offen
  buffer_load_dwordx4 v[236:239], v3, s[20:23], s28 offen
  buffer_load_dwordx4 v[108:111], v1, s[92:95], s28 offen
  s_mov_b32 s28, 524288
  buffer_load_dwordx4 v[136:139], v1, s[12:15], s28 offen
  buffer_load_dwordx4 v[200:203], v3, s[20:23], s28 offen
  buffer_load_dwordx4 v[72:75], v1, s[92:95], s28 offen
  s_mov_b32 s28, 655360
  buffer_load_dwordx4 v[140:143], v1, s[12:15], s28 offen
  buffer_load_dwordx4 v[204:207], v3, s[20:23], s28 offen
  buffer_load_dwordx4 v[76:79], v1, s[92:95], s28 offen
  s_mov_b32 s28, 1310720
  buffer_load_dwordx4 v[176:179], v1, s[12:15], s28 offen
  buffer_load_dwordx4 v[240:243], v3, s[20:23], s28 offen
  buffer_load_dwordx4 v[112:115], v1, s[92:95], s28 offen
  s_mov_b32 s28, 1441792
  buffer_load_dwordx4 v[180:183], v1, s[12:15], s28 offen
  buffer_load_dwordx4 v[244:247], v3, s[20:23], s28 offen
  buffer_load_dwordx4 v[116:119], v1, s[92:95], s28 offen
  s_mov_b32 s28, 1048576
  buffer_load_dwordx4 v[144:147], v1, s[12:15], s28 offen
  buffer_load_dwordx4 v[208:211], v3, s[20:23], s28 offen
  buffer_load_dwordx4 v[80:83], v1, s[92:95], s28 offen
  s_mov_b32 s28, 1179648
  buffer_load_dwordx4 v[148:151], v1, s[12:15], s28 offen
  buffer_load_dwordx4 v[212:215], v3, s[20:23], s28 offen
  buffer_load_dwordx4 v[84:87], v1, s[92:95], s28 offen
  s_mov_b32 s28, 1835008
  buffer_load_dwordx4 v[184:187], v1, s[12:15], s28 offen
  buffer_load_dwordx4 v[248:251], v3, s[20:23], s28 offen
  buffer_load_dwordx4 v[120:123], v1, s[92:95], s28 offen
  s_mov_b32 s28, 1966080
  buffer_load_dwordx4 v[188:191], v1, s[12:15], s28 offen
  buffer_load_dwordx4 v[252:255], v3, s[20:23], s28 offen
  buffer_load_dwordx4 v[124:127], v1, s[92:95], s28 offen
  s_mov_b32 s28, 1572864
  buffer_load_dwordx4 v[152:155], v1, s[12:15], s28 offen
  buffer_load_dwordx4 v[216:219], v3, s[20:23], s28 offen
  buffer_load_dwordx4 v[88:91], v1, s[92:95], s28 offen
  s_mov_b32 s28, 1703936
  buffer_load_dwordx4 v[156:159], v1, s[12:15], s28 offen
  buffer_load_dwordx4 v[220:223], v3, s[20:23], s28 offen
  buffer_load_dwordx4 v[92:95], v1, s[92:95], s28 offen
L_wlP2:
  v_and_b32 v10, 15, v0
  v_lshrrev_b32 v11, 4, v0
  s_lshl_b32 s30, s26, 12
  s_add_u32 s30, s30, 131072
  v_lshlrev_b32 v60, 4, v0
  v_add_u32 v60, s30, v60
  v_lshrrev_b32 v6, 2, v10
  v_lshl_add_u32 v61, v11, 3, v6
  v_lshlrev_b32 v61, 6, v61
  v_and_b32 v6, 3, v10
  v_lshrrev_b32 v7, 1, v6
  v_lshl_add_u32 v61, v7, 3, v61
  v_and_b32 v7, 1, v6
  v_lshl_add_u32 v61, v7, 4, v61
  v_add_u32 v61, s30, v61
  v_lshrrev_b32 v6, 2, v10
  v_lshl_add_u32 v62, v11, 3, v6
  v_lshlrev_b32 v62, 6, v62
  v_and_b32 v6, 3, v10
  v_lshl_add_u32 v62, v6, 4, v62
  v_add_u32 v62, s30, v62
  v_lshrrev_b32 v5, 1, v10
  v_lshlrev_b32 v5, 7, v5
  v_lshl_add_u32 v5, v11, 5, v5
  v_and_b32 v6, 1, v10
  v_lshl_add_u32 v5, v6, 2, v5
  v_add_u32 v5, s34, v5
  v_lshlrev_b32 v1, 4, v0
  s_lshl_b32 s28, s26, 12
  v_add_u32 v1, s28, v1
  v_mov_b32 v2, 0x4444
  v_mov_b32 v6, 0xeeee
  v_and_b32 v7, 1, v0
  v_cmp_eq_u32 vcc, 1, v7
  s_nop 1
  v_cndmask_b32 v2, v2, v6, vcc
  v_mul_u32_u24 v3, 576, v11
  v_lshl_add_u32 v3, v10, 2, v3
  s_mul_i32 s28, s26, 2304
  v_add_u32 v3, s28, v3
  v_lshlrev_b32 v7, 4, v0
  v_add_u32 v7, 9216, v7
  s_lshl_b32 s28, s26, 10
  v_add_u32 v4, s28, v7
  s_mov_b32 s53, 65536
  s_lshr_b32 s28, s26, 1
  s_lshl_b32 s42, s28, 24
  s_lshl_b32 s28, s46, 19
  s_add_u32 s42, s42, s28
  s_and_b32 s28, s26, 2
  s_xor_b32 s28, s28, s47
  s_lshl_b32 s28, s28, 11
  s_add_u32 s42, s42, s28
  s_and_b32 s28, s26, 1
  s_lshl_b32 s28, s28, 10
  s_add_u32 s42, s42, s28
  s_add_u32 s42, s42, 16384
  v_xor_b32 v12, v10, v11
  v_lshlrev_b32 v12, 4, v12
  v_lshl_add_u32 v12, v10, 9, v12
  v_add_u32 v12, s55, v12
  v_xor_b32 v13, 64, v12
  v_xor_b32 v14, 128, v12
  v_xor_b32 v15, 192, v12
  s_waitcnt vmcnt(56)
  ds_write_b128 v60, v[128:131] offset:0
  ds_write_b128 v60, v[132:135] offset:1024
  ds_write_b128 v60, v[160:163] offset:2048
  ds_write_b128 v60, v[164:167] offset:3072
  ds_read_b64_tr_b16 v[128:129], v61 offset:0
  ds_read_b64_tr_b16 v[130:131], v61 offset:256
  ds_read_b64_tr_b16 v[132:133], v61 offset:2048
  ds_read_b64_tr_b16 v[134:135], v61 offset:2304
  ds_read_b64_tr_b16 v[160:161], v61 offset:32
  ds_read_b64_tr_b16 v[162:163], v61 offset:288
  ds_read_b64_tr_b16 v[164:165], v61 offset:2080
  ds_read_b64_tr_b16 v[166:167], v61 offset:2336
  ds_write_b128 v60, v[192:195] offset:0
  ds_write_b128 v60, v[196:199] offset:1024
  ds_write_b128 v60, v[224:227] offset:2048
  ds_write_b128 v60, v[228:231] offset:3072
  ds_read_b64_tr_b16 v[192:193], v62 offset:0
  ds_read_b64_tr_b16 v[194:195], v62 offset:256
  ds_read_b64_tr_b16 v[196:197], v62 offset:2048
  ds_read_b64_tr_b16 v[198:199], v62 offset:2304
  ds_read_b64_tr_b16 v[224:225], v62 offset:8
  ds_read_b64_tr_b16 v[226:227], v62 offset:264
  ds_read_b64_tr_b16 v[228:229], v62 offset:2056
  ds_read_b64_tr_b16 v[230:231], v62 offset:2312
  ds_write_b128 v60, v[64:67] offset:0
  ds_write_b128 v60, v[68:71] offset:1024
  ds_write_b128 v60, v[96:99] offset:2048
  ds_write_b128 v60, v[100:103] offset:3072
  ds_read_b64_tr_b16 v[64:65], v61 offset:0
  ds_read_b64_tr_b16 v[66:67], v61 offset:256
  ds_read_b64_tr_b16 v[68:69], v61 offset:2048
  ds_read_b64_tr_b16 v[70:71], v61 offset:2304
  ds_read_b64_tr_b16 v[96:97], v61 offset:32
  ds_read_b64_tr_b16 v[98:99], v61 offset:288
  ds_read_b64_tr_b16 v[100:101], v61 offset:2080
  ds_read_b64_tr_b16 v[102:103], v61 offset:2336
  s_waitcnt vmcnt(24)
  ds_write_b128 v60, v[136:139] offset:0
  ds_write_b128 v60, v[140:143] offset:1024
  ds_write_b128 v60, v[168:171] offset:2048
  ds_write_b128 v60, v[172:175] offset:3072
  ds_read_b64_tr_b16 v[136:137], v61 offset:0
  ds_read_b64_tr_b16 v[138:139], v61 offset:256
  ds_read_b64_tr_b16 v[140:141], v61 offset:2048
  ds_read_b64_tr_b16 v[142:143], v61 offset:2304
  ds_read_b64_tr_b16 v[168:169], v61 offset:32
  ds_read_b64_tr_b16 v[170:171], v61 offset:288
  ds_read_b64_tr_b16 v[172:173], v61 offset:2080
  ds_read_b64_tr_b16 v[174:175], v61 offset:2336
  ds_write_b128 v60, v[200:203] offset:0
  ds_write_b128 v60, v[204:207] offset:1024
  ds_write_b128 v60, v[232:235] offset:2048
  ds_write_b128 v60, v[236:239] offset:3072
  ds_read_b64_tr_b16 v[200:201], v62 offset:0
  ds_read_b64_tr_b16 v[202:203], v62 offset:256
  ds_read_b64_tr_b16 v[204:205], v62 offset:2048
  ds_read_b64_tr_b16 v[206:207], v62 offset:2304
  ds_read_b64_tr_b16 v[232:233], v62 offset:8
  ds_read_b64_tr_b16 v[234:235], v62 offset:264
  ds_read_b64_tr_b16 v[236:237], v62 offset:2056
  ds_read_b64_tr_b16 v[238:239], v62 offset:2312
  ds_write_b128 v60, v[72:75] offset:0
  ds_write_b128 v60, v[76:79] offset:1024
  ds_write_b128 v60, v[104:107] offset:2048
  ds_write_b128 v60, v[108:111] offset:3072
  ds_read_b64_tr_b16 v[72:73], v61 offset:0
  ds_read_b64_tr_b16 v[74:75], v61 offset:256
  ds_read_b64_tr_b16 v[76:77], v61 offset:2048
  ds_read_b64_tr_b16 v[78:79], v61 offset:2304
  ds_read_b64_tr_b16 v[104:105], v61 offset:32
  ds_read_b64_tr_b16 v[106:107], v61 offset:288
  ds_read_b64_tr_b16 v[108:109], v61 offset:2080
  ds_read_b64_tr_b16 v[110:111], v61 offset:2336
  s_waitcnt vmcnt(12)
  ds_write_b128 v60, v[144:147] offset:0
  ds_write_b128 v60, v[148:151] offset:1024
  ds_write_b128 v60, v[176:179] offset:2048
  ds_write_b128 v60, v[180:183] offset:3072
  ds_read_b64_tr_b16 v[144:145], v61 offset:0
  ds_read_b64_tr_b16 v[146:147], v61 offset:256
  ds_read_b64_tr_b16 v[148:149], v61 offset:2048
  ds_read_b64_tr_b16 v[150:151], v61 offset:2304
  ds_read_b64_tr_b16 v[176:177], v61 offset:32
  ds_read_b64_tr_b16 v[178:179], v61 offset:288
  ds_read_b64_tr_b16 v[180:181], v61 offset:2080
  ds_read_b64_tr_b16 v[182:183], v61 offset:2336
  ds_write_b128 v60, v[208:211] offset:0
  ds_write_b128 v60, v[212:215] offset:1024
  ds_write_b128 v60, v[240:243] offset:2048
  ds_write_b128 v60, v[244:247] offset:3072
  ds_read_b64_tr_b16 v[208:209], v62 offset:0
  ds_read_b64_tr_b16 v[210:211], v62 offset:256
  ds_read_b64_tr_b16 v[212:213], v62 offset:2048
  ds_read_b64_tr_b16 v[214:215], v62 offset:2304
  ds_read_b64_tr_b16 v[240:241], v62 offset:8
  ds_read_b64_tr_b16 v[242:243], v62 offset:264
  ds_read_b64_tr_b16 v[244:245], v62 offset:2056
  ds_read_b64_tr_b16 v[246:247], v62 offset:2312
  ds_write_b128 v60, v[80:83] offset:0
  ds_write_b128 v60, v[84:87] offset:1024
  ds_write_b128 v60, v[112:115] offset:2048
  ds_write_b128 v60, v[116:119] offset:3072
  ds_read_b64_tr_b16 v[80:81], v61 offset:0
  ds_read_b64_tr_b16 v[82:83], v61 offset:256
  ds_read_b64_tr_b16 v[84:85], v61 offset:2048
  ds_read_b64_tr_b16 v[86:87], v61 offset:2304
  ds_read_b64_tr_b16 v[112:113], v61 offset:32
  ds_read_b64_tr_b16 v[114:115], v61 offset:288
  ds_read_b64_tr_b16 v[116:117], v61 offset:2080
  ds_read_b64_tr_b16 v[118:119], v61 offset:2336
  s_waitcnt vmcnt(0)
  ds_write_b128 v60, v[152:155] offset:0
  ds_write_b128 v60, v[156:159] offset:1024
  ds_write_b128 v60, v[184:187] offset:2048
  ds_write_b128 v60, v[188:191] offset:3072
  ds_read_b64_tr_b16 v[152:153], v61 offset:0
  ds_read_b64_tr_b16 v[154:155], v61 offset:256
  ds_read_b64_tr_b16 v[156:157], v61 offset:2048
  ds_read_b64_tr_b16 v[158:159], v61 offset:2304
  ds_read_b64_tr_b16 v[184:185], v61 offset:32
  ds_read_b64_tr_b16 v[186:187], v61 offset:288
  ds_read_b64_tr_b16 v[188:189], v61 offset:2080
  ds_read_b64_tr_b16 v[190:191], v61 offset:2336
  ds_write_b128 v60, v[216:219] offset:0
  ds_write_b128 v60, v[220:223] offset:1024
  ds_write_b128 v60, v[248:251] offset:2048
  ds_write_b128 v60, v[252:255] offset:3072
  ds_read_b64_tr_b16 v[216:217], v62 offset:0
  ds_read_b64_tr_b16 v[218:219], v62 offset:256
  ds_read_b64_tr_b16 v[220:221], v62 offset:2048
  ds_read_b64_tr_b16 v[222:223], v62 offset:2304
  ds_read_b64_tr_b16 v[248:249], v62 offset:8
  ds_read_b64_tr_b16 v[250:251], v62 offset:264
  ds_read_b64_tr_b16 v[252:253], v62 offset:2056
  ds_read_b64_tr_b16 v[254:255], v62 offset:2312
  ds_write_b128 v60, v[88:91] offset:0
  ds_write_b128 v60, v[92:95] offset:1024
  ds_write_b128 v60, v[120:123] offset:2048
  ds_write_b128 v60, v[124:127] offset:3072
  ds_read_b64_tr_b16 v[88:89], v61 offset:0
  ds_read_b64_tr_b16 v[90:91], v61 offset:256
  ds_read_b64_tr_b16 v[92:93], v61 offset:2048
  ds_read_b64_tr_b16 v[94:95], v61 offset:2304
  ds_read_b64_tr_b16 v[120:121], v61 offset:32
  ds_read_b64_tr_b16 v[122:123], v61 offset:288
  ds_read_b64_tr_b16 v[124:125], v61 offset:2080
  ds_read_b64_tr_b16 v[126:127], v61 offset:2336
  s_waitcnt lgkmcnt(0)
  ds_read_b128 v[16:19], v12 offset:0
  ds_read_b128 v[20:23], v13 offset:0
  ds_read_b128 v[24:27], v14 offset:0
  ds_read_b128 v[28:31], v15 offset:0
  s_waitcnt lgkmcnt(3)
  v_mfma_f32_16x16x32_bf16 v[32:35], v[128:131], v[16:19], 0
  v_mfma_f32_16x16x32_bf16 v[36:39], v[160:163], v[16:19], 0
  v_mfma_f32_16x16x32_bf16 v[40:43], v[16:19], v[192:195], 0
  v_mfma_f32_16x16x32_bf16 v[44:47], v[16:19], v[224:227], 0
  ds_read_b128 v[16:19], v12 offset:256
  s_waitcnt lgkmcnt(3)
  v_mfma_f32_16x16x32_bf16 v[32:35], v[132:135], v[20:23], v[32:35]
  v_mfma_f32_16x16x32_bf16 v[36:39], v[164:167], v[20:23], v[36:39]
  v_mfma_f32_16x16x32_bf16 v[40:43], v[20:23], v[196:199], v[40:43]
  v_mfma_f32_16x16x32_bf16 v[44:47], v[20:23], v[228:231], v[44:47]
  ds_read_b128 v[20:23], v13 offset:256
  s_waitcnt lgkmcnt(3)
  v_mfma_f32_16x16x32_bf16 v[32:35], v[136:139], v[24:27], v[32:35]
  v_mfma_f32_16x16x32_bf16 v[36:39], v[168:171], v[24:27], v[36:39]
  v_mfma_f32_16x16x32_bf16 v[40:43], v[24:27], v[200:203], v[40:43]
  v_mfma_f32_16x16x32_bf16 v[44:47], v[24:27], v[232:235], v[44:47]
  ds_read_b128 v[24:27], v14 offset:256
  s_waitcnt lgkmcnt(3)
  v_mfma_f32_16x16x32_bf16 v[32:35], v[140:143], v[28:31], v[32:35]
  v_mfma_f32_16x16x32_bf16 v[36:39], v[172:175], v[28:31], v[36:39]
  v_mfma_f32_16x16x32_bf16 v[40:43], v[28:31], v[204:207], v[40:43]
  v_mfma_f32_16x16x32_bf16 v[44:47], v[28:31], v[236:239], v[44:47]
  ds_read_b128 v[28:31], v15 offset:256
  s_waitcnt lgkmcnt(3)
  v_mfma_f32_16x16x32_bf16 v[32:35], v[144:147], v[16:19], v[32:35]
  v_mfma_f32_16x16x32_bf16 v[36:39], v[176:179], v[16:19], v[36:39]
  v_mfma_f32_16x16x32_bf16 v[40:43], v[16:19], v[208:211], v[40:43]
  v_mfma_f32_16x16x32_bf16 v[44:47], v[16:19], v[240:243], v[44:47]
  ds_read_b128 v[16:19], v12 offset:8192
  s_waitcnt lgkmcnt(3)
  v_mfma_f32_16x16x32_bf16 v[32:35], v[148:151], v[20:23], v[32:35]
  v_mfma_f32_16x16x32_bf16 v[36:39], v[180:183], v[20:23], v[36:39]
  v_mfma_f32_16x16x32_bf16 v[40:43], v[20:23], v[212:215], v[40:43]
  v_mfma_f32_16x16x32_bf16 v[44:47], v[20:23], v[244:247], v[44:47]
  ds_read_b128 v[20:23], v13 offset:8192
  s_waitcnt lgkmcnt(3)
  v_mfma_f32_16x16x32_bf16 v[32:35], v[152:155], v[24:27], v[32:35]
  v_mfma_f32_16x16x32_bf16 v[36:39], v[184:187], v[24:27], v[36:39]
  v_mfma_f32_16x16x32_bf16 v[40:43], v[24:27], v[216:219], v[40:43]
  v_mfma_f32_16x16x32_bf16 v[44:47], v[24:27], v[248:251], v[44:47]
  ds_read_b128 v[24:27], v14 offset:8192
  s_waitcnt lgkmcnt(3)
  v_mfma_f32_16x16x32_bf16 v[32:35], v[156:159], v[28:31], v[32:35]
  v_mfma_f32_16x16x32_bf16 v[36:39], v[188:191], v[28:31], v[36:39]
  v_mfma_f32_16x16x32_bf16 v[40:43], v[28:31], v[220:223], v[40:43]
  v_mfma_f32_16x16x32_bf16 v[44:47], v[28:31], v[252:255], v[44:47]
  ds_read_b128 v[28:31], v15 offset:8192
  s_waitcnt lgkmcnt(3)
  v_mfma_f32_16x16x32_bf16 v[48:51], v[128:131], v[16:19], 0
  v_mfma_f32_16x16x32_bf16 v[52:55], v[160:163], v[16:19], 0
  v_mfma_f32_16x16x32_bf16 v[56:59], v[16:19], v[192:195], 0
  v_mfma_f32_16x16x32_bf16 v[60:63], v[16:19], v[224:227], 0
  ds_read_b128 v[16:19], v12 offset:8448
  s_waitcnt lgkmcnt(3)
  v_mfma_f32_16x16x32_bf16 v[48:51], v[132:135], v[20:23], v[48:51]
  v_mfma_f32_16x16x32_bf16 v[52:55], v[164:167], v[20:23], v[52:55]
  v_mfma_f32_16x16x32_bf16 v[56:59], v[20:23], v[196:199], v[56:59]
  v_mfma_f32_16x16x32_bf16 v[60:63], v[20:23], v[228:231], v[60:63]
  ds_read_b128 v[20:23], v13 offset:8448
  s_waitcnt lgkmcnt(3)
  v_mfma_f32_16x16x32_bf16 v[48:51], v[136:139], v[24:27], v[48:51]
  v_mfma_f32_16x16x32_bf16 v[52:55], v[168:171], v[24:27], v[52:55]
  ds_write_b128 v4, v[32:35] offset:15360
  v_mfma_f32_16x16x32_bf16 v[56:59], v[24:27], v[200:203], v[56:59]
  v_mfma_f32_16x16x32_bf16 v[60:63], v[24:27], v[232:235], v[60:63]
  ds_write_b128 v4, v[36:39] offset:19456
  ds_read_b128 v[24:27], v14 offset:8448
  s_waitcnt lgkmcnt(5)
  v_mfma_f32_16x16x32_bf16 v[48:51], v[140:143], v[28:31], v[48:51]
  v_mfma_f32_16x16x32_bf16 v[52:55], v[172:175], v[28:31], v[52:55]
  ds_write_b128 v4, v[40:43] offset:31744
  v_mfma_f32_16x16x32_bf16 v[56:59], v[28:31], v[204:207], v[56:59]
  v_mfma_f32_16x16x32_bf16 v[60:63], v[28:31], v[236:239], v[60:63]
  ds_write_b128 v4, v[44:47] offset:35840
  ds_read_b128 v[28:31], v15 offset:8448
  s_waitcnt lgkmcnt(7)
  v_mfma_f32_16x16x32_bf16 v[48:51], v[144:147], v[16:19], v[48:51]
  v_mfma_f32_16x16x32_bf16 v[52:55], v[176:179], v[16:19], v[52:55]
  v_mfma_f32_16x16x32_bf16 v[56:59], v[16:19], v[208:211], v[56:59]
  v_mfma_f32_16x16x32_bf16 v[60:63], v[16:19], v[240:243], v[60:63]
  s_waitcnt lgkmcnt(6)
  v_mfma_f32_16x16x32_bf16 v[48:51], v[148:151], v[20:23], v[48:51]
  v_mfma_f32_16x16x32_bf16 v[52:55], v[180:183], v[20:23], v[52:55]
  v_mfma_f32_16x16x32_bf16 v[56:59], v[20:23], v[212:215], v[56:59]
  v_mfma_f32_16x16x32_bf16 v[60:63], v[20:23], v[244:247], v[60:63]
  s_waitcnt lgkmcnt(3)
  v_mfma_f32_16x16x32_bf16 v[48:51], v[152:155], v[24:27], v[48:51]
  v_mfma_f32_16x16x32_bf16 v[52:55], v[184:187], v[24:27], v[52:55]
  v_mfma_f32_16x16x32_bf16 v[56:59], v[24:27], v[216:219], v[56:59]
  v_mfma_f32_16x16x32_bf16 v[60:63], v[24:27], v[248:251], v[60:63]
  s_waitcnt lgkmcnt(0)
  v_mfma_f32_16x16x32_bf16 v[48:51], v[156:159], v[28:31], v[48:51]
  v_mfma_f32_16x16x32_bf16 v[52:55], v[188:191], v[28:31], v[52:55]
  v_mfma_f32_16x16x32_bf16 v[56:59], v[28:31], v[220:223], v[56:59]
  v_mfma_f32_16x16x32_bf16 v[60:63], v[28:31], v[252:255], v[60:63]
  s_nop 4
  ds_write_b128 v4, v[48:51] offset:23552
  ds_write_b128 v4, v[52:55] offset:27648
  ds_write_b128 v4, v[56:59] offset:39936
  ds_write_b128 v4, v[60:63] offset:44032
  s_waitcnt lgkmcnt(0)
  v_add_u32 v6, 0, v5
  ds_read2_b32 v[16:17], v6 offset0:0 offset1:2
  ds_read2_b32 v[18:19], v6 offset0:4 offset1:6
  v_add_u32 v6, 1024, v5
  ds_read2_b32 v[20:21], v6 offset0:0 offset1:2
  ds_read2_b32 v[22:23], v6 offset0:4 offset1:6
  v_add_u32 v6, 2048, v5
  ds_read2_b32 v[24:25], v6 offset0:0 offset1:2
  ds_read2_b32 v[26:27], v6 offset0:4 offset1:6
  v_add_u32 v6, 3072, v5
  ds_read2_b32 v[28:29], v6 offset0:0 offset1:2
  ds_read2_b32 v[30:31], v6 offset0:4 offset1:6
  v_xor_b32 v9, 0x0, v8
  s_add_u32 m0, s55, 0
  s_nop 0
  buffer_load_dwordx4 v9, s[16:19], s53 offen lds
  v_xor_b32 v9, 0x1020, v8
  s_add_u32 m0, s55, 1024
  s_nop 0
  buffer_load_dwordx4 v9, s[16:19], s53 offen lds
  v_xor_b32 v9, 0x2040, v8
  s_add_u32 m0, s55, 2048
  s_nop 0
  buffer_load_dwordx4 v9, s[16:19], s53 offen lds
  v_xor_b32 v9, 0x3060, v8
  s_add_u32 m0, s55, 3072
  s_nop 0
  buffer_load_dwordx4 v9, s[16:19], s53 offen lds
  v_xor_b32 v9, 0x4080, v8
  s_add_u32 m0, s55, 4096
  s_nop 0
  buffer_load_dwordx4 v9, s[16:19], s53 offen lds
  v_xor_b32 v9, 0x50a0, v8
  s_add_u32 m0, s55, 5120
  s_nop 0
  buffer_load_dwordx4 v9, s[16:19], s53 offen lds
  v_xor_b32 v9, 0x60c0, v8
  s_add_u32 m0, s55, 6144
  s_nop 0
  buffer_load_dwordx4 v9, s[16:19], s53 offen lds
  v_xor_b32 v9, 0x70e0, v8
  s_add_u32 m0, s55, 7168
  s_nop 0
  buffer_load_dwordx4 v9, s[16:19], s53 offen lds
  v_mov_b32 v32, 0
  v_mov_b32 v33, 0
  v_mov_b32 v34, 0
  v_mov_b32 v35, 0
  v_mov_b32 v36, 0
  v_mov_b32 v37, 0
  v_mov_b32 v38, 0
  v_mov_b32 v39, 0
  v_mov_b32 v40, 0
  v_mov_b32 v41, 0
  v_mov_b32 v42, 0
  v_mov_b32 v43, 0
  v_mov_b32 v44, 0
  v_mov_b32 v45, 0
  v_mov_b32 v46, 0
  v_mov_b32 v47, 0
  v_mov_b32 v48, 0
  v_mov_b32 v49, 0
  v_mov_b32 v50, 0
  v_mov_b32 v51, 0
  v_mov_b32 v52, 0
  v_mov_b32 v53, 0
  v_mov_b32 v54, 0
  v_mov_b32 v55, 0
  s_waitcnt lgkmcnt(0)
  v_smfmac_f32_16x16x64_bf16 v[32:35], v[16:19], v[64:71], v2
  v_smfmac_f32_16x16x64_bf16 v[40:43], v[16:19], v[128:135], v2
  v_smfmac_f32_16x16x64_bf16 v[36:39], v[16:19], v[96:103], v2
  v_smfmac_f32_16x16x64_bf16 v[44:47], v[16:19], v[160:167], v2
  v_smfmac_f32_16x16x64_bf16 v[32:35], v[20:23], v[72:79], v2
  v_smfmac_f32_16x16x64_bf16 v[40:43], v[20:23], v[136:143], v2
  v_smfmac_f32_16x16x64_bf16 v[36:39], v[20:23], v[104:111], v2
  v_smfmac_f32_16x16x64_bf16 v[44:47], v[20:23], v[168:175], v2
  v_smfmac_f32_16x16x64_bf16 v[32:35], v[24:27], v[80:87], v2
  v_smfmac_f32_16x16x64_bf16 v[40:43], v[24:27], v[144:151], v2
  v_smfmac_f32_16x16x64_bf16 v[36:39], v[24:27], v[112:119], v2
  v_smfmac_f32_16x16x64_bf16 v[44:47], v[24:27], v[176:183], v2
  v_smfmac_f32_16x16x64_bf16 v[32:35], v[28:31], v[88:95], v2
  v_smfmac_f32_16x16x64_bf16 v[40:43], v[28:31], v[152:159], v2
  v_smfmac_f32_16x16x64_bf16 v[36:39], v[28:31], v[120:127], v2
  v_smfmac_f32_16x16x64_bf16 v[44:47], v[28:31], v[184:191], v2
  s_barrier
  s_waitcnt vmcnt(0)
  s_barrier
  s_branch L_P_enterf
.p2align 6
L_P_loopf:
  s_barrier
  s_nop 15
  s_nop 13
  buffer_load_dwordx4 v[16:19], v1, s[4:7], s38 offen offset:0 sc1
  s_nop 3
  buffer_load_dwordx4 v[20:23], v1, s[4:7], s38 offen offset:1024 sc1
  s_nop 3
  buffer_load_dwordx4 v[24:27], v1, s[4:7], s38 offen offset:2048 sc1
  s_nop 3
  buffer_load_dwordx4 v[28:31], v1, s[4:7], s38 offen offset:3072 sc1
  s_waitcnt vmcnt(3)
  v_max_u32 v60, v16, v18
  v_cmp_eq_u32 vcc, -1, v60
  s_cbranch_vccnz L_Pm_25_b0123
L_Pm_25_k0123:
  v_smfmac_f32_16x16x64_bf16 v[32:35], v[16:19], v[64:71], v2
  s_waitcnt vmcnt(2)
  v_max_u32 v60, v20, v22
  v_smfmac_f32_16x16x64_bf16 v[40:43], v[16:19], v[128:135], v2
  v_cmp_eq_u32 vcc, -1, v60
  v_smfmac_f32_16x16x64_bf16 v[36:39], v[16:19], v[96:103], v2
  v_smfmac_f32_16x16x64_bf16 v[44:47], v[16:19], v[160:167], v2
  s_cbranch_vccnz L_Pm_25_b123
L_Pm_25_k123:
  v_smfmac_f32_16x16x64_bf16 v[32:35], v[20:23], v[72:79], v2
  s_waitcnt vmcnt(1)
  v_max_u32 v60, v24, v26
  v_smfmac_f32_16x16x64_bf16 v[40:43], v[20:23], v[136:143], v2
  v_cmp_eq_u32 vcc, -1, v60
  v_smfmac_f32_16x16x64_bf16 v[36:39], v[20:23], v[104:111], v2
  v_smfmac_f32_16x16x64_bf16 v[44:47], v[20:23], v[168:175], v2
  s_cbranch_vccnz L_Pm_25_b23
L_Pm_25_k23:
  v_smfmac_f32_16x16x64_bf16 v[32:35], v[24:27], v[80:87], v2
  s_waitcnt vmcnt(0)
  v_max_u32 v60, v28, v30
  v_smfmac_f32_16x16x64_bf16 v[40:43], v[24:27], v[144:151], v2
  v_cmp_eq_u32 vcc, -1, v60
  v_smfmac_f32_16x16x64_bf16 v[36:39], v[24:27], v[112:119], v2
  v_smfmac_f32_16x16x64_bf16 v[44:47], v[24:27], v[176:183], v2
  s_cbranch_vccnz L_Pm_25_b3
L_Pm_25_k3:
  v_smfmac_f32_16x16x64_bf16 v[32:35], v[28:31], v[88:95], v2
  v_smfmac_f32_16x16x64_bf16 v[40:43], v[28:31], v[152:159], v2
  v_smfmac_f32_16x16x64_bf16 v[36:39], v[28:31], v[120:127], v2
  v_smfmac_f32_16x16x64_bf16 v[44:47], v[28:31], v[184:191], v2
L_Pm_25_e:
L_P_enterf:
  s_nop 4
  v_add_f32 v32, v32, v33
  v_add_f32 v34, v34, v35
  ds_write2_b32 v3, v32, v34 offset0:72 offset1:108
  v_add_f32 v40, v40, v41
  v_add_f32 v42, v42, v43
  ds_write2_b32 v3, v40, v42 offset0:0 offset1:36
  v_add_f32 v36, v36, v37
  v_add_f32 v38, v38, v39
  ds_write2_b32 v3, v36, v38 offset0:88 offset1:124
  v_add_f32 v44, v44, v45
  v_add_f32 v46, v46, v47
  ds_write2_b32 v3, v44, v46 offset0:16 offset1:52
  s_waitcnt lgkmcnt(0)
  s_barrier
  s_cmp_lt_u32 s36, 11
  s_cbranch_scc1 L_P_x
  v_smfmac_f32_16x16x64_bf16 v[48:51], v[16:19], v[192:199], v2
  v_smfmac_f32_16x16x64_bf16 v[52:55], v[16:19], v[224:231], v2
  v_smfmac_f32_16x16x64_bf16 v[48:51], v[20:23], v[200:207], v2
  v_smfmac_f32_16x16x64_bf16 v[52:55], v[20:23], v[232:239], v2
  v_smfmac_f32_16x16x64_bf16 v[48:51], v[24:27], v[208:215], v2
  v_smfmac_f32_16x16x64_bf16 v[52:55], v[24:27], v[240:247], v2
  v_smfmac_f32_16x16x64_bf16 v[48:51], v[28:31], v[216:223], v2
  v_smfmac_f32_16x16x64_bf16 v[52:55], v[28:31], v[248:255], v2
  s_nop 6
  v_add_f32 v32, v48, v49
  v_add_f32 v33, v50, v51
  v_add_f32 v34, v52, v53
  v_add_f32 v35, v54, v55
  ds_write_b128 v4, v[32:35]
  s_waitcnt lgkmcnt(0)
  s_barrier
  s_cmp_eq_u32 s36, 63
  s_cbranch_scc1 L_R_done
  s_min_u32 s28, s36, 61
  s_lshl_b32 s28, s28, 13
  s_add_u32 s28, s28, s42
  s_buffer_load_dword s29, s[4:7], s28 offset:0
  s_buffer_load_dword s29, s[4:7], s28 offset:64
  s_buffer_load_dword s29, s[4:7], s28 offset:128
  s_buffer_load_dword s29, s[4:7], s28 offset:192
  s_buffer_load_dword s29, s[4:7], s28 offset:256
  s_buffer_load_dword s29, s[4:7], s28 offset:320
  s_buffer_load_dword s29, s[4:7], s28 offset:384
  s_buffer_load_dword s29, s[4:7], s28 offset:448
  s_barrier
  s_buffer_load_dword s29, s[4:7], s28 offset:512
  s_buffer_load_dword s29, s[4:7], s28 offset:576
  s_buffer_load_dword s29, s[4:7], s28 offset:640
  s_buffer_load_dword s29, s[4:7], s28 offset:704
  s_buffer_load_dword s29, s[4:7], s28 offset:768
  s_barrier
  s_barrier
  s_buffer_load_dword s29, s[4:7], s28 offset:832
  s_buffer_load_dword s29, s[4:7], s28 offset:896
  s_buffer_load_dword s29, s[4:7], s28 offset:960
L_P_tail:
  s_add_u32 s36, s36, 1
  s_add_u32 s28, s36, 3
  s_and_b32 s28, s28, 3
  s_lshl_b32 s28, s28, 17
  s_add_u32 s38, s44, s28
  v_mov_b32 v32, 0
  v_mov_b32 v33, 0
  v_mov_b32 v34, 0
  v_mov_b32 v35, 0
  v_mov_b32 v36, 0
  v_mov_b32 v37, 0
  v_mov_b32 v38, 0
  v_mov_b32 v39, 0
  v_mov_b32 v40, 0
  v_mov_b32 v41, 0
  v_mov_b32 v42, 0
  v_mov_b32 v43, 0
  v_mov_b32 v44, 0
  v_mov_b32 v45, 0
  v_mov_b32 v46, 0
  v_mov_b32 v47, 0
  v_mov_b32 v48, 0
  v_mov_b32 v49, 0
  v_mov_b32 v50, 0
  v_mov_b32 v51, 0
  v_mov_b32 v52, 0
  v_mov_b32 v53, 0
  v_mov_b32 v54, 0
  v_mov_b32 v55, 0
  s_branch L_P_loopf
L_Pm_25_b0123:
  s_mov_b64 exec, vcc
  buffer_load_dwordx4 v[16:19], v1, s[4:7], s38 offen offset:0 sc1
  s_mov_b64 exec, -1
  s_waitcnt vmcnt(3)
  v_max_u32 v60, v20, v22
  v_cmp_eq_u32 vcc, -1, v60
  s_cbranch_vccnz L_Pm_25_b1230
L_Pm_25_k1230:
  v_smfmac_f32_16x16x64_bf16 v[32:35], v[20:23], v[72:79], v2
  s_waitcnt vmcnt(2)
  v_max_u32 v60, v24, v26
  v_smfmac_f32_16x16x64_bf16 v[40:43], v[20:23], v[136:143], v2
  v_cmp_eq_u32 vcc, -1, v60
  v_smfmac_f32_16x16x64_bf16 v[36:39], v[20:23], v[104:111], v2
  v_smfmac_f32_16x16x64_bf16 v[44:47], v[20:23], v[168:175], v2
  s_cbranch_vccnz L_Pm_25_b230
L_Pm_25_k230:
  v_smfmac_f32_16x16x64_bf16 v[32:35], v[24:27], v[80:87], v2
  s_waitcnt vmcnt(1)
  v_max_u32 v60, v28, v30
  v_smfmac_f32_16x16x64_bf16 v[40:43], v[24:27], v[144:151], v2
  v_cmp_eq_u32 vcc, -1, v60
  v_smfmac_f32_16x16x64_bf16 v[36:39], v[24:27], v[112:119], v2
  v_smfmac_f32_16x16x64_bf16 v[44:47], v[24:27], v[176:183], v2
  s_cbranch_vccnz L_Pm_25_b30
L_Pm_25_k30:
  v_smfmac_f32_16x16x64_bf16 v[32:35], v[28:31], v[88:95], v2
  v_smfmac_f32_16x16x64_bf16 v[40:43], v[28:31], v[152:159], v2
  v_smfmac_f32_16x16x64_bf16 v[36:39], v[28:31], v[120:127], v2
  v_smfmac_f32_16x16x64_bf16 v[44:47], v[28:31], v[184:191], v2
  s_waitcnt vmcnt(0)
  v_max_u32 v60, v16, v18
  v_cmp_eq_u32 vcc, -1, v60
  s_cbranch_vccnz L_Pm_25_b0
L_Pm_25_k0:
  v_smfmac_f32_16x16x64_bf16 v[32:35], v[16:19], v[64:71], v2
  v_smfmac_f32_16x16x64_bf16 v[40:43], v[16:19], v[128:135], v2
  v_smfmac_f32_16x16x64_bf16 v[36:39], v[16:19], v[96:103], v2
  v_smfmac_f32_16x16x64_bf16 v[44:47], v[16:19], v[160:167], v2
  s_branch L_Pm_25_e
L_Pm_25_b123:
  s_mov_b64 exec, vcc
  buffer_load_dwordx4 v[20:23], v1, s[4:7], s38 offen offset:1024 sc1
  s_mov_b64 exec, -1
  s_waitcnt vmcnt(2)
  v_max_u32 v60, v24, v26
  v_cmp_eq_u32 vcc, -1, v60
  s_cbranch_vccnz L_Pm_25_b231
L_Pm_25_k231:
  v_smfmac_f32_16x16x64_bf16 v[32:35], v[24:27], v[80:87], v2
  s_waitcnt vmcnt(1)
  v_max_u32 v60, v28, v30
  v_smfmac_f32_16x16x64_bf16 v[40:43], v[24:27], v[144:151], v2
  v_cmp_eq_u32 vcc, -1, v60
  v_smfmac_f32_16x16x64_bf16 v[36:39], v[24:27], v[112:119], v2
  v_smfmac_f32_16x16x64_bf16 v[44:47], v[24:27], v[176:183], v2
  s_cbranch_vccnz L_Pm_25_b31
L_Pm_25_k31:
  v_smfmac_f32_16x16x64_bf16 v[32:35], v[28:31], v[88:95], v2
  v_smfmac_f32_16x16x64_bf16 v[40:43], v[28:31], v[152:159], v2
  v_smfmac_f32_16x16x64_bf16 v[36:39], v[28:31], v[120:127], v2
  v_smfmac_f32_16x16x64_bf16 v[44:47], v[28:31], v[184:191], v2
  s_waitcnt vmcnt(0)
  v_max_u32 v60, v20, v22
  v_cmp_eq_u32 vcc, -1, v60
  s_cbranch_vccnz L_Pm_25_b1
L_Pm_25_k1:
  v_smfmac_f32_16x16x64_bf16 v[32:35], v[20:23], v[72:79], v2
  v_smfmac_f32_16x16x64_bf16 v[40:43], v[20:23], v[136:143], v2
  v_smfmac_f32_16x16x64_bf16 v[36:39], v[20:23], v[104:111], v2
  v_smfmac_f32_16x16x64_bf16 v[44:47], v[20:23], v[168:175], v2
  s_branch L_Pm_25_e
L_Pm_25_b23:
  s_mov_b64 exec, vcc
  buffer_load_dwordx4 v[24:27], v1, s[4:7], s38 offen offset:2048 sc1
  s_mov_b64 exec, -1
  s_waitcnt vmcnt(1)
  v_max_u32 v60, v28, v30
  v_cmp_eq_u32 vcc, -1, v60
  s_cbranch_vccnz L_Pm_25_b32
L_Pm_25_k32:
  v_smfmac_f32_16x16x64_bf16 v[32:35], v[28:31], v[88:95], v2
  v_smfmac_f32_16x16x64_bf16 v[40:43], v[28:31], v[152:159], v2
  v_smfmac_f32_16x16x64_bf16 v[36:39], v[28:31], v[120:127], v2
  v_smfmac_f32_16x16x64_bf16 v[44:47], v[28:31], v[184:191], v2
  s_waitcnt vmcnt(0)
  v_max_u32 v60, v24, v26
  v_cmp_eq_u32 vcc, -1, v60
  s_cbranch_vccnz L_Pm_25_b2
L_Pm_25_k2:
  v_smfmac_f32_16x16x64_bf16 v[32:35], v[24:27], v[80:87], v2
  v_smfmac_f32_16x16x64_bf16 v[40:43], v[24:27], v[144:151], v2
  v_smfmac_f32_16x16x64_bf16 v[36:39], v[24:27], v[112:119], v2
  v_smfmac_f32_16x16x64_bf16 v[44:47], v[24:27], v[176:183], v2
  s_branch L_Pm_25_e
L_Pm_25_b3:
  s_mov_b64 exec, vcc
  buffer_load_dwordx4 v[28:31], v1, s[4:7], s38 offen offset:3072 sc1
  s_mov_b64 exec, -1
  s_add_u32 s27, s27, 1
  s_cmp_ge_u32 s27, 0x80000
  s_cbranch_scc1 L_Pm_25_e
  s_waitcnt vmcnt(0)
  v_max_u32 v60, v28, v30
  v_cmp_eq_u32 vcc, -1, v60
  s_cbranch_vccz L_Pm_25_k3
  s_branch L_Pm_25_b3
L_Pm_25_b1230:
  s_mov_b64 exec, vcc
  buffer_load_dwordx4 v[20:23], v1, s[4:7], s38 offen offset:1024 sc1
  s_mov_b64 exec, -1
  s_waitcnt vmcnt(3)
  v_max_u32 v60, v24, v26
  v_cmp_eq_u32 vcc, -1, v60
  s_cbranch_vccnz L_Pm_25_b2301
L_Pm_25_k2301:
  v_smfmac_f32_16x16x64_bf16 v[32:35], v[24:27], v[80:87], v2
  s_waitcnt vmcnt(2)
  v_max_u32 v60, v28, v30
  v_smfmac_f32_16x16x64_bf16 v[40:43], v[24:27], v[144:151], v2
  v_cmp_eq_u32 vcc, -1, v60
  v_smfmac_f32_16x16x64_bf16 v[36:39], v[24:27], v[112:119], v2
  v_smfmac_f32_16x16x64_bf16 v[44:47], v[24:27], v[176:183], v2
  s_cbranch_vccnz L_Pm_25_b301
L_Pm_25_k301:
  v_smfmac_f32_16x16x64_bf16 v[32:35], v[28:31], v[88:95], v2
  v_smfmac_f32_16x16x64_bf16 v[40:43], v[28:31], v[152:159], v2
  v_smfmac_f32_16x16x64_bf16 v[36:39], v[28:31], v[120:127], v2
  v_smfmac_f32_16x16x64_bf16 v[44:47], v[28:31], v[184:191], v2
  s_waitcnt vmcnt(1)
  v_max_u32 v60, v16, v18
  v_cmp_eq_u32 vcc, -1, v60
  s_cbranch_vccnz L_Pm_25_b01
L_Pm_25_k01:
  v_smfmac_f32_16x16x64_bf16 v[32:35], v[16:19], v[64:71], v2
  s_waitcnt vmcnt(0)
  v_max_u32 v60, v20, v22
  v_smfmac_f32_16x16x64_bf16 v[40:43], v[16:19], v[128:135], v2
  v_cmp_eq_u32 vcc, -1, v60
  v_smfmac_f32_16x16x64_bf16 v[36:39], v[16:19], v[96:103], v2
  v_smfmac_f32_16x16x64_bf16 v[44:47], v[16:19], v[160:167], v2
  s_cbranch_vccz L_Pm_25_k1
L_Pm_25_b1:
  s_mov_b64 exec, vcc
  buffer_load_dwordx4 v[20:23], v1, s[4:7], s38 offen offset:1024 sc1
  s_mov_b64 exec, -1
  s_add_u32 s27, s27, 1
  s_cmp_ge_u32 s27, 0x80000
  s_cbranch_scc1 L_Pm_25_e
  s_waitcnt vmcnt(0)
  v_max_u32 v60, v20, v22
  v_cmp_eq_u32 vcc, -1, v60
  s_cbranch_vccz L_Pm_25_k1
  s_branch L_Pm_25_b1
L_Pm_25_b230:
  s_mov_b64 exec, vcc
  buffer_load_dwordx4 v[24:27], v1, s[4:7], s38 offen offset:2048 sc1
  s_mov_b64 exec, -1
  s_waitcnt vmcnt(2)
  v_max_u32 v60, v28, v30
  v_cmp_eq_u32 vcc, -1, v60
  s_cbranch_vccnz L_Pm_25_b302
L_Pm_25_k302:
  v_smfmac_f32_16x16x64_bf16 v[32:35], v[28:31], v[88:95], v2
  v_smfmac_f32_16x16x64_bf16 v[40:43], v[28:31], v[152:159], v2
  v_smfmac_f32_16x16x64_bf16 v[36:39], v[28:31], v[120:127], v2
  v_smfmac_f32_16x16x64_bf16 v[44:47], v[28:31], v[184:191], v2
  s_waitcnt vmcnt(1)
  v_max_u32 v60, v16, v18
  v_cmp_eq_u32 vcc, -1, v60
  s_cbranch_vccnz L_Pm_25_b02
L_Pm_25_k02:
  v_smfmac_f32_16x16x64_bf16 v[32:35], v[16:19], v[64:71], v2
  s_waitcnt vmcnt(0)
  v_max_u32 v60, v24, v26
  v_smfmac_f32_16x16x64_bf16 v[40:43], v[16:19], v[128:135], v2
  v_cmp_eq_u32 vcc, -1, v60
  v_smfmac_f32_16x16x64_bf16 v[36:39], v[16:19], v[96:103], v2
  v_smfmac_f32_16x16x64_bf16 v[44:47], v[16:19], v[160:167], v2
  s_cbranch_vccz L_Pm_25_k2
L_Pm_25_b2:
  s_mov_b64 exec, vcc
  buffer_load_dwordx4 v[24:27], v1, s[4:7], s38 offen offset:2048 sc1
  s_mov_b64 exec, -1
  s_add_u32 s27, s27, 1
  s_cmp_ge_u32 s27, 0x80000
  s_cbranch_scc1 L_Pm_25_e
  s_waitcnt vmcnt(0)
  v_max_u32 v60, v24, v26
  v_cmp_eq_u32 vcc, -1, v60
  s_cbranch_vccz L_Pm_25_k2
  s_branch L_Pm_25_b2
L_Pm_25_b30:
  s_mov_b64 exec, vcc
  buffer_load_dwordx4 v[28:31], v1, s[4:7], s38 offen offset:3072 sc1
  s_mov_b64 exec, -1
  s_add_u32 s27, s27, 1
  s_cmp_ge_u32 s27, 0x80000
  s_cbranch_scc1 L_Pm_25_e
  s_waitcnt vmcnt(1)
  v_max_u32 v60, v16, v18
  v_cmp_eq_u32 vcc, -1, v60
  s_cbranch_vccnz L_Pm_25_b03
L_Pm_25_k03:
  v_smfmac_f32_16x16x64_bf16 v[32:35], v[16:19], v[64:71], v2
  s_waitcnt vmcnt(0)
  v_max_u32 v60, v28, v30
  v_smfmac_f32_16x16x64_bf16 v[40:43], v[16:19], v[128:135], v2
  v_cmp_eq_u32 vcc, -1, v60
  v_smfmac_f32_16x16x64_bf16 v[36:39], v[16:19], v[96:103], v2
  v_smfmac_f32_16x16x64_bf16 v[44:47], v[16:19], v[160:167], v2
  s_cbranch_vccz L_Pm_25_k3
  s_branch L_Pm_25_b3
L_Pm_25_b0:
  s_mov_b64 exec, vcc
  buffer_load_dwordx4 v[16:19], v1, s[4:7], s38 offen offset:0 sc1
  s_mov_b64 exec, -1
  s_add_u32 s27, s27, 1
  s_cmp_ge_u32 s27, 0x80000
  s_cbranch_scc1 L_Pm_25_e
  s_waitcnt vmcnt(0)
  v_max_u32 v60, v16, v18
  v_cmp_eq_u32 vcc, -1, v60
  s_cbranch_vccz L_Pm_25_k0
  s_branch L_Pm_25_b0
L_Pm_25_b231:
  s_mov_b64 exec, vcc
  buffer_load_dwordx4 v[24:27], v1, s[4:7], s38 offen offset:2048 sc1
  s_mov_b64 exec, -1
  s_waitcnt vmcnt(2)
  v_max_u32 v60, v28, v30
  v_cmp_eq_u32 vcc, -1, v60
  s_cbranch_vccnz L_Pm_25_b312
L_Pm_25_k312:
  v_smfmac_f32_16x16x64_bf16 v[32:35], v[28:31], v[88:95], v2
  v_smfmac_f32_16x16x64_bf16 v[40:43], v[28:31], v[152:159], v2
  v_smfmac_f32_16x16x64_bf16 v[36:39], v[28:31], v[120:127], v2
  v_smfmac_f32_16x16x64_bf16 v[44:47], v[28:31], v[184:191], v2
  s_waitcnt vmcnt(1)
  v_max_u32 v60, v20, v22
  v_cmp_eq_u32 vcc, -1, v60
  s_cbranch_vccnz L_Pm_25_b12
L_Pm_25_k12:
  v_smfmac_f32_16x16x64_bf16 v[32:35], v[20:23], v[72:79], v2
  s_waitcnt vmcnt(0)
  v_max_u32 v60, v24, v26
  v_smfmac_f32_16x16x64_bf16 v[40:43], v[20:23], v[136:143], v2
  v_cmp_eq_u32 vcc, -1, v60
  v_smfmac_f32_16x16x64_bf16 v[36:39], v[20:23], v[104:111], v2
  v_smfmac_f32_16x16x64_bf16 v[44:47], v[20:23], v[168:175], v2
  s_cbranch_vccz L_Pm_25_k2
  s_branch L_Pm_25_b2
L_Pm_25_b31:
  s_mov_b64 exec, vcc
  buffer_load_dwordx4 v[28:31], v1, s[4:7], s38 offen offset:3072 sc1
  s_mov_b64 exec, -1
  s_add_u32 s27, s27, 1
  s_cmp_ge_u32 s27, 0x80000
  s_cbranch_scc1 L_Pm_25_e
  s_waitcnt vmcnt(1)
  v_max_u32 v60, v20, v22
  v_cmp_eq_u32 vcc, -1, v60
  s_cbranch_vccnz L_Pm_25_b13
L_Pm_25_k13:
  v_smfmac_f32_16x16x64_bf16 v[32:35], v[20:23], v[72:79], v2
  s_waitcnt vmcnt(0)
  v_max_u32 v60, v28, v30
  v_smfmac_f32_16x16x64_bf16 v[40:43], v[20:23], v[136:143], v2
  v_cmp_eq_u32 vcc, -1, v60
  v_smfmac_f32_16x16x64_bf16 v[36:39], v[20:23], v[104:111], v2
  v_smfmac_f32_16x16x64_bf16 v[44:47], v[20:23], v[168:175], v2
  s_cbranch_vccz L_Pm_25_k3
  s_branch L_Pm_25_b3
L_Pm_25_b32:
  s_mov_b64 exec, vcc
  buffer_load_dwordx4 v[28:31], v1, s[4:7], s38 offen offset:3072 sc1
  s_mov_b64 exec, -1
  s_add_u32 s27, s27, 1
  s_cmp_ge_u32 s27, 0x80000
  s_cbranch_scc1 L_Pm_25_e
  s_waitcnt vmcnt(1)
  v_max_u32 v60, v24, v26
  v_cmp_eq_u32 vcc, -1, v60
  s_cbranch_vccz L_Pm_25_k23
  s_branch L_Pm_25_b23
L_Pm_25_b2301:
  s_mov_b64 exec, vcc
  buffer_load_dwordx4 v[24:27], v1, s[4:7], s38 offen offset:2048 sc1
  s_mov_b64 exec, -1
  s_waitcnt vmcnt(3)
  v_max_u32 v60, v28, v30
  v_cmp_eq_u32 vcc, -1, v60
  s_cbranch_vccnz L_Pm_25_b3012
L_Pm_25_k3012:
  v_smfmac_f32_16x16x64_bf16 v[32:35], v[28:31], v[88:95], v2
  v_smfmac_f32_16x16x64_bf16 v[40:43], v[28:31], v[152:159], v2
  v_smfmac_f32_16x16x64_bf16 v[36:39], v[28:31], v[120:127], v2
  v_smfmac_f32_16x16x64_bf16 v[44:47], v[28:31], v[184:191], v2
  s_waitcnt vmcnt(2)
  v_max_u32 v60, v16, v18
  v_cmp_eq_u32 vcc, -1, v60
  s_cbranch_vccnz L_Pm_25_b012
L_Pm_25_k012:
  v_smfmac_f32_16x16x64_bf16 v[32:35], v[16:19], v[64:71], v2
  s_waitcnt vmcnt(1)
  v_max_u32 v60, v20, v22
  v_smfmac_f32_16x16x64_bf16 v[40:43], v[16:19], v[128:135], v2
  v_cmp_eq_u32 vcc, -1, v60
  v_smfmac_f32_16x16x64_bf16 v[36:39], v[16:19], v[96:103], v2
  v_smfmac_f32_16x16x64_bf16 v[44:47], v[16:19], v[160:167], v2
  s_cbranch_vccz L_Pm_25_k12
L_Pm_25_b12:
  s_mov_b64 exec, vcc
  buffer_load_dwordx4 v[20:23], v1, s[4:7], s38 offen offset:1024 sc1
  s_mov_b64 exec, -1
  s_waitcnt vmcnt(1)
  v_max_u32 v60, v24, v26
  v_cmp_eq_u32 vcc, -1, v60
  s_cbranch_vccnz L_Pm_25_b21
L_Pm_25_k21:
  v_smfmac_f32_16x16x64_bf16 v[32:35], v[24:27], v[80:87], v2
  v_smfmac_f32_16x16x64_bf16 v[40:43], v[24:27], v[144:151], v2
  v_smfmac_f32_16x16x64_bf16 v[36:39], v[24:27], v[112:119], v2
  v_smfmac_f32_16x16x64_bf16 v[44:47], v[24:27], v[176:183], v2
  s_waitcnt vmcnt(0)
  v_max_u32 v60, v20, v22
  v_cmp_eq_u32 vcc, -1, v60
  s_cbranch_vccz L_Pm_25_k1
  s_branch L_Pm_25_b1
L_Pm_25_b301:
  s_mov_b64 exec, vcc
  buffer_load_dwordx4 v[28:31], v1, s[4:7], s38 offen offset:3072 sc1
  s_mov_b64 exec, -1
  s_add_u32 s27, s27, 1
  s_cmp_ge_u32 s27, 0x80000
  s_cbranch_scc1 L_Pm_25_e
  s_waitcnt vmcnt(2)
  v_max_u32 v60, v16, v18
  v_cmp_eq_u32 vcc, -1, v60
  s_cbranch_vccnz L_Pm_25_b013
L_Pm_25_k013:
  v_smfmac_f32_16x16x64_bf16 v[32:35], v[16:19], v[64:71], v2
  s_waitcnt vmcnt(1)
  v_max_u32 v60, v20, v22
  v_smfmac_f32_16x16x64_bf16 v[40:43], v[16:19], v[128:135], v2
  v_cmp_eq_u32 vcc, -1, v60
  v_smfmac_f32_16x16x64_bf16 v[36:39], v[16:19], v[96:103], v2
  v_smfmac_f32_16x16x64_bf16 v[44:47], v[16:19], v[160:167], v2
  s_cbranch_vccz L_Pm_25_k13
L_Pm_25_b13:
  s_mov_b64 exec, vcc
  buffer_load_dwordx4 v[20:23], v1, s[4:7], s38 offen offset:1024 sc1
  s_mov_b64 exec, -1
  s_waitcnt vmcnt(1)
  v_max_u32 v60, v28, v30
  v_cmp_eq_u32 vcc, -1, v60
  s_cbranch_vccz L_Pm_25_k31
  s_branch L_Pm_25_b31
L_Pm_25_b01:
  s_mov_b64 exec, vcc
  buffer_load_dwordx4 v[16:19], v1, s[4:7], s38 offen offset:0 sc1
  s_mov_b64 exec, -1
  s_waitcnt vmcnt(1)
  v_max_u32 v60, v20, v22
  v_cmp_eq_u32 vcc, -1, v60
  s_cbranch_vccnz L_Pm_25_b10
L_Pm_25_k10:
  v_smfmac_f32_16x16x64_bf16 v[32:35], v[20:23], v[72:79], v2
  v_smfmac_f32_16x16x64_bf16 v[40:43], v[20:23], v[136:143], v2
  v_smfmac_f32_16x16x64_bf16 v[36:39], v[20:23], v[104:111], v2
  v_smfmac_f32_16x16x64_bf16 v[44:47], v[20:23], v[168:175], v2
  s_waitcnt vmcnt(0)
  v_max_u32 v60, v16, v18
  v_cmp_eq_u32 vcc, -1, v60
  s_cbranch_vccz L_Pm_25_k0
  s_branch L_Pm_25_b0
L_Pm_25_b302:
  s_mov_b64 exec, vcc
  buffer_load_dwordx4 v[28:31], v1, s[4:7], s38 offen offset:3072 sc1
  s_mov_b64 exec, -1
  s_add_u32 s27, s27, 1
  s_cmp_ge_u32 s27, 0x80000
  s_cbranch_scc1 L_Pm_25_e
  s_waitcnt vmcnt(2)
  v_max_u32 v60, v16, v18
  v_cmp_eq_u32 vcc, -1, v60
  s_cbranch_vccnz L_Pm_25_b023
L_Pm_25_k023:
  v_smfmac_f32_16x16x64_bf16 v[32:35], v[16:19], v[64:71], v2
  s_waitcnt vmcnt(1)
  v_max_u32 v60, v24, v26
  v_smfmac_f32_16x16x64_bf16 v[40:43], v[16:19], v[128:135], v2
  v_cmp_eq_u32 vcc, -1, v60
  v_smfmac_f32_16x16x64_bf16 v[36:39], v[16:19], v[96:103], v2
  v_smfmac_f32_16x16x64_bf16 v[44:47], v[16:19], v[160:167], v2
  s_cbranch_vccz L_Pm_25_k23
  s_branch L_Pm_25_b23
L_Pm_25_b02:
  s_mov_b64 exec, vcc
  buffer_load_dwordx4 v[16:19], v1, s[4:7], s38 offen offset:0 sc1
  s_mov_b64 exec, -1
  s_waitcnt vmcnt(1)
  v_max_u32 v60, v24, v26
  v_cmp_eq_u32 vcc, -1, v60
  s_cbranch_vccnz L_Pm_25_b20
L_Pm_25_k20:
  v_smfmac_f32_16x16x64_bf16 v[32:35], v[24:27], v[80:87], v2
  v_smfmac_f32_16x16x64_bf16 v[40:43], v[24:27], v[144:151], v2
  v_smfmac_f32_16x16x64_bf16 v[36:39], v[24:27], v[112:119], v2
  v_smfmac_f32_16x16x64_bf16 v[44:47], v[24:27], v[176:183], v2
  s_waitcnt vmcnt(0)
  v_max_u32 v60, v16, v18
  v_cmp_eq_u32 vcc, -1, v60
  s_cbranch_vccz L_Pm_25_k0
  s_branch L_Pm_25_b0
L_Pm_25_b03:
  s_mov_b64 exec, vcc
  buffer_load_dwordx4 v[16:19], v1, s[4:7], s38 offen offset:0 sc1
  s_mov_b64 exec, -1
  s_waitcnt vmcnt(1)
  v_max_u32 v60, v28, v30
  v_cmp_eq_u32 vcc, -1, v60
  s_cbranch_vccz L_Pm_25_k30
  s_branch L_Pm_25_b30
L_Pm_25_b312:
  s_mov_b64 exec, vcc
  buffer_load_dwordx4 v[28:31], v1, s[4:7], s38 offen offset:3072 sc1
  s_mov_b64 exec, -1
  s_add_u32 s27, s27, 1
  s_cmp_ge_u32 s27, 0x80000
  s_cbranch_scc1 L_Pm_25_e
  s_waitcnt vmcnt(2)
  v_max_u32 v60, v20, v22
  v_cmp_eq_u32 vcc, -1, v60
  s_cbranch_vccz L_Pm_25_k123
  s_branch L_Pm_25_b123
L_Pm_25_b3012:
  s_mov_b64 exec, vcc
  buffer_load_dwordx4 v[28:31], v1, s[4:7], s38 offen offset:3072 sc1
  s_mov_b64 exec, -1
  s_add_u32 s27, s27, 1
  s_cmp_ge_u32 s27, 0x80000
  s_cbranch_scc1 L_Pm_25_e
  s_waitcnt vmcnt(3)
  v_max_u32 v60, v16, v18
  v_cmp_eq_u32 vcc, -1, v60
  s_cbranch_vccz L_Pm_25_k0123
  s_branch L_Pm_25_b0123
L_Pm_25_b012:
  s_mov_b64 exec, vcc
  buffer_load_dwordx4 v[16:19], v1, s[4:7], s38 offen offset:0 sc1
  s_mov_b64 exec, -1
  s_waitcnt vmcnt(2)
  v_max_u32 v60, v20, v22
  v_cmp_eq_u32 vcc, -1, v60
  s_cbranch_vccnz L_Pm_25_b120
L_Pm_25_k120:
  v_smfmac_f32_16x16x64_bf16 v[32:35], v[20:23], v[72:79], v2
  s_waitcnt vmcnt(1)
  v_max_u32 v60, v24, v26
  v_smfmac_f32_16x16x64_bf16 v[40:43], v[20:23], v[136:143], v2
  v_cmp_eq_u32 vcc, -1, v60
  v_smfmac_f32_16x16x64_bf16 v[36:39], v[20:23], v[104:111], v2
  v_smfmac_f32_16x16x64_bf16 v[44:47], v[20:23], v[168:175], v2
  s_cbranch_vccz L_Pm_25_k20
L_Pm_25_b20:
  s_mov_b64 exec, vcc
  buffer_load_dwordx4 v[24:27], v1, s[4:7], s38 offen offset:2048 sc1
  s_mov_b64 exec, -1
  s_add_u32 s27, s27, 1
  s_cmp_ge_u32 s27, 0x80000
  s_cbranch_scc1 L_Pm_25_e
  s_waitcnt vmcnt(1)
  v_max_u32 v60, v16, v18
  v_cmp_eq_u32 vcc, -1, v60
  s_cbranch_vccz L_Pm_25_k02
  s_branch L_Pm_25_b02
L_Pm_25_b21:
  s_mov_b64 exec, vcc
  buffer_load_dwordx4 v[24:27], v1, s[4:7], s38 offen offset:2048 sc1
  s_mov_b64 exec, -1
  s_add_u32 s27, s27, 1
  s_cmp_ge_u32 s27, 0x80000
  s_cbranch_scc1 L_Pm_25_e
  s_waitcnt vmcnt(1)
  v_max_u32 v60, v20, v22
  v_cmp_eq_u32 vcc, -1, v60
  s_cbranch_vccz L_Pm_25_k12
  s_branch L_Pm_25_b12
L_Pm_25_b013:
  s_mov_b64 exec, vcc
  buffer_load_dwordx4 v[16:19], v1, s[4:7], s38 offen offset:0 sc1
  s_mov_b64 exec, -1
  s_waitcnt vmcnt(2)
  v_max_u32 v60, v20, v22
  v_cmp_eq_u32 vcc, -1, v60
  s_cbranch_vccnz L_Pm_25_b130
L_Pm_25_k130:
  v_smfmac_f32_16x16x64_bf16 v[32:35], v[20:23], v[72:79], v2
  s_waitcnt vmcnt(1)
  v_max_u32 v60, v28, v30
  v_smfmac_f32_16x16x64_bf16 v[40:43], v[20:23], v[136:143], v2
  v_cmp_eq_u32 vcc, -1, v60
  v_smfmac_f32_16x16x64_bf16 v[36:39], v[20:23], v[104:111], v2
  v_smfmac_f32_16x16x64_bf16 v[44:47], v[20:23], v[168:175], v2
  s_cbranch_vccz L_Pm_25_k30
  s_branch L_Pm_25_b30
L_Pm_25_b10:
  s_mov_b64 exec, vcc
  buffer_load_dwordx4 v[20:23], v1, s[4:7], s38 offen offset:1024 sc1
  s_mov_b64 exec, -1
  s_add_u32 s27, s27, 1
  s_cmp_ge_u32 s27, 0x80000
  s_cbranch_scc1 L_Pm_25_e
  s_waitcnt vmcnt(1)
  v_max_u32 v60, v16, v18
  v_cmp_eq_u32 vcc, -1, v60
  s_cbranch_vccz L_Pm_25_k01
  s_branch L_Pm_25_b01
L_Pm_25_b023:
  s_mov_b64 exec, vcc
  buffer_load_dwordx4 v[16:19], v1, s[4:7], s38 offen offset:0 sc1
  s_mov_b64 exec, -1
  s_waitcnt vmcnt(2)
  v_max_u32 v60, v24, v26
  v_cmp_eq_u32 vcc, -1, v60
  s_cbranch_vccz L_Pm_25_k230
  s_branch L_Pm_25_b230
L_Pm_25_b120:
  s_mov_b64 exec, vcc
  buffer_load_dwordx4 v[20:23], v1, s[4:7], s38 offen offset:1024 sc1
  s_mov_b64 exec, -1
  s_waitcnt vmcnt(2)
  v_max_u32 v60, v24, v26
  v_cmp_eq_u32 vcc, -1, v60
  s_cbranch_vccnz L_Pm_25_b201
L_Pm_25_k201:
  v_smfmac_f32_16x16x64_bf16 v[32:35], v[24:27], v[80:87], v2
  v_smfmac_f32_16x16x64_bf16 v[40:43], v[24:27], v[144:151], v2
  v_smfmac_f32_16x16x64_bf16 v[36:39], v[24:27], v[112:119], v2
  v_smfmac_f32_16x16x64_bf16 v[44:47], v[24:27], v[176:183], v2
  s_waitcnt vmcnt(1)
  v_max_u32 v60, v16, v18
  v_cmp_eq_u32 vcc, -1, v60
  s_cbranch_vccz L_Pm_25_k01
  s_branch L_Pm_25_b01
L_Pm_25_b130:
  s_mov_b64 exec, vcc
  buffer_load_dwordx4 v[20:23], v1, s[4:7], s38 offen offset:1024 sc1
  s_mov_b64 exec, -1
  s_waitcnt vmcnt(2)
  v_max_u32 v60, v28, v30
  v_cmp_eq_u32 vcc, -1, v60
  s_cbranch_vccz L_Pm_25_k301
  s_branch L_Pm_25_b301
L_Pm_25_b201:
  s_mov_b64 exec, vcc
  buffer_load_dwordx4 v[24:27], v1, s[4:7], s38 offen offset:2048 sc1
  s_mov_b64 exec, -1
  s_add_u32 s27, s27, 1
  s_cmp_ge_u32 s27, 0x80000
  s_cbranch_scc1 L_Pm_25_e
  s_waitcnt vmcnt(2)
  v_max_u32 v60, v16, v18
  v_cmp_eq_u32 vcc, -1, v60
  s_cbranch_vccz L_Pm_25_k012
  s_branch L_Pm_25_b012
L_P_x:
  v_smfmac_f32_16x16x64_bf16 v[48:51], v[16:19], v[192:199], v2
  v_xor_b32 v9, 0x8000, v8
  s_add_u32 m0, s55, 8192
  s_nop 0
  buffer_load_dwordx4 v9, s[16:19], s53 offen lds
  v_smfmac_f32_16x16x64_bf16 v[52:55], v[16:19], v[224:231], v2
  v_xor_b32 v9, 0x9020, v8
  s_add_u32 m0, s55, 9216
  s_nop 0
  buffer_load_dwordx4 v9, s[16:19], s53 offen lds
  v_smfmac_f32_16x16x64_bf16 v[48:51], v[20:23], v[200:207], v2
  v_xor_b32 v9, 0xa040, v8
  s_add_u32 m0, s55, 10240
  s_nop 0
  buffer_load_dwordx4 v9, s[16:19], s53 offen lds
  v_smfmac_f32_16x16x64_bf16 v[52:55], v[20:23], v[232:239], v2
  v_xor_b32 v9, 0xb060, v8
  s_add_u32 m0, s55, 11264
  s_nop 0
  buffer_load_dwordx4 v9, s[16:19], s53 offen lds
  v_smfmac_f32_16x16x64_bf16 v[48:51], v[24:27], v[208:215], v2
  v_xor_b32 v9, 0xc080, v8
  s_add_u32 m0, s55, 12288
  s_nop 0
  buffer_load_dwordx4 v9, s[16:19], s53 offen lds
  v_smfmac_f32_16x16x64_bf16 v[52:55], v[24:27], v[240:247], v2
  v_xor_b32 v9, 0xd0a0, v8
  s_add_u32 m0, s55, 13312
  s_nop 0
  buffer_load_dwordx4 v9, s[16:19], s53 offen lds
  v_smfmac_f32_16x16x64_bf16 v[48:51], v[28:31], v[216:223], v2
  v_xor_b32 v9, 0xe0c0, v8
  s_add_u32 m0, s55, 14336
  s_nop 0
  buffer_load_dwordx4 v9, s[16:19], s53 offen lds
  v_smfmac_f32_16x16x64_bf16 v[52:55], v[28:31], v[248:255], v2
  v_xor_b32 v9, 0xf0e0, v8
  s_add_u32 m0, s55, 15360
  s_nop 0
  buffer_load_dwordx4 v9, s[16:19], s53 offen lds
  v_add_f32 v32, v48, v49
  v_add_f32 v33, v50, v51
  s_nop 1
  v_add_f32 v34, v52, v53
  v_add_f32 v35, v54, v55
  ds_write_b128 v4, v[32:35]
  s_waitcnt lgkmcnt(0)
  s_barrier
  ds_read_b128 v[16:19], v12 offset:0
  ds_read_b128 v[20:23], v13 offset:0
  ds_read_b128 v[24:27], v14 offset:0
  ds_read_b128 v[28:31], v15 offset:0
  s_waitcnt lgkmcnt(3)
  v_mfma_f32_16x16x32_bf16 v[32:35], v[128:131], v[16:19], 0
  v_mfma_f32_16x16x32_bf16 v[36:39], v[160:163], v[16:19], 0
  v_mfma_f32_16x16x32_bf16 v[40:43], v[16:19], v[192:195], 0
  v_mfma_f32_16x16x32_bf16 v[44:47], v[16:19], v[224:227], 0
  ds_read_b128 v[16:19], v12 offset:256
  s_waitcnt lgkmcnt(3)
  v_mfma_f32_16x16x32_bf16 v[32:35], v[132:135], v[20:23], v[32:35]
  v_mfma_f32_16x16x32_bf16 v[36:39], v[164:167], v[20:23], v[36:39]
  v_mfma_f32_16x16x32_bf16 v[40:43], v[20:23], v[196:199], v[40:43]
  v_mfma_f32_16x16x32_bf16 v[44:47], v[20:23], v[228:231], v[44:47]
  ds_read_b128 v[20:23], v13 offset:256
  s_waitcnt lgkmcnt(3)
  v_mfma_f32_16x16x32_bf16 v[32:35], v[136:139], v[24:27], v[32:35]
  v_mfma_f32_16x16x32_bf16 v[36:39], v[168:171], v[24:27], v[36:39]
  v_mfma_f32_16x16x32_bf16 v[40:43], v[24:27], v[200:203], v[40:43]
  v_mfma_f32_16x16x32_bf16 v[44:47], v[24:27], v[232:235], v[44:47]
  ds_read_b128 v[24:27], v14 offset:256
  s_waitcnt lgkmcnt(3)
  v_mfma_f32_16x16x32_bf16 v[32:35], v[140:143], v[28:31], v[32:35]
  v_mfma_f32_16x16x32_bf16 v[36:39], v[172:175], v[28:31], v[36:39]
  v_mfma_f32_16x16x32_bf16 v[40:43], v[28:31], v[204:207], v[40:43]
  v_mfma_f32_16x16x32_bf16 v[44:47], v[28:31], v[236:239], v[44:47]
  ds_read_b128 v[28:31], v15 offset:256
  s_waitcnt vmcnt(0)
  s_add_u32 s53, s53, 65536
  s_waitcnt lgkmcnt(3)
  v_mfma_f32_16x16x32_bf16 v[32:35], v[144:147], v[16:19], v[32:35]
  v_mfma_f32_16x16x32_bf16 v[36:39], v[176:179], v[16:19], v[36:39]
  v_mfma_f32_16x16x32_bf16 v[40:43], v[16:19], v[208:211], v[40:43]
  v_mfma_f32_16x16x32_bf16 v[44:47], v[16:19], v[240:243], v[44:47]
  ds_read_b128 v[16:19], v12 offset:8192
  s_waitcnt lgkmcnt(3)
  v_mfma_f32_16x16x32_bf16 v[32:35], v[148:151], v[20:23], v[32:35]
  v_mfma_f32_16x16x32_bf16 v[36:39], v[180:183], v[20:23], v[36:39]
  v_mfma_f32_16x16x32_bf16 v[40:43], v[20:23], v[212:215], v[40:43]
  v_mfma_f32_16x16x32_bf16 v[44:47], v[20:23], v[244:247], v[44:47]
  ds_read_b128 v[20:23], v13 offset:8192
  s_waitcnt lgkmcnt(3)
  v_mfma_f32_16x16x32_bf16 v[32:35], v[152:155], v[24:27], v[32:35]
  v_mfma_f32_16x16x32_bf16 v[36:39], v[184:187], v[24:27], v[36:39]
  v_mfma_f32_16x16x32_bf16 v[40:43], v[24:27], v[216:219], v[40:43]
  v_mfma_f32_16x16x32_bf16 v[44:47], v[24:27], v[248:251], v[44:47]
  ds_read_b128 v[24:27], v14 offset:8192
  s_waitcnt lgkmcnt(3)
  v_mfma_f32_16x16x32_bf16 v[32:35], v[156:159], v[28:31], v[32:35]
  v_mfma_f32_16x16x32_bf16 v[36:39], v[188:191], v[28:31], v[36:39]
  v_xor_b32 v9, 0x0, v8
  s_add_u32 m0, s55, 0
  s_nop 0
  buffer_load_dwordx4 v9, s[16:19], s53 offen lds
  v_xor_b32 v9, 0x1020, v8
  s_add_u32 m0, s55, 1024
  s_nop 0
  buffer_load_dwordx4 v9, s[16:19], s53 offen lds
  v_mfma_f32_16x16x32_bf16 v[40:43], v[28:31], v[220:223], v[40:43]
  v_xor_b32 v9, 0x2040, v8
  s_add_u32 m0, s55, 2048
  s_nop 0
  buffer_load_dwordx4 v9, s[16:19], s53 offen lds
  v_xor_b32 v9, 0x3060, v8
  s_add_u32 m0, s55, 3072
  s_nop 0
  buffer_load_dwordx4 v9, s[16:19], s53 offen lds
  v_mfma_f32_16x16x32_bf16 v[44:47], v[28:31], v[252:255], v[44:47]
  ds_read_b128 v[28:31], v15 offset:8192
  v_xor_b32 v9, 0x4080, v8
  s_add_u32 m0, s55, 4096
  s_nop 0
  buffer_load_dwordx4 v9, s[16:19], s53 offen lds
  v_xor_b32 v9, 0x50a0, v8
  s_add_u32 m0, s55, 5120
  s_nop 0
  buffer_load_dwordx4 v9, s[16:19], s53 offen lds
  v_xor_b32 v9, 0x60c0, v8
  s_add_u32 m0, s55, 6144
  s_nop 0
  buffer_load_dwordx4 v9, s[16:19], s53 offen lds
  v_xor_b32 v9, 0x70e0, v8
  s_add_u32 m0, s55, 7168
  s_nop 0
  buffer_load_dwordx4 v9, s[16:19], s53 offen lds
  s_barrier
  s_waitcnt lgkmcnt(3)
  v_mfma_f32_16x16x32_bf16 v[48:51], v[128:131], v[16:19], 0
  v_mfma_f32_16x16x32_bf16 v[52:55], v[160:163], v[16:19], 0
  v_mfma_f32_16x16x32_bf16 v[56:59], v[16:19], v[192:195], 0
  v_mfma_f32_16x16x32_bf16 v[60:63], v[16:19], v[224:227], 0
  ds_read_b128 v[16:19], v12 offset:8448
  s_waitcnt lgkmcnt(3)
  v_mfma_f32_16x16x32_bf16 v[48:51], v[132:135], v[20:23], v[48:51]
  v_mfma_f32_16x16x32_bf16 v[52:55], v[164:167], v[20:23], v[52:55]
  v_mfma_f32_16x16x32_bf16 v[56:59], v[20:23], v[196:199], v[56:59]
  v_mfma_f32_16x16x32_bf16 v[60:63], v[20:23], v[228:231], v[60:63]
  ds_read_b128 v[20:23], v13 offset:8448
  s_waitcnt lgkmcnt(3)
  v_mfma_f32_16x16x32_bf16 v[48:51], v[136:139], v[24:27], v[48:51]
  v_mfma_f32_16x16x32_bf16 v[52:55], v[168:171], v[24:27], v[52:55]
  ds_write_b128 v4, v[32:35] offset:15360
  v_mfma_f32_16x16x32_bf16 v[56:59], v[24:27], v[200:203], v[56:59]
  v_mfma_f32_16x16x32_bf16 v[60:63], v[24:27], v[232:235], v[60:63]
  ds_write_b128 v4, v[36:39] offset:19456
  ds_read_b128 v[24:27], v14 offset:8448
  s_waitcnt lgkmcnt(5)
  v_mfma_f32_16x16x32_bf16 v[48:51], v[140:143], v[28:31], v[48:51]
  v_mfma_f32_16x16x32_bf16 v[52:55], v[172:175], v[28:31], v[52:55]
  ds_write_b128 v4, v[40:43] offset:31744
  v_mfma_f32_16x16x32_bf16 v[56:59], v[28:31], v[204:207], v[56:59]
  v_mfma_f32_16x16x32_bf16 v[60:63], v[28:31], v[236:239], v[60:63]
  ds_write_b128 v4, v[44:47] offset:35840
  ds_read_b128 v[28:31], v15 offset:8448
  s_waitcnt lgkmcnt(7)
  v_mfma_f32_16x16x32_bf16 v[48:51], v[144:147], v[16:19], v[48:51]
  v_mfma_f32_16x16x32_bf16 v[52:55], v[176:179], v[16:19], v[52:55]
  v_mfma_f32_16x16x32_bf16 v[56:59], v[16:19], v[208:211], v[56:59]
  v_mfma_f32_16x16x32_bf16 v[60:63], v[16:19], v[240:243], v[60:63]
  s_waitcnt lgkmcnt(6)
  v_mfma_f32_16x16x32_bf16 v[48:51], v[148:151], v[20:23], v[48:51]
  v_mfma_f32_16x16x32_bf16 v[52:55], v[180:183], v[20:23], v[52:55]
  v_mfma_f32_16x16x32_bf16 v[56:59], v[20:23], v[212:215], v[56:59]
  v_mfma_f32_16x16x32_bf16 v[60:63], v[20:23], v[244:247], v[60:63]
  s_waitcnt lgkmcnt(3)
  v_mfma_f32_16x16x32_bf16 v[48:51], v[152:155], v[24:27], v[48:51]
  v_mfma_f32_16x16x32_bf16 v[52:55], v[184:187], v[24:27], v[52:55]
  v_mfma_f32_16x16x32_bf16 v[56:59], v[24:27], v[216:219], v[56:59]
  v_mfma_f32_16x16x32_bf16 v[60:63], v[24:27], v[248:251], v[60:63]
  s_waitcnt lgkmcnt(0)
  v_mfma_f32_16x16x32_bf16 v[48:51], v[156:159], v[28:31], v[48:51]
  v_mfma_f32_16x16x32_bf16 v[52:55], v[188:191], v[28:31], v[52:55]
  v_mfma_f32_16x16x32_bf16 v[56:59], v[28:31], v[220:223], v[56:59]
  v_mfma_f32_16x16x32_bf16 v[60:63], v[28:31], v[252:255], v[60:63]
  s_nop 4
  ds_write_b128 v4, v[48:51] offset:23552
  ds_write_b128 v4, v[52:55] offset:27648
  ds_write_b128 v4, v[56:59] offset:39936
  ds_write_b128 v4, v[60:63] offset:44032
  s_waitcnt lgkmcnt(0)
  s_barrier
  s_barrier
  s_branch L_P_tail
L_R_O:
  s_load_dwordx2 s[16:17], s[0:1], 40
  s_load_dwordx2 s[12:13], s[0:1], 80
  v_and_b32 v10, 15, v0
  v_lshrrev_b32 v11, 4, v0
  s_sub_u32 s31, s26, 4
  v_lshrrev_b32 v1, 2, v0
  s_lshl_b32 s28, s24, 10
  s_lshl_b32 s29, s31, 8
  s_add_u32 s28, s28, s29
  v_add_u32 v1, s28, v1
  v_lshlrev_b32 v1, 11, v1
  v_and_b32 v2, 3, v0
  v_lshl_add_u32 v1, v2, 4, v1
  s_xor_b32 s28, s25, 8
  s_lshl_b32 s28, s28, 6
  v_add_u32 v1, s28, v1
  v_lshlrev_b32 v2, 7, v10
  v_lshl_add_u32 v2, v11, 16, v2
  s_lshl_b32 s28, s31, 18
  s_lshl_b32 s29, s25, 11
  s_add_u32 s29, s28, s29
  s_waitcnt lgkmcnt(0)
  s_and_b32 s17, s17, 0xffff
  s_mov_b32 s18, 0x400000
  s_mov_b32 s19, 0x20000
  s_and_b32 s13, s13, 0xffff
  s_mov_b32 s14, 0x800000
  s_mov_b32 s15, 0x20000
  s_bitcmp1_b32 s25, 0
  s_cbranch_scc1 L_wlO1
  s_mov_b32 s28, 0
  buffer_load_dwordx4 v[192:195], v1, s[12:15], s28 offen
  s_mov_b32 s28, 32768
  buffer_load_dwordx4 v[196:199], v1, s[12:15], s28 offen
  s_mov_b32 s28, 65536
  buffer_load_dwordx4 v[224:227], v1, s[12:15], s28 offen
  s_mov_b32 s28, 98304
  buffer_load_dwordx4 v[228:231], v1, s[12:15], s28 offen
  s_mov_b32 s28, 131072
  buffer_load_dwordx4 v[200:203], v1, s[12:15], s28 offen
  s_mov_b32 s28, 163840
  buffer_load_dwordx4 v[204:207], v1, s[12:15], s28 offen
  s_mov_b32 s28, 196608
  buffer_load_dwordx4 v[232:235], v1, s[12:15], s28 offen
  s_mov_b32 s28, 229376
  buffer_load_dwordx4 v[236:239], v1, s[12:15], s28 offen
  buffer_load_dword v16, v2, s[16:19], s29 offen
  s_mov_b32 s28, 262144
  buffer_load_dwordx4 v[208:211], v1, s[12:15], s28 offen
  s_mov_b32 s28, 294912
  buffer_load_dwordx4 v[212:215], v1, s[12:15], s28 offen
  s_mov_b32 s28, 327680
  buffer_load_dwordx4 v[240:243], v1, s[12:15], s28 offen
  s_mov_b32 s28, 360448
  buffer_load_dwordx4 v[244:247], v1, s[12:15], s28 offen
  s_mov_b32 s28, 393216
  buffer_load_dwordx4 v[216:219], v1, s[12:15], s28 offen
  s_mov_b32 s28, 425984
  buffer_load_dwordx4 v[220:223], v1, s[12:15], s28 offen
  s_mov_b32 s28, 458752
  buffer_load_dwordx4 v[248:251], v1, s[12:15], s28 offen
  s_mov_b32 s28, 491520
  buffer_load_dwordx4 v[252:255], v1, s[12:15], s28 offen
  s_branch L_wlO2
L_wlO1:
  s_mov_b32 s28, 65536
  buffer_load_dwordx4 v[224:227], v1, s[12:15], s28 offen
  s_mov_b32 s28, 98304
  buffer_load_dwordx4 v[228:231], v1, s[12:15], s28 offen
  s_mov_b32 s28, 0
  buffer_load_dwordx4 v[192:195], v1, s[12:15], s28 offen
  s_mov_b32 s28, 32768
  buffer_load_dwordx4 v[196:199], v1, s[12:15], s28 offen
  s_mov_b32 s28, 196608
  buffer_load_dwordx4 v[232:235], v1, s[12:15], s28 offen
  s_mov_b32 s28, 229376
  buffer_load_dwordx4 v[236:239], v1, s[12:15], s28 offen
  s_mov_b32 s28, 131072
  buffer_load_dwordx4 v[200:203], v1, s[12:15], s28 offen
  s_mov_b32 s28, 163840
  buffer_load_dwordx4 v[204:207], v1, s[12:15], s28 offen
  buffer_load_dword v16, v2, s[16:19], s29 offen
  s_mov_b32 s28, 327680
  buffer_load_dwordx4 v[240:243], v1, s[12:15], s28 offen
  s_mov_b32 s28, 360448
  buffer_load_dwordx4 v[244:247], v1, s[12:15], s28 offen
  s_mov_b32 s28, 262144
  buffer_load_dwordx4 v[208:211], v1, s[12:15], s28 offen
  s_mov_b32 s28, 294912
  buffer_load_dwordx4 v[212:215], v1, s[12:15], s28 offen
  s_mov_b32 s28, 458752
  buffer_load_dwordx4 v[248:251], v1, s[12:15], s28 offen
  s_mov_b32 s28, 491520
  buffer_load_dwordx4 v[252:255], v1, s[12:15], s28 offen
  s_mov_b32 s28, 393216
  buffer_load_dwordx4 v[216:219], v1, s[12:15], s28 offen
  s_mov_b32 s28, 425984
  buffer_load_dwordx4 v[220:223], v1, s[12:15], s28 offen
L_wlO2:
  s_lshl_b32 s30, s26, 12
  s_add_u32 s30, s30, 131072
  v_lshlrev_b32 v60, 4, v0
  v_add_u32 v60, s30, v60
  v_lshrrev_b32 v6, 1, v11
  v_lshlrev_b32 v61, 4, v6
  v_and_b32 v6, 1, v11
  v_lshl_add_u32 v61, v6, 2, v61
  v_bfe_u32 v6, v10, 2, 1
  v_add_u32 v61, v61, v6
  v_bfe_u32 v6, v10, 3, 1
  v_lshl_add_u32 v61, v6, 3, v61
  v_lshlrev_b32 v61, 6, v61
  v_and_b32 v6, 3, v10
  v_lshl_add_u32 v61, v6, 3, v61
  v_add_u32 v61, s30, v61
  v_lshlrev_b32 v1, 4, v0
  s_lshl_b32 s28, s31, 12
  s_add_u32 s28, s28, 16384
  v_add_u32 v1, s28, v1
  v_mov_b32 v2, 0x4444
  v_mov_b32 v6, 0xeeee
  v_and_b32 v7, 1, v0
  v_cmp_eq_u32 vcc, 1, v7
  s_nop 1
  v_cndmask_b32 v2, v2, v6, vcc
  v_mul_u32_u24 v3, 320, v11
  v_and_b32 v6, 1, v10
  v_lshl_add_u32 v3, v6, 2, v3
  v_lshrrev_b32 v6, 2, v10
  v_lshl_add_u32 v3, v6, 3, v3
  v_bfe_u32 v6, v10, 1, 1
  v_lshl_add_u32 v3, v6, 5, v3
  s_mul_i32 s28, s31, 1280
  s_add_u32 s28, s28, 13312
  v_add_u32 v3, s28, v3
  s_cmp_eq_u32 s26, 5
  s_cbranch_scc1 L_O5
  s_cmp_eq_u32 s26, 6
  s_cbranch_scc1 L_O6
  s_cmp_eq_u32 s26, 7
  s_cbranch_scc1 L_O7
L_O4:
  v_mul_u32_u24 v5, 144, v10
  v_lshl_add_u32 v5, v11, 5, v5
  v_lshlrev_b32 v7, 4, v0
  v_add_u32 v7, 9216, v7
  v_lshrrev_b32 v6, 2, v10
  v_and_b32 v14, 1, v10
  v_lshl_add_u32 v6, v6, 1, v14
  s_lshr_b32 s28, s25, 2
  s_mul_i32 s28, s28, 5120
  s_add_u32 s28, s28, 32768
  s_lshl_b32 s29, s47, 10
  s_add_u32 s29, s29, s28
  v_lshlrev_b32 v15, 4, v0
  v_add_u32 v8, s29, v15
  s_lshl_b32 s29, s47, 2
  s_add_u32 s29, s29, s28
  s_add_u32 s29, s29, 4096
  v_add_u32 v15, s29, v15
  v_lshlrev_b32 v9, 4, v0
  v_add_u32 v9, s28, v9
  v_add_u32 v12, 4096, v9
  s_xor_b32 s29, s47, 1
  s_lshl_b32 s29, s29, 10
  v_add_u32 v53, s29, v9
  s_xor_b32 s29, s47, 2
  s_lshl_b32 s29, s29, 10
  v_add_u32 v54, s29, v9
  s_xor_b32 s29, s47, 3
  s_lshl_b32 s29, s29, 10
  v_add_u32 v55, s29, v9
  v_lshlrev_b32 v13, 5, v6
  v_lshrrev_b32 v14, 1, v11
  v_lshl_add_u32 v13, v14, 8, v13
  v_and_b32 v14, 1, v11
  v_lshl_add_u32 v13, v14, 4, v13
  s_xor_b32 s28, s25, 2
  s_lshl_b32 s28, s28, 9
  s_add_u32 s28, s28, 16384
  v_add_u32 v13, s28, v13
  v_lshlrev_b32 v4, 9, v11
  v_add_u32 v4, 18432, v4
  v_lshrrev_b32 v6, 2, v10
  v_lshl_add_u32 v14, v6, 7, v4
  v_and_b32 v6, 3, v10
  v_lshl_add_u32 v14, v6, 4, v14
  v_lshrrev_b32 v6, 3, v10
  v_lshl_add_u32 v4, v6, 8, v4
  v_and_b32 v6, 7, v10
  v_lshl_add_u32 v4, v6, 4, v4
  v_lshrrev_b32 v6, 2, v10
  v_lshlrev_b32 v41, 7, v6
  v_and_b32 v6, 3, v10
  v_lshl_add_u32 v41, v6, 4, v41
  v_lshl_add_u32 v41, v11, 2, v41
  s_lshl_b32 s28, s47, 9
  s_xor_b32 s29, s28, 0x400
  s_add_u32 s29, s29, 71301120
  v_add_u32 v41, s29, v41
  v_lshrrev_b32 v40, 2, v10
  v_and_b32 v6, 1, v10
  v_lshl_add_u32 v40, v40, 1, v6
  v_lshlrev_b32 v40, 4, v40
  v_lshl_add_u32 v40, v11, 7, v40
  s_add_u32 s29, s28, 67106816
  v_add_u32 v40, s29, v40
  v_and_b32 v6, 31, v0
  v_lshlrev_b32 v6, 4, v6
  v_lshrrev_b32 v42, 5, v0
  v_lshl_add_u32 v42, v42, 14, v6
  s_xor_b32 s28, s25, 8
  s_lshl_b32 s28, s28, 9
  v_add_u32 v42, s28, v42
  v_lshrrev_b32 v6, 5, v0
  v_mul_u32_u24 v6, 5120, v6
  v_xor_b32 v42, v42, v6
  s_lshr_b32 s28, s25, 2
  s_mul_i32 s28, s28, 5120
  s_add_u32 s28, s28, 32768
  s_lshl_b32 s29, s47, 10
  s_add_u32 s29, s29, s28
  v_lshlrev_b32 v15, 4, v0
  v_add_u32 v8, s29, v15
  s_lshl_b32 s29, s47, 2
  s_add_u32 s29, s29, s28
  s_add_u32 s29, s29, 4096
  v_add_u32 v15, s29, v15
  s_lshl_b32 s43, s46, 17
  v_mov_b32 v44, -1
  v_mov_b32 v45, -1
  v_mov_b32 v46, -1
  v_mov_b32 v47, -1
  s_waitcnt vmcnt(13)
  ds_write_b128 v60, v[192:195] offset:0
  ds_write_b128 v60, v[196:199] offset:1024
  ds_write_b128 v60, v[224:227] offset:2048
  ds_write_b128 v60, v[228:231] offset:3072
  ds_read_b64_tr_b16 v[192:193], v61 offset:0
  ds_read_b64_tr_b16 v[194:195], v61 offset:128
  ds_read_b64_tr_b16 v[196:197], v61 offset:2048
  ds_read_b64_tr_b16 v[198:199], v61 offset:2176
  ds_read_b64_tr_b16 v[224:225], v61 offset:32
  ds_read_b64_tr_b16 v[226:227], v61 offset:160
  ds_read_b64_tr_b16 v[228:229], v61 offset:2080
  ds_read_b64_tr_b16 v[230:231], v61 offset:2208
  s_waitcnt vmcnt(9)
  ds_write_b128 v60, v[200:203] offset:0
  ds_write_b128 v60, v[204:207] offset:1024
  ds_write_b128 v60, v[232:235] offset:2048
  ds_write_b128 v60, v[236:239] offset:3072
  ds_read_b64_tr_b16 v[200:201], v61 offset:0
  ds_read_b64_tr_b16 v[202:203], v61 offset:128
  ds_read_b64_tr_b16 v[204:205], v61 offset:2048
  ds_read_b64_tr_b16 v[206:207], v61 offset:2176
  ds_read_b64_tr_b16 v[232:233], v61 offset:32
  ds_read_b64_tr_b16 v[234:235], v61 offset:160
  ds_read_b64_tr_b16 v[236:237], v61 offset:2080
  ds_read_b64_tr_b16 v[238:239], v61 offset:2208
  s_waitcnt vmcnt(4)
  ds_write_b128 v60, v[208:211] offset:0
  ds_write_b128 v60, v[212:215] offset:1024
  ds_write_b128 v60, v[240:243] offset:2048
  ds_write_b128 v60, v[244:247] offset:3072
  ds_read_b64_tr_b16 v[208:209], v61 offset:0
  ds_read_b64_tr_b16 v[210:211], v61 offset:128
  ds_read_b64_tr_b16 v[212:213], v61 offset:2048
  ds_read_b64_tr_b16 v[214:215], v61 offset:2176
  ds_read_b64_tr_b16 v[240:241], v61 offset:32
  ds_read_b64_tr_b16 v[242:243], v61 offset:160
  ds_read_b64_tr_b16 v[244:245], v61 offset:2080
  ds_read_b64_tr_b16 v[246:247], v61 offset:2208
  s_waitcnt vmcnt(0)
  ds_write_b128 v60, v[216:219] offset:0
  ds_write_b128 v60, v[220:223] offset:1024
  ds_write_b128 v60, v[248:251] offset:2048
  ds_write_b128 v60, v[252:255] offset:3072
  ds_read_b64_tr_b16 v[216:217], v61 offset:0
  ds_read_b64_tr_b16 v[218:219], v61 offset:128
  ds_read_b64_tr_b16 v[220:221], v61 offset:2048
  ds_read_b64_tr_b16 v[222:223], v61 offset:2176
  ds_read_b64_tr_b16 v[248:249], v61 offset:32
  ds_read_b64_tr_b16 v[250:251], v61 offset:160
  ds_read_b64_tr_b16 v[252:253], v61 offset:2080
  ds_read_b64_tr_b16 v[254:255], v61 offset:2208
  s_setprio 2
  s_barrier
  v_mov_b32 v62, 22528
  ds_read_b32 v63, v62
  s_waitcnt lgkmcnt(0)
  v_readfirstlane_b32 s33, v63
  s_nop 0
  s_lshr_b32 s28, s33, 3
  s_and_b32 s28, s28, 0x2000
  s_add_u32 s45, s45, s28
  s_and_b32 s33, s33, 0xffff
  s_barrier
  s_cmp_ge_u32 s33, 32
  s_cbranch_scc0 L_O4_slow
  v_mov_b32 v92, 0x3f803f80
  v_mov_b32 v93, 0x3f803f80
  v_mov_b32 v94, 0x3f803f80
  v_mov_b32 v95, 0x3f803f80
  s_mov_b32 s53, s52
  v_mov_b32 v81, 0
  v_mov_b32 v82, 0
  v_mov_b32 v83, 0
  v_mov_b32 v85, 0
  v_mov_b32 v86, 0
  v_mov_b32 v87, 0
  v_mov_b32 v137, 0
  v_mov_b32 v138, 0
  v_mov_b32 v139, 0
.p2align 6
L_O4_loopf:
  s_add_u32 s28, s36, 0
  s_and_b32 s28, s28, 3
  s_lshl_b32 s28, s28, 17
  s_add_u32 s37, s44, s28
  v_mov_b32 v32, 0
  v_mov_b32 v33, 0
  v_mov_b32 v34, 0
  v_mov_b32 v35, 0
  v_mov_b32 v36, 0
  v_mov_b32 v37, 0
  v_mov_b32 v38, 0
  v_mov_b32 v39, 0
  s_cmp_eq_u32 s36, 63
  ds_read_b128 v[64:67], v4 offset:0
  ds_read_b128 v[68:71], v4 offset:128
  ds_read_b128 v[72:75], v14 offset:2048
  ds_read_b128 v[76:79], v14 offset:2112
  s_waitcnt lgkmcnt(0)
  s_barrier
  ds_read_b128 v[144:147], v5 offset:0
  ds_read_b128 v[148:151], v5 offset:16
  ds_read_b128 v[152:155], v5 offset:2304
  ds_read_b128 v[156:159], v5 offset:2320
  ds_read_b128 v[160:163], v5 offset:4608
  ds_read_b128 v[164:167], v5 offset:4624
  ds_read_b128 v[168:171], v5 offset:6912
  ds_read_b128 v[172:175], v5 offset:6928
  s_waitcnt lgkmcnt(5)
  v_pk_add_f32 v[144:145], v[144:145], v[152:153]
  v_pk_add_f32 v[146:147], v[146:147], v[154:155]
  s_waitcnt lgkmcnt(4)
  v_pk_add_f32 v[148:149], v[148:149], v[156:157]
  v_pk_add_f32 v[150:151], v[150:151], v[158:159]
  s_waitcnt lgkmcnt(3)
  v_pk_add_f32 v[144:145], v[144:145], v[160:161]
  v_pk_add_f32 v[146:147], v[146:147], v[162:163]
  s_waitcnt lgkmcnt(2)
  v_pk_add_f32 v[148:149], v[148:149], v[164:165]
  v_pk_add_f32 v[150:151], v[150:151], v[166:167]
  s_waitcnt lgkmcnt(1)
  v_pk_add_f32 v[144:145], v[144:145], v[168:169]
  v_pk_add_f32 v[146:147], v[146:147], v[170:171]
  v_cvt_pk_bf16_f32 v88, v144, v145
  v_cvt_pk_bf16_f32 v89, v146, v147
  s_waitcnt lgkmcnt(0)
  v_pk_add_f32 v[148:149], v[148:149], v[172:173]
  v_pk_add_f32 v[150:151], v[150:151], v[174:175]
  v_cvt_pk_bf16_f32 v90, v148, v149
  v_cvt_pk_bf16_f32 v91, v150, v151
  s_cbranch_scc1 L_O4_lastf
  s_nop 0
  v_mfma_f32_16x16x32_bf16 v[176:179], v[64:67], v[88:91], 0
  v_mfma_f32_16x16x32_bf16 v[180:183], v[68:71], v[88:91], 0
  v_mfma_f32_16x16x32_bf16 v[184:187], v[88:91], v[88:91], 0
  s_mov_b64 vcc, s[48:49]
  s_nop 5
  v_cndmask_b32_dpp v96, v176, v180, vcc quad_perm:[2,3,0,1] row_mask:0xf bank_mask:0xf
  v_cndmask_b32_dpp v97, v177, v181, vcc quad_perm:[2,3,0,1] row_mask:0xf bank_mask:0xf
  v_cndmask_b32_dpp v98, v178, v182, vcc quad_perm:[2,3,0,1] row_mask:0xf bank_mask:0xf
  v_cndmask_b32_dpp v99, v179, v183, vcc quad_perm:[2,3,0,1] row_mask:0xf bank_mask:0xf
  buffer_store_dwordx4 v[96:99], v8, s[4:7], s37 offen
  v_cndmask_b32_dpp v185, v184, v185, vcc quad_perm:[2,3,0,1] row_mask:0xf bank_mask:0xf
  buffer_store_dword v185, v15, s[4:7], s37 offen
  s_barrier
  ds_read_b128 v[144:147], v7 offset:0
  ds_read_b128 v[148:151], v7 offset:1024
  ds_read_b128 v[152:155], v7 offset:2048
  ds_read_b128 v[156:159], v7 offset:3072
  s_waitcnt lgkmcnt(0)
  v_pk_add_f32 v[144:145], v[144:145], v[148:149]
  v_pk_add_f32 v[146:147], v[146:147], v[150:151]
  v_pk_add_f32 v[152:153], v[152:153], v[156:157]
  v_pk_add_f32 v[154:155], v[154:155], v[158:159]
  v_pk_add_f32 v[144:145], v[144:145], v[152:153]
  v_pk_add_f32 v[146:147], v[146:147], v[154:155]
  v_cvt_pk_bf16_f32 v80, v144, v145
  v_cvt_pk_bf16_f32 v84, v146, v147
  v_min_u32 v48, -2, v88
  v_min_u32 v49, -2, v89
  v_min_u32 v50, -2, v90
  v_min_u32 v51, -2, v91
  v_min_u32 v56, -2, v80
  v_min_u32 v57, -2, v84
  s_nop 11
  buffer_load_dwordx4 v[100:103], v53, s[4:7], s37 offen sc1
  buffer_load_dwordx4 v[104:107], v54, s[4:7], s37 offen sc1
  buffer_load_dwordx4 v[108:111], v55, s[4:7], s37 offen sc1
  buffer_load_dwordx4 v[112:115], v12, s[4:7], s37 offen sc1
  s_nop 15
  s_nop 3
  buffer_load_dwordx4 v[100:103], v53, s[4:7], s37 offen sc1
  buffer_load_dwordx4 v[104:107], v54, s[4:7], s37 offen sc1
  buffer_load_dwordx4 v[108:111], v55, s[4:7], s37 offen sc1
  buffer_load_dwordx4 v[112:115], v12, s[4:7], s37 offen sc1
L_O4_spf:
  s_waitcnt vmcnt(4)
  v_pk_add_f32 v[180:181], v[112:113], v[114:115]
  v_pk_add_f32 v[176:177], v[96:97], v[100:101]
  v_pk_add_f32 v[178:179], v[98:99], v[102:103]
  v_pk_add_f32 v[182:183], v[104:105], v[108:109]
  v_pk_add_f32 v[184:185], v[106:107], v[110:111]
  v_add_f32 v180, v180, v181
  v_pk_add_f32 v[176:177], v[176:177], v[182:183]
  v_pk_add_f32 v[178:179], v[178:179], v[184:185]
  v_mul_f32 v180, s52, v180
  v_pk_mul_f32 v[176:177], v[176:177], s[52:53]
  v_pk_mul_f32 v[178:179], v[178:179], s[52:53]
  v_exp_f32 v186, v180
  v_maximum3_f32 v140, |v180|, |v176|, |v177|
  v_exp_f32 v182, v176
  v_maximum3_f32 v140, v140, |v178|, |v179|
  v_exp_f32 v183, v177
  v_cmp_nge_f32 vcc, 0x41c00000, v140
  v_exp_f32 v184, v178
  v_exp_f32 v185, v179
  s_cbranch_vccnz L_O4_mxf
L_O4_mkf:
  v_mov_b32_dpp v187, v186 quad_perm:[2,3,0,1] row_mask:0xf bank_mask:0xf
  v_cvt_pk_bf16_f32 v134, v182, v183
  v_cvt_pk_bf16_f32 v135, v184, v185
  v_cvt_pk_bf16_f32 v136, v187, v186
  v_mov_b32_dpp v132, v134 quad_perm:[2,3,0,1] row_mask:0xf bank_mask:0xf
  v_mov_b32_dpp v133, v135 quad_perm:[2,3,0,1] row_mask:0xf bank_mask:0xf
  v_mfma_f32_16x16x32_bf16 v[140:143], v[92:95], v[136:139], 0
  v_mfma_f32_16x16x32_bf16 v[124:127], v[80:83], v[136:139], 0
  v_mfma_f32_16x16x32_bf16 v[128:131], v[84:87], v[136:139], 0
  v_mfma_f32_16x16x32_bf16 v[140:143], v[92:95], v[132:135], v[140:143]
  v_mfma_f32_16x16x32_bf16 v[124:127], v[72:75], v[132:135], v[124:127]
  v_mfma_f32_16x16x32_bf16 v[128:131], v[76:79], v[132:135], v[128:131]
  s_nop 5
  v_rcp_f32 v140, v140
  s_nop 0
  v_pk_mul_f32 v[124:125], v[124:125], v[140:141] op_sel_hi:[1,0]
  v_pk_mul_f32 v[126:127], v[126:127], v[140:141] op_sel_hi:[1,0]
  v_pk_mul_f32 v[128:129], v[128:129], v[140:141] op_sel_hi:[1,0]
  v_pk_mul_f32 v[130:131], v[130:131], v[140:141] op_sel_hi:[1,0]
  v_cvt_pk_bf16_f32 v124, v124, v125
  v_cvt_pk_bf16_f32 v125, v126, v127
  v_cvt_pk_bf16_f32 v126, v128, v129
  v_cvt_pk_bf16_f32 v127, v130, v131
  v_min_u32 v124, -2, v124
  s_mov_b64 exec, s[48:49]
  buffer_store_dwordx4 v[124:127], v13, s[4:7], s37 offen
  s_mov_b64 exec, -1
  s_barrier
  s_nop 15
  s_nop 13
  buffer_load_dwordx4 v[16:19], v1, s[4:7], s37 offen offset:0 sc1
  s_nop 3
  buffer_load_dwordx4 v[20:23], v1, s[4:7], s37 offen offset:1024 sc1
  s_nop 3
  buffer_load_dwordx4 v[24:27], v1, s[4:7], s37 offen offset:2048 sc1
  s_nop 3
  buffer_load_dwordx4 v[28:31], v1, s[4:7], s37 offen offset:3072 sc1
  s_waitcnt vmcnt(3)
  v_cmp_eq_u32 vcc, -1, v16
  s_cbranch_vccnz L_Oo_26_b0123
L_Oo_26_k0123:
  v_smfmac_f32_16x16x64_bf16 v[32:35], v[16:19], v[192:199], v2
  v_smfmac_f32_16x16x64_bf16 v[36:39], v[16:19], v[224:231], v2
  s_waitcnt vmcnt(2)
  v_cmp_eq_u32 vcc, -1, v20
  s_cbranch_vccnz L_Oo_26_b123
L_Oo_26_k123:
  v_smfmac_f32_16x16x64_bf16 v[32:35], v[20:23], v[200:207], v2
  v_smfmac_f32_16x16x64_bf16 v[36:39], v[20:23], v[232:239], v2
  s_waitcnt vmcnt(1)
  v_cmp_eq_u32 vcc, -1, v24
  s_cbranch_vccnz L_Oo_26_b23
L_Oo_26_k23:
  v_smfmac_f32_16x16x64_bf16 v[32:35], v[24:27], v[208:215], v2
  v_smfmac_f32_16x16x64_bf16 v[36:39], v[24:27], v[240:247], v2
  s_waitcnt vmcnt(0)
  v_cmp_eq_u32 vcc, -1, v28
  s_cbranch_vccnz L_Oo_26_b3
L_Oo_26_k3:
  v_smfmac_f32_16x16x64_bf16 v[32:35], v[28:31], v[216:223], v2
  v_smfmac_f32_16x16x64_bf16 v[36:39], v[28:31], v[248:255], v2
L_Oo_26_e:
  s_nop 6
  v_add_f32 v32, v32, v33
  v_add_f32 v34, v34, v35
  ds_write2_b32 v3, v32, v34 offset0:0 offset1:40
  v_add_f32 v36, v36, v37
  v_add_f32 v38, v38, v39
  ds_write2_b32 v3, v36, v38 offset0:16 offset1:56
  s_waitcnt lgkmcnt(0)
  s_barrier
  s_barrier
  s_mov_b64 exec, s[50:51]
  buffer_store_dwordx4 v[48:51], v40, s[4:7], s43 offen offset:2048 sc1
  s_mov_b64 exec, -1
  buffer_store_dword v56, v41, s[4:7], s43 offen offset:2048 sc1
  buffer_store_dword v57, v41, s[4:7], s43 offen offset:2112 sc1
  s_add_u32 s43, s43, 2048
  s_add_u32 s28, s36, 2
  s_and_b32 s28, s28, 3
  s_lshl_b32 s28, s28, 17
  s_add_u32 s39, s44, s28
  buffer_store_dwordx4 v[44:47], v42, s[4:7], s39 offen
  buffer_store_dwordx4 v[44:47], v8, s[4:7], s39 offen
  buffer_store_dword v44, v15, s[4:7], s39 offen
  s_barrier
  s_add_u32 s36, s36, 1
  s_branch L_O4_loopf
L_O4_lastf:
  v_min_u32 v48, -2, v88
  v_min_u32 v49, -2, v89
  v_min_u32 v50, -2, v90
  v_min_u32 v51, -2, v91
  s_mov_b64 exec, s[50:51]
  buffer_store_dwordx4 v[48:51], v40, s[4:7], s43 offen offset:2048 sc1
  s_mov_b64 exec, -1
  s_barrier
  ds_read_b128 v[144:147], v7 offset:0
  ds_read_b128 v[148:151], v7 offset:1024
  ds_read_b128 v[152:155], v7 offset:2048
  ds_read_b128 v[156:159], v7 offset:3072
  s_waitcnt lgkmcnt(0)
  v_pk_add_f32 v[144:145], v[144:145], v[148:149]
  v_pk_add_f32 v[146:147], v[146:147], v[150:151]
  v_pk_add_f32 v[152:153], v[152:153], v[156:157]
  v_pk_add_f32 v[154:155], v[154:155], v[158:159]
  v_pk_add_f32 v[144:145], v[144:145], v[152:153]
  v_pk_add_f32 v[146:147], v[146:147], v[154:155]
  v_cvt_pk_bf16_f32 v80, v144, v145
  v_cvt_pk_bf16_f32 v84, v146, v147
  v_min_u32 v56, -2, v80
  v_min_u32 v57, -2, v84
  buffer_store_dword v56, v41, s[4:7], s43 offen offset:2048 sc1
  buffer_store_dword v57, v41, s[4:7], s43 offen offset:2112 sc1
  s_branch L_R_done
L_O4_mxf:
  v_max3_u32 v60, v100, v104, v108
  v_max3_u32 v60, v60, v112, v113
  v_max3_u32 v60, v60, v114, v115
  v_cmp_eq_u32 vcc, -1, v60
  s_cbranch_vccz L_O4_myf
  s_add_u32 s27, s27, 1
  s_cmp_ge_u32 s27, 0x80000
  s_cbranch_scc1 L_O4_myf
  s_mov_b64 exec, vcc
  buffer_load_dwordx4 v[100:103], v53, s[4:7], s37 offen sc1
  buffer_load_dwordx4 v[104:107], v54, s[4:7], s37 offen sc1
  buffer_load_dwordx4 v[108:111], v55, s[4:7], s37 offen sc1
  buffer_load_dwordx4 v[112:115], v12, s[4:7], s37 offen sc1
  s_mov_b64 exec, -1
  s_waitcnt vmcnt(4)
  s_branch L_O4_mxf
L_O4_myf:
  v_pk_add_f32 v[180:181], v[112:113], v[114:115]
  v_pk_add_f32 v[176:177], v[96:97], v[100:101]
  v_pk_add_f32 v[178:179], v[98:99], v[102:103]
  v_pk_add_f32 v[182:183], v[104:105], v[108:109]
  v_pk_add_f32 v[184:185], v[106:107], v[110:111]
  v_add_f32 v180, v180, v181
  v_pk_add_f32 v[176:177], v[176:177], v[182:183]
  v_pk_add_f32 v[178:179], v[178:179], v[184:185]
  v_mul_f32 v180, s52, v180
  v_pk_mul_f32 v[176:177], v[176:177], s[52:53]
  v_pk_mul_f32 v[178:179], v[178:179], s[52:53]
  v_exp_f32 v186, v180
  v_maximum3_f32 v140, |v180|, |v176|, |v177|
  v_exp_f32 v182, v176
  v_maximum3_f32 v140, v140, |v178|, |v179|
  v_exp_f32 v183, v177
  v_cmp_nge_f32 vcc, 0x41c00000, v140
  v_exp_f32 v184, v178
  v_exp_f32 v185, v179
  s_cbranch_vccz L_O4_mkf
  v_max3_f32 v140, v180, v176, v177
  v_max3_f32 v140, v140, v178, v179
  s_nop 1
  v_max_f32_dpp v140, v140, v140 quad_perm:[2,3,0,1] row_mask:0xf bank_mask:0xf
  v_mov_b32 v141, v140
  s_nop 1
  v_permlane16_swap_b32 v140, v141
  v_max_f32 v140, v140, v141
  v_mov_b32 v141, v140
  s_nop 1
  v_permlane32_swap_b32 v140, v141
  v_max_f32 v140, v140, v141
  v_sub_f32 v176, v176, v140
  v_sub_f32 v177, v177, v140
  v_sub_f32 v178, v178, v140
  v_sub_f32 v179, v179, v140
  v_sub_f32 v180, v180, v140
  v_exp_f32 v182, v176
  v_exp_f32 v183, v177
  v_exp_f32 v184, v178
  v_exp_f32 v185, v179
  v_exp_f32 v186, v180
  s_nop 1
  s_branch L_O4_mkf
L_Oo_26_b0123:
  s_mov_b64 exec, vcc
  buffer_load_dwordx4 v[16:19], v1, s[4:7], s37 offen offset:0 sc1
  s_mov_b64 exec, -1
  s_waitcnt vmcnt(3)
  v_cmp_eq_u32 vcc, -1, v20
  s_cbranch_vccnz L_Oo_26_b1230
L_Oo_26_k1230:
  v_smfmac_f32_16x16x64_bf16 v[32:35], v[20:23], v[200:207], v2
  v_smfmac_f32_16x16x64_bf16 v[36:39], v[20:23], v[232:239], v2
  s_waitcnt vmcnt(2)
  v_cmp_eq_u32 vcc, -1, v24
  s_cbranch_vccnz L_Oo_26_b230
L_Oo_26_k230:
  v_smfmac_f32_16x16x64_bf16 v[32:35], v[24:27], v[208:215], v2
  v_smfmac_f32_16x16x64_bf16 v[36:39], v[24:27], v[240:247], v2
  s_waitcnt vmcnt(1)
  v_cmp_eq_u32 vcc, -1, v28
  s_cbranch_vccnz L_Oo_26_b30
L_Oo_26_k30:
  v_smfmac_f32_16x16x64_bf16 v[32:35], v[28:31], v[216:223], v2
  v_smfmac_f32_16x16x64_bf16 v[36:39], v[28:31], v[248:255], v2
  s_waitcnt vmcnt(0)
  v_cmp_eq_u32 vcc, -1, v16
  s_cbranch_vccnz L_Oo_26_b0
L_Oo_26_k0:
  v_smfmac_f32_16x16x64_bf16 v[32:35], v[16:19], v[192:199], v2
  v_smfmac_f32_16x16x64_bf16 v[36:39], v[16:19], v[224:231], v2
  s_branch L_Oo_26_e
L_Oo_26_b123:
  s_mov_b64 exec, vcc
  buffer_load_dwordx4 v[20:23], v1, s[4:7], s37 offen offset:1024 sc1
  s_mov_b64 exec, -1
  s_waitcnt vmcnt(2)
  v_cmp_eq_u32 vcc, -1, v24
  s_cbranch_vccnz L_Oo_26_b231
L_Oo_26_k231:
  v_smfmac_f32_16x16x64_bf16 v[32:35], v[24:27], v[208:215], v2
  v_smfmac_f32_16x16x64_bf16 v[36:39], v[24:27], v[240:247], v2
  s_waitcnt vmcnt(1)
  v_cmp_eq_u32 vcc, -1, v28
  s_cbranch_vccnz L_Oo_26_b31
L_Oo_26_k31:
  v_smfmac_f32_16x16x64_bf16 v[32:35], v[28:31], v[216:223], v2
  v_smfmac_f32_16x16x64_bf16 v[36:39], v[28:31], v[248:255], v2
  s_waitcnt vmcnt(0)
  v_cmp_eq_u32 vcc, -1, v20
  s_cbranch_vccnz L_Oo_26_b1
L_Oo_26_k1:
  v_smfmac_f32_16x16x64_bf16 v[32:35], v[20:23], v[200:207], v2
  v_smfmac_f32_16x16x64_bf16 v[36:39], v[20:23], v[232:239], v2
  s_branch L_Oo_26_e
L_Oo_26_b23:
  s_mov_b64 exec, vcc
  buffer_load_dwordx4 v[24:27], v1, s[4:7], s37 offen offset:2048 sc1
  s_mov_b64 exec, -1
  s_waitcnt vmcnt(1)
  v_cmp_eq_u32 vcc, -1, v28
  s_cbranch_vccnz L_Oo_26_b32
L_Oo_26_k32:
  v_smfmac_f32_16x16x64_bf16 v[32:35], v[28:31], v[216:223], v2
  v_smfmac_f32_16x16x64_bf16 v[36:39], v[28:31], v[248:255], v2
  s_waitcnt vmcnt(0)
  v_cmp_eq_u32 vcc, -1, v24
  s_cbranch_vccnz L_Oo_26_b2
L_Oo_26_k2:
  v_smfmac_f32_16x16x64_bf16 v[32:35], v[24:27], v[208:215], v2
  v_smfmac_f32_16x16x64_bf16 v[36:39], v[24:27], v[240:247], v2
  s_branch L_Oo_26_e
L_Oo_26_b3:
  s_mov_b64 exec, vcc
  buffer_load_dwordx4 v[28:31], v1, s[4:7], s37 offen offset:3072 sc1
  s_mov_b64 exec, -1
  s_add_u32 s27, s27, 1
  s_cmp_ge_u32 s27, 0x80000
  s_cbranch_scc1 L_Oo_26_e
  s_waitcnt vmcnt(0)
  v_cmp_eq_u32 vcc, -1, v28
  s_cbranch_vccz L_Oo_26_k3
  s_branch L_Oo_26_b3
L_Oo_26_b1230:
  s_mov_b64 exec, vcc
  buffer_load_dwordx4 v[20:23], v1, s[4:7], s37 offen offset:1024 sc1
  s_mov_b64 exec, -1
  s_waitcnt vmcnt(3)
  v_cmp_eq_u32 vcc, -1, v24
  s_cbranch_vccnz L_Oo_26_b2301
L_Oo_26_k2301:
  v_smfmac_f32_16x16x64_bf16 v[32:35], v[24:27], v[208:215], v2
  v_smfmac_f32_16x16x64_bf16 v[36:39], v[24:27], v[240:247], v2
  s_waitcnt vmcnt(2)
  v_cmp_eq_u32 vcc, -1, v28
  s_cbranch_vccnz L_Oo_26_b301
L_Oo_26_k301:
  v_smfmac_f32_16x16x64_bf16 v[32:35], v[28:31], v[216:223], v2
  v_smfmac_f32_16x16x64_bf16 v[36:39], v[28:31], v[248:255], v2
  s_waitcnt vmcnt(1)
  v_cmp_eq_u32 vcc, -1, v16
  s_cbranch_vccnz L_Oo_26_b01
L_Oo_26_k01:
  v_smfmac_f32_16x16x64_bf16 v[32:35], v[16:19], v[192:199], v2
  v_smfmac_f32_16x16x64_bf16 v[36:39], v[16:19], v[224:231], v2
  s_waitcnt vmcnt(0)
  v_cmp_eq_u32 vcc, -1, v20
  s_cbranch_vccz L_Oo_26_k1
L_Oo_26_b1:
  s_mov_b64 exec, vcc
  buffer_load_dwordx4 v[20:23], v1, s[4:7], s37 offen offset:1024 sc1
  s_mov_b64 exec, -1
  s_add_u32 s27, s27, 1
  s_cmp_ge_u32 s27, 0x80000
  s_cbranch_scc1 L_Oo_26_e
  s_waitcnt vmcnt(0)
  v_cmp_eq_u32 vcc, -1, v20
  s_cbranch_vccz L_Oo_26_k1
  s_branch L_Oo_26_b1
L_Oo_26_b230:
  s_mov_b64 exec, vcc
  buffer_load_dwordx4 v[24:27], v1, s[4:7], s37 offen offset:2048 sc1
  s_mov_b64 exec, -1
  s_waitcnt vmcnt(2)
  v_cmp_eq_u32 vcc, -1, v28
  s_cbranch_vccnz L_Oo_26_b302
L_Oo_26_k302:
  v_smfmac_f32_16x16x64_bf16 v[32:35], v[28:31], v[216:223], v2
  v_smfmac_f32_16x16x64_bf16 v[36:39], v[28:31], v[248:255], v2
  s_waitcnt vmcnt(1)
  v_cmp_eq_u32 vcc, -1, v16
  s_cbranch_vccnz L_Oo_26_b02
L_Oo_26_k02:
  v_smfmac_f32_16x16x64_bf16 v[32:35], v[16:19], v[192:199], v2
  v_smfmac_f32_16x16x64_bf16 v[36:39], v[16:19], v[224:231], v2
  s_waitcnt vmcnt(0)
  v_cmp_eq_u32 vcc, -1, v24
  s_cbranch_vccz L_Oo_26_k2
L_Oo_26_b2:
  s_mov_b64 exec, vcc
  buffer_load_dwordx4 v[24:27], v1, s[4:7], s37 offen offset:2048 sc1
  s_mov_b64 exec, -1
  s_add_u32 s27, s27, 1
  s_cmp_ge_u32 s27, 0x80000
  s_cbranch_scc1 L_Oo_26_e
  s_waitcnt vmcnt(0)
  v_cmp_eq_u32 vcc, -1, v24
  s_cbranch_vccz L_Oo_26_k2
  s_branch L_Oo_26_b2
L_Oo_26_b30:
  s_mov_b64 exec, vcc
  buffer_load_dwordx4 v[28:31], v1, s[4:7], s37 offen offset:3072 sc1
  s_mov_b64 exec, -1
  s_add_u32 s27, s27, 1
  s_cmp_ge_u32 s27, 0x80000
  s_cbranch_scc1 L_Oo_26_e
  s_waitcnt vmcnt(1)
  v_cmp_eq_u32 vcc, -1, v16
  s_cbranch_vccnz L_Oo_26_b03
L_Oo_26_k03:
  v_smfmac_f32_16x16x64_bf16 v[32:35], v[16:19], v[192:199], v2
  v_smfmac_f32_16x16x64_bf16 v[36:39], v[16:19], v[224:231], v2
  s_waitcnt vmcnt(0)
  v_cmp_eq_u32 vcc, -1, v28
  s_cbranch_vccz L_Oo_26_k3
  s_branch L_Oo_26_b3
L_Oo_26_b0:
  s_mov_b64 exec, vcc
  buffer_load_dwordx4 v[16:19], v1, s[4:7], s37 offen offset:0 sc1
  s_mov_b64 exec, -1
  s_add_u32 s27, s27, 1
  s_cmp_ge_u32 s27, 0x80000
  s_cbranch_scc1 L_Oo_26_e
  s_waitcnt vmcnt(0)
  v_cmp_eq_u32 vcc, -1, v16
  s_cbranch_vccz L_Oo_26_k0
  s_branch L_Oo_26_b0
L_Oo_26_b231:
  s_mov_b64 exec, vcc
  buffer_load_dwordx4 v[24:27], v1, s[4:7], s37 offen offset:2048 sc1
  s_mov_b64 exec, -1
  s_waitcnt vmcnt(2)
  v_cmp_eq_u32 vcc, -1, v28
  s_cbranch_vccnz L_Oo_26_b312
L_Oo_26_k312:
  v_smfmac_f32_16x16x64_bf16 v[32:35], v[28:31], v[216:223], v2
  v_smfmac_f32_16x16x64_bf16 v[36:39], v[28:31], v[248:255], v2
  s_waitcnt vmcnt(1)
  v_cmp_eq_u32 vcc, -1, v20
  s_cbranch_vccnz L_Oo_26_b12
L_Oo_26_k12:
  v_smfmac_f32_16x16x64_bf16 v[32:35], v[20:23], v[200:207], v2
  v_smfmac_f32_16x16x64_bf16 v[36:39], v[20:23], v[232:239], v2
  s_waitcnt vmcnt(0)
  v_cmp_eq_u32 vcc, -1, v24
  s_cbranch_vccz L_Oo_26_k2
  s_branch L_Oo_26_b2
L_Oo_26_b31:
  s_mov_b64 exec, vcc
  buffer_load_dwordx4 v[28:31], v1, s[4:7], s37 offen offset:3072 sc1
  s_mov_b64 exec, -1
  s_add_u32 s27, s27, 1
  s_cmp_ge_u32 s27, 0x80000
  s_cbranch_scc1 L_Oo_26_e
  s_waitcnt vmcnt(1)
  v_cmp_eq_u32 vcc, -1, v20
  s_cbranch_vccnz L_Oo_26_b13
L_Oo_26_k13:
  v_smfmac_f32_16x16x64_bf16 v[32:35], v[20:23], v[200:207], v2
  v_smfmac_f32_16x16x64_bf16 v[36:39], v[20:23], v[232:239], v2
  s_waitcnt vmcnt(0)
  v_cmp_eq_u32 vcc, -1, v28
  s_cbranch_vccz L_Oo_26_k3
  s_branch L_Oo_26_b3
L_Oo_26_b32:
  s_mov_b64 exec, vcc
  buffer_load_dwordx4 v[28:31], v1, s[4:7], s37 offen offset:3072 sc1
  s_mov_b64 exec, -1
  s_add_u32 s27, s27, 1
  s_cmp_ge_u32 s27, 0x80000
  s_cbranch_scc1 L_Oo_26_e
  s_waitcnt vmcnt(1)
  v_cmp_eq_u32 vcc, -1, v24
  s_cbranch_vccz L_Oo_26_k23
  s_branch L_Oo_26_b23
L_Oo_26_b2301:
  s_mov_b64 exec, vcc
  buffer_load_dwordx4 v[24:27], v1, s[4:7], s37 offen offset:2048 sc1
  s_mov_b64 exec, -1
  s_waitcnt vmcnt(3)
  v_cmp_eq_u32 vcc, -1, v28
  s_cbranch_vccnz L_Oo_26_b3012
L_Oo_26_k3012:
  v_smfmac_f32_16x16x64_bf16 v[32:35], v[28:31], v[216:223], v2
  v_smfmac_f32_16x16x64_bf16 v[36:39], v[28:31], v[248:255], v2
  s_waitcnt vmcnt(2)
  v_cmp_eq_u32 vcc, -1, v16
  s_cbranch_vccnz L_Oo_26_b012
L_Oo_26_k012:
  v_smfmac_f32_16x16x64_bf16 v[32:35], v[16:19], v[192:199], v2
  v_smfmac_f32_16x16x64_bf16 v[36:39], v[16:19], v[224:231], v2
  s_waitcnt vmcnt(1)
  v_cmp_eq_u32 vcc, -1, v20
  s_cbranch_vccz L_Oo_26_k12
L_Oo_26_b12:
  s_mov_b64 exec, vcc
  buffer_load_dwordx4 v[20:23], v1, s[4:7], s37 offen offset:1024 sc1
  s_mov_b64 exec, -1
  s_waitcnt vmcnt(1)
  v_cmp_eq_u32 vcc, -1, v24
  s_cbranch_vccnz L_Oo_26_b21
L_Oo_26_k21:
  v_smfmac_f32_16x16x64_bf16 v[32:35], v[24:27], v[208:215], v2
  v_smfmac_f32_16x16x64_bf16 v[36:39], v[24:27], v[240:247], v2
  s_waitcnt vmcnt(0)
  v_cmp_eq_u32 vcc, -1, v20
  s_cbranch_vccz L_Oo_26_k1
  s_branch L_Oo_26_b1
L_Oo_26_b301:
  s_mov_b64 exec, vcc
  buffer_load_dwordx4 v[28:31], v1, s[4:7], s37 offen offset:3072 sc1
  s_mov_b64 exec, -1
  s_add_u32 s27, s27, 1
  s_cmp_ge_u32 s27, 0x80000
  s_cbranch_scc1 L_Oo_26_e
  s_waitcnt vmcnt(2)
  v_cmp_eq_u32 vcc, -1, v16
  s_cbranch_vccnz L_Oo_26_b013
L_Oo_26_k013:
  v_smfmac_f32_16x16x64_bf16 v[32:35], v[16:19], v[192:199], v2
  v_smfmac_f32_16x16x64_bf16 v[36:39], v[16:19], v[224:231], v2
  s_waitcnt vmcnt(1)
  v_cmp_eq_u32 vcc, -1, v20
  s_cbranch_vccz L_Oo_26_k13
L_Oo_26_b13:
  s_mov_b64 exec, vcc
  buffer_load_dwordx4 v[20:23], v1, s[4:7], s37 offen offset:1024 sc1
  s_mov_b64 exec, -1
  s_waitcnt vmcnt(1)
  v_cmp_eq_u32 vcc, -1, v28
  s_cbranch_vccz L_Oo_26_k31
  s_branch L_Oo_26_b31
L_Oo_26_b01:
  s_mov_b64 exec, vcc
  buffer_load_dwordx4 v[16:19], v1, s[4:7], s37 offen offset:0 sc1
  s_mov_b64 exec, -1
  s_waitcnt vmcnt(1)
  v_cmp_eq_u32 vcc, -1, v20
  s_cbranch_vccnz L_Oo_26_b10
L_Oo_26_k10:
  v_smfmac_f32_16x16x64_bf16 v[32:35], v[20:23], v[200:207], v2
  v_smfmac_f32_16x16x64_bf16 v[36:39], v[20:23], v[232:239], v2
  s_waitcnt vmcnt(0)
  v_cmp_eq_u32 vcc, -1, v16
  s_cbranch_vccz L_Oo_26_k0
  s_branch L_Oo_26_b0
L_Oo_26_b302:
  s_mov_b64 exec, vcc
  buffer_load_dwordx4 v[28:31], v1, s[4:7], s37 offen offset:3072 sc1
  s_mov_b64 exec, -1
  s_add_u32 s27, s27, 1
  s_cmp_ge_u32 s27, 0x80000
  s_cbranch_scc1 L_Oo_26_e
  s_waitcnt vmcnt(2)
  v_cmp_eq_u32 vcc, -1, v16
  s_cbranch_vccnz L_Oo_26_b023
L_Oo_26_k023:
  v_smfmac_f32_16x16x64_bf16 v[32:35], v[16:19], v[192:199], v2
  v_smfmac_f32_16x16x64_bf16 v[36:39], v[16:19], v[224:231], v2
  s_waitcnt vmcnt(1)
  v_cmp_eq_u32 vcc, -1, v24
  s_cbranch_vccz L_Oo_26_k23
  s_branch L_Oo_26_b23
L_Oo_26_b02:
  s_mov_b64 exec, vcc
  buffer_load_dwordx4 v[16:19], v1, s[4:7], s37 offen offset:0 sc1
  s_mov_b64 exec, -1
  s_waitcnt vmcnt(1)
  v_cmp_eq_u32 vcc, -1, v24
  s_cbranch_vccnz L_Oo_26_b20
L_Oo_26_k20:
  v_smfmac_f32_16x16x64_bf16 v[32:35], v[24:27], v[208:215], v2
  v_smfmac_f32_16x16x64_bf16 v[36:39], v[24:27], v[240:247], v2
  s_waitcnt vmcnt(0)
  v_cmp_eq_u32 vcc, -1, v16
  s_cbranch_vccz L_Oo_26_k0
  s_branch L_Oo_26_b0
L_Oo_26_b03:
  s_mov_b64 exec, vcc
  buffer_load_dwordx4 v[16:19], v1, s[4:7], s37 offen offset:0 sc1
  s_mov_b64 exec, -1
  s_waitcnt vmcnt(1)
  v_cmp_eq_u32 vcc, -1, v28
  s_cbranch_vccz L_Oo_26_k30
  s_branch L_Oo_26_b30
L_Oo_26_b312:
  s_mov_b64 exec, vcc
  buffer_load_dwordx4 v[28:31], v1, s[4:7], s37 offen offset:3072 sc1
  s_mov_b64 exec, -1
  s_add_u32 s27, s27, 1
  s_cmp_ge_u32 s27, 0x80000
  s_cbranch_scc1 L_Oo_26_e
  s_waitcnt vmcnt(2)
  v_cmp_eq_u32 vcc, -1, v20
  s_cbranch_vccz L_Oo_26_k123
  s_branch L_Oo_26_b123
L_Oo_26_b3012:
  s_mov_b64 exec, vcc
  buffer_load_dwordx4 v[28:31], v1, s[4:7], s37 offen offset:3072 sc1
  s_mov_b64 exec, -1
  s_add_u32 s27, s27, 1
  s_cmp_ge_u32 s27, 0x80000
  s_cbranch_scc1 L_Oo_26_e
  s_waitcnt vmcnt(3)
  v_cmp_eq_u32 vcc, -1, v16
  s_cbranch_vccz L_Oo_26_k0123
  s_branch L_Oo_26_b0123
L_Oo_26_b012:
  s_mov_b64 exec, vcc
  buffer_load_dwordx4 v[16:19], v1, s[4:7], s37 offen offset:0 sc1
  s_mov_b64 exec, -1
  s_waitcnt vmcnt(2)
  v_cmp_eq_u32 vcc, -1, v20
  s_cbranch_vccnz L_Oo_26_b120
L_Oo_26_k120:
  v_smfmac_f32_16x16x64_bf16 v[32:35], v[20:23], v[200:207], v2
  v_smfmac_f32_16x16x64_bf16 v[36:39], v[20:23], v[232:239], v2
  s_waitcnt vmcnt(1)
  v_cmp_eq_u32 vcc, -1, v24
  s_cbranch_vccz L_Oo_26_k20
L_Oo_26_b20:
  s_mov_b64 exec, vcc
  buffer_load_dwordx4 v[24:27], v1, s[4:7], s37 offen offset:2048 sc1
  s_mov_b64 exec, -1
  s_add_u32 s27, s27, 1
  s_cmp_ge_u32 s27, 0x80000
  s_cbranch_scc1 L_Oo_26_e
  s_waitcnt vmcnt(1)
  v_cmp_eq_u32 vcc, -1, v16
  s_cbranch_vccz L_Oo_26_k02
  s_branch L_Oo_26_b02
L_Oo_26_b21:
  s_mov_b64 exec, vcc
  buffer_load_dwordx4 v[24:27], v1, s[4:7], s37 offen offset:2048 sc1
  s_mov_b64 exec, -1
  s_add_u32 s27, s27, 1
  s_cmp_ge_u32 s27, 0x80000
  s_cbranch_scc1 L_Oo_26_e
  s_waitcnt vmcnt(1)
  v_cmp_eq_u32 vcc, -1, v20
  s_cbranch_vccz L_Oo_26_k12
  s_branch L_Oo_26_b12
L_Oo_26_b013:
  s_mov_b64 exec, vcc
  buffer_load_dwordx4 v[16:19], v1, s[4:7], s37 offen offset:0 sc1
  s_mov_b64 exec, -1
  s_waitcnt vmcnt(2)
  v_cmp_eq_u32 vcc, -1, v20
  s_cbranch_vccnz L_Oo_26_b130
L_Oo_26_k130:
  v_smfmac_f32_16x16x64_bf16 v[32:35], v[20:23], v[200:207], v2
  v_smfmac_f32_16x16x64_bf16 v[36:39], v[20:23], v[232:239], v2
  s_waitcnt vmcnt(1)
  v_cmp_eq_u32 vcc, -1, v28
  s_cbranch_vccz L_Oo_26_k30
  s_branch L_Oo_26_b30
L_Oo_26_b10:
  s_mov_b64 exec, vcc
  buffer_load_dwordx4 v[20:23], v1, s[4:7], s37 offen offset:1024 sc1
  s_mov_b64 exec, -1
  s_add_u32 s27, s27, 1
  s_cmp_ge_u32 s27, 0x80000
  s_cbranch_scc1 L_Oo_26_e
  s_waitcnt vmcnt(1)
  v_cmp_eq_u32 vcc, -1, v16
  s_cbranch_vccz L_Oo_26_k01
  s_branch L_Oo_26_b01
L_Oo_26_b023:
  s_mov_b64 exec, vcc
  buffer_load_dwordx4 v[16:19], v1, s[4:7], s37 offen offset:0 sc1
  s_mov_b64 exec, -1
  s_waitcnt vmcnt(2)
  v_cmp_eq_u32 vcc, -1, v24
  s_cbranch_vccz L_Oo_26_k230
  s_branch L_Oo_26_b230
L_Oo_26_b120:
  s_mov_b64 exec, vcc
  buffer_load_dwordx4 v[20:23], v1, s[4:7], s37 offen offset:1024 sc1
  s_mov_b64 exec, -1
  s_waitcnt vmcnt(2)
  v_cmp_eq_u32 vcc, -1, v24
  s_cbranch_vccnz L_Oo_26_b201
L_Oo_26_k201:
  v_smfmac_f32_16x16x64_bf16 v[32:35], v[24:27], v[208:215], v2
  v_smfmac_f32_16x16x64_bf16 v[36:39], v[24:27], v[240:247], v2
  s_waitcnt vmcnt(1)
  v_cmp_eq_u32 vcc, -1, v16
  s_cbranch_vccz L_Oo_26_k01
  s_branch L_Oo_26_b01
L_Oo_26_b130:
  s_mov_b64 exec, vcc
  buffer_load_dwordx4 v[20:23], v1, s[4:7], s37 offen offset:1024 sc1
  s_mov_b64 exec, -1
  s_waitcnt vmcnt(2)
  v_cmp_eq_u32 vcc, -1, v28
  s_cbranch_vccz L_Oo_26_k301
  s_branch L_Oo_26_b301
L_Oo_26_b201:
  s_mov_b64 exec, vcc
  buffer_load_dwordx4 v[24:27], v1, s[4:7], s37 offen offset:2048 sc1
  s_mov_b64 exec, -1
  s_add_u32 s27, s27, 1
  s_cmp_ge_u32 s27, 0x80000
  s_cbranch_scc1 L_Oo_26_e
  s_waitcnt vmcnt(2)
  v_cmp_eq_u32 vcc, -1, v16
  s_cbranch_vccz L_Oo_26_k012
  s_branch L_Oo_26_b012
L_O4_slow:
  v_mov_b32 v92, 0x3f803f80
  v_mov_b32 v93, 0x3f803f80
  v_mov_b32 v94, 0x3f803f80
  v_mov_b32 v95, 0x3f803f80
  s_mov_b32 s53, s52
  v_mov_b32 v81, 0
  v_mov_b32 v82, 0
  v_mov_b32 v83, 0
  v_mov_b32 v85, 0
  v_mov_b32 v86, 0
  v_mov_b32 v87, 0
  v_mov_b32 v137, 0
  v_mov_b32 v138, 0
  v_mov_b32 v139, 0
.p2align 6
L_O4_loops:
  s_add_u32 s28, s36, 0
  s_and_b32 s28, s28, 3
  s_lshl_b32 s28, s28, 17
  s_add_u32 s37, s44, s28
  v_mov_b32 v32, 0
  v_mov_b32 v33, 0
  v_mov_b32 v34, 0
  v_mov_b32 v35, 0
  v_mov_b32 v36, 0
  v_mov_b32 v37, 0
  v_mov_b32 v38, 0
  v_mov_b32 v39, 0
  s_cmp_eq_u32 s36, 63
  ds_read_b128 v[64:67], v4 offset:0
  ds_read_b128 v[68:71], v4 offset:128
  ds_read_b128 v[72:75], v14 offset:2048
  ds_read_b128 v[76:79], v14 offset:2112
  s_waitcnt lgkmcnt(0)
  s_barrier
  ds_read_b128 v[144:147], v5 offset:0
  ds_read_b128 v[148:151], v5 offset:16
  ds_read_b128 v[152:155], v5 offset:2304
  ds_read_b128 v[156:159], v5 offset:2320
  ds_read_b128 v[160:163], v5 offset:4608
  ds_read_b128 v[164:167], v5 offset:4624
  ds_read_b128 v[168:171], v5 offset:6912
  ds_read_b128 v[172:175], v5 offset:6928
  s_waitcnt lgkmcnt(5)
  v_pk_add_f32 v[144:145], v[144:145], v[152:153]
  v_pk_add_f32 v[146:147], v[146:147], v[154:155]
  s_waitcnt lgkmcnt(4)
  v_pk_add_f32 v[148:149], v[148:149], v[156:157]
  v_pk_add_f32 v[150:151], v[150:151], v[158:159]
  s_waitcnt lgkmcnt(3)
  v_pk_add_f32 v[144:145], v[144:145], v[160:161]
  v_pk_add_f32 v[146:147], v[146:147], v[162:163]
  s_waitcnt lgkmcnt(2)
  v_pk_add_f32 v[148:149], v[148:149], v[164:165]
  v_pk_add_f32 v[150:151], v[150:151], v[166:167]
  s_waitcnt lgkmcnt(1)
  v_pk_add_f32 v[144:145], v[144:145], v[168:169]
  v_pk_add_f32 v[146:147], v[146:147], v[170:171]
  v_cvt_pk_bf16_f32 v88, v144, v145
  v_cvt_pk_bf16_f32 v89, v146, v147
  s_waitcnt lgkmcnt(0)
  v_pk_add_f32 v[148:149], v[148:149], v[172:173]
  v_pk_add_f32 v[150:151], v[150:151], v[174:175]
  v_cvt_pk_bf16_f32 v90, v148, v149
  v_cvt_pk_bf16_f32 v91, v150, v151
  s_cbranch_scc1 L_O4_lasts
  s_nop 0
  v_mfma_f32_16x16x32_bf16 v[176:179], v[64:67], v[88:91], 0
  v_mfma_f32_16x16x32_bf16 v[180:183], v[68:71], v[88:91], 0
  v_mfma_f32_16x16x32_bf16 v[184:187], v[88:91], v[88:91], 0
  s_mov_b64 vcc, s[48:49]
  s_nop 5
  v_cndmask_b32_dpp v96, v176, v180, vcc quad_perm:[2,3,0,1] row_mask:0xf bank_mask:0xf
  v_cndmask_b32_dpp v97, v177, v181, vcc quad_perm:[2,3,0,1] row_mask:0xf bank_mask:0xf
  v_cndmask_b32_dpp v98, v178, v182, vcc quad_perm:[2,3,0,1] row_mask:0xf bank_mask:0xf
  v_cndmask_b32_dpp v99, v179, v183, vcc quad_perm:[2,3,0,1] row_mask:0xf bank_mask:0xf
  buffer_store_dwordx4 v[96:99], v8, s[4:7], s37 offen sc1
  v_cndmask_b32_dpp v185, v184, v185, vcc quad_perm:[2,3,0,1] row_mask:0xf bank_mask:0xf
  buffer_store_dword v185, v15, s[4:7], s37 offen sc1
  s_barrier
  ds_read_b128 v[144:147], v7 offset:0
  ds_read_b128 v[148:151], v7 offset:1024
  ds_read_b128 v[152:155], v7 offset:2048
  ds_read_b128 v[156:159], v7 offset:3072
  s_waitcnt lgkmcnt(0)
  v_pk_add_f32 v[144:145], v[144:145], v[148:149]
  v_pk_add_f32 v[146:147], v[146:147], v[150:151]
  v_pk_add_f32 v[152:153], v[152:153], v[156:157]
  v_pk_add_f32 v[154:155], v[154:155], v[158:159]
  v_pk_add_f32 v[144:145], v[144:145], v[152:153]
  v_pk_add_f32 v[146:147], v[146:147], v[154:155]
  v_cvt_pk_bf16_f32 v80, v144, v145
  v_cvt_pk_bf16_f32 v84, v146, v147
  v_min_u32 v48, -2, v88
  v_min_u32 v49, -2, v89
  v_min_u32 v50, -2, v90
  v_min_u32 v51, -2, v91
  v_min_u32 v56, -2, v80
  v_min_u32 v57, -2, v84
  s_nop 11
  buffer_load_dwordx4 v[100:103], v53, s[4:7], s37 offen sc1
  buffer_load_dwordx4 v[104:107], v54, s[4:7], s37 offen sc1
  buffer_load_dwordx4 v[108:111], v55, s[4:7], s37 offen sc1
  buffer_load_dwordx4 v[112:115], v12, s[4:7], s37 offen sc1
  s_nop 15
  s_nop 3
  buffer_load_dwordx4 v[100:103], v53, s[4:7], s37 offen sc1
  buffer_load_dwordx4 v[104:107], v54, s[4:7], s37 offen sc1
  buffer_load_dwordx4 v[108:111], v55, s[4:7], s37 offen sc1
  buffer_load_dwordx4 v[112:115], v12, s[4:7], s37 offen sc1
L_O4_sps:
  s_waitcnt vmcnt(4)
  v_pk_add_f32 v[180:181], v[112:113], v[114:115]
  v_pk_add_f32 v[176:177], v[96:97], v[100:101]
  v_pk_add_f32 v[178:179], v[98:99], v[102:103]
  v_pk_add_f32 v[182:183], v[104:105], v[108:109]
  v_pk_add_f32 v[184:185], v[106:107], v[110:111]
  v_add_f32 v180, v180, v181
  v_pk_add_f32 v[176:177], v[176:177], v[182:183]
  v_pk_add_f32 v[178:179], v[178:179], v[184:185]
  v_mul_f32 v180, s52, v180
  v_pk_mul_f32 v[176:177], v[176:177], s[52:53]
  v_pk_mul_f32 v[178:179], v[178:179], s[52:53]
  v_exp_f32 v186, v180
  v_maximum3_f32 v140, |v180|, |v176|, |v177|
  v_exp_f32 v182, v176
  v_maximum3_f32 v140, v140, |v178|, |v179|
  v_exp_f32 v183, v177
  v_cmp_nge_f32 vcc, 0x41c00000, v140
  v_exp_f32 v184, v178
  v_exp_f32 v185, v179
  s_cbranch_vccnz L_O4_mxs
L_O4_mks:
  v_mov_b32_dpp v187, v186 quad_perm:[2,3,0,1] row_mask:0xf bank_mask:0xf
  v_cvt_pk_bf16_f32 v134, v182, v183
  v_cvt_pk_bf16_f32 v135, v184, v185
  v_cvt_pk_bf16_f32 v136, v187, v186
  v_mov_b32_dpp v132, v134 quad_perm:[2,3,0,1] row_mask:0xf bank_mask:0xf
  v_mov_b32_dpp v133, v135 quad_perm:[2,3,0,1] row_mask:0xf bank_mask:0xf
  v_mfma_f32_16x16x32_bf16 v[140:143], v[92:95], v[136:139], 0
  v_mfma_f32_16x16x32_bf16 v[124:127], v[80:83], v[136:139], 0
  v_mfma_f32_16x16x32_bf16 v[128:131], v[84:87], v[136:139], 0
  v_mfma_f32_16x16x32_bf16 v[140:143], v[92:95], v[132:135], v[140:143]
  v_mfma_f32_16x16x32_bf16 v[124:127], v[72:75], v[132:135], v[124:127]
  v_mfma_f32_16x16x32_bf16 v[128:131], v[76:79], v[132:135], v[128:131]
  s_nop 5
  v_rcp_f32 v140, v140
  s_nop 0
  v_pk_mul_f32 v[124:125], v[124:125], v[140:141] op_sel_hi:[1,0]
  v_pk_mul_f32 v[126:127], v[126:127], v[140:141] op_sel_hi:[1,0]
  v_pk_mul_f32 v[128:129], v[128:129], v[140:141] op_sel_hi:[1,0]
  v_pk_mul_f32 v[130:131], v[130:131], v[140:141] op_sel_hi:[1,0]
  v_cvt_pk_bf16_f32 v124, v124, v125
  v_cvt_pk_bf16_f32 v125, v126, v127
  v_cvt_pk_bf16_f32 v126, v128, v129
  v_cvt_pk_bf16_f32 v127, v130, v131
  v_min_u32 v124, -2, v124
  s_mov_b64 exec, s[48:49]
  buffer_store_dwordx4 v[124:127], v13, s[4:7], s37 offen sc1
  s_mov_b64 exec, -1
  s_barrier
  s_nop 15
  s_nop 13
  buffer_load_dwordx4 v[16:19], v1, s[4:7], s37 offen offset:0 sc1
  s_nop 3
  buffer_load_dwordx4 v[20:23], v1, s[4:7], s37 offen offset:1024 sc1
  s_nop 3
  buffer_load_dwordx4 v[24:27], v1, s[4:7], s37 offen offset:2048 sc1
  s_nop 3
  buffer_load_dwordx4 v[28:31], v1, s[4:7], s37 offen offset:3072 sc1
  s_waitcnt vmcnt(3)
  v_cmp_eq_u32 vcc, -1, v16
  s_cbranch_vccnz L_Oo_27_b0123
L_Oo_27_k0123:
  v_smfmac_f32_16x16x64_bf16 v[32:35], v[16:19], v[192:199], v2
  v_smfmac_f32_16x16x64_bf16 v[36:39], v[16:19], v[224:231], v2
  s_waitcnt vmcnt(2)
  v_cmp_eq_u32 vcc, -1, v20
  s_cbranch_vccnz L_Oo_27_b123
L_Oo_27_k123:
  v_smfmac_f32_16x16x64_bf16 v[32:35], v[20:23], v[200:207], v2
  v_smfmac_f32_16x16x64_bf16 v[36:39], v[20:23], v[232:239], v2
  s_waitcnt vmcnt(1)
  v_cmp_eq_u32 vcc, -1, v24
  s_cbranch_vccnz L_Oo_27_b23
L_Oo_27_k23:
  v_smfmac_f32_16x16x64_bf16 v[32:35], v[24:27], v[208:215], v2
  v_smfmac_f32_16x16x64_bf16 v[36:39], v[24:27], v[240:247], v2
  s_waitcnt vmcnt(0)
  v_cmp_eq_u32 vcc, -1, v28
  s_cbranch_vccnz L_Oo_27_b3
L_Oo_27_k3:
  v_smfmac_f32_16x16x64_bf16 v[32:35], v[28:31], v[216:223], v2
  v_smfmac_f32_16x16x64_bf16 v[36:39], v[28:31], v[248:255], v2
L_Oo_27_e:
  s_nop 6
  v_add_f32 v32, v32, v33
  v_add_f32 v34, v34, v35
  ds_write2_b32 v3, v32, v34 offset0:0 offset1:40
  v_add_f32 v36, v36, v37
  v_add_f32 v38, v38, v39
  ds_write2_b32 v3, v36, v38 offset0:16 offset1:56
  s_waitcnt lgkmcnt(0)
  s_barrier
  s_barrier
  s_mov_b64 exec, s[50:51]
  buffer_store_dwordx4 v[48:51], v40, s[4:7], s43 offen offset:2048 sc1
  s_mov_b64 exec, -1
  buffer_store_dword v56, v41, s[4:7], s43 offen offset:2048 sc1
  buffer_store_dword v57, v41, s[4:7], s43 offen offset:2112 sc1
  s_add_u32 s43, s43, 2048
  s_add_u32 s28, s36, 2
  s_and_b32 s28, s28, 3
  s_lshl_b32 s28, s28, 17
  s_add_u32 s39, s44, s28
  buffer_store_dwordx4 v[44:47], v42, s[4:7], s39 offen sc1
  buffer_store_dwordx4 v[44:47], v8, s[4:7], s39 offen sc1
  buffer_store_dword v44, v15, s[4:7], s39 offen sc1
  s_barrier
  s_add_u32 s36, s36, 1
  s_branch L_O4_loops
L_O4_lasts:
  v_min_u32 v48, -2, v88
  v_min_u32 v49, -2, v89
  v_min_u32 v50, -2, v90
  v_min_u32 v51, -2, v91
  s_mov_b64 exec, s[50:51]
  buffer_store_dwordx4 v[48:51], v40, s[4:7], s43 offen offset:2048 sc1
  s_mov_b64 exec, -1
  s_barrier
  ds_read_b128 v[144:147], v7 offset:0
  ds_read_b128 v[148:151], v7 offset:1024
  ds_read_b128 v[152:155], v7 offset:2048
  ds_read_b128 v[156:159], v7 offset:3072
  s_waitcnt lgkmcnt(0)
  v_pk_add_f32 v[144:145], v[144:145], v[148:149]
  v_pk_add_f32 v[146:147], v[146:147], v[150:151]
  v_pk_add_f32 v[152:153], v[152:153], v[156:157]
  v_pk_add_f32 v[154:155], v[154:155], v[158:159]
  v_pk_add_f32 v[144:145], v[144:145], v[152:153]
  v_pk_add_f32 v[146:147], v[146:147], v[154:155]
  v_cvt_pk_bf16_f32 v80, v144, v145
  v_cvt_pk_bf16_f32 v84, v146, v147
  v_min_u32 v56, -2, v80
  v_min_u32 v57, -2, v84
  buffer_store_dword v56, v41, s[4:7], s43 offen offset:2048 sc1
  buffer_store_dword v57, v41, s[4:7], s43 offen offset:2112 sc1
  s_branch L_R_done
L_O4_mxs:
  v_max3_u32 v60, v100, v104, v108
  v_max3_u32 v60, v60, v112, v113
  v_max3_u32 v60, v60, v114, v115
  v_cmp_eq_u32 vcc, -1, v60
  s_cbranch_vccz L_O4_mys
  s_add_u32 s27, s27, 1
  s_cmp_ge_u32 s27, 0x80000
  s_cbranch_scc1 L_O4_mys
  s_mov_b64 exec, vcc
  buffer_load_dwordx4 v[100:103], v53, s[4:7], s37 offen sc1
  buffer_load_dwordx4 v[104:107], v54, s[4:7], s37 offen sc1
  buffer_load_dwordx4 v[108:111], v55, s[4:7], s37 offen sc1
  buffer_load_dwordx4 v[112:115], v12, s[4:7], s37 offen sc1
  s_mov_b64 exec, -1
  s_waitcnt vmcnt(4)
  s_branch L_O4_mxs
L_O4_mys:
  v_pk_add_f32 v[180:181], v[112:113], v[114:115]
  v_pk_add_f32 v[176:177], v[96:97], v[100:101]
  v_pk_add_f32 v[178:179], v[98:99], v[102:103]
  v_pk_add_f32 v[182:183], v[104:105], v[108:109]
  v_pk_add_f32 v[184:185], v[106:107], v[110:111]
  v_add_f32 v180, v180, v181
  v_pk_add_f32 v[176:177], v[176:177], v[182:183]
  v_pk_add_f32 v[178:179], v[178:179], v[184:185]
  v_mul_f32 v180, s52, v180
  v_pk_mul_f32 v[176:177], v[176:177], s[52:53]
  v_pk_mul_f32 v[178:179], v[178:179], s[52:53]
  v_exp_f32 v186, v180
  v_maximum3_f32 v140, |v180|, |v176|, |v177|
  v_exp_f32 v182, v176
  v_maximum3_f32 v140, v140, |v178|, |v179|
  v_exp_f32 v183, v177
  v_cmp_nge_f32 vcc, 0x41c00000, v140
  v_exp_f32 v184, v178
  v_exp_f32 v185, v179
  s_cbranch_vccz L_O4_mks
  v_max3_f32 v140, v180, v176, v177
  v_max3_f32 v140, v140, v178, v179
  s_nop 1
  v_max_f32_dpp v140, v140, v140 quad_perm:[2,3,0,1] row_mask:0xf bank_mask:0xf
  v_mov_b32 v141, v140
  s_nop 1
  v_permlane16_swap_b32 v140, v141
  v_max_f32 v140, v140, v141
  v_mov_b32 v141, v140
  s_nop 1
  v_permlane32_swap_b32 v140, v141
  v_max_f32 v140, v140, v141
  v_sub_f32 v176, v176, v140
  v_sub_f32 v177, v177, v140
  v_sub_f32 v178, v178, v140
  v_sub_f32 v179, v179, v140
  v_sub_f32 v180, v180, v140
  v_exp_f32 v182, v176
  v_exp_f32 v183, v177
  v_exp_f32 v184, v178
  v_exp_f32 v185, v179
  v_exp_f32 v186, v180
  s_nop 1
  s_branch L_O4_mks
L_Oo_27_b0123:
  s_mov_b64 exec, vcc
  buffer_load_dwordx4 v[16:19], v1, s[4:7], s37 offen offset:0 sc1
  s_mov_b64 exec, -1
  s_waitcnt vmcnt(3)
  v_cmp_eq_u32 vcc, -1, v20
  s_cbranch_vccnz L_Oo_27_b1230
L_Oo_27_k1230:
  v_smfmac_f32_16x16x64_bf16 v[32:35], v[20:23], v[200:207], v2
  v_smfmac_f32_16x16x64_bf16 v[36:39], v[20:23], v[232:239], v2
  s_waitcnt vmcnt(2)
  v_cmp_eq_u32 vcc, -1, v24
  s_cbranch_vccnz L_Oo_27_b230
L_Oo_27_k230:
  v_smfmac_f32_16x16x64_bf16 v[32:35], v[24:27], v[208:215], v2
  v_smfmac_f32_16x16x64_bf16 v[36:39], v[24:27], v[240:247], v2
  s_waitcnt vmcnt(1)
  v_cmp_eq_u32 vcc, -1, v28
  s_cbranch_vccnz L_Oo_27_b30
L_Oo_27_k30:
  v_smfmac_f32_16x16x64_bf16 v[32:35], v[28:31], v[216:223], v2
  v_smfmac_f32_16x16x64_bf16 v[36:39], v[28:31], v[248:255], v2
  s_waitcnt vmcnt(0)
  v_cmp_eq_u32 vcc, -1, v16
  s_cbranch_vccnz L_Oo_27_b0
L_Oo_27_k0:
  v_smfmac_f32_16x16x64_bf16 v[32:35], v[16:19], v[192:199], v2
  v_smfmac_f32_16x16x64_bf16 v[36:39], v[16:19], v[224:231], v2
  s_branch L_Oo_27_e
L_Oo_27_b123:
  s_mov_b64 exec, vcc
  buffer_load_dwordx4 v[20:23], v1, s[4:7], s37 offen offset:1024 sc1
  s_mov_b64 exec, -1
  s_waitcnt vmcnt(2)
  v_cmp_eq_u32 vcc, -1, v24
  s_cbranch_vccnz L_Oo_27_b231
L_Oo_27_k231:
  v_smfmac_f32_16x16x64_bf16 v[32:35], v[24:27], v[208:215], v2
  v_smfmac_f32_16x16x64_bf16 v[36:39], v[24:27], v[240:247], v2
  s_waitcnt vmcnt(1)
  v_cmp_eq_u32 vcc, -1, v28
  s_cbranch_vccnz L_Oo_27_b31
L_Oo_27_k31:
  v_smfmac_f32_16x16x64_bf16 v[32:35], v[28:31], v[216:223], v2
  v_smfmac_f32_16x16x64_bf16 v[36:39], v[28:31], v[248:255], v2
  s_waitcnt vmcnt(0)
  v_cmp_eq_u32 vcc, -1, v20
  s_cbranch_vccnz L_Oo_27_b1
L_Oo_27_k1:
  v_smfmac_f32_16x16x64_bf16 v[32:35], v[20:23], v[200:207], v2
  v_smfmac_f32_16x16x64_bf16 v[36:39], v[20:23], v[232:239], v2
  s_branch L_Oo_27_e
L_Oo_27_b23:
  s_mov_b64 exec, vcc
  buffer_load_dwordx4 v[24:27], v1, s[4:7], s37 offen offset:2048 sc1
  s_mov_b64 exec, -1
  s_waitcnt vmcnt(1)
  v_cmp_eq_u32 vcc, -1, v28
  s_cbranch_vccnz L_Oo_27_b32
L_Oo_27_k32:
  v_smfmac_f32_16x16x64_bf16 v[32:35], v[28:31], v[216:223], v2
  v_smfmac_f32_16x16x64_bf16 v[36:39], v[28:31], v[248:255], v2
  s_waitcnt vmcnt(0)
  v_cmp_eq_u32 vcc, -1, v24
  s_cbranch_vccnz L_Oo_27_b2
L_Oo_27_k2:
  v_smfmac_f32_16x16x64_bf16 v[32:35], v[24:27], v[208:215], v2
  v_smfmac_f32_16x16x64_bf16 v[36:39], v[24:27], v[240:247], v2
  s_branch L_Oo_27_e
L_Oo_27_b3:
  s_mov_b64 exec, vcc
  buffer_load_dwordx4 v[28:31], v1, s[4:7], s37 offen offset:3072 sc1
  s_mov_b64 exec, -1
  s_add_u32 s27, s27, 1
  s_cmp_ge_u32 s27, 0x80000
  s_cbranch_scc1 L_Oo_27_e
  s_waitcnt vmcnt(0)
  v_cmp_eq_u32 vcc, -1, v28
  s_cbranch_vccz L_Oo_27_k3
  s_branch L_Oo_27_b3
L_Oo_27_b1230:
  s_mov_b64 exec, vcc
  buffer_load_dwordx4 v[20:23], v1, s[4:7], s37 offen offset:1024 sc1
  s_mov_b64 exec, -1
  s_waitcnt vmcnt(3)
  v_cmp_eq_u32 vcc, -1, v24
  s_cbranch_vccnz L_Oo_27_b2301
L_Oo_27_k2301:
  v_smfmac_f32_16x16x64_bf16 v[32:35], v[24:27], v[208:215], v2
  v_smfmac_f32_16x16x64_bf16 v[36:39], v[24:27], v[240:247], v2
  s_waitcnt vmcnt(2)
  v_cmp_eq_u32 vcc, -1, v28
  s_cbranch_vccnz L_Oo_27_b301
L_Oo_27_k301:
  v_smfmac_f32_16x16x64_bf16 v[32:35], v[28:31], v[216:223], v2
  v_smfmac_f32_16x16x64_bf16 v[36:39], v[28:31], v[248:255], v2
  s_waitcnt vmcnt(1)
  v_cmp_eq_u32 vcc, -1, v16
  s_cbranch_vccnz L_Oo_27_b01
L_Oo_27_k01:
  v_smfmac_f32_16x16x64_bf16 v[32:35], v[16:19], v[192:199], v2
  v_smfmac_f32_16x16x64_bf16 v[36:39], v[16:19], v[224:231], v2
  s_waitcnt vmcnt(0)
  v_cmp_eq_u32 vcc, -1, v20
  s_cbranch_vccz L_Oo_27_k1
L_Oo_27_b1:
  s_mov_b64 exec, vcc
  buffer_load_dwordx4 v[20:23], v1, s[4:7], s37 offen offset:1024 sc1
  s_mov_b64 exec, -1
  s_add_u32 s27, s27, 1
  s_cmp_ge_u32 s27, 0x80000
  s_cbranch_scc1 L_Oo_27_e
  s_waitcnt vmcnt(0)
  v_cmp_eq_u32 vcc, -1, v20
  s_cbranch_vccz L_Oo_27_k1
  s_branch L_Oo_27_b1
L_Oo_27_b230:
  s_mov_b64 exec, vcc
  buffer_load_dwordx4 v[24:27], v1, s[4:7], s37 offen offset:2048 sc1
  s_mov_b64 exec, -1
  s_waitcnt vmcnt(2)
  v_cmp_eq_u32 vcc, -1, v28
  s_cbranch_vccnz L_Oo_27_b302
L_Oo_27_k302:
  v_smfmac_f32_16x16x64_bf16 v[32:35], v[28:31], v[216:223], v2
  v_smfmac_f32_16x16x64_bf16 v[36:39], v[28:31], v[248:255], v2
  s_waitcnt vmcnt(1)
  v_cmp_eq_u32 vcc, -1, v16
  s_cbranch_vccnz L_Oo_27_b02
L_Oo_27_k02:
  v_smfmac_f32_16x16x64_bf16 v[32:35], v[16:19], v[192:199], v2
  v_smfmac_f32_16x16x64_bf16 v[36:39], v[16:19], v[224:231], v2
  s_waitcnt vmcnt(0)
  v_cmp_eq_u32 vcc, -1, v24
  s_cbranch_vccz L_Oo_27_k2
L_Oo_27_b2:
  s_mov_b64 exec, vcc
  buffer_load_dwordx4 v[24:27], v1, s[4:7], s37 offen offset:2048 sc1
  s_mov_b64 exec, -1
  s_add_u32 s27, s27, 1
  s_cmp_ge_u32 s27, 0x80000
  s_cbranch_scc1 L_Oo_27_e
  s_waitcnt vmcnt(0)
  v_cmp_eq_u32 vcc, -1, v24
  s_cbranch_vccz L_Oo_27_k2
  s_branch L_Oo_27_b2
L_Oo_27_b30:
  s_mov_b64 exec, vcc
  buffer_load_dwordx4 v[28:31], v1, s[4:7], s37 offen offset:3072 sc1
  s_mov_b64 exec, -1
  s_add_u32 s27, s27, 1
  s_cmp_ge_u32 s27, 0x80000
  s_cbranch_scc1 L_Oo_27_e
  s_waitcnt vmcnt(1)
  v_cmp_eq_u32 vcc, -1, v16
  s_cbranch_vccnz L_Oo_27_b03
L_Oo_27_k03:
  v_smfmac_f32_16x16x64_bf16 v[32:35], v[16:19], v[192:199], v2
  v_smfmac_f32_16x16x64_bf16 v[36:39], v[16:19], v[224:231], v2
  s_waitcnt vmcnt(0)
  v_cmp_eq_u32 vcc, -1, v28
  s_cbranch_vccz L_Oo_27_k3
  s_branch L_Oo_27_b3
L_Oo_27_b0:
  s_mov_b64 exec, vcc
  buffer_load_dwordx4 v[16:19], v1, s[4:7], s37 offen offset:0 sc1
  s_mov_b64 exec, -1
  s_add_u32 s27, s27, 1
  s_cmp_ge_u32 s27, 0x80000
  s_cbranch_scc1 L_Oo_27_e
  s_waitcnt vmcnt(0)
  v_cmp_eq_u32 vcc, -1, v16
  s_cbranch_vccz L_Oo_27_k0
  s_branch L_Oo_27_b0
L_Oo_27_b231:
  s_mov_b64 exec, vcc
  buffer_load_dwordx4 v[24:27], v1, s[4:7], s37 offen offset:2048 sc1
  s_mov_b64 exec, -1
  s_waitcnt vmcnt(2)
  v_cmp_eq_u32 vcc, -1, v28
  s_cbranch_vccnz L_Oo_27_b312
L_Oo_27_k312:
  v_smfmac_f32_16x16x64_bf16 v[32:35], v[28:31], v[216:223], v2
  v_smfmac_f32_16x16x64_bf16 v[36:39], v[28:31], v[248:255], v2
  s_waitcnt vmcnt(1)
  v_cmp_eq_u32 vcc, -1, v20
  s_cbranch_vccnz L_Oo_27_b12
L_Oo_27_k12:
  v_smfmac_f32_16x16x64_bf16 v[32:35], v[20:23], v[200:207], v2
  v_smfmac_f32_16x16x64_bf16 v[36:39], v[20:23], v[232:239], v2
  s_waitcnt vmcnt(0)
  v_cmp_eq_u32 vcc, -1, v24
  s_cbranch_vccz L_Oo_27_k2
  s_branch L_Oo_27_b2
L_Oo_27_b31:
  s_mov_b64 exec, vcc
  buffer_load_dwordx4 v[28:31], v1, s[4:7], s37 offen offset:3072 sc1
  s_mov_b64 exec, -1
  s_add_u32 s27, s27, 1
  s_cmp_ge_u32 s27, 0x80000
  s_cbranch_scc1 L_Oo_27_e
  s_waitcnt vmcnt(1)
  v_cmp_eq_u32 vcc, -1, v20
  s_cbranch_vccnz L_Oo_27_b13
L_Oo_27_k13:
  v_smfmac_f32_16x16x64_bf16 v[32:35], v[20:23], v[200:207], v2
  v_smfmac_f32_16x16x64_bf16 v[36:39], v[20:23], v[232:239], v2
  s_waitcnt vmcnt(0)
  v_cmp_eq_u32 vcc, -1, v28
  s_cbranch_vccz L_Oo_27_k3
  s_branch L_Oo_27_b3
L_Oo_27_b32:
  s_mov_b64 exec, vcc
  buffer_load_dwordx4 v[28:31], v1, s[4:7], s37 offen offset:3072 sc1
  s_mov_b64 exec, -1
  s_add_u32 s27, s27, 1
  s_cmp_ge_u32 s27, 0x80000
  s_cbranch_scc1 L_Oo_27_e
  s_waitcnt vmcnt(1)
  v_cmp_eq_u32 vcc, -1, v24
  s_cbranch_vccz L_Oo_27_k23
  s_branch L_Oo_27_b23
L_Oo_27_b2301:
  s_mov_b64 exec, vcc
  buffer_load_dwordx4 v[24:27], v1, s[4:7], s37 offen offset:2048 sc1
  s_mov_b64 exec, -1
  s_waitcnt vmcnt(3)
  v_cmp_eq_u32 vcc, -1, v28
  s_cbranch_vccnz L_Oo_27_b3012
L_Oo_27_k3012:
  v_smfmac_f32_16x16x64_bf16 v[32:35], v[28:31], v[216:223], v2
  v_smfmac_f32_16x16x64_bf16 v[36:39], v[28:31], v[248:255], v2
  s_waitcnt vmcnt(2)
  v_cmp_eq_u32 vcc, -1, v16
  s_cbranch_vccnz L_Oo_27_b012
L_Oo_27_k012:
  v_smfmac_f32_16x16x64_bf16 v[32:35], v[16:19], v[192:199], v2
  v_smfmac_f32_16x16x64_bf16 v[36:39], v[16:19], v[224:231], v2
  s_waitcnt vmcnt(1)
  v_cmp_eq_u32 vcc, -1, v20
  s_cbranch_vccz L_Oo_27_k12
L_Oo_27_b12:
  s_mov_b64 exec, vcc
  buffer_load_dwordx4 v[20:23], v1, s[4:7], s37 offen offset:1024 sc1
  s_mov_b64 exec, -1
  s_waitcnt vmcnt(1)
  v_cmp_eq_u32 vcc, -1, v24
  s_cbranch_vccnz L_Oo_27_b21
L_Oo_27_k21:
  v_smfmac_f32_16x16x64_bf16 v[32:35], v[24:27], v[208:215], v2
  v_smfmac_f32_16x16x64_bf16 v[36:39], v[24:27], v[240:247], v2
  s_waitcnt vmcnt(0)
  v_cmp_eq_u32 vcc, -1, v20
  s_cbranch_vccz L_Oo_27_k1
  s_branch L_Oo_27_b1
L_Oo_27_b301:
  s_mov_b64 exec, vcc
  buffer_load_dwordx4 v[28:31], v1, s[4:7], s37 offen offset:3072 sc1
  s_mov_b64 exec, -1
  s_add_u32 s27, s27, 1
  s_cmp_ge_u32 s27, 0x80000
  s_cbranch_scc1 L_Oo_27_e
  s_waitcnt vmcnt(2)
  v_cmp_eq_u32 vcc, -1, v16
  s_cbranch_vccnz L_Oo_27_b013
L_Oo_27_k013:
  v_smfmac_f32_16x16x64_bf16 v[32:35], v[16:19], v[192:199], v2
  v_smfmac_f32_16x16x64_bf16 v[36:39], v[16:19], v[224:231], v2
  s_waitcnt vmcnt(1)
  v_cmp_eq_u32 vcc, -1, v20
  s_cbranch_vccz L_Oo_27_k13
L_Oo_27_b13:
  s_mov_b64 exec, vcc
  buffer_load_dwordx4 v[20:23], v1, s[4:7], s37 offen offset:1024 sc1
  s_mov_b64 exec, -1
  s_waitcnt vmcnt(1)
  v_cmp_eq_u32 vcc, -1, v28
  s_cbranch_vccz L_Oo_27_k31
  s_branch L_Oo_27_b31
L_Oo_27_b01:
  s_mov_b64 exec, vcc
  buffer_load_dwordx4 v[16:19], v1, s[4:7], s37 offen offset:0 sc1
  s_mov_b64 exec, -1
  s_waitcnt vmcnt(1)
  v_cmp_eq_u32 vcc, -1, v20
  s_cbranch_vccnz L_Oo_27_b10
L_Oo_27_k10:
  v_smfmac_f32_16x16x64_bf16 v[32:35], v[20:23], v[200:207], v2
  v_smfmac_f32_16x16x64_bf16 v[36:39], v[20:23], v[232:239], v2
  s_waitcnt vmcnt(0)
  v_cmp_eq_u32 vcc, -1, v16
  s_cbranch_vccz L_Oo_27_k0
  s_branch L_Oo_27_b0
L_Oo_27_b302:
  s_mov_b64 exec, vcc
  buffer_load_dwordx4 v[28:31], v1, s[4:7], s37 offen offset:3072 sc1
  s_mov_b64 exec, -1
  s_add_u32 s27, s27, 1
  s_cmp_ge_u32 s27, 0x80000
  s_cbranch_scc1 L_Oo_27_e
  s_waitcnt vmcnt(2)
  v_cmp_eq_u32 vcc, -1, v16
  s_cbranch_vccnz L_Oo_27_b023
L_Oo_27_k023:
  v_smfmac_f32_16x16x64_bf16 v[32:35], v[16:19], v[192:199], v2
  v_smfmac_f32_16x16x64_bf16 v[36:39], v[16:19], v[224:231], v2
  s_waitcnt vmcnt(1)
  v_cmp_eq_u32 vcc, -1, v24
  s_cbranch_vccz L_Oo_27_k23
  s_branch L_Oo_27_b23
L_Oo_27_b02:
  s_mov_b64 exec, vcc
  buffer_load_dwordx4 v[16:19], v1, s[4:7], s37 offen offset:0 sc1
  s_mov_b64 exec, -1
  s_waitcnt vmcnt(1)
  v_cmp_eq_u32 vcc, -1, v24
  s_cbranch_vccnz L_Oo_27_b20
L_Oo_27_k20:
  v_smfmac_f32_16x16x64_bf16 v[32:35], v[24:27], v[208:215], v2
  v_smfmac_f32_16x16x64_bf16 v[36:39], v[24:27], v[240:247], v2
  s_waitcnt vmcnt(0)
  v_cmp_eq_u32 vcc, -1, v16
  s_cbranch_vccz L_Oo_27_k0
  s_branch L_Oo_27_b0
L_Oo_27_b03:
  s_mov_b64 exec, vcc
  buffer_load_dwordx4 v[16:19], v1, s[4:7], s37 offen offset:0 sc1
  s_mov_b64 exec, -1
  s_waitcnt vmcnt(1)
  v_cmp_eq_u32 vcc, -1, v28
  s_cbranch_vccz L_Oo_27_k30
  s_branch L_Oo_27_b30
L_Oo_27_b312:
  s_mov_b64 exec, vcc
  buffer_load_dwordx4 v[28:31], v1, s[4:7], s37 offen offset:3072 sc1
  s_mov_b64 exec, -1
  s_add_u32 s27, s27, 1
  s_cmp_ge_u32 s27, 0x80000
  s_cbranch_scc1 L_Oo_27_e
  s_waitcnt vmcnt(2)
  v_cmp_eq_u32 vcc, -1, v20
  s_cbranch_vccz L_Oo_27_k123
  s_branch L_Oo_27_b123
L_Oo_27_b3012:
  s_mov_b64 exec, vcc
  buffer_load_dwordx4 v[28:31], v1, s[4:7], s37 offen offset:3072 sc1
  s_mov_b64 exec, -1
  s_add_u32 s27, s27, 1
  s_cmp_ge_u32 s27, 0x80000
  s_cbranch_scc1 L_Oo_27_e
  s_waitcnt vmcnt(3)
  v_cmp_eq_u32 vcc, -1, v16
  s_cbranch_vccz L_Oo_27_k0123
  s_branch L_Oo_27_b0123
L_Oo_27_b012:
  s_mov_b64 exec, vcc
  buffer_load_dwordx4 v[16:19], v1, s[4:7], s37 offen offset:0 sc1
  s_mov_b64 exec, -1
  s_waitcnt vmcnt(2)
  v_cmp_eq_u32 vcc, -1, v20
  s_cbranch_vccnz L_Oo_27_b120
L_Oo_27_k120:
  v_smfmac_f32_16x16x64_bf16 v[32:35], v[20:23], v[200:207], v2
  v_smfmac_f32_16x16x64_bf16 v[36:39], v[20:23], v[232:239], v2
  s_waitcnt vmcnt(1)
  v_cmp_eq_u32 vcc, -1, v24
  s_cbranch_vccz L_Oo_27_k20
L_Oo_27_b20:
  s_mov_b64 exec, vcc
  buffer_load_dwordx4 v[24:27], v1, s[4:7], s37 offen offset:2048 sc1
  s_mov_b64 exec, -1
  s_add_u32 s27, s27, 1
  s_cmp_ge_u32 s27, 0x80000
  s_cbranch_scc1 L_Oo_27_e
  s_waitcnt vmcnt(1)
  v_cmp_eq_u32 vcc, -1, v16
  s_cbranch_vccz L_Oo_27_k02
  s_branch L_Oo_27_b02
L_Oo_27_b21:
  s_mov_b64 exec, vcc
  buffer_load_dwordx4 v[24:27], v1, s[4:7], s37 offen offset:2048 sc1
  s_mov_b64 exec, -1
  s_add_u32 s27, s27, 1
  s_cmp_ge_u32 s27, 0x80000
  s_cbranch_scc1 L_Oo_27_e
  s_waitcnt vmcnt(1)
  v_cmp_eq_u32 vcc, -1, v20
  s_cbranch_vccz L_Oo_27_k12
  s_branch L_Oo_27_b12
L_Oo_27_b013:
  s_mov_b64 exec, vcc
  buffer_load_dwordx4 v[16:19], v1, s[4:7], s37 offen offset:0 sc1
  s_mov_b64 exec, -1
  s_waitcnt vmcnt(2)
  v_cmp_eq_u32 vcc, -1, v20
  s_cbranch_vccnz L_Oo_27_b130
L_Oo_27_k130:
  v_smfmac_f32_16x16x64_bf16 v[32:35], v[20:23], v[200:207], v2
  v_smfmac_f32_16x16x64_bf16 v[36:39], v[20:23], v[232:239], v2
  s_waitcnt vmcnt(1)
  v_cmp_eq_u32 vcc, -1, v28
  s_cbranch_vccz L_Oo_27_k30
  s_branch L_Oo_27_b30
L_Oo_27_b10:
  s_mov_b64 exec, vcc
  buffer_load_dwordx4 v[20:23], v1, s[4:7], s37 offen offset:1024 sc1
  s_mov_b64 exec, -1
  s_add_u32 s27, s27, 1
  s_cmp_ge_u32 s27, 0x80000
  s_cbranch_scc1 L_Oo_27_e
  s_waitcnt vmcnt(1)
  v_cmp_eq_u32 vcc, -1, v16
  s_cbranch_vccz L_Oo_27_k01
  s_branch L_Oo_27_b01
L_Oo_27_b023:
  s_mov_b64 exec, vcc
  buffer_load_dwordx4 v[16:19], v1, s[4:7], s37 offen offset:0 sc1
  s_mov_b64 exec, -1
  s_waitcnt vmcnt(2)
  v_cmp_eq_u32 vcc, -1, v24
  s_cbranch_vccz L_Oo_27_k230
  s_branch L_Oo_27_b230
L_Oo_27_b120:
  s_mov_b64 exec, vcc
  buffer_load_dwordx4 v[20:23], v1, s[4:7], s37 offen offset:1024 sc1
  s_mov_b64 exec, -1
  s_waitcnt vmcnt(2)
  v_cmp_eq_u32 vcc, -1, v24
  s_cbranch_vccnz L_Oo_27_b201
L_Oo_27_k201:
  v_smfmac_f32_16x16x64_bf16 v[32:35], v[24:27], v[208:215], v2
  v_smfmac_f32_16x16x64_bf16 v[36:39], v[24:27], v[240:247], v2
  s_waitcnt vmcnt(1)
  v_cmp_eq_u32 vcc, -1, v16
  s_cbranch_vccz L_Oo_27_k01
  s_branch L_Oo_27_b01
L_Oo_27_b130:
  s_mov_b64 exec, vcc
  buffer_load_dwordx4 v[20:23], v1, s[4:7], s37 offen offset:1024 sc1
  s_mov_b64 exec, -1
  s_waitcnt vmcnt(2)
  v_cmp_eq_u32 vcc, -1, v28
  s_cbranch_vccz L_Oo_27_k301
  s_branch L_Oo_27_b301
L_Oo_27_b201:
  s_mov_b64 exec, vcc
  buffer_load_dwordx4 v[24:27], v1, s[4:7], s37 offen offset:2048 sc1
  s_mov_b64 exec, -1
  s_add_u32 s27, s27, 1
  s_cmp_ge_u32 s27, 0x80000
  s_cbranch_scc1 L_Oo_27_e
  s_waitcnt vmcnt(2)
  v_cmp_eq_u32 vcc, -1, v16
  s_cbranch_vccz L_Oo_27_k012
  s_branch L_Oo_27_b012
L_O5:
  v_bfe_u32 v6, v0, 2, 3
  v_mul_u32_u24 v14, 160, v6
  v_lshrrev_b32 v6, 5, v0
  v_lshl_add_u32 v14, v6, 6, v14
  v_and_b32 v6, 3, v0
  v_lshl_add_u32 v14, v6, 4, v14
  v_add_u32 v14, 13312, v14
  v_lshlrev_b32 v15, 3, v0
  s_xor_b32 s28, s25, 8
  s_lshl_b32 s28, s28, 9
  v_add_u32 v15, s28, v15
  s_add_u32 s30, s24, 0
  s_and_b32 s30, s30, 3
  s_lshl_b32 s28, s30, 2
  s_lshr_b32 s29, s25, 3
  s_add_u32 s28, s28, s29
  s_lshl_b32 s28, s28, 14
  s_and_b32 s29, s25, 7
  s_lshl_b32 s29, s29, 10
  s_add_u32 s28, s28, s29
  v_lshlrev_b32 v56, 4, v0
  v_add_u32 v56, s28, v56
  s_add_u32 s30, s24, 1
  s_and_b32 s30, s30, 3
  s_lshl_b32 s28, s30, 2
  s_lshr_b32 s29, s25, 3
  s_add_u32 s28, s28, s29
  s_lshl_b32 s28, s28, 14
  s_and_b32 s29, s25, 7
  s_lshl_b32 s29, s29, 10
  s_add_u32 s28, s28, s29
  v_lshlrev_b32 v57, 4, v0
  v_add_u32 v57, s28, v57
  s_add_u32 s30, s24, 2
  s_and_b32 s30, s30, 3
  s_lshl_b32 s28, s30, 2
  s_lshr_b32 s29, s25, 3
  s_add_u32 s28, s28, s29
  s_lshl_b32 s28, s28, 14
  s_and_b32 s29, s25, 7
  s_lshl_b32 s29, s29, 10
  s_add_u32 s28, s28, s29
  v_lshlrev_b32 v58, 4, v0
  v_add_u32 v58, s28, v58
  s_add_u32 s30, s24, 3
  s_and_b32 s30, s30, 3
  s_lshl_b32 s28, s30, 2
  s_lshr_b32 s29, s25, 3
  s_add_u32 s28, s28, s29
  s_lshl_b32 s28, s28, 14
  s_and_b32 s29, s25, 7
  s_lshl_b32 s29, s29, 10
  s_add_u32 s28, s28, s29
  v_lshlrev_b32 v59, 4, v0
  v_add_u32 v59, s28, v59
  s_mov_b32 s55, 0xffff0000
  s_waitcnt vmcnt(13)
  ds_write_b128 v60, v[192:195] offset:0
  ds_write_b128 v60, v[196:199] offset:1024
  ds_write_b128 v60, v[224:227] offset:2048
  ds_write_b128 v60, v[228:231] offset:3072
  ds_read_b64_tr_b16 v[192:193], v61 offset:0
  ds_read_b64_tr_b16 v[194:195], v61 offset:128
  ds_read_b64_tr_b16 v[196:197], v61 offset:2048
  ds_read_b64_tr_b16 v[198:199], v61 offset:2176
  ds_read_b64_tr_b16 v[224:225], v61 offset:32
  ds_read_b64_tr_b16 v[226:227], v61 offset:160
  ds_read_b64_tr_b16 v[228:229], v61 offset:2080
  ds_read_b64_tr_b16 v[230:231], v61 offset:2208
  s_waitcnt vmcnt(9)
  ds_write_b128 v60, v[200:203] offset:0
  ds_write_b128 v60, v[204:207] offset:1024
  ds_write_b128 v60, v[232:235] offset:2048
  ds_write_b128 v60, v[236:239] offset:3072
  ds_read_b64_tr_b16 v[200:201], v61 offset:0
  ds_read_b64_tr_b16 v[202:203], v61 offset:128
  ds_read_b64_tr_b16 v[204:205], v61 offset:2048
  ds_read_b64_tr_b16 v[206:207], v61 offset:2176
  ds_read_b64_tr_b16 v[232:233], v61 offset:32
  ds_read_b64_tr_b16 v[234:235], v61 offset:160
  ds_read_b64_tr_b16 v[236:237], v61 offset:2080
  ds_read_b64_tr_b16 v[238:239], v61 offset:2208
  s_waitcnt vmcnt(4)
  ds_write_b128 v60, v[208:211] offset:0
  ds_write_b128 v60, v[212:215] offset:1024
  ds_write_b128 v60, v[240:243] offset:2048
  ds_write_b128 v60, v[244:247] offset:3072
  ds_read_b64_tr_b16 v[208:209], v61 offset:0
  ds_read_b64_tr_b16 v[210:211], v61 offset:128
  ds_read_b64_tr_b16 v[212:213], v61 offset:2048
  ds_read_b64_tr_b16 v[214:215], v61 offset:2176
  ds_read_b64_tr_b16 v[240:241], v61 offset:32
  ds_read_b64_tr_b16 v[242:243], v61 offset:160
  ds_read_b64_tr_b16 v[244:245], v61 offset:2080
  ds_read_b64_tr_b16 v[246:247], v61 offset:2208
  s_waitcnt vmcnt(0)
  ds_write_b128 v60, v[216:219] offset:0
  ds_write_b128 v60, v[220:223] offset:1024
  ds_write_b128 v60, v[248:251] offset:2048
  ds_write_b128 v60, v[252:255] offset:3072
  ds_read_b64_tr_b16 v[216:217], v61 offset:0
  ds_read_b64_tr_b16 v[218:219], v61 offset:128
  ds_read_b64_tr_b16 v[220:221], v61 offset:2048
  ds_read_b64_tr_b16 v[222:223], v61 offset:2176
  ds_read_b64_tr_b16 v[248:249], v61 offset:32
  ds_read_b64_tr_b16 v[250:251], v61 offset:160
  ds_read_b64_tr_b16 v[252:253], v61 offset:2080
  ds_read_b64_tr_b16 v[254:255], v61 offset:2208
  s_setprio 2
  s_barrier
  v_mov_b32 v62, 22528
  ds_read_b32 v63, v62
  s_waitcnt lgkmcnt(0)
  v_readfirstlane_b32 s33, v63
  s_nop 0
  s_lshr_b32 s28, s33, 3
  s_and_b32 s28, s28, 0x2000
  s_add_u32 s45, s45, s28
  s_and_b32 s33, s33, 0xffff
  s_barrier
  s_cmp_ge_u32 s33, 32
  s_cbranch_scc0 L_O5_slow
.p2align 6
L_O5_loopf:
  s_add_u32 s28, s36, 0
  s_and_b32 s28, s28, 3
  s_lshl_b32 s28, s28, 17
  s_add_u32 s37, s44, s28
  s_and_b32 s28, s36, 1
  s_lshl_b32 s28, s28, 18
  s_add_u32 s40, s45, s28
  s_bfe_u32 s41, s36, 0x10001
  v_mov_b32 v32, 0
  v_mov_b32 v33, 0
  v_mov_b32 v34, 0
  v_mov_b32 v35, 0
  v_mov_b32 v36, 0
  v_mov_b32 v37, 0
  v_mov_b32 v38, 0
  v_mov_b32 v39, 0
  s_cmp_eq_u32 s36, 63
  s_cbranch_scc1 L_O5_lastf
  s_barrier
  s_barrier
  s_barrier
  s_nop 15
  s_nop 13
  buffer_load_dwordx4 v[16:19], v1, s[4:7], s37 offen offset:0 sc1
  s_nop 3
  buffer_load_dwordx4 v[20:23], v1, s[4:7], s37 offen offset:1024 sc1
  s_nop 3
  buffer_load_dwordx4 v[24:27], v1, s[4:7], s37 offen offset:2048 sc1
  s_nop 3
  buffer_load_dwordx4 v[28:31], v1, s[4:7], s37 offen offset:3072 sc1
  s_waitcnt vmcnt(3)
  v_cmp_eq_u32 vcc, -1, v16
  s_cbranch_vccnz L_Oo_28_b0123
L_Oo_28_k0123:
  v_smfmac_f32_16x16x64_bf16 v[32:35], v[16:19], v[192:199], v2
  v_smfmac_f32_16x16x64_bf16 v[36:39], v[16:19], v[224:231], v2
  s_waitcnt vmcnt(2)
  v_cmp_eq_u32 vcc, -1, v20
  s_cbranch_vccnz L_Oo_28_b123
L_Oo_28_k123:
  v_smfmac_f32_16x16x64_bf16 v[32:35], v[20:23], v[200:207], v2
  v_smfmac_f32_16x16x64_bf16 v[36:39], v[20:23], v[232:239], v2
  s_waitcnt vmcnt(1)
  v_cmp_eq_u32 vcc, -1, v24
  s_cbranch_vccnz L_Oo_28_b23
L_Oo_28_k23:
  v_smfmac_f32_16x16x64_bf16 v[32:35], v[24:27], v[208:215], v2
  v_smfmac_f32_16x16x64_bf16 v[36:39], v[24:27], v[240:247], v2
  s_waitcnt vmcnt(0)
  v_cmp_eq_u32 vcc, -1, v28
  s_cbranch_vccnz L_Oo_28_b3
L_Oo_28_k3:
  v_smfmac_f32_16x16x64_bf16 v[32:35], v[28:31], v[216:223], v2
  v_smfmac_f32_16x16x64_bf16 v[36:39], v[28:31], v[248:255], v2
L_Oo_28_e:
  s_nop 6
  v_add_f32 v32, v32, v33
  v_add_f32 v34, v34, v35
  ds_write2_b32 v3, v32, v34 offset0:0 offset1:40
  v_add_f32 v36, v36, v37
  v_add_f32 v38, v38, v39
  ds_write2_b32 v3, v36, v38 offset0:16 offset1:56
  s_waitcnt lgkmcnt(0)
  s_barrier
  ds_read_b128 v[64:67], v14 offset:0
  ds_read_b128 v[68:71], v14 offset:1280
  ds_read_b128 v[72:75], v14 offset:2560
  ds_read_b128 v[76:79], v14 offset:3840
  s_waitcnt lgkmcnt(2)
  v_pk_add_f32 v[64:65], v[64:65], v[68:69]
  v_pk_add_f32 v[66:67], v[66:67], v[70:71]
  s_waitcnt lgkmcnt(1)
  v_pk_add_f32 v[64:65], v[64:65], v[72:73]
  v_pk_add_f32 v[66:67], v[66:67], v[74:75]
  s_waitcnt lgkmcnt(0)
  v_pk_add_f32 v[64:65], v[64:65], v[76:77]
  v_pk_add_f32 v[66:67], v[66:67], v[78:79]
  v_bfi_b32 v64, 1, s41, v64
  buffer_store_dwordx4 v[64:67], v56, s[4:7], s40 offen sc1
  s_barrier
  s_nop 15
  s_nop 15
  s_nop 15
  s_nop 15
  s_nop 15
  s_nop 15
  s_nop 3
  buffer_load_dwordx4 v[84:87], v57, s[4:7], s40 offen sc1
  buffer_load_dwordx4 v[88:91], v58, s[4:7], s40 offen sc1
  buffer_load_dwordx4 v[92:95], v59, s[4:7], s40 offen sc1
  s_nop 15
  s_nop 13
  buffer_load_dwordx4 v[84:87], v57, s[4:7], s40 offen sc1
  buffer_load_dwordx4 v[88:91], v58, s[4:7], s40 offen sc1
  buffer_load_dwordx4 v[92:95], v59, s[4:7], s40 offen sc1
  s_nop 15
  s_nop 13
  buffer_load_dwordx4 v[84:87], v57, s[4:7], s40 offen sc1
  buffer_load_dwordx4 v[88:91], v58, s[4:7], s40 offen sc1
  buffer_load_dwordx4 v[92:95], v59, s[4:7], s40 offen sc1
L_Ox_29:
  s_waitcnt vmcnt(6)
  v_bitop3_b32 v60, v84, v88, v64 bitop3:0x7e
  v_bitop3_b32 v60, v60, v92, v64 bitop3:0xf6
  v_and_b32 v60, 1, v60
  v_cmp_ne_u32 vcc, 0, v60
  s_cbranch_vccnz L_Oxr_31
L_Oxc_30:
  v_pk_add_f32 v[64:65], v[64:65], v[84:85]
  v_pk_add_f32 v[66:67], v[66:67], v[86:87]
  v_pk_add_f32 v[68:69], v[88:89], v[92:93]
  v_pk_add_f32 v[70:71], v[90:91], v[94:95]
  v_pk_add_f32 v[64:65], v[64:65], v[68:69]
  v_pk_add_f32 v[66:67], v[66:67], v[70:71]
  v_cvt_pk_bf16_f32 v68, v64, v65
  v_cvt_pk_bf16_f32 v69, v66, v67
  v_min_u32 v68, -2, v68
  buffer_store_dwordx2 v[68:69], v15, s[4:7], s37 offen
  s_barrier
  s_add_u32 s36, s36, 1
  s_branch L_O5_loopf
L_O5_lastf:
  s_branch L_R_done
L_Oo_28_b0123:
  s_mov_b64 exec, vcc
  buffer_load_dwordx4 v[16:19], v1, s[4:7], s37 offen offset:0 sc1
  s_mov_b64 exec, -1
  s_waitcnt vmcnt(3)
  v_cmp_eq_u32 vcc, -1, v20
  s_cbranch_vccnz L_Oo_28_b1230
L_Oo_28_k1230:
  v_smfmac_f32_16x16x64_bf16 v[32:35], v[20:23], v[200:207], v2
  v_smfmac_f32_16x16x64_bf16 v[36:39], v[20:23], v[232:239], v2
  s_waitcnt vmcnt(2)
  v_cmp_eq_u32 vcc, -1, v24
  s_cbranch_vccnz L_Oo_28_b230
L_Oo_28_k230:
  v_smfmac_f32_16x16x64_bf16 v[32:35], v[24:27], v[208:215], v2
  v_smfmac_f32_16x16x64_bf16 v[36:39], v[24:27], v[240:247], v2
  s_waitcnt vmcnt(1)
  v_cmp_eq_u32 vcc, -1, v28
  s_cbranch_vccnz L_Oo_28_b30
L_Oo_28_k30:
  v_smfmac_f32_16x16x64_bf16 v[32:35], v[28:31], v[216:223], v2
  v_smfmac_f32_16x16x64_bf16 v[36:39], v[28:31], v[248:255], v2
  s_waitcnt vmcnt(0)
  v_cmp_eq_u32 vcc, -1, v16
  s_cbranch_vccnz L_Oo_28_b0
L_Oo_28_k0:
  v_smfmac_f32_16x16x64_bf16 v[32:35], v[16:19], v[192:199], v2
  v_smfmac_f32_16x16x64_bf16 v[36:39], v[16:19], v[224:231], v2
  s_branch L_Oo_28_e
L_Oo_28_b123:
  s_mov_b64 exec, vcc
  buffer_load_dwordx4 v[20:23], v1, s[4:7], s37 offen offset:1024 sc1
  s_mov_b64 exec, -1
  s_waitcnt vmcnt(2)
  v_cmp_eq_u32 vcc, -1, v24
  s_cbranch_vccnz L_Oo_28_b231
L_Oo_28_k231:
  v_smfmac_f32_16x16x64_bf16 v[32:35], v[24:27], v[208:215], v2
  v_smfmac_f32_16x16x64_bf16 v[36:39], v[24:27], v[240:247], v2
  s_waitcnt vmcnt(1)
  v_cmp_eq_u32 vcc, -1, v28
  s_cbranch_vccnz L_Oo_28_b31
L_Oo_28_k31:
  v_smfmac_f32_16x16x64_bf16 v[32:35], v[28:31], v[216:223], v2
  v_smfmac_f32_16x16x64_bf16 v[36:39], v[28:31], v[248:255], v2
  s_waitcnt vmcnt(0)
  v_cmp_eq_u32 vcc, -1, v20
  s_cbranch_vccnz L_Oo_28_b1
L_Oo_28_k1:
  v_smfmac_f32_16x16x64_bf16 v[32:35], v[20:23], v[200:207], v2
  v_smfmac_f32_16x16x64_bf16 v[36:39], v[20:23], v[232:239], v2
  s_branch L_Oo_28_e
L_Oo_28_b23:
  s_mov_b64 exec, vcc
  buffer_load_dwordx4 v[24:27], v1, s[4:7], s37 offen offset:2048 sc1
  s_mov_b64 exec, -1
  s_waitcnt vmcnt(1)
  v_cmp_eq_u32 vcc, -1, v28
  s_cbranch_vccnz L_Oo_28_b32
L_Oo_28_k32:
  v_smfmac_f32_16x16x64_bf16 v[32:35], v[28:31], v[216:223], v2
  v_smfmac_f32_16x16x64_bf16 v[36:39], v[28:31], v[248:255], v2
  s_waitcnt vmcnt(0)
  v_cmp_eq_u32 vcc, -1, v24
  s_cbranch_vccnz L_Oo_28_b2
L_Oo_28_k2:
  v_smfmac_f32_16x16x64_bf16 v[32:35], v[24:27], v[208:215], v2
  v_smfmac_f32_16x16x64_bf16 v[36:39], v[24:27], v[240:247], v2
  s_branch L_Oo_28_e
L_Oo_28_b3:
  s_mov_b64 exec, vcc
  buffer_load_dwordx4 v[28:31], v1, s[4:7], s37 offen offset:3072 sc1
  s_mov_b64 exec, -1
  s_add_u32 s27, s27, 1
  s_cmp_ge_u32 s27, 0x80000
  s_cbranch_scc1 L_Oo_28_e
  s_waitcnt vmcnt(0)
  v_cmp_eq_u32 vcc, -1, v28
  s_cbranch_vccz L_Oo_28_k3
  s_branch L_Oo_28_b3
L_Oo_28_b1230:
  s_mov_b64 exec, vcc
  buffer_load_dwordx4 v[20:23], v1, s[4:7], s37 offen offset:1024 sc1
  s_mov_b64 exec, -1
  s_waitcnt vmcnt(3)
  v_cmp_eq_u32 vcc, -1, v24
  s_cbranch_vccnz L_Oo_28_b2301
L_Oo_28_k2301:
  v_smfmac_f32_16x16x64_bf16 v[32:35], v[24:27], v[208:215], v2
  v_smfmac_f32_16x16x64_bf16 v[36:39], v[24:27], v[240:247], v2
  s_waitcnt vmcnt(2)
  v_cmp_eq_u32 vcc, -1, v28
  s_cbranch_vccnz L_Oo_28_b301
L_Oo_28_k301:
  v_smfmac_f32_16x16x64_bf16 v[32:35], v[28:31], v[216:223], v2
  v_smfmac_f32_16x16x64_bf16 v[36:39], v[28:31], v[248:255], v2
  s_waitcnt vmcnt(1)
  v_cmp_eq_u32 vcc, -1, v16
  s_cbranch_vccnz L_Oo_28_b01
L_Oo_28_k01:
  v_smfmac_f32_16x16x64_bf16 v[32:35], v[16:19], v[192:199], v2
  v_smfmac_f32_16x16x64_bf16 v[36:39], v[16:19], v[224:231], v2
  s_waitcnt vmcnt(0)
  v_cmp_eq_u32 vcc, -1, v20
  s_cbranch_vccz L_Oo_28_k1
L_Oo_28_b1:
  s_mov_b64 exec, vcc
  buffer_load_dwordx4 v[20:23], v1, s[4:7], s37 offen offset:1024 sc1
  s_mov_b64 exec, -1
  s_add_u32 s27, s27, 1
  s_cmp_ge_u32 s27, 0x80000
  s_cbranch_scc1 L_Oo_28_e
  s_waitcnt vmcnt(0)
  v_cmp_eq_u32 vcc, -1, v20
  s_cbranch_vccz L_Oo_28_k1
  s_branch L_Oo_28_b1
L_Oo_28_b230:
  s_mov_b64 exec, vcc
  buffer_load_dwordx4 v[24:27], v1, s[4:7], s37 offen offset:2048 sc1
  s_mov_b64 exec, -1
  s_waitcnt vmcnt(2)
  v_cmp_eq_u32 vcc, -1, v28
  s_cbranch_vccnz L_Oo_28_b302
L_Oo_28_k302:
  v_smfmac_f32_16x16x64_bf16 v[32:35], v[28:31], v[216:223], v2
  v_smfmac_f32_16x16x64_bf16 v[36:39], v[28:31], v[248:255], v2
  s_waitcnt vmcnt(1)
  v_cmp_eq_u32 vcc, -1, v16
  s_cbranch_vccnz L_Oo_28_b02
L_Oo_28_k02:
  v_smfmac_f32_16x16x64_bf16 v[32:35], v[16:19], v[192:199], v2
  v_smfmac_f32_16x16x64_bf16 v[36:39], v[16:19], v[224:231], v2
  s_waitcnt vmcnt(0)
  v_cmp_eq_u32 vcc, -1, v24
  s_cbranch_vccz L_Oo_28_k2
L_Oo_28_b2:
  s_mov_b64 exec, vcc
  buffer_load_dwordx4 v[24:27], v1, s[4:7], s37 offen offset:2048 sc1
  s_mov_b64 exec, -1
  s_add_u32 s27, s27, 1
  s_cmp_ge_u32 s27, 0x80000
  s_cbranch_scc1 L_Oo_28_e
  s_waitcnt vmcnt(0)
  v_cmp_eq_u32 vcc, -1, v24
  s_cbranch_vccz L_Oo_28_k2
  s_branch L_Oo_28_b2
L_Oo_28_b30:
  s_mov_b64 exec, vcc
  buffer_load_dwordx4 v[28:31], v1, s[4:7], s37 offen offset:3072 sc1
  s_mov_b64 exec, -1
  s_add_u32 s27, s27, 1
  s_cmp_ge_u32 s27, 0x80000
  s_cbranch_scc1 L_Oo_28_e
  s_waitcnt vmcnt(1)
  v_cmp_eq_u32 vcc, -1, v16
  s_cbranch_vccnz L_Oo_28_b03
L_Oo_28_k03:
  v_smfmac_f32_16x16x64_bf16 v[32:35], v[16:19], v[192:199], v2
  v_smfmac_f32_16x16x64_bf16 v[36:39], v[16:19], v[224:231], v2
  s_waitcnt vmcnt(0)
  v_cmp_eq_u32 vcc, -1, v28
  s_cbranch_vccz L_Oo_28_k3
  s_branch L_Oo_28_b3
L_Oo_28_b0:
  s_mov_b64 exec, vcc
  buffer_load_dwordx4 v[16:19], v1, s[4:7], s37 offen offset:0 sc1
  s_mov_b64 exec, -1
  s_add_u32 s27, s27, 1
  s_cmp_ge_u32 s27, 0x80000
  s_cbranch_scc1 L_Oo_28_e
  s_waitcnt vmcnt(0)
  v_cmp_eq_u32 vcc, -1, v16
  s_cbranch_vccz L_Oo_28_k0
  s_branch L_Oo_28_b0
L_Oo_28_b231:
  s_mov_b64 exec, vcc
  buffer_load_dwordx4 v[24:27], v1, s[4:7], s37 offen offset:2048 sc1
  s_mov_b64 exec, -1
  s_waitcnt vmcnt(2)
  v_cmp_eq_u32 vcc, -1, v28
  s_cbranch_vccnz L_Oo_28_b312
L_Oo_28_k312:
  v_smfmac_f32_16x16x64_bf16 v[32:35], v[28:31], v[216:223], v2
  v_smfmac_f32_16x16x64_bf16 v[36:39], v[28:31], v[248:255], v2
  s_waitcnt vmcnt(1)
  v_cmp_eq_u32 vcc, -1, v20
  s_cbranch_vccnz L_Oo_28_b12
L_Oo_28_k12:
  v_smfmac_f32_16x16x64_bf16 v[32:35], v[20:23], v[200:207], v2
  v_smfmac_f32_16x16x64_bf16 v[36:39], v[20:23], v[232:239], v2
  s_waitcnt vmcnt(0)
  v_cmp_eq_u32 vcc, -1, v24
  s_cbranch_vccz L_Oo_28_k2
  s_branch L_Oo_28_b2
L_Oo_28_b31:
  s_mov_b64 exec, vcc
  buffer_load_dwordx4 v[28:31], v1, s[4:7], s37 offen offset:3072 sc1
  s_mov_b64 exec, -1
  s_add_u32 s27, s27, 1
  s_cmp_ge_u32 s27, 0x80000
  s_cbranch_scc1 L_Oo_28_e
  s_waitcnt vmcnt(1)
  v_cmp_eq_u32 vcc, -1, v20
  s_cbranch_vccnz L_Oo_28_b13
L_Oo_28_k13:
  v_smfmac_f32_16x16x64_bf16 v[32:35], v[20:23], v[200:207], v2
  v_smfmac_f32_16x16x64_bf16 v[36:39], v[20:23], v[232:239], v2
  s_waitcnt vmcnt(0)
  v_cmp_eq_u32 vcc, -1, v28
  s_cbranch_vccz L_Oo_28_k3
  s_branch L_Oo_28_b3
L_Oo_28_b32:
  s_mov_b64 exec, vcc
  buffer_load_dwordx4 v[28:31], v1, s[4:7], s37 offen offset:3072 sc1
  s_mov_b64 exec, -1
  s_add_u32 s27, s27, 1
  s_cmp_ge_u32 s27, 0x80000
  s_cbranch_scc1 L_Oo_28_e
  s_waitcnt vmcnt(1)
  v_cmp_eq_u32 vcc, -1, v24
  s_cbranch_vccz L_Oo_28_k23
  s_branch L_Oo_28_b23
L_Oo_28_b2301:
  s_mov_b64 exec, vcc
  buffer_load_dwordx4 v[24:27], v1, s[4:7], s37 offen offset:2048 sc1
  s_mov_b64 exec, -1
  s_waitcnt vmcnt(3)
  v_cmp_eq_u32 vcc, -1, v28
  s_cbranch_vccnz L_Oo_28_b3012
L_Oo_28_k3012:
  v_smfmac_f32_16x16x64_bf16 v[32:35], v[28:31], v[216:223], v2
  v_smfmac_f32_16x16x64_bf16 v[36:39], v[28:31], v[248:255], v2
  s_waitcnt vmcnt(2)
  v_cmp_eq_u32 vcc, -1, v16
  s_cbranch_vccnz L_Oo_28_b012
L_Oo_28_k012:
  v_smfmac_f32_16x16x64_bf16 v[32:35], v[16:19], v[192:199], v2
  v_smfmac_f32_16x16x64_bf16 v[36:39], v[16:19], v[224:231], v2
  s_waitcnt vmcnt(1)
  v_cmp_eq_u32 vcc, -1, v20
  s_cbranch_vccz L_Oo_28_k12
L_Oo_28_b12:
  s_mov_b64 exec, vcc
  buffer_load_dwordx4 v[20:23], v1, s[4:7], s37 offen offset:1024 sc1
  s_mov_b64 exec, -1
  s_waitcnt vmcnt(1)
  v_cmp_eq_u32 vcc, -1, v24
  s_cbranch_vccnz L_Oo_28_b21
L_Oo_28_k21:
  v_smfmac_f32_16x16x64_bf16 v[32:35], v[24:27], v[208:215], v2
  v_smfmac_f32_16x16x64_bf16 v[36:39], v[24:27], v[240:247], v2
  s_waitcnt vmcnt(0)
  v_cmp_eq_u32 vcc, -1, v20
  s_cbranch_vccz L_Oo_28_k1
  s_branch L_Oo_28_b1
L_Oo_28_b301:
  s_mov_b64 exec, vcc
  buffer_load_dwordx4 v[28:31], v1, s[4:7], s37 offen offset:3072 sc1
  s_mov_b64 exec, -1
  s_add_u32 s27, s27, 1
  s_cmp_ge_u32 s27, 0x80000
  s_cbranch_scc1 L_Oo_28_e
  s_waitcnt vmcnt(2)
  v_cmp_eq_u32 vcc, -1, v16
  s_cbranch_vccnz L_Oo_28_b013
L_Oo_28_k013:
  v_smfmac_f32_16x16x64_bf16 v[32:35], v[16:19], v[192:199], v2
  v_smfmac_f32_16x16x64_bf16 v[36:39], v[16:19], v[224:231], v2
  s_waitcnt vmcnt(1)
  v_cmp_eq_u32 vcc, -1, v20
  s_cbranch_vccz L_Oo_28_k13
L_Oo_28_b13:
  s_mov_b64 exec, vcc
  buffer_load_dwordx4 v[20:23], v1, s[4:7], s37 offen offset:1024 sc1
  s_mov_b64 exec, -1
  s_waitcnt vmcnt(1)
  v_cmp_eq_u32 vcc, -1, v28
  s_cbranch_vccz L_Oo_28_k31
  s_branch L_Oo_28_b31
L_Oo_28_b01:
  s_mov_b64 exec, vcc
  buffer_load_dwordx4 v[16:19], v1, s[4:7], s37 offen offset:0 sc1
  s_mov_b64 exec, -1
  s_waitcnt vmcnt(1)
  v_cmp_eq_u32 vcc, -1, v20
  s_cbranch_vccnz L_Oo_28_b10
L_Oo_28_k10:
  v_smfmac_f32_16x16x64_bf16 v[32:35], v[20:23], v[200:207], v2
  v_smfmac_f32_16x16x64_bf16 v[36:39], v[20:23], v[232:239], v2
  s_waitcnt vmcnt(0)
  v_cmp_eq_u32 vcc, -1, v16
  s_cbranch_vccz L_Oo_28_k0
  s_branch L_Oo_28_b0
L_Oo_28_b302:
  s_mov_b64 exec, vcc
  buffer_load_dwordx4 v[28:31], v1, s[4:7], s37 offen offset:3072 sc1
  s_mov_b64 exec, -1
  s_add_u32 s27, s27, 1
  s_cmp_ge_u32 s27, 0x80000
  s_cbranch_scc1 L_Oo_28_e
  s_waitcnt vmcnt(2)
  v_cmp_eq_u32 vcc, -1, v16
  s_cbranch_vccnz L_Oo_28_b023
L_Oo_28_k023:
  v_smfmac_f32_16x16x64_bf16 v[32:35], v[16:19], v[192:199], v2
  v_smfmac_f32_16x16x64_bf16 v[36:39], v[16:19], v[224:231], v2
  s_waitcnt vmcnt(1)
  v_cmp_eq_u32 vcc, -1, v24
  s_cbranch_vccz L_Oo_28_k23
  s_branch L_Oo_28_b23
L_Oo_28_b02:
  s_mov_b64 exec, vcc
  buffer_load_dwordx4 v[16:19], v1, s[4:7], s37 offen offset:0 sc1
  s_mov_b64 exec, -1
  s_waitcnt vmcnt(1)
  v_cmp_eq_u32 vcc, -1, v24
  s_cbranch_vccnz L_Oo_28_b20
L_Oo_28_k20:
  v_smfmac_f32_16x16x64_bf16 v[32:35], v[24:27], v[208:215], v2
  v_smfmac_f32_16x16x64_bf16 v[36:39], v[24:27], v[240:247], v2
  s_waitcnt vmcnt(0)
  v_cmp_eq_u32 vcc, -1, v16
  s_cbranch_vccz L_Oo_28_k0
  s_branch L_Oo_28_b0
L_Oo_28_b03:
  s_mov_b64 exec, vcc
  buffer_load_dwordx4 v[16:19], v1, s[4:7], s37 offen offset:0 sc1
  s_mov_b64 exec, -1
  s_waitcnt vmcnt(1)
  v_cmp_eq_u32 vcc, -1, v28
  s_cbranch_vccz L_Oo_28_k30
  s_branch L_Oo_28_b30
L_Oo_28_b312:
  s_mov_b64 exec, vcc
  buffer_load_dwordx4 v[28:31], v1, s[4:7], s37 offen offset:3072 sc1
  s_mov_b64 exec, -1
  s_add_u32 s27, s27, 1
  s_cmp_ge_u32 s27, 0x80000
  s_cbranch_scc1 L_Oo_28_e
  s_waitcnt vmcnt(2)
  v_cmp_eq_u32 vcc, -1, v20
  s_cbranch_vccz L_Oo_28_k123
  s_branch L_Oo_28_b123
L_Oo_28_b3012:
  s_mov_b64 exec, vcc
  buffer_load_dwordx4 v[28:31], v1, s[4:7], s37 offen offset:3072 sc1
  s_mov_b64 exec, -1
  s_add_u32 s27, s27, 1
  s_cmp_ge_u32 s27, 0x80000
  s_cbranch_scc1 L_Oo_28_e
  s_waitcnt vmcnt(3)
  v_cmp_eq_u32 vcc, -1, v16
  s_cbranch_vccz L_Oo_28_k0123
  s_branch L_Oo_28_b0123
L_Oo_28_b012:
  s_mov_b64 exec, vcc
  buffer_load_dwordx4 v[16:19], v1, s[4:7], s37 offen offset:0 sc1
  s_mov_b64 exec, -1
  s_waitcnt vmcnt(2)
  v_cmp_eq_u32 vcc, -1, v20
  s_cbranch_vccnz L_Oo_28_b120
L_Oo_28_k120:
  v_smfmac_f32_16x16x64_bf16 v[32:35], v[20:23], v[200:207], v2
  v_smfmac_f32_16x16x64_bf16 v[36:39], v[20:23], v[232:239], v2
  s_waitcnt vmcnt(1)
  v_cmp_eq_u32 vcc, -1, v24
  s_cbranch_vccz L_Oo_28_k20
L_Oo_28_b20:
  s_mov_b64 exec, vcc
  buffer_load_dwordx4 v[24:27], v1, s[4:7], s37 offen offset:2048 sc1
  s_mov_b64 exec, -1
  s_add_u32 s27, s27, 1
  s_cmp_ge_u32 s27, 0x80000
  s_cbranch_scc1 L_Oo_28_e
  s_waitcnt vmcnt(1)
  v_cmp_eq_u32 vcc, -1, v16
  s_cbranch_vccz L_Oo_28_k02
  s_branch L_Oo_28_b02
L_Oo_28_b21:
  s_mov_b64 exec, vcc
  buffer_load_dwordx4 v[24:27], v1, s[4:7], s37 offen offset:2048 sc1
  s_mov_b64 exec, -1
  s_add_u32 s27, s27, 1
  s_cmp_ge_u32 s27, 0x80000
  s_cbranch_scc1 L_Oo_28_e
  s_waitcnt vmcnt(1)
  v_cmp_eq_u32 vcc, -1, v20
  s_cbranch_vccz L_Oo_28_k12
  s_branch L_Oo_28_b12
L_Oo_28_b013:
  s_mov_b64 exec, vcc
  buffer_load_dwordx4 v[16:19], v1, s[4:7], s37 offen offset:0 sc1
  s_mov_b64 exec, -1
  s_waitcnt vmcnt(2)
  v_cmp_eq_u32 vcc, -1, v20
  s_cbranch_vccnz L_Oo_28_b130
L_Oo_28_k130:
  v_smfmac_f32_16x16x64_bf16 v[32:35], v[20:23], v[200:207], v2
  v_smfmac_f32_16x16x64_bf16 v[36:39], v[20:23], v[232:239], v2
  s_waitcnt vmcnt(1)
  v_cmp_eq_u32 vcc, -1, v28
  s_cbranch_vccz L_Oo_28_k30
  s_branch L_Oo_28_b30
L_Oo_28_b10:
  s_mov_b64 exec, vcc
  buffer_load_dwordx4 v[20:23], v1, s[4:7], s37 offen offset:1024 sc1
  s_mov_b64 exec, -1
  s_add_u32 s27, s27, 1
  s_cmp_ge_u32 s27, 0x80000
  s_cbranch_scc1 L_Oo_28_e
  s_waitcnt vmcnt(1)
  v_cmp_eq_u32 vcc, -1, v16
  s_cbranch_vccz L_Oo_28_k01
  s_branch L_Oo_28_b01
L_Oo_28_b023:
  s_mov_b64 exec, vcc
  buffer_load_dwordx4 v[16:19], v1, s[4:7], s37 offen offset:0 sc1
  s_mov_b64 exec, -1
  s_waitcnt vmcnt(2)
  v_cmp_eq_u32 vcc, -1, v24
  s_cbranch_vccz L_Oo_28_k230
  s_branch L_Oo_28_b230
L_Oo_28_b120:
  s_mov_b64 exec, vcc
  buffer_load_dwordx4 v[20:23], v1, s[4:7], s37 offen offset:1024 sc1
  s_mov_b64 exec, -1
  s_waitcnt vmcnt(2)
  v_cmp_eq_u32 vcc, -1, v24
  s_cbranch_vccnz L_Oo_28_b201
L_Oo_28_k201:
  v_smfmac_f32_16x16x64_bf16 v[32:35], v[24:27], v[208:215], v2
  v_smfmac_f32_16x16x64_bf16 v[36:39], v[24:27], v[240:247], v2
  s_waitcnt vmcnt(1)
  v_cmp_eq_u32 vcc, -1, v16
  s_cbranch_vccz L_Oo_28_k01
  s_branch L_Oo_28_b01
L_Oo_28_b130:
  s_mov_b64 exec, vcc
  buffer_load_dwordx4 v[20:23], v1, s[4:7], s37 offen offset:1024 sc1
  s_mov_b64 exec, -1
  s_waitcnt vmcnt(2)
  v_cmp_eq_u32 vcc, -1, v28
  s_cbranch_vccz L_Oo_28_k301
  s_branch L_Oo_28_b301
L_Oo_28_b201:
  s_mov_b64 exec, vcc
  buffer_load_dwordx4 v[24:27], v1, s[4:7], s37 offen offset:2048 sc1
  s_mov_b64 exec, -1
  s_add_u32 s27, s27, 1
  s_cmp_ge_u32 s27, 0x80000
  s_cbranch_scc1 L_Oo_28_e
  s_waitcnt vmcnt(2)
  v_cmp_eq_u32 vcc, -1, v16
  s_cbranch_vccz L_Oo_28_k012
  s_branch L_Oo_28_b012
L_Oxr_31:
  s_add_u32 s27, s27, 1
  s_cmp_ge_u32 s27, 0x80000
  s_cbranch_scc1 L_Oxc_30
  s_mov_b64 exec, vcc
  buffer_load_dwordx4 v[84:87], v57, s[4:7], s40 offen sc1
  buffer_load_dwordx4 v[88:91], v58, s[4:7], s40 offen sc1
  buffer_load_dwordx4 v[92:95], v59, s[4:7], s40 offen sc1
  s_mov_b64 exec, -1
  s_branch L_Ox_29
L_O5_slow:
.p2align 6
L_O5_loops:
  s_add_u32 s28, s36, 0
  s_and_b32 s28, s28, 3
  s_lshl_b32 s28, s28, 17
  s_add_u32 s37, s44, s28
  s_and_b32 s28, s36, 1
  s_lshl_b32 s28, s28, 18
  s_add_u32 s40, s45, s28
  s_bfe_u32 s41, s36, 0x10001
  v_mov_b32 v32, 0
  v_mov_b32 v33, 0
  v_mov_b32 v34, 0
  v_mov_b32 v35, 0
  v_mov_b32 v36, 0
  v_mov_b32 v37, 0
  v_mov_b32 v38, 0
  v_mov_b32 v39, 0
  s_cmp_eq_u32 s36, 63
  s_cbranch_scc1 L_O5_lasts
  s_barrier
  s_barrier
  s_barrier
  s_nop 15
  s_nop 13
  buffer_load_dwordx4 v[16:19], v1, s[4:7], s37 offen offset:0 sc1
  s_nop 3
  buffer_load_dwordx4 v[20:23], v1, s[4:7], s37 offen offset:1024 sc1
  s_nop 3
  buffer_load_dwordx4 v[24:27], v1, s[4:7], s37 offen offset:2048 sc1
  s_nop 3
  buffer_load_dwordx4 v[28:31], v1, s[4:7], s37 offen offset:3072 sc1
  s_waitcnt vmcnt(3)
  v_cmp_eq_u32 vcc, -1, v16
  s_cbranch_vccnz L_Oo_32_b0123
L_Oo_32_k0123:
  v_smfmac_f32_16x16x64_bf16 v[32:35], v[16:19], v[192:199], v2
  v_smfmac_f32_16x16x64_bf16 v[36:39], v[16:19], v[224:231], v2
  s_waitcnt vmcnt(2)
  v_cmp_eq_u32 vcc, -1, v20
  s_cbranch_vccnz L_Oo_32_b123
L_Oo_32_k123:
  v_smfmac_f32_16x16x64_bf16 v[32:35], v[20:23], v[200:207], v2
  v_smfmac_f32_16x16x64_bf16 v[36:39], v[20:23], v[232:239], v2
  s_waitcnt vmcnt(1)
  v_cmp_eq_u32 vcc, -1, v24
  s_cbranch_vccnz L_Oo_32_b23
L_Oo_32_k23:
  v_smfmac_f32_16x16x64_bf16 v[32:35], v[24:27], v[208:215], v2
  v_smfmac_f32_16x16x64_bf16 v[36:39], v[24:27], v[240:247], v2
  s_waitcnt vmcnt(0)
  v_cmp_eq_u32 vcc, -1, v28
  s_cbranch_vccnz L_Oo_32_b3
L_Oo_32_k3:
  v_smfmac_f32_16x16x64_bf16 v[32:35], v[28:31], v[216:223], v2
  v_smfmac_f32_16x16x64_bf16 v[36:39], v[28:31], v[248:255], v2
L_Oo_32_e:
  s_nop 6
  v_add_f32 v32, v32, v33
  v_add_f32 v34, v34, v35
  ds_write2_b32 v3, v32, v34 offset0:0 offset1:40
  v_add_f32 v36, v36, v37
  v_add_f32 v38, v38, v39
  ds_write2_b32 v3, v36, v38 offset0:16 offset1:56
  s_waitcnt lgkmcnt(0)
  s_barrier
  ds_read_b128 v[64:67], v14 offset:0
  ds_read_b128 v[68:71], v14 offset:1280
  ds_read_b128 v[72:75], v14 offset:2560
  ds_read_b128 v[76:79], v14 offset:3840
  s_waitcnt lgkmcnt(2)
  v_pk_add_f32 v[64:65], v[64:65], v[68:69]
  v_pk_add_f32 v[66:67], v[66:67], v[70:71]
  s_waitcnt lgkmcnt(1)
  v_pk_add_f32 v[64:65], v[64:65], v[72:73]
  v_pk_add_f32 v[66:67], v[66:67], v[74:75]
  s_waitcnt lgkmcnt(0)
  v_pk_add_f32 v[64:65], v[64:65], v[76:77]
  v_pk_add_f32 v[66:67], v[66:67], v[78:79]
  v_bfi_b32 v64, 1, s41, v64
  buffer_store_dwordx4 v[64:67], v56, s[4:7], s40 offen sc1
  s_barrier
  s_nop 15
  s_nop 15
  s_nop 15
  s_nop 15
  s_nop 15
  s_nop 15
  s_nop 3
  buffer_load_dwordx4 v[84:87], v57, s[4:7], s40 offen sc1
  buffer_load_dwordx4 v[88:91], v58, s[4:7], s40 offen sc1
  buffer_load_dwordx4 v[92:95], v59, s[4:7], s40 offen sc1
  s_nop 15
  s_nop 13
  buffer_load_dwordx4 v[84:87], v57, s[4:7], s40 offen sc1
  buffer_load_dwordx4 v[88:91], v58, s[4:7], s40 offen sc1
  buffer_load_dwordx4 v[92:95], v59, s[4:7], s40 offen sc1
  s_nop 15
  s_nop 13
  buffer_load_dwordx4 v[84:87], v57, s[4:7], s40 offen sc1
  buffer_load_dwordx4 v[88:91], v58, s[4:7], s40 offen sc1
  buffer_load_dwordx4 v[92:95], v59, s[4:7], s40 offen sc1
L_Ox_33:
  s_waitcnt vmcnt(6)
  v_bitop3_b32 v60, v84, v88, v64 bitop3:0x7e
  v_bitop3_b32 v60, v60, v92, v64 bitop3:0xf6
  v_and_b32 v60, 1, v60
  v_cmp_ne_u32 vcc, 0, v60
  s_cbranch_vccnz L_Oxr_35
L_Oxc_34:
  v_pk_add_f32 v[64:65], v[64:65], v[84:85]
  v_pk_add_f32 v[66:67], v[66:67], v[86:87]
  v_pk_add_f32 v[68:69], v[88:89], v[92:93]
  v_pk_add_f32 v[70:71], v[90:91], v[94:95]
  v_pk_add_f32 v[64:65], v[64:65], v[68:69]
  v_pk_add_f32 v[66:67], v[66:67], v[70:71]
  v_cvt_pk_bf16_f32 v68, v64, v65
  v_cvt_pk_bf16_f32 v69, v66, v67
  v_min_u32 v68, -2, v68
  buffer_store_dwordx2 v[68:69], v15, s[4:7], s37 offen sc1
  s_barrier
  s_add_u32 s36, s36, 1
  s_branch L_O5_loops
L_O5_lasts:
  s_branch L_R_done
L_Oo_32_b0123:
  s_mov_b64 exec, vcc
  buffer_load_dwordx4 v[16:19], v1, s[4:7], s37 offen offset:0 sc1
  s_mov_b64 exec, -1
  s_waitcnt vmcnt(3)
  v_cmp_eq_u32 vcc, -1, v20
  s_cbranch_vccnz L_Oo_32_b1230
L_Oo_32_k1230:
  v_smfmac_f32_16x16x64_bf16 v[32:35], v[20:23], v[200:207], v2
  v_smfmac_f32_16x16x64_bf16 v[36:39], v[20:23], v[232:239], v2
  s_waitcnt vmcnt(2)
  v_cmp_eq_u32 vcc, -1, v24
  s_cbranch_vccnz L_Oo_32_b230
L_Oo_32_k230:
  v_smfmac_f32_16x16x64_bf16 v[32:35], v[24:27], v[208:215], v2
  v_smfmac_f32_16x16x64_bf16 v[36:39], v[24:27], v[240:247], v2
  s_waitcnt vmcnt(1)
  v_cmp_eq_u32 vcc, -1, v28
  s_cbranch_vccnz L_Oo_32_b30
L_Oo_32_k30:
  v_smfmac_f32_16x16x64_bf16 v[32:35], v[28:31], v[216:223], v2
  v_smfmac_f32_16x16x64_bf16 v[36:39], v[28:31], v[248:255], v2
  s_waitcnt vmcnt(0)
  v_cmp_eq_u32 vcc, -1, v16
  s_cbranch_vccnz L_Oo_32_b0
L_Oo_32_k0:
  v_smfmac_f32_16x16x64_bf16 v[32:35], v[16:19], v[192:199], v2
  v_smfmac_f32_16x16x64_bf16 v[36:39], v[16:19], v[224:231], v2
  s_branch L_Oo_32_e
L_Oo_32_b123:
  s_mov_b64 exec, vcc
  buffer_load_dwordx4 v[20:23], v1, s[4:7], s37 offen offset:1024 sc1
  s_mov_b64 exec, -1
  s_waitcnt vmcnt(2)
  v_cmp_eq_u32 vcc, -1, v24
  s_cbranch_vccnz L_Oo_32_b231
L_Oo_32_k231:
  v_smfmac_f32_16x16x64_bf16 v[32:35], v[24:27], v[208:215], v2
  v_smfmac_f32_16x16x64_bf16 v[36:39], v[24:27], v[240:247], v2
  s_waitcnt vmcnt(1)
  v_cmp_eq_u32 vcc, -1, v28
  s_cbranch_vccnz L_Oo_32_b31
L_Oo_32_k31:
  v_smfmac_f32_16x16x64_bf16 v[32:35], v[28:31], v[216:223], v2
  v_smfmac_f32_16x16x64_bf16 v[36:39], v[28:31], v[248:255], v2
  s_waitcnt vmcnt(0)
  v_cmp_eq_u32 vcc, -1, v20
  s_cbranch_vccnz L_Oo_32_b1
L_Oo_32_k1:
  v_smfmac_f32_16x16x64_bf16 v[32:35], v[20:23], v[200:207], v2
  v_smfmac_f32_16x16x64_bf16 v[36:39], v[20:23], v[232:239], v2
  s_branch L_Oo_32_e
L_Oo_32_b23:
  s_mov_b64 exec, vcc
  buffer_load_dwordx4 v[24:27], v1, s[4:7], s37 offen offset:2048 sc1
  s_mov_b64 exec, -1
  s_waitcnt vmcnt(1)
  v_cmp_eq_u32 vcc, -1, v28
  s_cbranch_vccnz L_Oo_32_b32
L_Oo_32_k32:
  v_smfmac_f32_16x16x64_bf16 v[32:35], v[28:31], v[216:223], v2
  v_smfmac_f32_16x16x64_bf16 v[36:39], v[28:31], v[248:255], v2
  s_waitcnt vmcnt(0)
  v_cmp_eq_u32 vcc, -1, v24
  s_cbranch_vccnz L_Oo_32_b2
L_Oo_32_k2:
  v_smfmac_f32_16x16x64_bf16 v[32:35], v[24:27], v[208:215], v2
  v_smfmac_f32_16x16x64_bf16 v[36:39], v[24:27], v[240:247], v2
  s_branch L_Oo_32_e
L_Oo_32_b3:
  s_mov_b64 exec, vcc
  buffer_load_dwordx4 v[28:31], v1, s[4:7], s37 offen offset:3072 sc1
  s_mov_b64 exec, -1
  s_add_u32 s27, s27, 1
  s_cmp_ge_u32 s27, 0x80000
  s_cbranch_scc1 L_Oo_32_e
  s_waitcnt vmcnt(0)
  v_cmp_eq_u32 vcc, -1, v28
  s_cbranch_vccz L_Oo_32_k3
  s_branch L_Oo_32_b3
L_Oo_32_b1230:
  s_mov_b64 exec, vcc
  buffer_load_dwordx4 v[20:23], v1, s[4:7], s37 offen offset:1024 sc1
  s_mov_b64 exec, -1
  s_waitcnt vmcnt(3)
  v_cmp_eq_u32 vcc, -1, v24
  s_cbranch_vccnz L_Oo_32_b2301
L_Oo_32_k2301:
  v_smfmac_f32_16x16x64_bf16 v[32:35], v[24:27], v[208:215], v2
  v_smfmac_f32_16x16x64_bf16 v[36:39], v[24:27], v[240:247], v2
  s_waitcnt vmcnt(2)
  v_cmp_eq_u32 vcc, -1, v28
  s_cbranch_vccnz L_Oo_32_b301
L_Oo_32_k301:
  v_smfmac_f32_16x16x64_bf16 v[32:35], v[28:31], v[216:223], v2
  v_smfmac_f32_16x16x64_bf16 v[36:39], v[28:31], v[248:255], v2
  s_waitcnt vmcnt(1)
  v_cmp_eq_u32 vcc, -1, v16
  s_cbranch_vccnz L_Oo_32_b01
L_Oo_32_k01:
  v_smfmac_f32_16x16x64_bf16 v[32:35], v[16:19], v[192:199], v2
  v_smfmac_f32_16x16x64_bf16 v[36:39], v[16:19], v[224:231], v2
  s_waitcnt vmcnt(0)
  v_cmp_eq_u32 vcc, -1, v20
  s_cbranch_vccz L_Oo_32_k1
L_Oo_32_b1:
  s_mov_b64 exec, vcc
  buffer_load_dwordx4 v[20:23], v1, s[4:7], s37 offen offset:1024 sc1
  s_mov_b64 exec, -1
  s_add_u32 s27, s27, 1
  s_cmp_ge_u32 s27, 0x80000
  s_cbranch_scc1 L_Oo_32_e
  s_waitcnt vmcnt(0)
  v_cmp_eq_u32 vcc, -1, v20
  s_cbranch_vccz L_Oo_32_k1
  s_branch L_Oo_32_b1
L_Oo_32_b230:
  s_mov_b64 exec, vcc
  buffer_load_dwordx4 v[24:27], v1, s[4:7], s37 offen offset:2048 sc1
  s_mov_b64 exec, -1
  s_waitcnt vmcnt(2)
  v_cmp_eq_u32 vcc, -1, v28
  s_cbranch_vccnz L_Oo_32_b302
L_Oo_32_k302:
  v_smfmac_f32_16x16x64_bf16 v[32:35], v[28:31], v[216:223], v2
  v_smfmac_f32_16x16x64_bf16 v[36:39], v[28:31], v[248:255], v2
  s_waitcnt vmcnt(1)
  v_cmp_eq_u32 vcc, -1, v16
  s_cbranch_vccnz L_Oo_32_b02
L_Oo_32_k02:
  v_smfmac_f32_16x16x64_bf16 v[32:35], v[16:19], v[192:199], v2
  v_smfmac_f32_16x16x64_bf16 v[36:39], v[16:19], v[224:231], v2
  s_waitcnt vmcnt(0)
  v_cmp_eq_u32 vcc, -1, v24
  s_cbranch_vccz L_Oo_32_k2
L_Oo_32_b2:
  s_mov_b64 exec, vcc
  buffer_load_dwordx4 v[24:27], v1, s[4:7], s37 offen offset:2048 sc1
  s_mov_b64 exec, -1
  s_add_u32 s27, s27, 1
  s_cmp_ge_u32 s27, 0x80000
  s_cbranch_scc1 L_Oo_32_e
  s_waitcnt vmcnt(0)
  v_cmp_eq_u32 vcc, -1, v24
  s_cbranch_vccz L_Oo_32_k2
  s_branch L_Oo_32_b2
L_Oo_32_b30:
  s_mov_b64 exec, vcc
  buffer_load_dwordx4 v[28:31], v1, s[4:7], s37 offen offset:3072 sc1
  s_mov_b64 exec, -1
  s_add_u32 s27, s27, 1
  s_cmp_ge_u32 s27, 0x80000
  s_cbranch_scc1 L_Oo_32_e
  s_waitcnt vmcnt(1)
  v_cmp_eq_u32 vcc, -1, v16
  s_cbranch_vccnz L_Oo_32_b03
L_Oo_32_k03:
  v_smfmac_f32_16x16x64_bf16 v[32:35], v[16:19], v[192:199], v2
  v_smfmac_f32_16x16x64_bf16 v[36:39], v[16:19], v[224:231], v2
  s_waitcnt vmcnt(0)
  v_cmp_eq_u32 vcc, -1, v28
  s_cbranch_vccz L_Oo_32_k3
  s_branch L_Oo_32_b3
L_Oo_32_b0:
  s_mov_b64 exec, vcc
  buffer_load_dwordx4 v[16:19], v1, s[4:7], s37 offen offset:0 sc1
  s_mov_b64 exec, -1
  s_add_u32 s27, s27, 1
  s_cmp_ge_u32 s27, 0x80000
  s_cbranch_scc1 L_Oo_32_e
  s_waitcnt vmcnt(0)
  v_cmp_eq_u32 vcc, -1, v16
  s_cbranch_vccz L_Oo_32_k0
  s_branch L_Oo_32_b0
L_Oo_32_b231:
  s_mov_b64 exec, vcc
  buffer_load_dwordx4 v[24:27], v1, s[4:7], s37 offen offset:2048 sc1
  s_mov_b64 exec, -1
  s_waitcnt vmcnt(2)
  v_cmp_eq_u32 vcc, -1, v28
  s_cbranch_vccnz L_Oo_32_b312
L_Oo_32_k312:
  v_smfmac_f32_16x16x64_bf16 v[32:35], v[28:31], v[216:223], v2
  v_smfmac_f32_16x16x64_bf16 v[36:39], v[28:31], v[248:255], v2
  s_waitcnt vmcnt(1)
  v_cmp_eq_u32 vcc, -1, v20
  s_cbranch_vccnz L_Oo_32_b12
L_Oo_32_k12:
  v_smfmac_f32_16x16x64_bf16 v[32:35], v[20:23], v[200:207], v2
  v_smfmac_f32_16x16x64_bf16 v[36:39], v[20:23], v[232:239], v2
  s_waitcnt vmcnt(0)
  v_cmp_eq_u32 vcc, -1, v24
  s_cbranch_vccz L_Oo_32_k2
  s_branch L_Oo_32_b2
L_Oo_32_b31:
  s_mov_b64 exec, vcc
  buffer_load_dwordx4 v[28:31], v1, s[4:7], s37 offen offset:3072 sc1
  s_mov_b64 exec, -1
  s_add_u32 s27, s27, 1
  s_cmp_ge_u32 s27, 0x80000
  s_cbranch_scc1 L_Oo_32_e
  s_waitcnt vmcnt(1)
  v_cmp_eq_u32 vcc, -1, v20
  s_cbranch_vccnz L_Oo_32_b13
L_Oo_32_k13:
  v_smfmac_f32_16x16x64_bf16 v[32:35], v[20:23], v[200:207], v2
  v_smfmac_f32_16x16x64_bf16 v[36:39], v[20:23], v[232:239], v2
  s_waitcnt vmcnt(0)
  v_cmp_eq_u32 vcc, -1, v28
  s_cbranch_vccz L_Oo_32_k3
  s_branch L_Oo_32_b3
L_Oo_32_b32:
  s_mov_b64 exec, vcc
  buffer_load_dwordx4 v[28:31], v1, s[4:7], s37 offen offset:3072 sc1
  s_mov_b64 exec, -1
  s_add_u32 s27, s27, 1
  s_cmp_ge_u32 s27, 0x80000
  s_cbranch_scc1 L_Oo_32_e
  s_waitcnt vmcnt(1)
  v_cmp_eq_u32 vcc, -1, v24
  s_cbranch_vccz L_Oo_32_k23
  s_branch L_Oo_32_b23
L_Oo_32_b2301:
  s_mov_b64 exec, vcc
  buffer_load_dwordx4 v[24:27], v1, s[4:7], s37 offen offset:2048 sc1
  s_mov_b64 exec, -1
  s_waitcnt vmcnt(3)
  v_cmp_eq_u32 vcc, -1, v28
  s_cbranch_vccnz L_Oo_32_b3012
L_Oo_32_k3012:
  v_smfmac_f32_16x16x64_bf16 v[32:35], v[28:31], v[216:223], v2
  v_smfmac_f32_16x16x64_bf16 v[36:39], v[28:31], v[248:255], v2
  s_waitcnt vmcnt(2)
  v_cmp_eq_u32 vcc, -1, v16
  s_cbranch_vccnz L_Oo_32_b012
L_Oo_32_k012:
  v_smfmac_f32_16x16x64_bf16 v[32:35], v[16:19], v[192:199], v2
  v_smfmac_f32_16x16x64_bf16 v[36:39], v[16:19], v[224:231], v2
  s_waitcnt vmcnt(1)
  v_cmp_eq_u32 vcc, -1, v20
  s_cbranch_vccz L_Oo_32_k12
L_Oo_32_b12:
  s_mov_b64 exec, vcc
  buffer_load_dwordx4 v[20:23], v1, s[4:7], s37 offen offset:1024 sc1
  s_mov_b64 exec, -1
  s_waitcnt vmcnt(1)
  v_cmp_eq_u32 vcc, -1, v24
  s_cbranch_vccnz L_Oo_32_b21
L_Oo_32_k21:
  v_smfmac_f32_16x16x64_bf16 v[32:35], v[24:27], v[208:215], v2
  v_smfmac_f32_16x16x64_bf16 v[36:39], v[24:27], v[240:247], v2
  s_waitcnt vmcnt(0)
  v_cmp_eq_u32 vcc, -1, v20
  s_cbranch_vccz L_Oo_32_k1
  s_branch L_Oo_32_b1
L_Oo_32_b301:
  s_mov_b64 exec, vcc
  buffer_load_dwordx4 v[28:31], v1, s[4:7], s37 offen offset:3072 sc1
  s_mov_b64 exec, -1
  s_add_u32 s27, s27, 1
  s_cmp_ge_u32 s27, 0x80000
  s_cbranch_scc1 L_Oo_32_e
  s_waitcnt vmcnt(2)
  v_cmp_eq_u32 vcc, -1, v16
  s_cbranch_vccnz L_Oo_32_b013
L_Oo_32_k013:
  v_smfmac_f32_16x16x64_bf16 v[32:35], v[16:19], v[192:199], v2
  v_smfmac_f32_16x16x64_bf16 v[36:39], v[16:19], v[224:231], v2
  s_waitcnt vmcnt(1)
  v_cmp_eq_u32 vcc, -1, v20
  s_cbranch_vccz L_Oo_32_k13
L_Oo_32_b13:
  s_mov_b64 exec, vcc
  buffer_load_dwordx4 v[20:23], v1, s[4:7], s37 offen offset:1024 sc1
  s_mov_b64 exec, -1
  s_waitcnt vmcnt(1)
  v_cmp_eq_u32 vcc, -1, v28
  s_cbranch_vccz L_Oo_32_k31
  s_branch L_Oo_32_b31
L_Oo_32_b01:
  s_mov_b64 exec, vcc
  buffer_load_dwordx4 v[16:19], v1, s[4:7], s37 offen offset:0 sc1
  s_mov_b64 exec, -1
  s_waitcnt vmcnt(1)
  v_cmp_eq_u32 vcc, -1, v20
  s_cbranch_vccnz L_Oo_32_b10
L_Oo_32_k10:
  v_smfmac_f32_16x16x64_bf16 v[32:35], v[20:23], v[200:207], v2
  v_smfmac_f32_16x16x64_bf16 v[36:39], v[20:23], v[232:239], v2
  s_waitcnt vmcnt(0)
  v_cmp_eq_u32 vcc, -1, v16
  s_cbranch_vccz L_Oo_32_k0
  s_branch L_Oo_32_b0
L_Oo_32_b302:
  s_mov_b64 exec, vcc
  buffer_load_dwordx4 v[28:31], v1, s[4:7], s37 offen offset:3072 sc1
  s_mov_b64 exec, -1
  s_add_u32 s27, s27, 1
  s_cmp_ge_u32 s27, 0x80000
  s_cbranch_scc1 L_Oo_32_e
  s_waitcnt vmcnt(2)
  v_cmp_eq_u32 vcc, -1, v16
  s_cbranch_vccnz L_Oo_32_b023
L_Oo_32_k023:
  v_smfmac_f32_16x16x64_bf16 v[32:35], v[16:19], v[192:199], v2
  v_smfmac_f32_16x16x64_bf16 v[36:39], v[16:19], v[224:231], v2
  s_waitcnt vmcnt(1)
  v_cmp_eq_u32 vcc, -1, v24
  s_cbranch_vccz L_Oo_32_k23
  s_branch L_Oo_32_b23
L_Oo_32_b02:
  s_mov_b64 exec, vcc
  buffer_load_dwordx4 v[16:19], v1, s[4:7], s37 offen offset:0 sc1
  s_mov_b64 exec, -1
  s_waitcnt vmcnt(1)
  v_cmp_eq_u32 vcc, -1, v24
  s_cbranch_vccnz L_Oo_32_b20
L_Oo_32_k20:
  v_smfmac_f32_16x16x64_bf16 v[32:35], v[24:27], v[208:215], v2
  v_smfmac_f32_16x16x64_bf16 v[36:39], v[24:27], v[240:247], v2
  s_waitcnt vmcnt(0)
  v_cmp_eq_u32 vcc, -1, v16
  s_cbranch_vccz L_Oo_32_k0
  s_branch L_Oo_32_b0
L_Oo_32_b03:
  s_mov_b64 exec, vcc
  buffer_load_dwordx4 v[16:19], v1, s[4:7], s37 offen offset:0 sc1
  s_mov_b64 exec, -1
  s_waitcnt vmcnt(1)
  v_cmp_eq_u32 vcc, -1, v28
  s_cbranch_vccz L_Oo_32_k30
  s_branch L_Oo_32_b30
L_Oo_32_b312:
  s_mov_b64 exec, vcc
  buffer_load_dwordx4 v[28:31], v1, s[4:7], s37 offen offset:3072 sc1
  s_mov_b64 exec, -1
  s_add_u32 s27, s27, 1
  s_cmp_ge_u32 s27, 0x80000
  s_cbranch_scc1 L_Oo_32_e
  s_waitcnt vmcnt(2)
  v_cmp_eq_u32 vcc, -1, v20
  s_cbranch_vccz L_Oo_32_k123
  s_branch L_Oo_32_b123
L_Oo_32_b3012:
  s_mov_b64 exec, vcc
  buffer_load_dwordx4 v[28:31], v1, s[4:7], s37 offen offset:3072 sc1
  s_mov_b64 exec, -1
  s_add_u32 s27, s27, 1
  s_cmp_ge_u32 s27, 0x80000
  s_cbranch_scc1 L_Oo_32_e
  s_waitcnt vmcnt(3)
  v_cmp_eq_u32 vcc, -1, v16
  s_cbranch_vccz L_Oo_32_k0123
  s_branch L_Oo_32_b0123
L_Oo_32_b012:
  s_mov_b64 exec, vcc
  buffer_load_dwordx4 v[16:19], v1, s[4:7], s37 offen offset:0 sc1
  s_mov_b64 exec, -1
  s_waitcnt vmcnt(2)
  v_cmp_eq_u32 vcc, -1, v20
  s_cbranch_vccnz L_Oo_32_b120
L_Oo_32_k120:
  v_smfmac_f32_16x16x64_bf16 v[32:35], v[20:23], v[200:207], v2
  v_smfmac_f32_16x16x64_bf16 v[36:39], v[20:23], v[232:239], v2
  s_waitcnt vmcnt(1)
  v_cmp_eq_u32 vcc, -1, v24
  s_cbranch_vccz L_Oo_32_k20
L_Oo_32_b20:
  s_mov_b64 exec, vcc
  buffer_load_dwordx4 v[24:27], v1, s[4:7], s37 offen offset:2048 sc1
  s_mov_b64 exec, -1
  s_add_u32 s27, s27, 1
  s_cmp_ge_u32 s27, 0x80000
  s_cbranch_scc1 L_Oo_32_e
  s_waitcnt vmcnt(1)
  v_cmp_eq_u32 vcc, -1, v16
  s_cbranch_vccz L_Oo_32_k02
  s_branch L_Oo_32_b02
L_Oo_32_b21:
  s_mov_b64 exec, vcc
  buffer_load_dwordx4 v[24:27], v1, s[4:7], s37 offen offset:2048 sc1
  s_mov_b64 exec, -1
  s_add_u32 s27, s27, 1
  s_cmp_ge_u32 s27, 0x80000
  s_cbranch_scc1 L_Oo_32_e
  s_waitcnt vmcnt(1)
  v_cmp_eq_u32 vcc, -1, v20
  s_cbranch_vccz L_Oo_32_k12
  s_branch L_Oo_32_b12
L_Oo_32_b013:
  s_mov_b64 exec, vcc
  buffer_load_dwordx4 v[16:19], v1, s[4:7], s37 offen offset:0 sc1
  s_mov_b64 exec, -1
  s_waitcnt vmcnt(2)
  v_cmp_eq_u32 vcc, -1, v20
  s_cbranch_vccnz L_Oo_32_b130
L_Oo_32_k130:
  v_smfmac_f32_16x16x64_bf16 v[32:35], v[20:23], v[200:207], v2
  v_smfmac_f32_16x16x64_bf16 v[36:39], v[20:23], v[232:239], v2
  s_waitcnt vmcnt(1)
  v_cmp_eq_u32 vcc, -1, v28
  s_cbranch_vccz L_Oo_32_k30
  s_branch L_Oo_32_b30
L_Oo_32_b10:
  s_mov_b64 exec, vcc
  buffer_load_dwordx4 v[20:23], v1, s[4:7], s37 offen offset:1024 sc1
  s_mov_b64 exec, -1
  s_add_u32 s27, s27, 1
  s_cmp_ge_u32 s27, 0x80000
  s_cbranch_scc1 L_Oo_32_e
  s_waitcnt vmcnt(1)
  v_cmp_eq_u32 vcc, -1, v16
  s_cbranch_vccz L_Oo_32_k01
  s_branch L_Oo_32_b01
L_Oo_32_b023:
  s_mov_b64 exec, vcc
  buffer_load_dwordx4 v[16:19], v1, s[4:7], s37 offen offset:0 sc1
  s_mov_b64 exec, -1
  s_waitcnt vmcnt(2)
  v_cmp_eq_u32 vcc, -1, v24
  s_cbranch_vccz L_Oo_32_k230
  s_branch L_Oo_32_b230
L_Oo_32_b120:
  s_mov_b64 exec, vcc
  buffer_load_dwordx4 v[20:23], v1, s[4:7], s37 offen offset:1024 sc1
  s_mov_b64 exec, -1
  s_waitcnt vmcnt(2)
  v_cmp_eq_u32 vcc, -1, v24
  s_cbranch_vccnz L_Oo_32_b201
L_Oo_32_k201:
  v_smfmac_f32_16x16x64_bf16 v[32:35], v[24:27], v[208:215], v2
  v_smfmac_f32_16x16x64_bf16 v[36:39], v[24:27], v[240:247], v2
  s_waitcnt vmcnt(1)
  v_cmp_eq_u32 vcc, -1, v16
  s_cbranch_vccz L_Oo_32_k01
  s_branch L_Oo_32_b01
L_Oo_32_b130:
  s_mov_b64 exec, vcc
  buffer_load_dwordx4 v[20:23], v1, s[4:7], s37 offen offset:1024 sc1
  s_mov_b64 exec, -1
  s_waitcnt vmcnt(2)
  v_cmp_eq_u32 vcc, -1, v28
  s_cbranch_vccz L_Oo_32_k301
  s_branch L_Oo_32_b301
L_Oo_32_b201:
  s_mov_b64 exec, vcc
  buffer_load_dwordx4 v[24:27], v1, s[4:7], s37 offen offset:2048 sc1
  s_mov_b64 exec, -1
  s_add_u32 s27, s27, 1
  s_cmp_ge_u32 s27, 0x80000
  s_cbranch_scc1 L_Oo_32_e
  s_waitcnt vmcnt(2)
  v_cmp_eq_u32 vcc, -1, v16
  s_cbranch_vccz L_Oo_32_k012
  s_branch L_Oo_32_b012
L_Oxr_35:
  s_add_u32 s27, s27, 1
  s_cmp_ge_u32 s27, 0x80000
  s_cbranch_scc1 L_Oxc_34
  s_mov_b64 exec, vcc
  buffer_load_dwordx4 v[84:87], v57, s[4:7], s40 offen sc1
  buffer_load_dwordx4 v[88:91], v58, s[4:7], s40 offen sc1
  buffer_load_dwordx4 v[92:95], v59, s[4:7], s40 offen sc1
  s_mov_b64 exec, -1
  s_branch L_Ox_33
L_O6:
  s_lshl_b32 s28, s46, 7
  s_lshl_b32 s29, s47, 3
  s_add_u32 s28, s28, s29
  s_add_u32 s28, s28, 84946944
  v_mov_b32 v13, s28
  v_mov_b32 v14, 0
  s_lshr_b32 s28, s46, 1
  s_lshl_b32 s28, s28, 2
  s_add_u32 s28, s28, 84934656
  v_mov_b32 v15, s28
  s_lshl_b32 s28, s25, 11
  s_add_u32 s53, s28, 262144
  s_lshl_b32 s42, s46, 19
  s_xor_b32 s28, s47, 0
  s_lshl_b32 s28, s28, 11
  s_add_u32 s42, s42, s28
  v_lshrrev_b32 v5, 5, v0
  v_and_b32 v6, 1, v11
  v_lshlrev_b32 v11, 13, v6
  v_lshl_add_u32 v11, v5, 9, v11
  v_lshl_add_u32 v11, v10, 4, v11
  v_add_u32 v11, 24576, v11
  v_and_b32 v12, 31, v0
  v_lshlrev_b32 v12, 4, v12
  v_lshl_add_u32 v12, v5, 22, v12
  s_lshl_b32 s28, s47, 9
  s_add_u32 s28, s28, 67108864
  v_add_u32 v12, s28, v12
  v_lshlrev_b32 v6, 10, v5
  v_xor_b32 v12, v12, v6
  s_lshl_b32 s43, s46, 17
  v_mov_b32 v44, -1
  v_mov_b32 v45, -1
  v_mov_b32 v46, -1
  v_mov_b32 v47, -1
  v_lshlrev_b32 v10, 4, v0
  s_mov_b32 s54, s42
  s_add_u32 s42, s42, 98304
  buffer_store_dwordx4 v[44:47], v12, s[4:7], s43 offen sc1
  s_add_u32 s43, s43, 2048
  buffer_store_dwordx4 v[44:47], v12, s[4:7], s43 offen sc1
  s_add_u32 s43, s43, 2048
  buffer_store_dwordx4 v[44:47], v12, s[4:7], s43 offen sc1
  s_add_u32 s43, s43, 2048
  buffer_store_dwordx4 v[44:47], v12, s[4:7], s43 offen sc1
  s_add_u32 s43, s43, 2048
  buffer_store_dwordx4 v[44:47], v12, s[4:7], s43 offen sc1
  s_add_u32 s43, s43, 2048
  buffer_store_dwordx4 v[44:47], v12, s[4:7], s43 offen sc1
  s_add_u32 s43, s43, 2048
  buffer_store_dwordx4 v[44:47], v12, s[4:7], s43 offen sc1
  s_add_u32 s43, s43, 2048
  buffer_store_dwordx4 v[44:47], v12, s[4:7], s43 offen sc1
  s_add_u32 s43, s43, 2048
  buffer_store_dwordx4 v[44:47], v12, s[4:7], s43 offen sc1
  s_add_u32 s43, s43, 2048
  buffer_store_dwordx4 v[44:47], v12, s[4:7], s43 offen sc1
  s_add_u32 s43, s43, 2048
  buffer_store_dwordx4 v[44:47], v12, s[4:7], s43 offen sc1
  s_add_u32 s43, s43, 2048
  buffer_store_dwordx4 v[44:47], v12, s[4:7], s43 offen sc1
  s_add_u32 s43, s43, 2048
  s_waitcnt vmcnt(25)
  ds_write_b128 v60, v[192:195] offset:0
  ds_write_b128 v60, v[196:199] offset:1024
  ds_write_b128 v60, v[224:227] offset:2048
  ds_write_b128 v60, v[228:231] offset:3072
  ds_read_b64_tr_b16 v[192:193], v61 offset:0
  ds_read_b64_tr_b16 v[194:195], v61 offset:128
  ds_read_b64_tr_b16 v[196:197], v61 offset:2048
  ds_read_b64_tr_b16 v[198:199], v61 offset:2176
  ds_read_b64_tr_b16 v[224:225], v61 offset:32
  ds_read_b64_tr_b16 v[226:227], v61 offset:160
  ds_read_b64_tr_b16 v[228:229], v61 offset:2080
  ds_read_b64_tr_b16 v[230:231], v61 offset:2208
  s_waitcnt vmcnt(21)
  ds_write_b128 v60, v[200:203] offset:0
  ds_write_b128 v60, v[204:207] offset:1024
  ds_write_b128 v60, v[232:235] offset:2048
  ds_write_b128 v60, v[236:239] offset:3072
  ds_read_b64_tr_b16 v[200:201], v61 offset:0
  ds_read_b64_tr_b16 v[202:203], v61 offset:128
  ds_read_b64_tr_b16 v[204:205], v61 offset:2048
  ds_read_b64_tr_b16 v[206:207], v61 offset:2176
  ds_read_b64_tr_b16 v[232:233], v61 offset:32
  ds_read_b64_tr_b16 v[234:235], v61 offset:160
  ds_read_b64_tr_b16 v[236:237], v61 offset:2080
  ds_read_b64_tr_b16 v[238:239], v61 offset:2208
  s_waitcnt vmcnt(16)
  ds_write_b128 v60, v[208:211] offset:0
  ds_write_b128 v60, v[212:215] offset:1024
  ds_write_b128 v60, v[240:243] offset:2048
  ds_write_b128 v60, v[244:247] offset:3072
  ds_read_b64_tr_b16 v[208:209], v61 offset:0
  ds_read_b64_tr_b16 v[210:211], v61 offset:128
  ds_read_b64_tr_b16 v[212:213], v61 offset:2048
  ds_read_b64_tr_b16 v[214:215], v61 offset:2176
  ds_read_b64_tr_b16 v[240:241], v61 offset:32
  ds_read_b64_tr_b16 v[242:243], v61 offset:160
  ds_read_b64_tr_b16 v[244:245], v61 offset:2080
  ds_read_b64_tr_b16 v[246:247], v61 offset:2208
  s_waitcnt vmcnt(12)
  ds_write_b128 v60, v[216:219] offset:0
  ds_write_b128 v60, v[220:223] offset:1024
  ds_write_b128 v60, v[248:251] offset:2048
  ds_write_b128 v60, v[252:255] offset:3072
  ds_read_b64_tr_b16 v[216:217], v61 offset:0
  ds_read_b64_tr_b16 v[218:219], v61 offset:128
  ds_read_b64_tr_b16 v[220:221], v61 offset:2048
  ds_read_b64_tr_b16 v[222:223], v61 offset:2176
  ds_read_b64_tr_b16 v[248:249], v61 offset:32
  ds_read_b64_tr_b16 v[250:251], v61 offset:160
  ds_read_b64_tr_b16 v[252:253], v61 offset:2080
  ds_read_b64_tr_b16 v[254:255], v61 offset:2208
  s_setprio 2
  s_waitcnt lgkmcnt(0)
  s_barrier
  ds_read_b128 v[64:67], v11 offset:0
  ds_read_b128 v[68:71], v11 offset:256
  ds_read_b128 v[72:75], v11 offset:1024
  ds_read_b128 v[76:79], v11 offset:1280
  ds_read_b128 v[80:83], v11 offset:2048
  ds_read_b128 v[84:87], v11 offset:2304
  ds_read_b128 v[88:91], v11 offset:3072
  ds_read_b128 v[92:95], v11 offset:3328
  s_waitcnt lgkmcnt(4)
  ds_read_b128 v[96:99], v11 offset:4096
  ds_read_b128 v[100:103], v11 offset:4352
  ds_read_b128 v[104:107], v11 offset:5120
  ds_read_b128 v[108:111], v11 offset:5376
  ds_read_b128 v[112:115], v11 offset:6144
  ds_read_b128 v[116:119], v11 offset:6400
  ds_read_b128 v[120:123], v11 offset:7168
  ds_read_b128 v[124:127], v11 offset:7424
  v_pk_add_f32 v[64:65], v[64:65], v[72:73]
  v_pk_add_f32 v[66:67], v[66:67], v[74:75]
  v_pk_add_f32 v[68:69], v[68:69], v[76:77]
  v_pk_add_f32 v[70:71], v[70:71], v[78:79]
  s_waitcnt lgkmcnt(8)
  v_pk_add_f32 v[80:81], v[80:81], v[88:89]
  v_pk_add_f32 v[82:83], v[82:83], v[90:91]
  v_pk_add_f32 v[84:85], v[84:85], v[92:93]
  v_pk_add_f32 v[86:87], v[86:87], v[94:95]
  v_pk_add_f32 v[64:65], v[64:65], v[80:81]
  v_pk_add_f32 v[66:67], v[66:67], v[82:83]
  v_pk_add_f32 v[68:69], v[68:69], v[84:85]
  v_pk_add_f32 v[70:71], v[70:71], v[86:87]
  v_cvt_pk_bf16_f32 v128, v64, v65
  v_cvt_pk_bf16_f32 v129, v66, v67
  v_cvt_pk_bf16_f32 v130, v68, v69
  v_cvt_pk_bf16_f32 v131, v70, v71
  ds_write_b128 v10, v[128:131] offset:18432
  s_waitcnt lgkmcnt(5)
  v_pk_add_f32 v[96:97], v[96:97], v[104:105]
  v_pk_add_f32 v[98:99], v[98:99], v[106:107]
  v_pk_add_f32 v[100:101], v[100:101], v[108:109]
  v_pk_add_f32 v[102:103], v[102:103], v[110:111]
  s_waitcnt lgkmcnt(1)
  v_pk_add_f32 v[112:113], v[112:113], v[120:121]
  v_pk_add_f32 v[114:115], v[114:115], v[122:123]
  v_pk_add_f32 v[116:117], v[116:117], v[124:125]
  v_pk_add_f32 v[118:119], v[118:119], v[126:127]
  v_pk_add_f32 v[96:97], v[96:97], v[112:113]
  v_pk_add_f32 v[98:99], v[98:99], v[114:115]
  v_pk_add_f32 v[100:101], v[100:101], v[116:117]
  v_pk_add_f32 v[102:103], v[102:103], v[118:119]
  v_cvt_pk_bf16_f32 v132, v96, v97
  v_cvt_pk_bf16_f32 v133, v98, v99
  v_cvt_pk_bf16_f32 v134, v100, v101
  v_cvt_pk_bf16_f32 v135, v102, v103
  ds_write_b128 v10, v[132:135] offset:19456
  s_waitcnt lgkmcnt(0)
  s_barrier
.p2align 6
L_O6_loopf:
  s_add_u32 s28, s36, 0
  s_and_b32 s28, s28, 3
  s_lshl_b32 s28, s28, 17
  s_add_u32 s37, s44, s28
  v_mov_b32 v32, 0
  v_mov_b32 v33, 0
  v_mov_b32 v34, 0
  v_mov_b32 v35, 0
  v_mov_b32 v36, 0
  v_mov_b32 v37, 0
  v_mov_b32 v38, 0
  v_mov_b32 v39, 0
  s_cmp_eq_u32 s36, 63
  s_cbranch_scc1 L_O6_lastf
  s_barrier
  s_cmp_ge_u32 s36, 11
  s_cbranch_scc1 L_O6_nw
  s_buffer_load_dword s29, s[16:19], s53 offset:1024
  s_buffer_load_dword s29, s[16:19], s53 offset:1152
  s_buffer_load_dword s29, s[16:19], s53 offset:1280
  s_buffer_load_dword s29, s[16:19], s53 offset:1408
  s_buffer_load_dword s29, s[16:19], s53 offset:1536
  s_buffer_load_dword s29, s[16:19], s53 offset:1664
  s_buffer_load_dword s29, s[16:19], s53 offset:1792
  s_buffer_load_dword s29, s[16:19], s53 offset:1920
  s_branch L_O6_nw2
L_O6_nw:
  s_mov_b32 m0, 18432
  s_nop 0
  buffer_load_dwordx4 v10, s[4:7], s42 offen offset:0 lds
  buffer_load_dwordx4 v10, s[4:7], s42 offen offset:1024 lds
  s_add_u32 s42, s42, 8192
L_O6_nw2:
  s_barrier
  s_barrier
  s_nop 15
  s_nop 13
  buffer_load_dwordx4 v[16:19], v1, s[4:7], s37 offen offset:0 sc1
  s_nop 3
  buffer_load_dwordx4 v[20:23], v1, s[4:7], s37 offen offset:1024 sc1
  s_nop 3
  buffer_load_dwordx4 v[24:27], v1, s[4:7], s37 offen offset:2048 sc1
  s_nop 3
  buffer_load_dwordx4 v[28:31], v1, s[4:7], s37 offen offset:3072 sc1
  s_waitcnt vmcnt(3)
  v_cmp_eq_u32 vcc, -1, v16
  s_cbranch_vccnz L_Oo_36_b0123
L_Oo_36_k0123:
  v_smfmac_f32_16x16x64_bf16 v[32:35], v[16:19], v[192:199], v2
  v_smfmac_f32_16x16x64_bf16 v[36:39], v[16:19], v[224:231], v2
  s_waitcnt vmcnt(2)
  v_cmp_eq_u32 vcc, -1, v20
  s_cbranch_vccnz L_Oo_36_b123
L_Oo_36_k123:
  v_smfmac_f32_16x16x64_bf16 v[32:35], v[20:23], v[200:207], v2
  v_smfmac_f32_16x16x64_bf16 v[36:39], v[20:23], v[232:239], v2
  s_waitcnt vmcnt(1)
  v_cmp_eq_u32 vcc, -1, v24
  s_cbranch_vccnz L_Oo_36_b23
L_Oo_36_k23:
  v_smfmac_f32_16x16x64_bf16 v[32:35], v[24:27], v[208:215], v2
  v_smfmac_f32_16x16x64_bf16 v[36:39], v[24:27], v[240:247], v2
  s_waitcnt vmcnt(0)
  v_cmp_eq_u32 vcc, -1, v28
  s_cbranch_vccnz L_Oo_36_b3
L_Oo_36_k3:
  v_smfmac_f32_16x16x64_bf16 v[32:35], v[28:31], v[216:223], v2
  v_smfmac_f32_16x16x64_bf16 v[36:39], v[28:31], v[248:255], v2
L_Oo_36_e:
  s_nop 6
  v_add_f32 v32, v32, v33
  v_add_f32 v34, v34, v35
  ds_write2_b32 v3, v32, v34 offset0:0 offset1:40
  v_add_f32 v36, v36, v37
  v_add_f32 v38, v38, v39
  ds_write2_b32 v3, v36, v38 offset0:16 offset1:56
  s_waitcnt lgkmcnt(0)
  s_barrier
  s_barrier
  s_add_u32 s28, s36, 4
  s_and_b32 s28, s28, 3
  s_cmp_lt_u32 s28, 2
  s_cbranch_scc1 L_O6_f
L_O6_fk:
  s_cmp_le_u32 s36, 12
  s_cbranch_scc1 L_O6_x
L_O6_nx:
L_O6_c:
  s_barrier
  s_add_u32 s36, s36, 1
  s_branch L_O6_loopf
L_O6_lastf:
  s_branch L_R_done
L_Oo_36_b0123:
  s_mov_b64 exec, vcc
  buffer_load_dwordx4 v[16:19], v1, s[4:7], s37 offen offset:0 sc1
  s_mov_b64 exec, -1
  s_waitcnt vmcnt(3)
  v_cmp_eq_u32 vcc, -1, v20
  s_cbranch_vccnz L_Oo_36_b1230
L_Oo_36_k1230:
  v_smfmac_f32_16x16x64_bf16 v[32:35], v[20:23], v[200:207], v2
  v_smfmac_f32_16x16x64_bf16 v[36:39], v[20:23], v[232:239], v2
  s_waitcnt vmcnt(2)
  v_cmp_eq_u32 vcc, -1, v24
  s_cbranch_vccnz L_Oo_36_b230
L_Oo_36_k230:
  v_smfmac_f32_16x16x64_bf16 v[32:35], v[24:27], v[208:215], v2
  v_smfmac_f32_16x16x64_bf16 v[36:39], v[24:27], v[240:247], v2
  s_waitcnt vmcnt(1)
  v_cmp_eq_u32 vcc, -1, v28
  s_cbranch_vccnz L_Oo_36_b30
L_Oo_36_k30:
  v_smfmac_f32_16x16x64_bf16 v[32:35], v[28:31], v[216:223], v2
  v_smfmac_f32_16x16x64_bf16 v[36:39], v[28:31], v[248:255], v2
  s_waitcnt vmcnt(0)
  v_cmp_eq_u32 vcc, -1, v16
  s_cbranch_vccnz L_Oo_36_b0
L_Oo_36_k0:
  v_smfmac_f32_16x16x64_bf16 v[32:35], v[16:19], v[192:199], v2
  v_smfmac_f32_16x16x64_bf16 v[36:39], v[16:19], v[224:231], v2
  s_branch L_Oo_36_e
L_Oo_36_b123:
  s_mov_b64 exec, vcc
  buffer_load_dwordx4 v[20:23], v1, s[4:7], s37 offen offset:1024 sc1
  s_mov_b64 exec, -1
  s_waitcnt vmcnt(2)
  v_cmp_eq_u32 vcc, -1, v24
  s_cbranch_vccnz L_Oo_36_b231
L_Oo_36_k231:
  v_smfmac_f32_16x16x64_bf16 v[32:35], v[24:27], v[208:215], v2
  v_smfmac_f32_16x16x64_bf16 v[36:39], v[24:27], v[240:247], v2
  s_waitcnt vmcnt(1)
  v_cmp_eq_u32 vcc, -1, v28
  s_cbranch_vccnz L_Oo_36_b31
L_Oo_36_k31:
  v_smfmac_f32_16x16x64_bf16 v[32:35], v[28:31], v[216:223], v2
  v_smfmac_f32_16x16x64_bf16 v[36:39], v[28:31], v[248:255], v2
  s_waitcnt vmcnt(0)
  v_cmp_eq_u32 vcc, -1, v20
  s_cbranch_vccnz L_Oo_36_b1
L_Oo_36_k1:
  v_smfmac_f32_16x16x64_bf16 v[32:35], v[20:23], v[200:207], v2
  v_smfmac_f32_16x16x64_bf16 v[36:39], v[20:23], v[232:239], v2
  s_branch L_Oo_36_e
L_Oo_36_b23:
  s_mov_b64 exec, vcc
  buffer_load_dwordx4 v[24:27], v1, s[4:7], s37 offen offset:2048 sc1
  s_mov_b64 exec, -1
  s_waitcnt vmcnt(1)
  v_cmp_eq_u32 vcc, -1, v28
  s_cbranch_vccnz L_Oo_36_b32
L_Oo_36_k32:
  v_smfmac_f32_16x16x64_bf16 v[32:35], v[28:31], v[216:223], v2
  v_smfmac_f32_16x16x64_bf16 v[36:39], v[28:31], v[248:255], v2
  s_waitcnt vmcnt(0)
  v_cmp_eq_u32 vcc, -1, v24
  s_cbranch_vccnz L_Oo_36_b2
L_Oo_36_k2:
  v_smfmac_f32_16x16x64_bf16 v[32:35], v[24:27], v[208:215], v2
  v_smfmac_f32_16x16x64_bf16 v[36:39], v[24:27], v[240:247], v2
  s_branch L_Oo_36_e
L_Oo_36_b3:
  s_mov_b64 exec, vcc
  buffer_load_dwordx4 v[28:31], v1, s[4:7], s37 offen offset:3072 sc1
  s_mov_b64 exec, -1
  s_add_u32 s27, s27, 1
  s_cmp_ge_u32 s27, 0x80000
  s_cbranch_scc1 L_Oo_36_e
  s_waitcnt vmcnt(0)
  v_cmp_eq_u32 vcc, -1, v28
  s_cbranch_vccz L_Oo_36_k3
  s_branch L_Oo_36_b3
L_Oo_36_b1230:
  s_mov_b64 exec, vcc
  buffer_load_dwordx4 v[20:23], v1, s[4:7], s37 offen offset:1024 sc1
  s_mov_b64 exec, -1
  s_waitcnt vmcnt(3)
  v_cmp_eq_u32 vcc, -1, v24
  s_cbranch_vccnz L_Oo_36_b2301
L_Oo_36_k2301:
  v_smfmac_f32_16x16x64_bf16 v[32:35], v[24:27], v[208:215], v2
  v_smfmac_f32_16x16x64_bf16 v[36:39], v[24:27], v[240:247], v2
  s_waitcnt vmcnt(2)
  v_cmp_eq_u32 vcc, -1, v28
  s_cbranch_vccnz L_Oo_36_b301
L_Oo_36_k301:
  v_smfmac_f32_16x16x64_bf16 v[32:35], v[28:31], v[216:223], v2
  v_smfmac_f32_16x16x64_bf16 v[36:39], v[28:31], v[248:255], v2
  s_waitcnt vmcnt(1)
  v_cmp_eq_u32 vcc, -1, v16
  s_cbranch_vccnz L_Oo_36_b01
L_Oo_36_k01:
  v_smfmac_f32_16x16x64_bf16 v[32:35], v[16:19], v[192:199], v2
  v_smfmac_f32_16x16x64_bf16 v[36:39], v[16:19], v[224:231], v2
  s_waitcnt vmcnt(0)
  v_cmp_eq_u32 vcc, -1, v20
  s_cbranch_vccz L_Oo_36_k1
L_Oo_36_b1:
  s_mov_b64 exec, vcc
  buffer_load_dwordx4 v[20:23], v1, s[4:7], s37 offen offset:1024 sc1
  s_mov_b64 exec, -1
  s_add_u32 s27, s27, 1
  s_cmp_ge_u32 s27, 0x80000
  s_cbranch_scc1 L_Oo_36_e
  s_waitcnt vmcnt(0)
  v_cmp_eq_u32 vcc, -1, v20
  s_cbranch_vccz L_Oo_36_k1
  s_branch L_Oo_36_b1
L_Oo_36_b230:
  s_mov_b64 exec, vcc
  buffer_load_dwordx4 v[24:27], v1, s[4:7], s37 offen offset:2048 sc1
  s_mov_b64 exec, -1
  s_waitcnt vmcnt(2)
  v_cmp_eq_u32 vcc, -1, v28
  s_cbranch_vccnz L_Oo_36_b302
L_Oo_36_k302:
  v_smfmac_f32_16x16x64_bf16 v[32:35], v[28:31], v[216:223], v2
  v_smfmac_f32_16x16x64_bf16 v[36:39], v[28:31], v[248:255], v2
  s_waitcnt vmcnt(1)
  v_cmp_eq_u32 vcc, -1, v16
  s_cbranch_vccnz L_Oo_36_b02
L_Oo_36_k02:
  v_smfmac_f32_16x16x64_bf16 v[32:35], v[16:19], v[192:199], v2
  v_smfmac_f32_16x16x64_bf16 v[36:39], v[16:19], v[224:231], v2
  s_waitcnt vmcnt(0)
  v_cmp_eq_u32 vcc, -1, v24
  s_cbranch_vccz L_Oo_36_k2
L_Oo_36_b2:
  s_mov_b64 exec, vcc
  buffer_load_dwordx4 v[24:27], v1, s[4:7], s37 offen offset:2048 sc1
  s_mov_b64 exec, -1
  s_add_u32 s27, s27, 1
  s_cmp_ge_u32 s27, 0x80000
  s_cbranch_scc1 L_Oo_36_e
  s_waitcnt vmcnt(0)
  v_cmp_eq_u32 vcc, -1, v24
  s_cbranch_vccz L_Oo_36_k2
  s_branch L_Oo_36_b2
L_Oo_36_b30:
  s_mov_b64 exec, vcc
  buffer_load_dwordx4 v[28:31], v1, s[4:7], s37 offen offset:3072 sc1
  s_mov_b64 exec, -1
  s_add_u32 s27, s27, 1
  s_cmp_ge_u32 s27, 0x80000
  s_cbranch_scc1 L_Oo_36_e
  s_waitcnt vmcnt(1)
  v_cmp_eq_u32 vcc, -1, v16
  s_cbranch_vccnz L_Oo_36_b03
L_Oo_36_k03:
  v_smfmac_f32_16x16x64_bf16 v[32:35], v[16:19], v[192:199], v2
  v_smfmac_f32_16x16x64_bf16 v[36:39], v[16:19], v[224:231], v2
  s_waitcnt vmcnt(0)
  v_cmp_eq_u32 vcc, -1, v28
  s_cbranch_vccz L_Oo_36_k3
  s_branch L_Oo_36_b3
L_Oo_36_b0:
  s_mov_b64 exec, vcc
  buffer_load_dwordx4 v[16:19], v1, s[4:7], s37 offen offset:0 sc1
  s_mov_b64 exec, -1
  s_add_u32 s27, s27, 1
  s_cmp_ge_u32 s27, 0x80000
  s_cbranch_scc1 L_Oo_36_e
  s_waitcnt vmcnt(0)
  v_cmp_eq_u32 vcc, -1, v16
  s_cbranch_vccz L_Oo_36_k0
  s_branch L_Oo_36_b0
L_Oo_36_b231:
  s_mov_b64 exec, vcc
  buffer_load_dwordx4 v[24:27], v1, s[4:7], s37 offen offset:2048 sc1
  s_mov_b64 exec, -1
  s_waitcnt vmcnt(2)
  v_cmp_eq_u32 vcc, -1, v28
  s_cbranch_vccnz L_Oo_36_b312
L_Oo_36_k312:
  v_smfmac_f32_16x16x64_bf16 v[32:35], v[28:31], v[216:223], v2
  v_smfmac_f32_16x16x64_bf16 v[36:39], v[28:31], v[248:255], v2
  s_waitcnt vmcnt(1)
  v_cmp_eq_u32 vcc, -1, v20
  s_cbranch_vccnz L_Oo_36_b12
L_Oo_36_k12:
  v_smfmac_f32_16x16x64_bf16 v[32:35], v[20:23], v[200:207], v2
  v_smfmac_f32_16x16x64_bf16 v[36:39], v[20:23], v[232:239], v2
  s_waitcnt vmcnt(0)
  v_cmp_eq_u32 vcc, -1, v24
  s_cbranch_vccz L_Oo_36_k2
  s_branch L_Oo_36_b2
L_Oo_36_b31:
  s_mov_b64 exec, vcc
  buffer_load_dwordx4 v[28:31], v1, s[4:7], s37 offen offset:3072 sc1
  s_mov_b64 exec, -1
  s_add_u32 s27, s27, 1
  s_cmp_ge_u32 s27, 0x80000
  s_cbranch_scc1 L_Oo_36_e
  s_waitcnt vmcnt(1)
  v_cmp_eq_u32 vcc, -1, v20
  s_cbranch_vccnz L_Oo_36_b13
L_Oo_36_k13:
  v_smfmac_f32_16x16x64_bf16 v[32:35], v[20:23], v[200:207], v2
  v_smfmac_f32_16x16x64_bf16 v[36:39], v[20:23], v[232:239], v2
  s_waitcnt vmcnt(0)
  v_cmp_eq_u32 vcc, -1, v28
  s_cbranch_vccz L_Oo_36_k3
  s_branch L_Oo_36_b3
L_Oo_36_b32:
  s_mov_b64 exec, vcc
  buffer_load_dwordx4 v[28:31], v1, s[4:7], s37 offen offset:3072 sc1
  s_mov_b64 exec, -1
  s_add_u32 s27, s27, 1
  s_cmp_ge_u32 s27, 0x80000
  s_cbranch_scc1 L_Oo_36_e
  s_waitcnt vmcnt(1)
  v_cmp_eq_u32 vcc, -1, v24
  s_cbranch_vccz L_Oo_36_k23
  s_branch L_Oo_36_b23
L_Oo_36_b2301:
  s_mov_b64 exec, vcc
  buffer_load_dwordx4 v[24:27], v1, s[4:7], s37 offen offset:2048 sc1
  s_mov_b64 exec, -1
  s_waitcnt vmcnt(3)
  v_cmp_eq_u32 vcc, -1, v28
  s_cbranch_vccnz L_Oo_36_b3012
L_Oo_36_k3012:
  v_smfmac_f32_16x16x64_bf16 v[32:35], v[28:31], v[216:223], v2
  v_smfmac_f32_16x16x64_bf16 v[36:39], v[28:31], v[248:255], v2
  s_waitcnt vmcnt(2)
  v_cmp_eq_u32 vcc, -1, v16
  s_cbranch_vccnz L_Oo_36_b012
L_Oo_36_k012:
  v_smfmac_f32_16x16x64_bf16 v[32:35], v[16:19], v[192:199], v2
  v_smfmac_f32_16x16x64_bf16 v[36:39], v[16:19], v[224:231], v2
  s_waitcnt vmcnt(1)
  v_cmp_eq_u32 vcc, -1, v20
  s_cbranch_vccz L_Oo_36_k12
L_Oo_36_b12:
  s_mov_b64 exec, vcc
  buffer_load_dwordx4 v[20:23], v1, s[4:7], s37 offen offset:1024 sc1
  s_mov_b64 exec, -1
  s_waitcnt vmcnt(1)
  v_cmp_eq_u32 vcc, -1, v24
  s_cbranch_vccnz L_Oo_36_b21
L_Oo_36_k21:
  v_smfmac_f32_16x16x64_bf16 v[32:35], v[24:27], v[208:215], v2
  v_smfmac_f32_16x16x64_bf16 v[36:39], v[24:27], v[240:247], v2
  s_waitcnt vmcnt(0)
  v_cmp_eq_u32 vcc, -1, v20
  s_cbranch_vccz L_Oo_36_k1
  s_branch L_Oo_36_b1
L_Oo_36_b301:
  s_mov_b64 exec, vcc
  buffer_load_dwordx4 v[28:31], v1, s[4:7], s37 offen offset:3072 sc1
  s_mov_b64 exec, -1
  s_add_u32 s27, s27, 1
  s_cmp_ge_u32 s27, 0x80000
  s_cbranch_scc1 L_Oo_36_e
  s_waitcnt vmcnt(2)
  v_cmp_eq_u32 vcc, -1, v16
  s_cbranch_vccnz L_Oo_36_b013
L_Oo_36_k013:
  v_smfmac_f32_16x16x64_bf16 v[32:35], v[16:19], v[192:199], v2
  v_smfmac_f32_16x16x64_bf16 v[36:39], v[16:19], v[224:231], v2
  s_waitcnt vmcnt(1)
  v_cmp_eq_u32 vcc, -1, v20
  s_cbranch_vccz L_Oo_36_k13
L_Oo_36_b13:
  s_mov_b64 exec, vcc
  buffer_load_dwordx4 v[20:23], v1, s[4:7], s37 offen offset:1024 sc1
  s_mov_b64 exec, -1
  s_waitcnt vmcnt(1)
  v_cmp_eq_u32 vcc, -1, v28
  s_cbranch_vccz L_Oo_36_k31
  s_branch L_Oo_36_b31
L_Oo_36_b01:
  s_mov_b64 exec, vcc
  buffer_load_dwordx4 v[16:19], v1, s[4:7], s37 offen offset:0 sc1
  s_mov_b64 exec, -1
  s_waitcnt vmcnt(1)
  v_cmp_eq_u32 vcc, -1, v20
  s_cbranch_vccnz L_Oo_36_b10
L_Oo_36_k10:
  v_smfmac_f32_16x16x64_bf16 v[32:35], v[20:23], v[200:207], v2
  v_smfmac_f32_16x16x64_bf16 v[36:39], v[20:23], v[232:239], v2
  s_waitcnt vmcnt(0)
  v_cmp_eq_u32 vcc, -1, v16
  s_cbranch_vccz L_Oo_36_k0
  s_branch L_Oo_36_b0
L_Oo_36_b302:
  s_mov_b64 exec, vcc
  buffer_load_dwordx4 v[28:31], v1, s[4:7], s37 offen offset:3072 sc1
  s_mov_b64 exec, -1
  s_add_u32 s27, s27, 1
  s_cmp_ge_u32 s27, 0x80000
  s_cbranch_scc1 L_Oo_36_e
  s_waitcnt vmcnt(2)
  v_cmp_eq_u32 vcc, -1, v16
  s_cbranch_vccnz L_Oo_36_b023
L_Oo_36_k023:
  v_smfmac_f32_16x16x64_bf16 v[32:35], v[16:19], v[192:199], v2
  v_smfmac_f32_16x16x64_bf16 v[36:39], v[16:19], v[224:231], v2
  s_waitcnt vmcnt(1)
  v_cmp_eq_u32 vcc, -1, v24
  s_cbranch_vccz L_Oo_36_k23
  s_branch L_Oo_36_b23
L_Oo_36_b02:
  s_mov_b64 exec, vcc
  buffer_load_dwordx4 v[16:19], v1, s[4:7], s37 offen offset:0 sc1
  s_mov_b64 exec, -1
  s_waitcnt vmcnt(1)
  v_cmp_eq_u32 vcc, -1, v24
  s_cbranch_vccnz L_Oo_36_b20
L_Oo_36_k20:
  v_smfmac_f32_16x16x64_bf16 v[32:35], v[24:27], v[208:215], v2
  v_smfmac_f32_16x16x64_bf16 v[36:39], v[24:27], v[240:247], v2
  s_waitcnt vmcnt(0)
  v_cmp_eq_u32 vcc, -1, v16
  s_cbranch_vccz L_Oo_36_k0
  s_branch L_Oo_36_b0
L_Oo_36_b03:
  s_mov_b64 exec, vcc
  buffer_load_dwordx4 v[16:19], v1, s[4:7], s37 offen offset:0 sc1
  s_mov_b64 exec, -1
  s_waitcnt vmcnt(1)
  v_cmp_eq_u32 vcc, -1, v28
  s_cbranch_vccz L_Oo_36_k30
  s_branch L_Oo_36_b30
L_Oo_36_b312:
  s_mov_b64 exec, vcc
  buffer_load_dwordx4 v[28:31], v1, s[4:7], s37 offen offset:3072 sc1
  s_mov_b64 exec, -1
  s_add_u32 s27, s27, 1
  s_cmp_ge_u32 s27, 0x80000
  s_cbranch_scc1 L_Oo_36_e
  s_waitcnt vmcnt(2)
  v_cmp_eq_u32 vcc, -1, v20
  s_cbranch_vccz L_Oo_36_k123
  s_branch L_Oo_36_b123
L_Oo_36_b3012:
  s_mov_b64 exec, vcc
  buffer_load_dwordx4 v[28:31], v1, s[4:7], s37 offen offset:3072 sc1
  s_mov_b64 exec, -1
  s_add_u32 s27, s27, 1
  s_cmp_ge_u32 s27, 0x80000
  s_cbranch_scc1 L_Oo_36_e
  s_waitcnt vmcnt(3)
  v_cmp_eq_u32 vcc, -1, v16
  s_cbranch_vccz L_Oo_36_k0123
  s_branch L_Oo_36_b0123
L_Oo_36_b012:
  s_mov_b64 exec, vcc
  buffer_load_dwordx4 v[16:19], v1, s[4:7], s37 offen offset:0 sc1
  s_mov_b64 exec, -1
  s_waitcnt vmcnt(2)
  v_cmp_eq_u32 vcc, -1, v20
  s_cbranch_vccnz L_Oo_36_b120
L_Oo_36_k120:
  v_smfmac_f32_16x16x64_bf16 v[32:35], v[20:23], v[200:207], v2
  v_smfmac_f32_16x16x64_bf16 v[36:39], v[20:23], v[232:239], v2
  s_waitcnt vmcnt(1)
  v_cmp_eq_u32 vcc, -1, v24
  s_cbranch_vccz L_Oo_36_k20
L_Oo_36_b20:
  s_mov_b64 exec, vcc
  buffer_load_dwordx4 v[24:27], v1, s[4:7], s37 offen offset:2048 sc1
  s_mov_b64 exec, -1
  s_add_u32 s27, s27, 1
  s_cmp_ge_u32 s27, 0x80000
  s_cbranch_scc1 L_Oo_36_e
  s_waitcnt vmcnt(1)
  v_cmp_eq_u32 vcc, -1, v16
  s_cbranch_vccz L_Oo_36_k02
  s_branch L_Oo_36_b02
L_Oo_36_b21:
  s_mov_b64 exec, vcc
  buffer_load_dwordx4 v[24:27], v1, s[4:7], s37 offen offset:2048 sc1
  s_mov_b64 exec, -1
  s_add_u32 s27, s27, 1
  s_cmp_ge_u32 s27, 0x80000
  s_cbranch_scc1 L_Oo_36_e
  s_waitcnt vmcnt(1)
  v_cmp_eq_u32 vcc, -1, v20
  s_cbranch_vccz L_Oo_36_k12
  s_branch L_Oo_36_b12
L_Oo_36_b013:
  s_mov_b64 exec, vcc
  buffer_load_dwordx4 v[16:19], v1, s[4:7], s37 offen offset:0 sc1
  s_mov_b64 exec, -1
  s_waitcnt vmcnt(2)
  v_cmp_eq_u32 vcc, -1, v20
  s_cbranch_vccnz L_Oo_36_b130
L_Oo_36_k130:
  v_smfmac_f32_16x16x64_bf16 v[32:35], v[20:23], v[200:207], v2
  v_smfmac_f32_16x16x64_bf16 v[36:39], v[20:23], v[232:239], v2
  s_waitcnt vmcnt(1)
  v_cmp_eq_u32 vcc, -1, v28
  s_cbranch_vccz L_Oo_36_k30
  s_branch L_Oo_36_b30
L_Oo_36_b10:
  s_mov_b64 exec, vcc
  buffer_load_dwordx4 v[20:23], v1, s[4:7], s37 offen offset:1024 sc1
  s_mov_b64 exec, -1
  s_add_u32 s27, s27, 1
  s_cmp_ge_u32 s27, 0x80000
  s_cbranch_scc1 L_Oo_36_e
  s_waitcnt vmcnt(1)
  v_cmp_eq_u32 vcc, -1, v16
  s_cbranch_vccz L_Oo_36_k01
  s_branch L_Oo_36_b01
L_Oo_36_b023:
  s_mov_b64 exec, vcc
  buffer_load_dwordx4 v[16:19], v1, s[4:7], s37 offen offset:0 sc1
  s_mov_b64 exec, -1
  s_waitcnt vmcnt(2)
  v_cmp_eq_u32 vcc, -1, v24
  s_cbranch_vccz L_Oo_36_k230
  s_branch L_Oo_36_b230
L_Oo_36_b120:
  s_mov_b64 exec, vcc
  buffer_load_dwordx4 v[20:23], v1, s[4:7], s37 offen offset:1024 sc1
  s_mov_b64 exec, -1
  s_waitcnt vmcnt(2)
  v_cmp_eq_u32 vcc, -1, v24
  s_cbranch_vccnz L_Oo_36_b201
L_Oo_36_k201:
  v_smfmac_f32_16x16x64_bf16 v[32:35], v[24:27], v[208:215], v2
  v_smfmac_f32_16x16x64_bf16 v[36:39], v[24:27], v[240:247], v2
  s_waitcnt vmcnt(1)
  v_cmp_eq_u32 vcc, -1, v16
  s_cbranch_vccz L_Oo_36_k01
  s_branch L_Oo_36_b01
L_Oo_36_b130:
  s_mov_b64 exec, vcc
  buffer_load_dwordx4 v[20:23], v1, s[4:7], s37 offen offset:1024 sc1
  s_mov_b64 exec, -1
  s_waitcnt vmcnt(2)
  v_cmp_eq_u32 vcc, -1, v28
  s_cbranch_vccz L_Oo_36_k301
  s_branch L_Oo_36_b301
L_Oo_36_b201:
  s_mov_b64 exec, vcc
  buffer_load_dwordx4 v[24:27], v1, s[4:7], s37 offen offset:2048 sc1
  s_mov_b64 exec, -1
  s_add_u32 s27, s27, 1
  s_cmp_ge_u32 s27, 0x80000
  s_cbranch_scc1 L_Oo_36_e
  s_waitcnt vmcnt(2)
  v_cmp_eq_u32 vcc, -1, v16
  s_cbranch_vccz L_Oo_36_k012
  s_branch L_Oo_36_b012
L_O6_f:
  s_add_u32 s29, s36, 4
  s_andn2_b32 s29, s29, 1
  s_cmp_lt_u32 s29, 12
  s_cbranch_scc1 L_O6_fk
  s_cmp_ge_u32 s29, 64
  s_cbranch_scc1 L_O6_fk
  s_mul_i32 s29, s29, 48
  s_cmp_eq_u32 s28, 1
  s_cbranch_scc1 L_O6_fc
  buffer_load_dword v40, v15, s[4:7], s29 offen sc1
  s_branch L_O6_fk
L_O6_fw:
  buffer_load_dword v40, v15, s[4:7], s29 offen sc1
  s_waitcnt vmcnt(0)
L_O6_fc:
  v_cmp_eq_u32 vcc, 0, v40
  s_cbranch_vccz L_O6_fk
  s_add_u32 s27, s27, 1
  s_cmp_lt_u32 s27, 0x80000
  s_cbranch_scc1 L_O6_fw
  s_branch L_O6_fk
L_O6_x:
  v_mov_b32 v14, s36
  s_mov_b64 exec, 1
  buffer_store_dword v14, v13, s[4:7], 0 offen sc1
  s_mov_b64 exec, -1
  s_cmp_eq_u32 s36, 12
  s_cbranch_scc1 L_O6_nx
  buffer_store_dwordx4 v[128:131], v10, s[4:7], s54 offen offset:0 sc1
  buffer_store_dwordx4 v[132:135], v10, s[4:7], s54 offen offset:1024 sc1
  s_add_u32 s54, s54, 8192
  s_cmp_eq_u32 s36, 11
  s_cbranch_scc1 L_O6_nx
  ds_read_b128 v[64:67], v11 offset:0
  ds_read_b128 v[68:71], v11 offset:256
  ds_read_b128 v[72:75], v11 offset:1024
  ds_read_b128 v[76:79], v11 offset:1280
  ds_read_b128 v[80:83], v11 offset:2048
  ds_read_b128 v[84:87], v11 offset:2304
  ds_read_b128 v[88:91], v11 offset:3072
  ds_read_b128 v[92:95], v11 offset:3328
  s_waitcnt lgkmcnt(4)
  ds_read_b128 v[96:99], v11 offset:4096
  ds_read_b128 v[100:103], v11 offset:4352
  ds_read_b128 v[104:107], v11 offset:5120
  ds_read_b128 v[108:111], v11 offset:5376
  ds_read_b128 v[112:115], v11 offset:6144
  ds_read_b128 v[116:119], v11 offset:6400
  ds_read_b128 v[120:123], v11 offset:7168
  ds_read_b128 v[124:127], v11 offset:7424
  v_pk_add_f32 v[64:65], v[64:65], v[72:73]
  v_pk_add_f32 v[66:67], v[66:67], v[74:75]
  v_pk_add_f32 v[68:69], v[68:69], v[76:77]
  v_pk_add_f32 v[70:71], v[70:71], v[78:79]
  s_waitcnt lgkmcnt(8)
  v_pk_add_f32 v[80:81], v[80:81], v[88:89]
  v_pk_add_f32 v[82:83], v[82:83], v[90:91]
  v_pk_add_f32 v[84:85], v[84:85], v[92:93]
  v_pk_add_f32 v[86:87], v[86:87], v[94:95]
  v_pk_add_f32 v[64:65], v[64:65], v[80:81]
  v_pk_add_f32 v[66:67], v[66:67], v[82:83]
  v_pk_add_f32 v[68:69], v[68:69], v[84:85]
  v_pk_add_f32 v[70:71], v[70:71], v[86:87]
  v_cvt_pk_bf16_f32 v128, v64, v65
  v_cvt_pk_bf16_f32 v129, v66, v67
  v_cvt_pk_bf16_f32 v130, v68, v69
  v_cvt_pk_bf16_f32 v131, v70, v71
  ds_write_b128 v10, v[128:131] offset:18432
  s_waitcnt lgkmcnt(5)
  v_pk_add_f32 v[96:97], v[96:97], v[104:105]
  v_pk_add_f32 v[98:99], v[98:99], v[106:107]
  v_pk_add_f32 v[100:101], v[100:101], v[108:109]
  v_pk_add_f32 v[102:103], v[102:103], v[110:111]
  s_waitcnt lgkmcnt(1)
  v_pk_add_f32 v[112:113], v[112:113], v[120:121]
  v_pk_add_f32 v[114:115], v[114:115], v[122:123]
  v_pk_add_f32 v[116:117], v[116:117], v[124:125]
  v_pk_add_f32 v[118:119], v[118:119], v[126:127]
  v_pk_add_f32 v[96:97], v[96:97], v[112:113]
  v_pk_add_f32 v[98:99], v[98:99], v[114:115]
  v_pk_add_f32 v[100:101], v[100:101], v[116:117]
  v_pk_add_f32 v[102:103], v[102:103], v[118:119]
  v_cvt_pk_bf16_f32 v132, v96, v97
  v_cvt_pk_bf16_f32 v133, v98, v99
  v_cvt_pk_bf16_f32 v134, v100, v101
  v_cvt_pk_bf16_f32 v135, v102, v103
  ds_write_b128 v10, v[132:135] offset:19456
  s_waitcnt lgkmcnt(0)
  s_buffer_load_dword s29, s[16:19], s53 offset:0
  s_buffer_load_dword s29, s[16:19], s53 offset:128
  s_buffer_load_dword s29, s[16:19], s53 offset:256
  s_buffer_load_dword s29, s[16:19], s53 offset:384
  s_buffer_load_dword s29, s[16:19], s53 offset:512
  s_buffer_load_dword s29, s[16:19], s53 offset:640
  s_buffer_load_dword s29, s[16:19], s53 offset:768
  s_buffer_load_dword s29, s[16:19], s53 offset:896
  s_add_u32 s53, s53, 65536
  s_branch L_O6_c
L_O7:
  v_lshlrev_b32 v52, 2, v0
  buffer_load_dword v53, v52, s[8:11], 0 offen sc1
  s_lshl_b32 s28, s46, 7
  s_lshl_b32 s29, s47, 3
  s_add_u32 s28, s28, s29
  s_add_u32 s28, s28, 84946948
  v_mov_b32 v13, s28
  v_mov_b32 v14, 0
  s_lshr_b32 s28, s46, 1
  s_lshl_b32 s28, s28, 2
  s_add_u32 s28, s28, 84934720
  v_mov_b32 v15, s28
  s_lshl_b32 s28, s25, 11
  s_add_u32 s53, s28, 262144
  s_lshl_b32 s42, s46, 19
  s_xor_b32 s28, s47, 2
  s_lshl_b32 s28, s28, 11
  s_add_u32 s42, s42, s28
  v_lshrrev_b32 v5, 5, v0
  s_add_u32 s42, s42, 16777216
  v_bfe_u32 v11, v0, 2, 1
  v_lshlrev_b32 v11, 12, v11
  v_lshl_add_u32 v11, v5, 8, v11
  v_bfe_u32 v6, v0, 3, 2
  v_lshl_add_u32 v11, v6, 6, v11
  v_and_b32 v6, 3, v0
  v_lshl_add_u32 v11, v6, 4, v11
  v_add_u32 v11, 40960, v11
  v_lshlrev_b32 v10, 4, v0
  s_mov_b32 s54, s42
  s_add_u32 s42, s42, 98304
  s_waitcnt vmcnt(14)
  ds_write_b128 v60, v[192:195] offset:0
  ds_write_b128 v60, v[196:199] offset:1024
  ds_write_b128 v60, v[224:227] offset:2048
  ds_write_b128 v60, v[228:231] offset:3072
  ds_read_b64_tr_b16 v[192:193], v61 offset:0
  ds_read_b64_tr_b16 v[194:195], v61 offset:128
  ds_read_b64_tr_b16 v[196:197], v61 offset:2048
  ds_read_b64_tr_b16 v[198:199], v61 offset:2176
  ds_read_b64_tr_b16 v[224:225], v61 offset:32
  ds_read_b64_tr_b16 v[226:227], v61 offset:160
  ds_read_b64_tr_b16 v[228:229], v61 offset:2080
  ds_read_b64_tr_b16 v[230:231], v61 offset:2208
  s_waitcnt vmcnt(10)
  ds_write_b128 v60, v[200:203] offset:0
  ds_write_b128 v60, v[204:207] offset:1024
  ds_write_b128 v60, v[232:235] offset:2048
  ds_write_b128 v60, v[236:239] offset:3072
  ds_read_b64_tr_b16 v[200:201], v61 offset:0
  ds_read_b64_tr_b16 v[202:203], v61 offset:128
  ds_read_b64_tr_b16 v[204:205], v61 offset:2048
  ds_read_b64_tr_b16 v[206:207], v61 offset:2176
  ds_read_b64_tr_b16 v[232:233], v61 offset:32
  ds_read_b64_tr_b16 v[234:235], v61 offset:160
  ds_read_b64_tr_b16 v[236:237], v61 offset:2080
  ds_read_b64_tr_b16 v[238:239], v61 offset:2208
  s_waitcnt vmcnt(5)
  ds_write_b128 v60, v[208:211] offset:0
  ds_write_b128 v60, v[212:215] offset:1024
  ds_write_b128 v60, v[240:243] offset:2048
  ds_write_b128 v60, v[244:247] offset:3072
  ds_read_b64_tr_b16 v[208:209], v61 offset:0
  ds_read_b64_tr_b16 v[210:211], v61 offset:128
  ds_read_b64_tr_b16 v[212:213], v61 offset:2048
  ds_read_b64_tr_b16 v[214:215], v61 offset:2176
  ds_read_b64_tr_b16 v[240:241], v61 offset:32
  ds_read_b64_tr_b16 v[242:243], v61 offset:160
  ds_read_b64_tr_b16 v[244:245], v61 offset:2080
  ds_read_b64_tr_b16 v[246:247], v61 offset:2208
  s_waitcnt vmcnt(1)
  ds_write_b128 v60, v[216:219] offset:0
  ds_write_b128 v60, v[220:223] offset:1024
  ds_write_b128 v60, v[248:251] offset:2048
  ds_write_b128 v60, v[252:255] offset:3072
  ds_read_b64_tr_b16 v[216:217], v61 offset:0
  ds_read_b64_tr_b16 v[218:219], v61 offset:128
  ds_read_b64_tr_b16 v[220:221], v61 offset:2048
  ds_read_b64_tr_b16 v[222:223], v61 offset:2176
  ds_read_b64_tr_b16 v[248:249], v61 offset:32
  ds_read_b64_tr_b16 v[250:251], v61 offset:160
  ds_read_b64_tr_b16 v[252:253], v61 offset:2080
  ds_read_b64_tr_b16 v[254:255], v61 offset:2208
  s_setprio 2
L_winit:
  s_waitcnt vmcnt(0)
  v_readlane_b32 s30, v53, 0
  v_readlane_b32 s31, v53, 16
  s_nop 0
  s_add_u32 s30, s30, s31
  v_readlane_b32 s31, v53, 32
  s_nop 0
  s_add_u32 s30, s30, s31
  v_readlane_b32 s31, v53, 48
  s_nop 0
  s_add_u32 s30, s30, s31
  v_readlane_b32 s31, v53, 1
  s_nop 0
  s_add_u32 s30, s30, s31
  v_readlane_b32 s31, v53, 17
  s_nop 0
  s_add_u32 s30, s30, s31
  v_readlane_b32 s31, v53, 33
  s_nop 0
  s_add_u32 s30, s30, s31
  v_readlane_b32 s31, v53, 49
  s_nop 0
  s_add_u32 s30, s30, s31
  v_readlane_b32 s31, v53, 34
  v_readlane_b32 s29, v53, 35
  s_cmp_lt_u32 s31, 128
  s_cselect_b32 s30, 0, s30
  s_cmp_eq_u32 s29, 0
  s_cselect_b32 s30, 0, s30
  s_cmp_ge_u32 s30, 256
  s_cbranch_scc1 L_winit_go
  v_lshlrev_b32 v52, 2, v0
  buffer_load_dword v53, v52, s[8:11], 0 offen sc1
  s_add_u32 s27, s27, 1
  s_cmp_lt_u32 s27, 0x80000
  s_cbranch_scc1 L_winit
  s_waitcnt vmcnt(0)
L_winit_go:
  s_and_b32 s30, s24, 3
  s_lshl_b32 s30, s30, 4
  s_lshr_b32 s31, s24, 2
  s_add_u32 s30, s30, s31
  v_readlane_b32 s28, v53, s30
  s_and_b32 s29, s29, 2
  s_lshl_b32 s29, s29, 15
  s_or_b32 s28, s28, s29
  v_mov_b32 v61, s28
  v_mov_b32 v62, 22528
  ds_write_b32 v62, v61
  s_waitcnt lgkmcnt(0)
  s_barrier
  ds_read_b128 v[64:67], v11 offset:0
  ds_read_b128 v[68:71], v11 offset:512
  ds_read_b128 v[72:75], v11 offset:1024
  ds_read_b128 v[76:79], v11 offset:1536
  ds_read_b128 v[80:83], v11 offset:2048
  ds_read_b128 v[84:87], v11 offset:2560
  ds_read_b128 v[88:91], v11 offset:3072
  ds_read_b128 v[92:95], v11 offset:3584
  s_waitcnt lgkmcnt(4)
  ds_read_b128 v[96:99], v11 offset:8192
  ds_read_b128 v[100:103], v11 offset:8704
  ds_read_b128 v[104:107], v11 offset:9216
  ds_read_b128 v[108:111], v11 offset:9728
  ds_read_b128 v[112:115], v11 offset:10240
  ds_read_b128 v[116:119], v11 offset:10752
  ds_read_b128 v[120:123], v11 offset:11264
  ds_read_b128 v[124:127], v11 offset:11776
  v_pk_add_f32 v[64:65], v[64:65], v[72:73]
  v_pk_add_f32 v[66:67], v[66:67], v[74:75]
  v_pk_add_f32 v[68:69], v[68:69], v[76:77]
  v_pk_add_f32 v[70:71], v[70:71], v[78:79]
  s_waitcnt lgkmcnt(8)
  v_pk_add_f32 v[80:81], v[80:81], v[88:89]
  v_pk_add_f32 v[82:83], v[82:83], v[90:91]
  v_pk_add_f32 v[84:85], v[84:85], v[92:93]
  v_pk_add_f32 v[86:87], v[86:87], v[94:95]
  v_pk_add_f32 v[64:65], v[64:65], v[80:81]
  v_pk_add_f32 v[66:67], v[66:67], v[82:83]
  v_pk_add_f32 v[68:69], v[68:69], v[84:85]
  v_pk_add_f32 v[70:71], v[70:71], v[86:87]
  v_cvt_pk_bf16_f32 v128, v64, v65
  v_cvt_pk_bf16_f32 v129, v66, v67
  v_cvt_pk_bf16_f32 v130, v68, v69
  v_cvt_pk_bf16_f32 v131, v70, v71
  ds_write_b128 v10, v[128:131] offset:20480
  s_waitcnt lgkmcnt(5)
  v_pk_add_f32 v[96:97], v[96:97], v[104:105]
  v_pk_add_f32 v[98:99], v[98:99], v[106:107]
  v_pk_add_f32 v[100:101], v[100:101], v[108:109]
  v_pk_add_f32 v[102:103], v[102:103], v[110:111]
  s_waitcnt lgkmcnt(1)
  v_pk_add_f32 v[112:113], v[112:113], v[120:121]
  v_pk_add_f32 v[114:115], v[114:115], v[122:123]
  v_pk_add_f32 v[116:117], v[116:117], v[124:125]
  v_pk_add_f32 v[118:119], v[118:119], v[126:127]
  v_pk_add_f32 v[96:97], v[96:97], v[112:113]
  v_pk_add_f32 v[98:99], v[98:99], v[114:115]
  v_pk_add_f32 v[100:101], v[100:101], v[116:117]
  v_pk_add_f32 v[102:103], v[102:103], v[118:119]
  v_cvt_pk_bf16_f32 v132, v96, v97
  v_cvt_pk_bf16_f32 v133, v98, v99
  v_cvt_pk_bf16_f32 v134, v100, v101
  v_cvt_pk_bf16_f32 v135, v102, v103
  ds_write_b128 v10, v[132:135] offset:21504
  s_waitcnt lgkmcnt(0)
  s_barrier
.p2align 6
L_O7_loopf:
  s_add_u32 s28, s36, 0
  s_and_b32 s28, s28, 3
  s_lshl_b32 s28, s28, 17
  s_add_u32 s37, s44, s28
  v_mov_b32 v32, 0
  v_mov_b32 v33, 0
  v_mov_b32 v34, 0
  v_mov_b32 v35, 0
  v_mov_b32 v36, 0
  v_mov_b32 v37, 0
  v_mov_b32 v38, 0
  v_mov_b32 v39, 0
  s_cmp_eq_u32 s36, 63
  s_cbranch_scc1 L_O7_lastf
  s_barrier
  s_cmp_ge_u32 s36, 11
  s_cbranch_scc1 L_O7_nw
  s_buffer_load_dword s29, s[16:19], s53 offset:1088
  s_buffer_load_dword s29, s[16:19], s53 offset:1216
  s_buffer_load_dword s29, s[16:19], s53 offset:1344
  s_buffer_load_dword s29, s[16:19], s53 offset:1472
  s_buffer_load_dword s29, s[16:19], s53 offset:1600
  s_buffer_load_dword s29, s[16:19], s53 offset:1728
  s_buffer_load_dword s29, s[16:19], s53 offset:1856
  s_buffer_load_dword s29, s[16:19], s53 offset:1984
  s_branch L_O7_nw2
L_O7_nw:
  s_mov_b32 m0, 20480
  s_nop 0
  buffer_load_dwordx4 v10, s[4:7], s42 offen offset:0 lds
  buffer_load_dwordx4 v10, s[4:7], s42 offen offset:1024 lds
  s_add_u32 s42, s42, 8192
L_O7_nw2:
  s_barrier
  s_barrier
  s_nop 15
  s_nop 13
  buffer_load_dwordx4 v[16:19], v1, s[4:7], s37 offen offset:0 sc1
  s_nop 3
  buffer_load_dwordx4 v[20:23], v1, s[4:7], s37 offen offset:1024 sc1
  s_nop 3
  buffer_load_dwordx4 v[24:27], v1, s[4:7], s37 offen offset:2048 sc1
  s_nop 3
  buffer_load_dwordx4 v[28:31], v1, s[4:7], s37 offen offset:3072 sc1
  s_waitcnt vmcnt(3)
  v_cmp_eq_u32 vcc, -1, v16
  s_cbranch_vccnz L_Oo_37_b0123
L_Oo_37_k0123:
  v_smfmac_f32_16x16x64_bf16 v[32:35], v[16:19], v[192:199], v2
  v_smfmac_f32_16x16x64_bf16 v[36:39], v[16:19], v[224:231], v2
  s_waitcnt vmcnt(2)
  v_cmp_eq_u32 vcc, -1, v20
  s_cbranch_vccnz L_Oo_37_b123
L_Oo_37_k123:
  v_smfmac_f32_16x16x64_bf16 v[32:35], v[20:23], v[200:207], v2
  v_smfmac_f32_16x16x64_bf16 v[36:39], v[20:23], v[232:239], v2
  s_waitcnt vmcnt(1)
  v_cmp_eq_u32 vcc, -1, v24
  s_cbranch_vccnz L_Oo_37_b23
L_Oo_37_k23:
  v_smfmac_f32_16x16x64_bf16 v[32:35], v[24:27], v[208:215], v2
  v_smfmac_f32_16x16x64_bf16 v[36:39], v[24:27], v[240:247], v2
  s_waitcnt vmcnt(0)
  v_cmp_eq_u32 vcc, -1, v28
  s_cbranch_vccnz L_Oo_37_b3
L_Oo_37_k3:
  v_smfmac_f32_16x16x64_bf16 v[32:35], v[28:31], v[216:223], v2
  v_smfmac_f32_16x16x64_bf16 v[36:39], v[28:31], v[248:255], v2
L_Oo_37_e:
  s_nop 6
  v_add_f32 v32, v32, v33
  v_add_f32 v34, v34, v35
  ds_write2_b32 v3, v32, v34 offset0:0 offset1:40
  v_add_f32 v36, v36, v37
  v_add_f32 v38, v38, v39
  ds_write2_b32 v3, v36, v38 offset0:16 offset1:56
  s_waitcnt lgkmcnt(0)
  s_barrier
  s_barrier
  s_add_u32 s28, s36, 4
  s_and_b32 s28, s28, 3
  s_cmp_lt_u32 s28, 2
  s_cbranch_scc1 L_O7_f
L_O7_fk:
  s_cmp_le_u32 s36, 12
  s_cbranch_scc1 L_O7_x
L_O7_nx:
L_O7_c:
  s_barrier
  s_add_u32 s36, s36, 1
  s_branch L_O7_loopf
L_O7_lastf:
  s_branch L_R_done
L_Oo_37_b0123:
  s_mov_b64 exec, vcc
  buffer_load_dwordx4 v[16:19], v1, s[4:7], s37 offen offset:0 sc1
  s_mov_b64 exec, -1
  s_waitcnt vmcnt(3)
  v_cmp_eq_u32 vcc, -1, v20
  s_cbranch_vccnz L_Oo_37_b1230
L_Oo_37_k1230:
  v_smfmac_f32_16x16x64_bf16 v[32:35], v[20:23], v[200:207], v2
  v_smfmac_f32_16x16x64_bf16 v[36:39], v[20:23], v[232:239], v2
  s_waitcnt vmcnt(2)
  v_cmp_eq_u32 vcc, -1, v24
  s_cbranch_vccnz L_Oo_37_b230
L_Oo_37_k230:
  v_smfmac_f32_16x16x64_bf16 v[32:35], v[24:27], v[208:215], v2
  v_smfmac_f32_16x16x64_bf16 v[36:39], v[24:27], v[240:247], v2
  s_waitcnt vmcnt(1)
  v_cmp_eq_u32 vcc, -1, v28
  s_cbranch_vccnz L_Oo_37_b30
L_Oo_37_k30:
  v_smfmac_f32_16x16x64_bf16 v[32:35], v[28:31], v[216:223], v2
  v_smfmac_f32_16x16x64_bf16 v[36:39], v[28:31], v[248:255], v2
  s_waitcnt vmcnt(0)
  v_cmp_eq_u32 vcc, -1, v16
  s_cbranch_vccnz L_Oo_37_b0
L_Oo_37_k0:
  v_smfmac_f32_16x16x64_bf16 v[32:35], v[16:19], v[192:199], v2
  v_smfmac_f32_16x16x64_bf16 v[36:39], v[16:19], v[224:231], v2
  s_branch L_Oo_37_e
L_Oo_37_b123:
  s_mov_b64 exec, vcc
  buffer_load_dwordx4 v[20:23], v1, s[4:7], s37 offen offset:1024 sc1
  s_mov_b64 exec, -1
  s_waitcnt vmcnt(2)
  v_cmp_eq_u32 vcc, -1, v24
  s_cbranch_vccnz L_Oo_37_b231
L_Oo_37_k231:
  v_smfmac_f32_16x16x64_bf16 v[32:35], v[24:27], v[208:215], v2
  v_smfmac_f32_16x16x64_bf16 v[36:39], v[24:27], v[240:247], v2
  s_waitcnt vmcnt(1)
  v_cmp_eq_u32 vcc, -1, v28
  s_cbranch_vccnz L_Oo_37_b31
L_Oo_37_k31:
  v_smfmac_f32_16x16x64_bf16 v[32:35], v[28:31], v[216:223], v2
  v_smfmac_f32_16x16x64_bf16 v[36:39], v[28:31], v[248:255], v2
  s_waitcnt vmcnt(0)
  v_cmp_eq_u32 vcc, -1, v20
  s_cbranch_vccnz L_Oo_37_b1
L_Oo_37_k1:
  v_smfmac_f32_16x16x64_bf16 v[32:35], v[20:23], v[200:207], v2
  v_smfmac_f32_16x16x64_bf16 v[36:39], v[20:23], v[232:239], v2
  s_branch L_Oo_37_e
L_Oo_37_b23:
  s_mov_b64 exec, vcc
  buffer_load_dwordx4 v[24:27], v1, s[4:7], s37 offen offset:2048 sc1
  s_mov_b64 exec, -1
  s_waitcnt vmcnt(1)
  v_cmp_eq_u32 vcc, -1, v28
  s_cbranch_vccnz L_Oo_37_b32
L_Oo_37_k32:
  v_smfmac_f32_16x16x64_bf16 v[32:35], v[28:31], v[216:223], v2
  v_smfmac_f32_16x16x64_bf16 v[36:39], v[28:31], v[248:255], v2
  s_waitcnt vmcnt(0)
  v_cmp_eq_u32 vcc, -1, v24
  s_cbranch_vccnz L_Oo_37_b2
L_Oo_37_k2:
  v_smfmac_f32_16x16x64_bf16 v[32:35], v[24:27], v[208:215], v2
  v_smfmac_f32_16x16x64_bf16 v[36:39], v[24:27], v[240:247], v2
  s_branch L_Oo_37_e
L_Oo_37_b3:
  s_mov_b64 exec, vcc
  buffer_load_dwordx4 v[28:31], v1, s[4:7], s37 offen offset:3072 sc1
  s_mov_b64 exec, -1
  s_add_u32 s27, s27, 1
  s_cmp_ge_u32 s27, 0x80000
  s_cbranch_scc1 L_Oo_37_e
  s_waitcnt vmcnt(0)
  v_cmp_eq_u32 vcc, -1, v28
  s_cbranch_vccz L_Oo_37_k3
  s_branch L_Oo_37_b3
L_Oo_37_b1230:
  s_mov_b64 exec, vcc
  buffer_load_dwordx4 v[20:23], v1, s[4:7], s37 offen offset:1024 sc1
  s_mov_b64 exec, -1
  s_waitcnt vmcnt(3)
  v_cmp_eq_u32 vcc, -1, v24
  s_cbranch_vccnz L_Oo_37_b2301
L_Oo_37_k2301:
  v_smfmac_f32_16x16x64_bf16 v[32:35], v[24:27], v[208:215], v2
  v_smfmac_f32_16x16x64_bf16 v[36:39], v[24:27], v[240:247], v2
  s_waitcnt vmcnt(2)
  v_cmp_eq_u32 vcc, -1, v28
  s_cbranch_vccnz L_Oo_37_b301
L_Oo_37_k301:
  v_smfmac_f32_16x16x64_bf16 v[32:35], v[28:31], v[216:223], v2
  v_smfmac_f32_16x16x64_bf16 v[36:39], v[28:31], v[248:255], v2
  s_waitcnt vmcnt(1)
  v_cmp_eq_u32 vcc, -1, v16
  s_cbranch_vccnz L_Oo_37_b01
L_Oo_37_k01:
  v_smfmac_f32_16x16x64_bf16 v[32:35], v[16:19], v[192:199], v2
  v_smfmac_f32_16x16x64_bf16 v[36:39], v[16:19], v[224:231], v2
  s_waitcnt vmcnt(0)
  v_cmp_eq_u32 vcc, -1, v20
  s_cbranch_vccz L_Oo_37_k1
L_Oo_37_b1:
  s_mov_b64 exec, vcc
  buffer_load_dwordx4 v[20:23], v1, s[4:7], s37 offen offset:1024 sc1
  s_mov_b64 exec, -1
  s_add_u32 s27, s27, 1
  s_cmp_ge_u32 s27, 0x80000
  s_cbranch_scc1 L_Oo_37_e
  s_waitcnt vmcnt(0)
  v_cmp_eq_u32 vcc, -1, v20
  s_cbranch_vccz L_Oo_37_k1
  s_branch L_Oo_37_b1
L_Oo_37_b230:
  s_mov_b64 exec, vcc
  buffer_load_dwordx4 v[24:27], v1, s[4:7], s37 offen offset:2048 sc1
  s_mov_b64 exec, -1
  s_waitcnt vmcnt(2)
  v_cmp_eq_u32 vcc, -1, v28
  s_cbranch_vccnz L_Oo_37_b302
L_Oo_37_k302:
  v_smfmac_f32_16x16x64_bf16 v[32:35], v[28:31], v[216:223], v2
  v_smfmac_f32_16x16x64_bf16 v[36:39], v[28:31], v[248:255], v2
  s_waitcnt vmcnt(1)
  v_cmp_eq_u32 vcc, -1, v16
  s_cbranch_vccnz L_Oo_37_b02
L_Oo_37_k02:
  v_smfmac_f32_16x16x64_bf16 v[32:35], v[16:19], v[192:199], v2
  v_smfmac_f32_16x16x64_bf16 v[36:39], v[16:19], v[224:231], v2
  s_waitcnt vmcnt(0)
  v_cmp_eq_u32 vcc, -1, v24
  s_cbranch_vccz L_Oo_37_k2
L_Oo_37_b2:
  s_mov_b64 exec, vcc
  buffer_load_dwordx4 v[24:27], v1, s[4:7], s37 offen offset:2048 sc1
  s_mov_b64 exec, -1
  s_add_u32 s27, s27, 1
  s_cmp_ge_u32 s27, 0x80000
  s_cbranch_scc1 L_Oo_37_e
  s_waitcnt vmcnt(0)
  v_cmp_eq_u32 vcc, -1, v24
  s_cbranch_vccz L_Oo_37_k2
  s_branch L_Oo_37_b2
L_Oo_37_b30:
  s_mov_b64 exec, vcc
  buffer_load_dwordx4 v[28:31], v1, s[4:7], s37 offen offset:3072 sc1
  s_mov_b64 exec, -1
  s_add_u32 s27, s27, 1
  s_cmp_ge_u32 s27, 0x80000
  s_cbranch_scc1 L_Oo_37_e
  s_waitcnt vmcnt(1)
  v_cmp_eq_u32 vcc, -1, v16
  s_cbranch_vccnz L_Oo_37_b03
L_Oo_37_k03:
  v_smfmac_f32_16x16x64_bf16 v[32:35], v[16:19], v[192:199], v2
  v_smfmac_f32_16x16x64_bf16 v[36:39], v[16:19], v[224:231], v2
  s_waitcnt vmcnt(0)
  v_cmp_eq_u32 vcc, -1, v28
  s_cbranch_vccz L_Oo_37_k3
  s_branch L_Oo_37_b3
L_Oo_37_b0:
  s_mov_b64 exec, vcc
  buffer_load_dwordx4 v[16:19], v1, s[4:7], s37 offen offset:0 sc1
  s_mov_b64 exec, -1
  s_add_u32 s27, s27, 1
  s_cmp_ge_u32 s27, 0x80000
  s_cbranch_scc1 L_Oo_37_e
  s_waitcnt vmcnt(0)
  v_cmp_eq_u32 vcc, -1, v16
  s_cbranch_vccz L_Oo_37_k0
  s_branch L_Oo_37_b0
L_Oo_37_b231:
  s_mov_b64 exec, vcc
  buffer_load_dwordx4 v[24:27], v1, s[4:7], s37 offen offset:2048 sc1
  s_mov_b64 exec, -1
  s_waitcnt vmcnt(2)
  v_cmp_eq_u32 vcc, -1, v28
  s_cbranch_vccnz L_Oo_37_b312
L_Oo_37_k312:
  v_smfmac_f32_16x16x64_bf16 v[32:35], v[28:31], v[216:223], v2
  v_smfmac_f32_16x16x64_bf16 v[36:39], v[28:31], v[248:255], v2
  s_waitcnt vmcnt(1)
  v_cmp_eq_u32 vcc, -1, v20
  s_cbranch_vccnz L_Oo_37_b12
L_Oo_37_k12:
  v_smfmac_f32_16x16x64_bf16 v[32:35], v[20:23], v[200:207], v2
  v_smfmac_f32_16x16x64_bf16 v[36:39], v[20:23], v[232:239], v2
  s_waitcnt vmcnt(0)
  v_cmp_eq_u32 vcc, -1, v24
  s_cbranch_vccz L_Oo_37_k2
  s_branch L_Oo_37_b2
L_Oo_37_b31:
  s_mov_b64 exec, vcc
  buffer_load_dwordx4 v[28:31], v1, s[4:7], s37 offen offset:3072 sc1
  s_mov_b64 exec, -1
  s_add_u32 s27, s27, 1
  s_cmp_ge_u32 s27, 0x80000
  s_cbranch_scc1 L_Oo_37_e
  s_waitcnt vmcnt(1)
  v_cmp_eq_u32 vcc, -1, v20
  s_cbranch_vccnz L_Oo_37_b13
L_Oo_37_k13:
  v_smfmac_f32_16x16x64_bf16 v[32:35], v[20:23], v[200:207], v2
  v_smfmac_f32_16x16x64_bf16 v[36:39], v[20:23], v[232:239], v2
  s_waitcnt vmcnt(0)
  v_cmp_eq_u32 vcc, -1, v28
  s_cbranch_vccz L_Oo_37_k3
  s_branch L_Oo_37_b3
L_Oo_37_b32:
  s_mov_b64 exec, vcc
  buffer_load_dwordx4 v[28:31], v1, s[4:7], s37 offen offset:3072 sc1
  s_mov_b64 exec, -1
  s_add_u32 s27, s27, 1
  s_cmp_ge_u32 s27, 0x80000
  s_cbranch_scc1 L_Oo_37_e
  s_waitcnt vmcnt(1)
  v_cmp_eq_u32 vcc, -1, v24
  s_cbranch_vccz L_Oo_37_k23
  s_branch L_Oo_37_b23
L_Oo_37_b2301:
  s_mov_b64 exec, vcc
  buffer_load_dwordx4 v[24:27], v1, s[4:7], s37 offen offset:2048 sc1
  s_mov_b64 exec, -1
  s_waitcnt vmcnt(3)
  v_cmp_eq_u32 vcc, -1, v28
  s_cbranch_vccnz L_Oo_37_b3012
L_Oo_37_k3012:
  v_smfmac_f32_16x16x64_bf16 v[32:35], v[28:31], v[216:223], v2
  v_smfmac_f32_16x16x64_bf16 v[36:39], v[28:31], v[248:255], v2
  s_waitcnt vmcnt(2)
  v_cmp_eq_u32 vcc, -1, v16
  s_cbranch_vccnz L_Oo_37_b012
L_Oo_37_k012:
  v_smfmac_f32_16x16x64_bf16 v[32:35], v[16:19], v[192:199], v2
  v_smfmac_f32_16x16x64_bf16 v[36:39], v[16:19], v[224:231], v2
  s_waitcnt vmcnt(1)
  v_cmp_eq_u32 vcc, -1, v20
  s_cbranch_vccz L_Oo_37_k12
L_Oo_37_b12:
  s_mov_b64 exec, vcc
  buffer_load_dwordx4 v[20:23], v1, s[4:7], s37 offen offset:1024 sc1
  s_mov_b64 exec, -1
  s_waitcnt vmcnt(1)
  v_cmp_eq_u32 vcc, -1, v24
  s_cbranch_vccnz L_Oo_37_b21
L_Oo_37_k21:
  v_smfmac_f32_16x16x64_bf16 v[32:35], v[24:27], v[208:215], v2
  v_smfmac_f32_16x16x64_bf16 v[36:39], v[24:27], v[240:247], v2
  s_waitcnt vmcnt(0)
  v_cmp_eq_u32 vcc, -1, v20
  s_cbranch_vccz L_Oo_37_k1
  s_branch L_Oo_37_b1
L_Oo_37_b301:
  s_mov_b64 exec, vcc
  buffer_load_dwordx4 v[28:31], v1, s[4:7], s37 offen offset:3072 sc1
  s_mov_b64 exec, -1
  s_add_u32 s27, s27, 1
  s_cmp_ge_u32 s27, 0x80000
  s_cbranch_scc1 L_Oo_37_e
  s_waitcnt vmcnt(2)
  v_cmp_eq_u32 vcc, -1, v16
  s_cbranch_vccnz L_Oo_37_b013
L_Oo_37_k013:
  v_smfmac_f32_16x16x64_bf16 v[32:35], v[16:19], v[192:199], v2
  v_smfmac_f32_16x16x64_bf16 v[36:39], v[16:19], v[224:231], v2
  s_waitcnt vmcnt(1)
  v_cmp_eq_u32 vcc, -1, v20
  s_cbranch_vccz L_Oo_37_k13
L_Oo_37_b13:
  s_mov_b64 exec, vcc
  buffer_load_dwordx4 v[20:23], v1, s[4:7], s37 offen offset:1024 sc1
  s_mov_b64 exec, -1
  s_waitcnt vmcnt(1)
  v_cmp_eq_u32 vcc, -1, v28
  s_cbranch_vccz L_Oo_37_k31
  s_branch L_Oo_37_b31
L_Oo_37_b01:
  s_mov_b64 exec, vcc
  buffer_load_dwordx4 v[16:19], v1, s[4:7], s37 offen offset:0 sc1
  s_mov_b64 exec, -1
  s_waitcnt vmcnt(1)
  v_cmp_eq_u32 vcc, -1, v20
  s_cbranch_vccnz L_Oo_37_b10
L_Oo_37_k10:
  v_smfmac_f32_16x16x64_bf16 v[32:35], v[20:23], v[200:207], v2
  v_smfmac_f32_16x16x64_bf16 v[36:39], v[20:23], v[232:239], v2
  s_waitcnt vmcnt(0)
  v_cmp_eq_u32 vcc, -1, v16
  s_cbranch_vccz L_Oo_37_k0
  s_branch L_Oo_37_b0
L_Oo_37_b302:
  s_mov_b64 exec, vcc
  buffer_load_dwordx4 v[28:31], v1, s[4:7], s37 offen offset:3072 sc1
  s_mov_b64 exec, -1
  s_add_u32 s27, s27, 1
  s_cmp_ge_u32 s27, 0x80000
  s_cbranch_scc1 L_Oo_37_e
  s_waitcnt vmcnt(2)
  v_cmp_eq_u32 vcc, -1, v16
  s_cbranch_vccnz L_Oo_37_b023
L_Oo_37_k023:
  v_smfmac_f32_16x16x64_bf16 v[32:35], v[16:19], v[192:199], v2
  v_smfmac_f32_16x16x64_bf16 v[36:39], v[16:19], v[224:231], v2
  s_waitcnt vmcnt(1)
  v_cmp_eq_u32 vcc, -1, v24
  s_cbranch_vccz L_Oo_37_k23
  s_branch L_Oo_37_b23
L_Oo_37_b02:
  s_mov_b64 exec, vcc
  buffer_load_dwordx4 v[16:19], v1, s[4:7], s37 offen offset:0 sc1
  s_mov_b64 exec, -1
  s_waitcnt vmcnt(1)
  v_cmp_eq_u32 vcc, -1, v24
  s_cbranch_vccnz L_Oo_37_b20
L_Oo_37_k20:
  v_smfmac_f32_16x16x64_bf16 v[32:35], v[24:27], v[208:215], v2
  v_smfmac_f32_16x16x64_bf16 v[36:39], v[24:27], v[240:247], v2
  s_waitcnt vmcnt(0)
  v_cmp_eq_u32 vcc, -1, v16
  s_cbranch_vccz L_Oo_37_k0
  s_branch L_Oo_37_b0
L_Oo_37_b03:
  s_mov_b64 exec, vcc
  buffer_load_dwordx4 v[16:19], v1, s[4:7], s37 offen offset:0 sc1
  s_mov_b64 exec, -1
  s_waitcnt vmcnt(1)
  v_cmp_eq_u32 vcc, -1, v28
  s_cbranch_vccz L_Oo_37_k30
  s_branch L_Oo_37_b30
L_Oo_37_b312:
  s_mov_b64 exec, vcc
  buffer_load_dwordx4 v[28:31], v1, s[4:7], s37 offen offset:3072 sc1
  s_mov_b64 exec, -1
  s_add_u32 s27, s27, 1
  s_cmp_ge_u32 s27, 0x80000
  s_cbranch_scc1 L_Oo_37_e
  s_waitcnt vmcnt(2)
  v_cmp_eq_u32 vcc, -1, v20
  s_cbranch_vccz L_Oo_37_k123
  s_branch L_Oo_37_b123
L_Oo_37_b3012:
  s_mov_b64 exec, vcc
  buffer_load_dwordx4 v[28:31], v1, s[4:7], s37 offen offset:3072 sc1
  s_mov_b64 exec, -1
  s_add_u32 s27, s27, 1
  s_cmp_ge_u32 s27, 0x80000
  s_cbranch_scc1 L_Oo_37_e
  s_waitcnt vmcnt(3)
  v_cmp_eq_u32 vcc, -1, v16
  s_cbranch_vccz L_Oo_37_k0123
  s_branch L_Oo_37_b0123
L_Oo_37_b012:
  s_mov_b64 exec, vcc
  buffer_load_dwordx4 v[16:19], v1, s[4:7], s37 offen offset:0 sc1
  s_mov_b64 exec, -1
  s_waitcnt vmcnt(2)
  v_cmp_eq_u32 vcc, -1, v20
  s_cbranch_vccnz L_Oo_37_b120
L_Oo_37_k120:
  v_smfmac_f32_16x16x64_bf16 v[32:35], v[20:23], v[200:207], v2
  v_smfmac_f32_16x16x64_bf16 v[36:39], v[20:23], v[232:239], v2
  s_waitcnt vmcnt(1)
  v_cmp_eq_u32 vcc, -1, v24
  s_cbranch_vccz L_Oo_37_k20
L_Oo_37_b20:
  s_mov_b64 exec, vcc
  buffer_load_dwordx4 v[24:27], v1, s[4:7], s37 offen offset:2048 sc1
  s_mov_b64 exec, -1
  s_add_u32 s27, s27, 1
  s_cmp_ge_u32 s27, 0x80000
  s_cbranch_scc1 L_Oo_37_e
  s_waitcnt vmcnt(1)
  v_cmp_eq_u32 vcc, -1, v16
  s_cbranch_vccz L_Oo_37_k02
  s_branch L_Oo_37_b02
L_Oo_37_b21:
  s_mov_b64 exec, vcc
  buffer_load_dwordx4 v[24:27], v1, s[4:7], s37 offen offset:2048 sc1
  s_mov_b64 exec, -1
  s_add_u32 s27, s27, 1
  s_cmp_ge_u32 s27, 0x80000
  s_cbranch_scc1 L_Oo_37_e
  s_waitcnt vmcnt(1)
  v_cmp_eq_u32 vcc, -1, v20
  s_cbranch_vccz L_Oo_37_k12
  s_branch L_Oo_37_b12
L_Oo_37_b013:
  s_mov_b64 exec, vcc
  buffer_load_dwordx4 v[16:19], v1, s[4:7], s37 offen offset:0 sc1
  s_mov_b64 exec, -1
  s_waitcnt vmcnt(2)
  v_cmp_eq_u32 vcc, -1, v20
  s_cbranch_vccnz L_Oo_37_b130
L_Oo_37_k130:
  v_smfmac_f32_16x16x64_bf16 v[32:35], v[20:23], v[200:207], v2
  v_smfmac_f32_16x16x64_bf16 v[36:39], v[20:23], v[232:239], v2
  s_waitcnt vmcnt(1)
  v_cmp_eq_u32 vcc, -1, v28
  s_cbranch_vccz L_Oo_37_k30
  s_branch L_Oo_37_b30
L_Oo_37_b10:
  s_mov_b64 exec, vcc
  buffer_load_dwordx4 v[20:23], v1, s[4:7], s37 offen offset:1024 sc1
  s_mov_b64 exec, -1
  s_add_u32 s27, s27, 1
  s_cmp_ge_u32 s27, 0x80000
  s_cbranch_scc1 L_Oo_37_e
  s_waitcnt vmcnt(1)
  v_cmp_eq_u32 vcc, -1, v16
  s_cbranch_vccz L_Oo_37_k01
  s_branch L_Oo_37_b01
L_Oo_37_b023:
  s_mov_b64 exec, vcc
  buffer_load_dwordx4 v[16:19], v1, s[4:7], s37 offen offset:0 sc1
  s_mov_b64 exec, -1
  s_waitcnt vmcnt(2)
  v_cmp_eq_u32 vcc, -1, v24
  s_cbranch_vccz L_Oo_37_k230
  s_branch L_Oo_37_b230
L_Oo_37_b120:
  s_mov_b64 exec, vcc
  buffer_load_dwordx4 v[20:23], v1, s[4:7], s37 offen offset:1024 sc1
  s_mov_b64 exec, -1
  s_waitcnt vmcnt(2)
  v_cmp_eq_u32 vcc, -1, v24
  s_cbranch_vccnz L_Oo_37_b201
L_Oo_37_k201:
  v_smfmac_f32_16x16x64_bf16 v[32:35], v[24:27], v[208:215], v2
  v_smfmac_f32_16x16x64_bf16 v[36:39], v[24:27], v[240:247], v2
  s_waitcnt vmcnt(1)
  v_cmp_eq_u32 vcc, -1, v16
  s_cbranch_vccz L_Oo_37_k01
  s_branch L_Oo_37_b01
L_Oo_37_b130:
  s_mov_b64 exec, vcc
  buffer_load_dwordx4 v[20:23], v1, s[4:7], s37 offen offset:1024 sc1
  s_mov_b64 exec, -1
  s_waitcnt vmcnt(2)
  v_cmp_eq_u32 vcc, -1, v28
  s_cbranch_vccz L_Oo_37_k301
  s_branch L_Oo_37_b301
L_Oo_37_b201:
  s_mov_b64 exec, vcc
  buffer_load_dwordx4 v[24:27], v1, s[4:7], s37 offen offset:2048 sc1
  s_mov_b64 exec, -1
  s_add_u32 s27, s27, 1
  s_cmp_ge_u32 s27, 0x80000
  s_cbranch_scc1 L_Oo_37_e
  s_waitcnt vmcnt(2)
  v_cmp_eq_u32 vcc, -1, v16
  s_cbranch_vccz L_Oo_37_k012
  s_branch L_Oo_37_b012
L_O7_f:
  s_add_u32 s29, s36, 4
  s_andn2_b32 s29, s29, 1
  s_cmp_lt_u32 s29, 12
  s_cbranch_scc1 L_O7_fk
  s_cmp_ge_u32 s29, 64
  s_cbranch_scc1 L_O7_fk
  s_mul_i32 s29, s29, 48
  s_cmp_eq_u32 s28, 1
  s_cbranch_scc1 L_O7_fc
  buffer_load_dword v40, v15, s[4:7], s29 offen sc1
  s_branch L_O7_fk
L_O7_fw:
  buffer_load_dword v40, v15, s[4:7], s29 offen sc1
  s_waitcnt vmcnt(0)
L_O7_fc:
  v_cmp_eq_u32 vcc, 0, v40
  s_cbranch_vccz L_O7_fk
  s_add_u32 s27, s27, 1
  s_cmp_lt_u32 s27, 0x80000
  s_cbranch_scc1 L_O7_fw
  s_branch L_O7_fk
L_O7_x:
  v_mov_b32 v14, s36
  s_mov_b64 exec, 1
  buffer_store_dword v14, v13, s[4:7], 0 offen sc1
  s_mov_b64 exec, -1
  s_cmp_eq_u32 s36, 12
  s_cbranch_scc1 L_O7_nx
  buffer_store_dwordx4 v[128:131], v10, s[4:7], s54 offen offset:0 sc1
  buffer_store_dwordx4 v[132:135], v10, s[4:7], s54 offen offset:1024 sc1
  s_add_u32 s54, s54, 8192
  s_cmp_eq_u32 s36, 11
  s_cbranch_scc1 L_O7_nx
  ds_read_b128 v[64:67], v11 offset:0
  ds_read_b128 v[68:71], v11 offset:512
  ds_read_b128 v[72:75], v11 offset:1024
  ds_read_b128 v[76:79], v11 offset:1536
  ds_read_b128 v[80:83], v11 offset:2048
  ds_read_b128 v[84:87], v11 offset:2560
  ds_read_b128 v[88:91], v11 offset:3072
  ds_read_b128 v[92:95], v11 offset:3584
  s_waitcnt lgkmcnt(4)
  ds_read_b128 v[96:99], v11 offset:8192
  ds_read_b128 v[100:103], v11 offset:8704
  ds_read_b128 v[104:107], v11 offset:9216
  ds_read_b128 v[108:111], v11 offset:9728
  ds_read_b128 v[112:115], v11 offset:10240
  ds_read_b128 v[116:119], v11 offset:10752
  ds_read_b128 v[120:123], v11 offset:11264
  ds_read_b128 v[124:127], v11 offset:11776
  v_pk_add_f32 v[64:65], v[64:65], v[72:73]
  v_pk_add_f32 v[66:67], v[66:67], v[74:75]
  v_pk_add_f32 v[68:69], v[68:69], v[76:77]
  v_pk_add_f32 v[70:71], v[70:71], v[78:79]
  s_waitcnt lgkmcnt(8)
  v_pk_add_f32 v[80:81], v[80:81], v[88:89]
  v_pk_add_f32 v[82:83], v[82:83], v[90:91]
  v_pk_add_f32 v[84:85], v[84:85], v[92:93]
  v_pk_add_f32 v[86:87], v[86:87], v[94:95]
  v_pk_add_f32 v[64:65], v[64:65], v[80:81]
  v_pk_add_f32 v[66:67], v[66:67], v[82:83]
  v_pk_add_f32 v[68:69], v[68:69], v[84:85]
  v_pk_add_f32 v[70:71], v[70:71], v[86:87]
  v_cvt_pk_bf16_f32 v128, v64, v65
  v_cvt_pk_bf16_f32 v129, v66, v67
  v_cvt_pk_bf16_f32 v130, v68, v69
  v_cvt_pk_bf16_f32 v131, v70, v71
  ds_write_b128 v10, v[128:131] offset:20480
  s_waitcnt lgkmcnt(5)
  v_pk_add_f32 v[96:97], v[96:97], v[104:105]
  v_pk_add_f32 v[98:99], v[98:99], v[106:107]
  v_pk_add_f32 v[100:101], v[100:101], v[108:109]
  v_pk_add_f32 v[102:103], v[102:103], v[110:111]
  s_waitcnt lgkmcnt(1)
  v_pk_add_f32 v[112:113], v[112:113], v[120:121]
  v_pk_add_f32 v[114:115], v[114:115], v[122:123]
  v_pk_add_f32 v[116:117], v[116:117], v[124:125]
  v_pk_add_f32 v[118:119], v[118:119], v[126:127]
  v_pk_add_f32 v[96:97], v[96:97], v[112:113]
  v_pk_add_f32 v[98:99], v[98:99], v[114:115]
  v_pk_add_f32 v[100:101], v[100:101], v[116:117]
  v_pk_add_f32 v[102:103], v[102:103], v[118:119]
  v_cvt_pk_bf16_f32 v132, v96, v97
  v_cvt_pk_bf16_f32 v133, v98, v99
  v_cvt_pk_bf16_f32 v134, v100, v101
  v_cvt_pk_bf16_f32 v135, v102, v103
  ds_write_b128 v10, v[132:135] offset:21504
  s_waitcnt lgkmcnt(0)
  s_buffer_load_dword s29, s[16:19], s53 offset:64
  s_buffer_load_dword s29, s[16:19], s53 offset:192
  s_buffer_load_dword s29, s[16:19], s53 offset:320
  s_buffer_load_dword s29, s[16:19], s53 offset:448
  s_buffer_load_dword s29, s[16:19], s53 offset:576
  s_buffer_load_dword s29, s[16:19], s53 offset:704
  s_buffer_load_dword s29, s[16:19], s53 offset:832
  s_buffer_load_dword s29, s[16:19], s53 offset:960
  s_add_u32 s53, s53, 65536
  s_branch L_O7_c
L_R_done:
  s_endpgm
.section .rodata,"a"
.p2align 6
.amdhsa_kernel concat_heads__grouped_kv_mqa__memory_aug_recurrent_mem_tr__prompt_kernel
  .amdhsa_next_free_vgpr 256
  .amdhsa_next_free_sgpr 102
  .amdhsa_accum_offset 256
  .amdhsa_group_segment_fixed_size 0
  .amdhsa_kernarg_size 120
  .amdhsa_user_sgpr_count 2
  .amdhsa_user_sgpr_kernarg_segment_ptr 1
  .amdhsa_system_sgpr_workgroup_id_x 1
  .amdhsa_float_denorm_mode_32 3
.end_amdhsa_kernel
.p2align 6
.type task_table,@object
task_table:
.long 0x9, 0x0, 0x0, 0x0, 0x0, 0x0, 0x0, 0x0, 0x0, 0x0, 0x0, 0x0, 0x0, 0x0, 0x0, 0x0
.long 0x9, 0x0, 0x0, 0x0, 0x0, 0x0, 0x0, 0x0, 0x0, 0x0, 0x0, 0x0, 0x0, 0x0, 0x0, 0x0
.long 0x9, 0x0, 0x0, 0x0, 0x0, 0x0, 0x0, 0x0, 0x0, 0x0, 0x0, 0x0, 0x0, 0x0, 0x0, 0x0
.long 0x9, 0x0, 0x0, 0x0, 0x0, 0x0, 0x0, 0x0, 0x0, 0x0, 0x0, 0x0, 0x0, 0x0, 0x0, 0x0
.long 0x9, 0x0, 0x0, 0x0, 0x0, 0x0, 0x0, 0x0, 0x0, 0x0, 0x0, 0x0, 0x0, 0x0, 0x0, 0x0
.long 0x9, 0x0, 0x0, 0x0, 0x0, 0x0, 0x0, 0x0, 0x0, 0x0, 0x0, 0x0, 0x0, 0x0, 0x0, 0x0
.long 0x9, 0x0, 0x0, 0x0, 0x0, 0x0, 0x0, 0x0, 0x0, 0x0, 0x0, 0x0, 0x0, 0x0, 0x0, 0x0
.long 0x9, 0x0, 0x0, 0x0, 0x0, 0x0, 0x0, 0x0, 0x0, 0x0, 0x0, 0x0, 0x0, 0x0, 0x0, 0x0
.long 0x9, 0x0, 0x0, 0x0, 0x0, 0x0, 0x0, 0x0, 0x0, 0x0, 0x0, 0x0, 0x0, 0x0, 0x0, 0x0
.long 0x9, 0x0, 0x0, 0x0, 0x0, 0x0, 0x0, 0x0, 0x0, 0x0, 0x0, 0x0, 0x0, 0x0, 0x0, 0x0
.long 0x9, 0x0, 0x0, 0x0, 0x0, 0x0, 0x0, 0x0, 0x0, 0x0, 0x0, 0x0, 0x0, 0x0, 0x0, 0x0
.long 0x9, 0x0, 0x0, 0x0, 0x0, 0x0, 0x0, 0x0, 0x0, 0x0, 0x0, 0x0, 0x0, 0x0, 0x0, 0x0
.long 0x9, 0x0, 0x0, 0x0, 0x0, 0x0, 0x0, 0x0, 0x0, 0x0, 0x0, 0x0, 0x0, 0x0, 0x0, 0x0
.long 0x9, 0x0, 0x0, 0x0, 0x0, 0x0, 0x0, 0x0, 0x0, 0x0, 0x0, 0x0, 0x0, 0x0, 0x0, 0x0
.long 0x9, 0x0, 0x0, 0x0, 0x0, 0x0, 0x0, 0x0, 0x0, 0x0, 0x0, 0x0, 0x0, 0x0, 0x0, 0x0
.long 0x9, 0x0, 0x0, 0x0, 0x0, 0x0, 0x0, 0x0, 0x0, 0x0, 0x0, 0x0, 0x0, 0x0, 0x0, 0x0
.long 0x9, 0x0, 0x0, 0x0, 0x0, 0x0, 0x0, 0x0, 0x0, 0x0, 0x0, 0x0, 0x0, 0x0, 0x0, 0x0
.long 0x9, 0x0, 0x0, 0x0, 0x0, 0x0, 0x0, 0x0, 0x0, 0x0, 0x0, 0x0, 0x0, 0x0, 0x0, 0x0
.long 0x9, 0x0, 0x0, 0x0, 0x0, 0x0, 0x0, 0x0, 0x0, 0x0, 0x0, 0x0, 0x0, 0x0, 0x0, 0x0
.long 0x9, 0x0, 0x0, 0x0, 0x0, 0x0, 0x0, 0x0, 0x0, 0x0, 0x0, 0x0, 0x0, 0x0, 0x0, 0x0
.long 0x9, 0x0, 0x0, 0x0, 0x0, 0x0, 0x0, 0x0, 0x0, 0x0, 0x0, 0x0, 0x0, 0x0, 0x0, 0x0
.long 0x9, 0x0, 0x0, 0x0, 0x0, 0x0, 0x0, 0x0, 0x0, 0x0, 0x0, 0x0, 0x0, 0x0, 0x0, 0x0
.long 0x9, 0x0, 0x0, 0x0, 0x0, 0x0, 0x0, 0x0, 0x0, 0x0, 0x0, 0x0, 0x0, 0x0, 0x0, 0x0
.long 0x9, 0x0, 0x0, 0x0, 0x0, 0x0, 0x0, 0x0, 0x0, 0x0, 0x0, 0x0, 0x0, 0x0, 0x0, 0x0
.long 0x9, 0x0, 0x0, 0x0, 0x0, 0x0, 0x0, 0x0, 0x0, 0x0, 0x0, 0x0, 0x0, 0x0, 0x0, 0x0
.long 0x9, 0x0, 0x0, 0x0, 0x0, 0x0, 0x0, 0x0, 0x0, 0x0, 0x0, 0x0, 0x0, 0x0, 0x0, 0x0
.long 0x9, 0x0, 0x0, 0x0, 0x0, 0x0, 0x0, 0x0, 0x0, 0x0, 0x0, 0x0, 0x0, 0x0, 0x0, 0x0
.long 0x9, 0x0, 0x0, 0x0, 0x0, 0x0, 0x0, 0x0, 0x0, 0x0, 0x0, 0x0, 0x0, 0x0, 0x0, 0x0
.long 0x9, 0x0, 0x0, 0x0, 0x0, 0x0, 0x0, 0x0, 0x0, 0x0, 0x0, 0x0, 0x0, 0x0, 0x0, 0x0
.long 0x9, 0x0, 0x0, 0x0, 0x0, 0x0, 0x0, 0x0, 0x0, 0x0, 0x0, 0x0, 0x0, 0x0, 0x0, 0x0
.long 0x9, 0x0, 0x0, 0x0, 0x0, 0x0, 0x0, 0x0, 0x0, 0x0, 0x0, 0x0, 0x0, 0x0, 0x0, 0x0
.long 0x9, 0x0, 0x0, 0x0, 0x0, 0x0, 0x0, 0x0, 0x0, 0x0, 0x0, 0x0, 0x0, 0x0, 0x0, 0x0
.long 0x9, 0x0, 0x0, 0x0, 0x0, 0x0, 0x0, 0x0, 0x0, 0x0, 0x0, 0x0, 0x0, 0x0, 0x0, 0x0
.long 0x9, 0x0, 0x0, 0x0, 0x0, 0x0, 0x0, 0x0, 0x0, 0x0, 0x0, 0x0, 0x0, 0x0, 0x0, 0x0
.long 0x9, 0x0, 0x0, 0x0, 0x0, 0x0, 0x0, 0x0, 0x0, 0x0, 0x0, 0x0, 0x0, 0x0, 0x0, 0x0
.long 0x9, 0x0, 0x0, 0x0, 0x0, 0x0, 0x0, 0x0, 0x0, 0x0, 0x0, 0x0, 0x0, 0x0, 0x0, 0x0
.long 0x9, 0x0, 0x0, 0x0, 0x0, 0x0, 0x0, 0x0, 0x0, 0x0, 0x0, 0x0, 0x0, 0x0, 0x0, 0x0
.long 0x9, 0x0, 0x0, 0x0, 0x0, 0x0, 0x0, 0x0, 0x0, 0x0, 0x0, 0x0, 0x0, 0x0, 0x0, 0x0
.long 0x9, 0x0, 0x0, 0x0, 0x0, 0x0, 0x0, 0x0, 0x0, 0x0, 0x0, 0x0, 0x0, 0x0, 0x0, 0x0
.long 0x9, 0x0, 0x0, 0x0, 0x0, 0x0, 0x0, 0x0, 0x0, 0x0, 0x0, 0x0, 0x0, 0x0, 0x0, 0x0
.long 0x9, 0x0, 0x0, 0x0, 0x0, 0x0, 0x0, 0x0, 0x0, 0x0, 0x0, 0x0, 0x0, 0x0, 0x0, 0x0
.long 0x9, 0x0, 0x0, 0x0, 0x0, 0x0, 0x0, 0x0, 0x0, 0x0, 0x0, 0x0, 0x0, 0x0, 0x0, 0x0
.long 0x9, 0x0, 0x0, 0x0, 0x0, 0x0, 0x0, 0x0, 0x0, 0x0, 0x0, 0x0, 0x0, 0x0, 0x0, 0x0
.long 0x9, 0x0, 0x0, 0x0, 0x0, 0x0, 0x0, 0x0, 0x0, 0x0, 0x0, 0x0, 0x0, 0x0, 0x0, 0x0
.long 0x9, 0x0, 0x0, 0x0, 0x0, 0x0, 0x0, 0x0, 0x0, 0x0, 0x0, 0x0, 0x0, 0x0, 0x0, 0x0
.long 0x9, 0x0, 0x0, 0x0, 0x0, 0x0, 0x0, 0x0, 0x0, 0x0, 0x0, 0x0, 0x0, 0x0, 0x0, 0x0
.long 0x9, 0x0, 0x0, 0x0, 0x0, 0x0, 0x0, 0x0, 0x0, 0x0, 0x0, 0x0, 0x0, 0x0, 0x0, 0x0
.long 0x9, 0x0, 0x0, 0x0, 0x0, 0x0, 0x0, 0x0, 0x0, 0x0, 0x0, 0x0, 0x0, 0x0, 0x0, 0x0
.long 0x9, 0x0, 0x0, 0x0, 0x0, 0x0, 0x0, 0x0, 0x0, 0x0, 0x0, 0x0, 0x0, 0x0, 0x0, 0x0
.long 0x9, 0x0, 0x0, 0x0, 0x0, 0x0, 0x0, 0x0, 0x0, 0x0, 0x0, 0x0, 0x0, 0x0, 0x0, 0x0
.long 0x9, 0x0, 0x0, 0x0, 0x0, 0x0, 0x0, 0x0, 0x0, 0x0, 0x0, 0x0, 0x0, 0x0, 0x0, 0x0
.long 0x9, 0x0, 0x0, 0x0, 0x0, 0x0, 0x0, 0x0, 0x0, 0x0, 0x0, 0x0, 0x0, 0x0, 0x0, 0x0
.long 0x9, 0x0, 0x0, 0x0, 0x0, 0x0, 0x0, 0x0, 0x0, 0x0, 0x0, 0x0, 0x0, 0x0, 0x0, 0x0
.long 0x9, 0x0, 0x0, 0x0, 0x0, 0x0, 0x0, 0x0, 0x0, 0x0, 0x0, 0x0, 0x0, 0x0, 0x0, 0x0
.long 0x9, 0x0, 0x0, 0x0, 0x0, 0x0, 0x0, 0x0, 0x0, 0x0, 0x0, 0x0, 0x0, 0x0, 0x0, 0x0
.long 0x9, 0x0, 0x0, 0x0, 0x0, 0x0, 0x0, 0x0, 0x0, 0x0, 0x0, 0x0, 0x0, 0x0, 0x0, 0x0
.long 0x9, 0x0, 0x0, 0x0, 0x0, 0x0, 0x0, 0x0, 0x0, 0x0, 0x0, 0x0, 0x0, 0x0, 0x0, 0x0
.long 0x9, 0x0, 0x0, 0x0, 0x0, 0x0, 0x0, 0x0, 0x0, 0x0, 0x0, 0x0, 0x0, 0x0, 0x0, 0x0
.long 0x9, 0x0, 0x0, 0x0, 0x0, 0x0, 0x0, 0x0, 0x0, 0x0, 0x0, 0x0, 0x0, 0x0, 0x0, 0x0
.long 0x9, 0x0, 0x0, 0x0, 0x0, 0x0, 0x0, 0x0, 0x0, 0x0, 0x0, 0x0, 0x0, 0x0, 0x0, 0x0
.long 0x9, 0x0, 0x0, 0x0, 0x0, 0x0, 0x0, 0x0, 0x0, 0x0, 0x0, 0x0, 0x0, 0x0, 0x0, 0x0
.long 0x9, 0x0, 0x0, 0x0, 0x0, 0x0, 0x0, 0x0, 0x0, 0x0, 0x0, 0x0, 0x0, 0x0, 0x0, 0x0
.long 0x9, 0x0, 0x0, 0x0, 0x0, 0x0, 0x0, 0x0, 0x0, 0x0, 0x0, 0x0, 0x0, 0x0, 0x0, 0x0
.long 0x9, 0x0, 0x0, 0x0, 0x0, 0x0, 0x0, 0x0, 0x0, 0x0, 0x0, 0x0, 0x0, 0x0, 0x0, 0x0
.long 0x9, 0x0, 0x0, 0x0, 0x0, 0x0, 0x0, 0x0, 0x0, 0x0, 0x0, 0x0, 0x0, 0x0, 0x0, 0x0
.long 0x9, 0x0, 0x0, 0x0, 0x0, 0x0, 0x0, 0x0, 0x0, 0x0, 0x0, 0x0, 0x0, 0x0, 0x0, 0x0
.long 0x9, 0x0, 0x0, 0x0, 0x0, 0x0, 0x0, 0x0, 0x0, 0x0, 0x0, 0x0, 0x0, 0x0, 0x0, 0x0
.long 0x9, 0x0, 0x0, 0x0, 0x0, 0x0, 0x0, 0x0, 0x0, 0x0, 0x0, 0x0, 0x0, 0x0, 0x0, 0x0
.long 0x9, 0x0, 0x0, 0x0, 0x0, 0x0, 0x0, 0x0, 0x0, 0x0, 0x0, 0x0, 0x0, 0x0, 0x0, 0x0
.long 0x9, 0x0, 0x0, 0x0, 0x0, 0x0, 0x0, 0x0, 0x0, 0x0, 0x0, 0x0, 0x0, 0x0, 0x0, 0x0
.long 0x9, 0x0, 0x0, 0x0, 0x0, 0x0, 0x0, 0x0, 0x0, 0x0, 0x0, 0x0, 0x0, 0x0, 0x0, 0x0
.long 0x9, 0x0, 0x0, 0x0, 0x0, 0x0, 0x0, 0x0, 0x0, 0x0, 0x0, 0x0, 0x0, 0x0, 0x0, 0x0
.long 0x9, 0x0, 0x0, 0x0, 0x0, 0x0, 0x0, 0x0, 0x0, 0x0, 0x0, 0x0, 0x0, 0x0, 0x0, 0x0
.long 0x9, 0x0, 0x0, 0x0, 0x0, 0x0, 0x0, 0x0, 0x0, 0x0, 0x0, 0x0, 0x0, 0x0, 0x0, 0x0
.long 0x9, 0x0, 0x0, 0x0, 0x0, 0x0, 0x0, 0x0, 0x0, 0x0, 0x0, 0x0, 0x0, 0x0, 0x0, 0x0
.long 0x9, 0x0, 0x0, 0x0, 0x0, 0x0, 0x0, 0x0, 0x0, 0x0, 0x0, 0x0, 0x0, 0x0, 0x0, 0x0
.long 0x9, 0x0, 0x0, 0x0, 0x0, 0x0, 0x0, 0x0, 0x0, 0x0, 0x0, 0x0, 0x0, 0x0, 0x0, 0x0
.long 0x9, 0x0, 0x0, 0x0, 0x0, 0x0, 0x0, 0x0, 0x0, 0x0, 0x0, 0x0, 0x0, 0x0, 0x0, 0x0
.long 0x9, 0x0, 0x0, 0x0, 0x0, 0x0, 0x0, 0x0, 0x0, 0x0, 0x0, 0x0, 0x0, 0x0, 0x0, 0x0
.long 0x9, 0x0, 0x0, 0x0, 0x0, 0x0, 0x0, 0x0, 0x0, 0x0, 0x0, 0x0, 0x0, 0x0, 0x0, 0x0
.long 0x9, 0x0, 0x0, 0x0, 0x0, 0x0, 0x0, 0x0, 0x0, 0x0, 0x0, 0x0, 0x0, 0x0, 0x0, 0x0
.long 0x9, 0x0, 0x0, 0x0, 0x0, 0x0, 0x0, 0x0, 0x0, 0x0, 0x0, 0x0, 0x0, 0x0, 0x0, 0x0
.long 0x9, 0x0, 0x0, 0x0, 0x0, 0x0, 0x0, 0x0, 0x0, 0x0, 0x0, 0x0, 0x0, 0x0, 0x0, 0x0
.long 0x9, 0x0, 0x0, 0x0, 0x0, 0x0, 0x0, 0x0, 0x0, 0x0, 0x0, 0x0, 0x0, 0x0, 0x0, 0x0
.long 0x9, 0x0, 0x0, 0x0, 0x0, 0x0, 0x0, 0x0, 0x0, 0x0, 0x0, 0x0, 0x0, 0x0, 0x0, 0x0
.long 0x9, 0x0, 0x0, 0x0, 0x0, 0x0, 0x0, 0x0, 0x0, 0x0, 0x0, 0x0, 0x0, 0x0, 0x0, 0x0
.long 0x9, 0x0, 0x0, 0x0, 0x0, 0x0, 0x0, 0x0, 0x0, 0x0, 0x0, 0x0, 0x0, 0x0, 0x0, 0x0
.long 0x9, 0x0, 0x0, 0x0, 0x0, 0x0, 0x0, 0x0, 0x0, 0x0, 0x0, 0x0, 0x0, 0x0, 0x0, 0x0
.long 0x9, 0x0, 0x0, 0x0, 0x0, 0x0, 0x0, 0x0, 0x0, 0x0, 0x0, 0x0, 0x0, 0x0, 0x0, 0x0
.long 0x9, 0x0, 0x0, 0x0, 0x0, 0x0, 0x0, 0x0, 0x0, 0x0, 0x0, 0x0, 0x0, 0x0, 0x0, 0x0
.long 0x9, 0x0, 0x0, 0x0, 0x0, 0x0, 0x0, 0x0, 0x0, 0x0, 0x0, 0x0, 0x0, 0x0, 0x0, 0x0
.long 0x9, 0x0, 0x0, 0x0, 0x0, 0x0, 0x0, 0x0, 0x0, 0x0, 0x0, 0x0, 0x0, 0x0, 0x0, 0x0
.long 0x9, 0x0, 0x0, 0x0, 0x0, 0x0, 0x0, 0x0, 0x0, 0x0, 0x0, 0x0, 0x0, 0x0, 0x0, 0x0
.long 0x9, 0x0, 0x0, 0x0, 0x0, 0x0, 0x0, 0x0, 0x0, 0x0, 0x0, 0x0, 0x0, 0x0, 0x0, 0x0
.long 0x9, 0x0, 0x0, 0x0, 0x0, 0x0, 0x0, 0x0, 0x0, 0x0, 0x0, 0x0, 0x0, 0x0, 0x0, 0x0
.long 0x9, 0x0, 0x0, 0x0, 0x0, 0x0, 0x0, 0x0, 0x0, 0x0, 0x0, 0x0, 0x0, 0x0, 0x0, 0x0
.long 0x9, 0x0, 0x0, 0x0, 0x0, 0x0, 0x0, 0x0, 0x0, 0x0, 0x0, 0x0, 0x0, 0x0, 0x0, 0x0
.long 0x9, 0x0, 0x0, 0x0, 0x0, 0x0, 0x0, 0x0, 0x0, 0x0, 0x0, 0x0, 0x0, 0x0, 0x0, 0x0
.long 0x9, 0x0, 0x0, 0x0, 0x0, 0x0, 0x0, 0x0, 0x0, 0x0, 0x0, 0x0, 0x0, 0x0, 0x0, 0x0
.long 0x9, 0x0, 0x0, 0x0, 0x0, 0x0, 0x0, 0x0, 0x0, 0x0, 0x0, 0x0, 0x0, 0x0, 0x0, 0x0
.long 0x9, 0x0, 0x0, 0x0, 0x0, 0x0, 0x0, 0x0, 0x0, 0x0, 0x0, 0x0, 0x0, 0x0, 0x0, 0x0
.long 0x9, 0x0, 0x0, 0x0, 0x0, 0x0, 0x0, 0x0, 0x0, 0x0, 0x0, 0x0, 0x0, 0x0, 0x0, 0x0
.long 0x9, 0x0, 0x0, 0x0, 0x0, 0x0, 0x0, 0x0, 0x0, 0x0, 0x0, 0x0, 0x0, 0x0, 0x0, 0x0
.long 0x9, 0x0, 0x0, 0x0, 0x0, 0x0, 0x0, 0x0, 0x0, 0x0, 0x0, 0x0, 0x0, 0x0, 0x0, 0x0
.long 0x9, 0x0, 0x0, 0x0, 0x0, 0x0, 0x0, 0x0, 0x0, 0x0, 0x0, 0x0, 0x0, 0x0, 0x0, 0x0
.long 0x9, 0x0, 0x0, 0x0, 0x0, 0x0, 0x0, 0x0, 0x0, 0x0, 0x0, 0x0, 0x0, 0x0, 0x0, 0x0
.long 0x9, 0x0, 0x0, 0x0, 0x0, 0x0, 0x0, 0x0, 0x0, 0x0, 0x0, 0x0, 0x0, 0x0, 0x0, 0x0
.long 0x9, 0x0, 0x0, 0x0, 0x0, 0x0, 0x0, 0x0, 0x0, 0x0, 0x0, 0x0, 0x0, 0x0, 0x0, 0x0
.long 0x9, 0x0, 0x0, 0x0, 0x0, 0x0, 0x0, 0x0, 0x0, 0x0, 0x0, 0x0, 0x0, 0x0, 0x0, 0x0
.long 0x9, 0x0, 0x0, 0x0, 0x0, 0x0, 0x0, 0x0, 0x0, 0x0, 0x0, 0x0, 0x0, 0x0, 0x0, 0x0
.long 0x9, 0x0, 0x0, 0x0, 0x0, 0x0, 0x0, 0x0, 0x0, 0x0, 0x0, 0x0, 0x0, 0x0, 0x0, 0x0
.long 0x9, 0x0, 0x0, 0x0, 0x0, 0x0, 0x0, 0x0, 0x0, 0x0, 0x0, 0x0, 0x0, 0x0, 0x0, 0x0
.long 0x9, 0x0, 0x0, 0x0, 0x0, 0x0, 0x0, 0x0, 0x0, 0x0, 0x0, 0x0, 0x0, 0x0, 0x0, 0x0
.long 0x9, 0x0, 0x0, 0x0, 0x0, 0x0, 0x0, 0x0, 0x0, 0x0, 0x0, 0x0, 0x0, 0x0, 0x0, 0x0
.long 0x9, 0x0, 0x0, 0x0, 0x0, 0x0, 0x0, 0x0, 0x0, 0x0, 0x0, 0x0, 0x0, 0x0, 0x0, 0x0
.long 0x9, 0x0, 0x0, 0x0, 0x0, 0x0, 0x0, 0x0, 0x0, 0x0, 0x0, 0x0, 0x0, 0x0, 0x0, 0x0
.long 0x9, 0x0, 0x0, 0x0, 0x0, 0x0, 0x0, 0x0, 0x0, 0x0, 0x0, 0x0, 0x0, 0x0, 0x0, 0x0
.long 0x9, 0x0, 0x0, 0x0, 0x0, 0x0, 0x0, 0x0, 0x0, 0x0, 0x0, 0x0, 0x0, 0x0, 0x0, 0x0
.long 0x9, 0x0, 0x0, 0x0, 0x0, 0x0, 0x0, 0x0, 0x0, 0x0, 0x0, 0x0, 0x0, 0x0, 0x0, 0x0
.long 0x9, 0x0, 0x0, 0x0, 0x0, 0x0, 0x0, 0x0, 0x0, 0x0, 0x0, 0x0, 0x0, 0x0, 0x0, 0x0
.long 0x9, 0x0, 0x0, 0x0, 0x0, 0x0, 0x0, 0x0, 0x0, 0x0, 0x0, 0x0, 0x0, 0x0, 0x0, 0x0
.long 0x9, 0x0, 0x0, 0x0, 0x0, 0x0, 0x0, 0x0, 0x0, 0x0, 0x0, 0x0, 0x0, 0x0, 0x0, 0x0
.long 0x9, 0x0, 0x0, 0x0, 0x0, 0x0, 0x0, 0x0, 0x0, 0x0, 0x0, 0x0, 0x0, 0x0, 0x0, 0x0
.long 0x9, 0x0, 0x0, 0x0, 0x0, 0x0, 0x0, 0x0, 0x0, 0x0, 0x0, 0x0, 0x0, 0x0, 0x0, 0x0
.long 0x9, 0x0, 0x0, 0x0, 0x0, 0x0, 0x0, 0x0, 0x0, 0x0, 0x0, 0x0, 0x0, 0x0, 0x0, 0x0
.long 0x9, 0x0, 0x0, 0x0, 0x0, 0x0, 0x0, 0x0, 0x0, 0x0, 0x0, 0x0, 0x0, 0x0, 0x0, 0x0
.long 0x9, 0x0, 0x0, 0x0, 0x0, 0x0, 0x0, 0x0, 0x0, 0x0, 0x0, 0x0, 0x0, 0x0, 0x0, 0x0
.long 0x9, 0x0, 0x0, 0x0, 0x0, 0x0, 0x0, 0x0, 0x0, 0x0, 0x0, 0x0, 0x0, 0x0, 0x0, 0x0
.long 0x2, 0x4, 0x6, 0x0, 0x0, 0x0, 0x0, 0x0, 0x0, 0x0, 0x0, 0x0, 0x0, 0x0, 0x0, 0x0
.long 0x400031, 0x22, 0x24, 0x164, 0x400076, 0x0, 0x0, 0x0, 0x0, 0x0, 0x0, 0x0, 0x0, 0x0, 0x0, 0x0
.long 0x401031, 0x42, 0x44, 0x184, 0x400086, 0x0, 0x0, 0x0, 0x0, 0x0, 0x0, 0x0, 0x0, 0x0, 0x0, 0x0
.long 0x402031, 0x62, 0x64, 0x400026, 0x5, 0x0, 0x0, 0x0, 0x0, 0x0, 0x0, 0x0, 0x0, 0x0, 0x0, 0x0
.long 0x10000041, 0x61, 0x84, 0x400036, 0x25, 0x0, 0x0, 0x0, 0x0, 0x0, 0x0, 0x0, 0x0, 0x0, 0x0, 0x0
.long 0x10001041, 0x1061, 0xa4, 0x400046, 0x45, 0x0, 0x0, 0x0, 0x0, 0x0, 0x0, 0x0, 0x0, 0x0, 0x0, 0x0
.long 0x10002041, 0x2061, 0xc4, 0x400056, 0x65, 0x0, 0x0, 0x0, 0x0, 0x0, 0x0, 0x0, 0x0, 0x0, 0x0, 0x0
.long 0x10003041, 0x3061, 0xe4, 0x400066, 0x85, 0x0, 0x0, 0x0, 0x0, 0x0, 0x0, 0x0, 0x0, 0x0, 0x0, 0x0
.long 0x403031, 0x82, 0x203081, 0x104, 0x3a4, 0xa5, 0x0, 0x0, 0x0, 0x0, 0x0, 0x0, 0x0, 0x0, 0x0, 0x0
.long 0x500031, 0xa2, 0xa1, 0x124, 0x3c4, 0xc5, 0x0, 0x0, 0x0, 0x0, 0x0, 0x0, 0x0, 0x0, 0x0, 0x0
.long 0x501031, 0xc2, 0x10a1, 0x144, 0x3e4, 0xe5, 0x0, 0x0, 0x0, 0x0, 0x0, 0x0, 0x0, 0x0, 0x0, 0x0
.long 0x10100041, 0x10100061, 0x101000a1, 0x10e1, 0x400096, 0x0, 0x0, 0x0, 0x0, 0x0, 0x0, 0x0, 0x0, 0x0, 0x0, 0x0
.long 0x10101041, 0x10101061, 0x101010a1, 0x20e1, 0x1e4, 0x24000288, 0x0, 0x0, 0x0, 0x0, 0x0, 0x0, 0x0, 0x0, 0x0, 0x0
.long 0x10102041, 0x10102061, 0x101020a1, 0x30e1, 0x204, 0x24001288, 0x0, 0x0, 0x0, 0x0, 0x0, 0x0, 0x0, 0x0, 0x0, 0x0
.long 0x10103041, 0x10103061, 0x101030a1, 0x1000e1, 0x224, 0x24002288, 0x0, 0x0, 0x0, 0x0, 0x0, 0x0, 0x0, 0x0, 0x0, 0x0
.long 0x10200001, 0x10000081, 0x100000c1, 0x1010e1, 0x244, 0x24004288, 0x0, 0x0, 0x0, 0x0, 0x0, 0x0, 0x0, 0x0, 0x0, 0x0
.long 0x10201001, 0x10001081, 0x100010c1, 0x1020e1, 0x264, 0x24005288, 0x0, 0x0, 0x0, 0x0, 0x0, 0x0, 0x0, 0x0, 0x0, 0x0
.long 0x10202001, 0x10002081, 0x100020c1, 0x1030e1, 0x284, 0x24006288, 0x0, 0x0, 0x0, 0x0, 0x0, 0x0, 0x0, 0x0, 0x0, 0x0
.long 0x10203001, 0x10003081, 0x100030c1, 0x2000c1, 0x2a4, 0x24007288, 0x0, 0x0, 0x0, 0x0, 0x0, 0x0, 0x0, 0x0, 0x0, 0x0
.long 0x502031, 0xe2, 0x100020a1, 0x2030a1, 0x1a4, 0x24003288, 0x0, 0x0, 0x0, 0x0, 0x0, 0x0, 0x0, 0x0, 0x0, 0x0
.long 0x10200021, 0x10100081, 0x101000c1, 0x2010c1, 0x2c4, 0x24000298, 0x0, 0x0, 0x0, 0x0, 0x0, 0x0, 0x0, 0x0, 0x0, 0x0
.long 0x10201021, 0x10101081, 0x101010c1, 0x2020c1, 0x2e4, 0x24001298, 0x0, 0x0, 0x0, 0x0, 0x0, 0x0, 0x0, 0x0, 0x0, 0x0
.long 0x10202021, 0x10102081, 0x101020c1, 0x2030c1, 0x304, 0x24002298, 0x0, 0x0, 0x0, 0x0, 0x0, 0x0, 0x0, 0x0, 0x0, 0x0
.long 0x10203021, 0x10103081, 0x101030c1, 0x2000e1, 0x324, 0x24004298, 0x0, 0x0, 0x0, 0x0, 0x0, 0x0, 0x0, 0x0, 0x0, 0x0
.long 0x10200041, 0x10200081, 0x102000a1, 0x2010e1, 0x344, 0x24005298, 0x0, 0x0, 0x0, 0x0, 0x0, 0x0, 0x0, 0x0, 0x0, 0x0
.long 0x10201041, 0x10201081, 0x102010a1, 0x2020e1, 0x364, 0x24006298, 0x0, 0x0, 0x0, 0x0, 0x0, 0x0, 0x0, 0x0, 0x0, 0x0
.long 0x10202041, 0x10202081, 0x102020a1, 0x2030e1, 0x384, 0x24007298, 0x0, 0x0, 0x0, 0x0, 0x0, 0x0, 0x0, 0x0, 0x0, 0x0
.long 0x503031, 0x10203041, 0x100030a1, 0xe1, 0x1c4, 0x24003298, 0x0, 0x0, 0x0, 0x0, 0x0, 0x0, 0x0, 0x0, 0x0, 0x0
.long 0x3, 0x30010b, 0x20100b, 0x200061, 0x44000007, 0x0, 0x0, 0x0, 0x0, 0x0, 0x0, 0x0, 0x0, 0x0, 0x0, 0x0
.long 0x13, 0x30013b, 0x20102b, 0x201061, 0x44000017, 0x0, 0x0, 0x0, 0x0, 0x0, 0x0, 0x0, 0x0, 0x0, 0x0, 0x0
.long 0x23, 0x30016b, 0x20104b, 0x202061, 0x44000027, 0x0, 0x0, 0x0, 0x0, 0x0, 0x0, 0x0, 0x0, 0x0, 0x0, 0x0
.long 0x33, 0x30019b, 0x20106b, 0x203061, 0x44000037, 0x0, 0x0, 0x0, 0x0, 0x0, 0x0, 0x0, 0x0, 0x0, 0x0, 0x0
.long 0x1002, 0x1004, 0x1006, 0x0, 0x0, 0x0, 0x0, 0x0, 0x0, 0x0, 0x0, 0x0, 0x0, 0x0, 0x0, 0x0
.long 0x404031, 0x1022, 0x1024, 0x1164, 0x401076, 0x0, 0x0, 0x0, 0x0, 0x0, 0x0, 0x0, 0x0, 0x0, 0x0, 0x0
.long 0x405031, 0x1042, 0x1044, 0x1184, 0x401086, 0x0, 0x0, 0x0, 0x0, 0x0, 0x0, 0x0, 0x0, 0x0, 0x0, 0x0
.long 0x406031, 0x1062, 0x1064, 0x401026, 0x1005, 0x0, 0x0, 0x0, 0x0, 0x0, 0x0, 0x0, 0x0, 0x0, 0x0, 0x0
.long 0x10004041, 0x4061, 0x1084, 0x401036, 0x1025, 0x0, 0x0, 0x0, 0x0, 0x0, 0x0, 0x0, 0x0, 0x0, 0x0, 0x0
.long 0x10005041, 0x5061, 0x10a4, 0x401046, 0x1045, 0x0, 0x0, 0x0, 0x0, 0x0, 0x0, 0x0, 0x0, 0x0, 0x0, 0x0
.long 0x10006041, 0x6061, 0x10c4, 0x401056, 0x1065, 0x0, 0x0, 0x0, 0x0, 0x0, 0x0, 0x0, 0x0, 0x0, 0x0, 0x0
.long 0x10007041, 0x7061, 0x10e4, 0x401066, 0x1085, 0x0, 0x0, 0x0, 0x0, 0x0, 0x0, 0x0, 0x0, 0x0, 0x0, 0x0
.long 0x407031, 0x1082, 0x207081, 0x1104, 0x13a4, 0x10a5, 0x0, 0x0, 0x0, 0x0, 0x0, 0x0, 0x0, 0x0, 0x0, 0x0
.long 0x504031, 0x10a2, 0x40a1, 0x1124, 0x13c4, 0x10c5, 0x0, 0x0, 0x0, 0x0, 0x0, 0x0, 0x0, 0x0, 0x0, 0x0
.long 0x505031, 0x10c2, 0x50a1, 0x1144, 0x13e4, 0x10e5, 0x0, 0x0, 0x0, 0x0, 0x0, 0x0, 0x0, 0x0, 0x0, 0x0
.long 0x10104041, 0x10104061, 0x101040a1, 0x50e1, 0x401096, 0x0, 0x0, 0x0, 0x0, 0x0, 0x0, 0x0, 0x0, 0x0, 0x0, 0x0
.long 0x10105041, 0x10105061, 0x101050a1, 0x60e1, 0x11e4, 0x24010288, 0x0, 0x0, 0x0, 0x0, 0x0, 0x0, 0x0, 0x0, 0x0, 0x0
.long 0x10106041, 0x10106061, 0x101060a1, 0x70e1, 0x1204, 0x24011288, 0x0, 0x0, 0x0, 0x0, 0x0, 0x0, 0x0, 0x0, 0x0, 0x0
.long 0x10107041, 0x10107061, 0x101070a1, 0x1040e1, 0x1224, 0x24012288, 0x0, 0x0, 0x0, 0x0, 0x0, 0x0, 0x0, 0x0, 0x0, 0x0
.long 0x10204001, 0x10004081, 0x100040c1, 0x1050e1, 0x1244, 0x24014288, 0x0, 0x0, 0x0, 0x0, 0x0, 0x0, 0x0, 0x0, 0x0, 0x0
.long 0x10205001, 0x10005081, 0x100050c1, 0x1060e1, 0x1264, 0x24015288, 0x0, 0x0, 0x0, 0x0, 0x0, 0x0, 0x0, 0x0, 0x0, 0x0
.long 0x10206001, 0x10006081, 0x100060c1, 0x1070e1, 0x1284, 0x24016288, 0x0, 0x0, 0x0, 0x0, 0x0, 0x0, 0x0, 0x0, 0x0, 0x0
.long 0x10207001, 0x10007081, 0x100070c1, 0x2040c1, 0x12a4, 0x24017288, 0x0, 0x0, 0x0, 0x0, 0x0, 0x0, 0x0, 0x0, 0x0, 0x0
.long 0x506031, 0x10e2, 0x100060a1, 0x2070a1, 0x11a4, 0x24013288, 0x0, 0x0, 0x0, 0x0, 0x0, 0x0, 0x0, 0x0, 0x0, 0x0
.long 0x10204021, 0x10104081, 0x101040c1, 0x2050c1, 0x12c4, 0x24010298, 0x0, 0x0, 0x0, 0x0, 0x0, 0x0, 0x0, 0x0, 0x0, 0x0
.long 0x10205021, 0x10105081, 0x101050c1, 0x2060c1, 0x12e4, 0x24011298, 0x0, 0x0, 0x0, 0x0, 0x0, 0x0, 0x0, 0x0, 0x0, 0x0
.long 0x10206021, 0x10106081, 0x101060c1, 0x2070c1, 0x1304, 0x24012298, 0x0, 0x0, 0x0, 0x0, 0x0, 0x0, 0x0, 0x0, 0x0, 0x0
.long 0x10207021, 0x10107081, 0x101070c1, 0x2040e1, 0x1324, 0x24014298, 0x0, 0x0, 0x0, 0x0, 0x0, 0x0, 0x0, 0x0, 0x0, 0x0
.long 0x10204041, 0x10204081, 0x102040a1, 0x2050e1, 0x1344, 0x24015298, 0x0, 0x0, 0x0, 0x0, 0x0, 0x0, 0x0, 0x0, 0x0, 0x0
.long 0x10205041, 0x10205081, 0x102050a1, 0x2060e1, 0x1364, 0x24016298, 0x0, 0x0, 0x0, 0x0, 0x0, 0x0, 0x0, 0x0, 0x0, 0x0
.long 0x10206041, 0x10206081, 0x102060a1, 0x2070e1, 0x1384, 0x24017298, 0x0, 0x0, 0x0, 0x0, 0x0, 0x0, 0x0, 0x0, 0x0, 0x0
.long 0x507031, 0x10207041, 0x100070a1, 0x40e1, 0x11c4, 0x24013298, 0x0, 0x0, 0x0, 0x0, 0x0, 0x0, 0x0, 0x0, 0x0, 0x0
.long 0x43, 0x3001cb, 0x20108b, 0x204061, 0x44001007, 0x0, 0x0, 0x0, 0x0, 0x0, 0x0, 0x0, 0x0, 0x0, 0x0, 0x0
.long 0x53, 0x3001fb, 0x2010ab, 0x205061, 0x44001017, 0x0, 0x0, 0x0, 0x0, 0x0, 0x0, 0x0, 0x0, 0x0, 0x0, 0x0
.long 0x63, 0x30022b, 0x2010cb, 0x206061, 0x44001027, 0x0, 0x0, 0x0, 0x0, 0x0, 0x0, 0x0, 0x0, 0x0, 0x0, 0x0
.long 0xa, 0x73, 0x30025b, 0x2010eb, 0x207061, 0x44001037, 0x0, 0x0, 0x0, 0x0, 0x0, 0x0, 0x0, 0x0, 0x0, 0x0
.long 0x2002, 0x14, 0x2006, 0x0, 0x0, 0x0, 0x0, 0x0, 0x0, 0x0, 0x0, 0x0, 0x0, 0x0, 0x0, 0x0
.long 0x408031, 0x2022, 0x34, 0x174, 0x402076, 0x0, 0x0, 0x0, 0x0, 0x0, 0x0, 0x0, 0x0, 0x0, 0x0, 0x0
.long 0x409031, 0x2042, 0x54, 0x194, 0x402086, 0x0, 0x0, 0x0, 0x0, 0x0, 0x0, 0x0, 0x0, 0x0, 0x0, 0x0
.long 0x40a031, 0x2062, 0x74, 0x402026, 0x2005, 0x0, 0x0, 0x0, 0x0, 0x0, 0x0, 0x0, 0x0, 0x0, 0x0, 0x0
.long 0x10008041, 0x8061, 0x94, 0x402036, 0x2025, 0x0, 0x0, 0x0, 0x0, 0x0, 0x0, 0x0, 0x0, 0x0, 0x0, 0x0
.long 0x10009041, 0x9061, 0xb4, 0x402046, 0x2045, 0x0, 0x0, 0x0, 0x0, 0x0, 0x0, 0x0, 0x0, 0x0, 0x0, 0x0
.long 0x1000a041, 0xa061, 0xd4, 0x402056, 0x2065, 0x0, 0x0, 0x0, 0x0, 0x0, 0x0, 0x0, 0x0, 0x0, 0x0, 0x0
.long 0x1000b041, 0xb061, 0xf4, 0x402066, 0x2085, 0x0, 0x0, 0x0, 0x0, 0x0, 0x0, 0x0, 0x0, 0x0, 0x0, 0x0
.long 0x40b031, 0x2082, 0x20b081, 0x114, 0x3b4, 0x20a5, 0x0, 0x0, 0x0, 0x0, 0x0, 0x0, 0x0, 0x0, 0x0, 0x0
.long 0x508031, 0x20a2, 0x80a1, 0x134, 0x3d4, 0x20c5, 0x0, 0x0, 0x0, 0x0, 0x0, 0x0, 0x0, 0x0, 0x0, 0x0
.long 0x509031, 0x20c2, 0x90a1, 0x154, 0x3f4, 0x20e5, 0x0, 0x0, 0x0, 0x0, 0x0, 0x0, 0x0, 0x0, 0x0, 0x0
.long 0x10108041, 0x10108061, 0x101080a1, 0x90e1, 0x402096, 0x0, 0x0, 0x0, 0x0, 0x0, 0x0, 0x0, 0x0, 0x0, 0x0, 0x0
.long 0x10109041, 0x10109061, 0x101090a1, 0xa0e1, 0x1f4, 0x24008288, 0x0, 0x0, 0x0, 0x0, 0x0, 0x0, 0x0, 0x0, 0x0, 0x0
.long 0x1010a041, 0x1010a061, 0x1010a0a1, 0xb0e1, 0x214, 0x24009288, 0x0, 0x0, 0x0, 0x0, 0x0, 0x0, 0x0, 0x0, 0x0, 0x0
.long 0x1010b041, 0x1010b061, 0x1010b0a1, 0x1080e1, 0x234, 0x2400a288, 0x0, 0x0, 0x0, 0x0, 0x0, 0x0, 0x0, 0x0, 0x0, 0x0
.long 0x10208001, 0x10008081, 0x100080c1, 0x1090e1, 0x254, 0x2400c288, 0x0, 0x0, 0x0, 0x0, 0x0, 0x0, 0x0, 0x0, 0x0, 0x0
.long 0x10209001, 0x10009081, 0x100090c1, 0x10a0e1, 0x274, 0x2400d288, 0x0, 0x0, 0x0, 0x0, 0x0, 0x0, 0x0, 0x0, 0x0, 0x0
.long 0x1020a001, 0x1000a081, 0x1000a0c1, 0x10b0e1, 0x294, 0x2400e288, 0x0, 0x0, 0x0, 0x0, 0x0, 0x0, 0x0, 0x0, 0x0, 0x0
.long 0x1020b001, 0x1000b081, 0x1000b0c1, 0x2080c1, 0x2b4, 0x2400f288, 0x0, 0x0, 0x0, 0x0, 0x0, 0x0, 0x0, 0x0, 0x0, 0x0
.long 0x50a031, 0x20e2, 0x1000a0a1, 0x20b0a1, 0x1b4, 0x2400b288, 0x0, 0x0, 0x0, 0x0, 0x0, 0x0, 0x0, 0x0, 0x0, 0x0
.long 0x10208021, 0x10108081, 0x101080c1, 0x2090c1, 0x2d4, 0x24008298, 0x0, 0x0, 0x0, 0x0, 0x0, 0x0, 0x0, 0x0, 0x0, 0x0
.long 0x10209021, 0x10109081, 0x101090c1, 0x20a0c1, 0x2f4, 0x24009298, 0x0, 0x0, 0x0, 0x0, 0x0, 0x0, 0x0, 0x0, 0x0, 0x0
.long 0x1020a021, 0x1010a081, 0x1010a0c1, 0x20b0c1, 0x314, 0x2400a298, 0x0, 0x0, 0x0, 0x0, 0x0, 0x0, 0x0, 0x0, 0x0, 0x0
.long 0x1020b021, 0x1010b081, 0x1010b0c1, 0x2080e1, 0x334, 0x2400c298, 0x0, 0x0, 0x0, 0x0, 0x0, 0x0, 0x0, 0x0, 0x0, 0x0
.long 0x10208041, 0x10208081, 0x102080a1, 0x2090e1, 0x354, 0x2400d298, 0x0, 0x0, 0x0, 0x0, 0x0, 0x0, 0x0, 0x0, 0x0, 0x0
.long 0x10209041, 0x10209081, 0x102090a1, 0x20a0e1, 0x374, 0x2400e298, 0x0, 0x0, 0x0, 0x0, 0x0, 0x0, 0x0, 0x0, 0x0, 0x0
.long 0x1020a041, 0x1020a081, 0x1020a0a1, 0x20b0e1, 0x394, 0x2400f298, 0x0, 0x0, 0x0, 0x0, 0x0, 0x0, 0x0, 0x0, 0x0, 0x0
.long 0x50b031, 0x1020b041, 0x1000b0a1, 0x80e1, 0x1d4, 0x2400b298, 0x0, 0x0, 0x0, 0x0, 0x0, 0x0, 0x0, 0x0, 0x0, 0x0
.long 0x83, 0x30028b, 0x20110b, 0x208061, 0x44002007, 0x0, 0x0, 0x0, 0x0, 0x0, 0x0, 0x0, 0x0, 0x0, 0x0, 0x0
.long 0x93, 0x3002bb, 0x20112b, 0x209061, 0x44002017, 0x0, 0x0, 0x0, 0x0, 0x0, 0x0, 0x0, 0x0, 0x0, 0x0, 0x0
.long 0xa3, 0x3002eb, 0x20114b, 0x20a061, 0x44002027, 0x0, 0x0, 0x0, 0x0, 0x0, 0x0, 0x0, 0x0, 0x0, 0x0, 0x0
.long 0xb3, 0x30031b, 0x20116b, 0x20b061, 0x44002037, 0x0, 0x0, 0x0, 0x0, 0x0, 0x0, 0x0, 0x0, 0x0, 0x0, 0x0
.long 0x3002, 0x1014, 0x3006, 0x0, 0x0, 0x0, 0x0, 0x0, 0x0, 0x0, 0x0, 0x0, 0x0, 0x0, 0x0, 0x0
.long 0x40c031, 0x3022, 0x1034, 0x1174, 0x403076, 0x0, 0x0, 0x0, 0x0, 0x0, 0x0, 0x0, 0x0, 0x0, 0x0, 0x0
.long 0x40d031, 0x3042, 0x1054, 0x1194, 0x403086, 0x0, 0x0, 0x0, 0x0, 0x0, 0x0, 0x0, 0x0, 0x0, 0x0, 0x0
.long 0x40e031, 0x3062, 0x1074, 0x403026, 0x3005, 0x0, 0x0, 0x0, 0x0, 0x0, 0x0, 0x0, 0x0, 0x0, 0x0, 0x0
.long 0x1000c041, 0xc061, 0x1094, 0x403036, 0x3025, 0x0, 0x0, 0x0, 0x0, 0x0, 0x0, 0x0, 0x0, 0x0, 0x0, 0x0
.long 0x1000d041, 0xd061, 0x10b4, 0x403046, 0x3045, 0x0, 0x0, 0x0, 0x0, 0x0, 0x0, 0x0, 0x0, 0x0, 0x0, 0x0
.long 0x1000e041, 0xe061, 0x10d4, 0x403056, 0x3065, 0x0, 0x0, 0x0, 0x0, 0x0, 0x0, 0x0, 0x0, 0x0, 0x0, 0x0
.long 0x1000f041, 0xf061, 0x10f4, 0x403066, 0x3085, 0x0, 0x0, 0x0, 0x0, 0x0, 0x0, 0x0, 0x0, 0x0, 0x0, 0x0
.long 0x40f031, 0x3082, 0x20f081, 0x1114, 0x13b4, 0x30a5, 0x0, 0x0, 0x0, 0x0, 0x0, 0x0, 0x0, 0x0, 0x0, 0x0
.long 0x50c031, 0x30a2, 0xc0a1, 0x1134, 0x13d4, 0x30c5, 0x0, 0x0, 0x0, 0x0, 0x0, 0x0, 0x0, 0x0, 0x0, 0x0
.long 0x50d031, 0x30c2, 0xd0a1, 0x1154, 0x13f4, 0x30e5, 0x0, 0x0, 0x0, 0x0, 0x0, 0x0, 0x0, 0x0, 0x0, 0x0
.long 0x1010c041, 0x1010c061, 0x1010c0a1, 0xd0e1, 0x403096, 0x0, 0x0, 0x0, 0x0, 0x0, 0x0, 0x0, 0x0, 0x0, 0x0, 0x0
.long 0x1010d041, 0x1010d061, 0x1010d0a1, 0xe0e1, 0x11f4, 0x24018288, 0x0, 0x0, 0x0, 0x0, 0x0, 0x0, 0x0, 0x0, 0x0, 0x0
.long 0x1010e041, 0x1010e061, 0x1010e0a1, 0xf0e1, 0x1214, 0x24019288, 0x0, 0x0, 0x0, 0x0, 0x0, 0x0, 0x0, 0x0, 0x0, 0x0
.long 0x1010f041, 0x1010f061, 0x1010f0a1, 0x10c0e1, 0x1234, 0x2401a288, 0x0, 0x0, 0x0, 0x0, 0x0, 0x0, 0x0, 0x0, 0x0, 0x0
.long 0x1020c001, 0x1000c081, 0x1000c0c1, 0x10d0e1, 0x1254, 0x2401c288, 0x0, 0x0, 0x0, 0x0, 0x0, 0x0, 0x0, 0x0, 0x0, 0x0
.long 0x1020d001, 0x1000d081, 0x1000d0c1, 0x10e0e1, 0x1274, 0x2401d288, 0x0, 0x0, 0x0, 0x0, 0x0, 0x0, 0x0, 0x0, 0x0, 0x0
.long 0x1020e001, 0x1000e081, 0x1000e0c1, 0x10f0e1, 0x1294, 0x2401e288, 0x0, 0x0, 0x0, 0x0, 0x0, 0x0, 0x0, 0x0, 0x0, 0x0
.long 0x1020f001, 0x1000f081, 0x1000f0c1, 0x20c0c1, 0x12b4, 0x2401f288, 0x0, 0x0, 0x0, 0x0, 0x0, 0x0, 0x0, 0x0, 0x0, 0x0
.long 0x50e031, 0x30e2, 0x1000e0a1, 0x20f0a1, 0x11b4, 0x2401b288, 0x0, 0x0, 0x0, 0x0, 0x0, 0x0, 0x0, 0x0, 0x0, 0x0
.long 0x1020c021, 0x1010c081, 0x1010c0c1, 0x20d0c1, 0x12d4, 0x24018298, 0x0, 0x0, 0x0, 0x0, 0x0, 0x0, 0x0, 0x0, 0x0, 0x0
.long 0x1020d021, 0x1010d081, 0x1010d0c1, 0x20e0c1, 0x12f4, 0x24019298, 0x0, 0x0, 0x0, 0x0, 0x0, 0x0, 0x0, 0x0, 0x0, 0x0
.long 0x1020e021, 0x1010e081, 0x1010e0c1, 0x20f0c1, 0x1314, 0x2401a298, 0x0, 0x0, 0x0, 0x0, 0x0, 0x0, 0x0, 0x0, 0x0, 0x0
.long 0x1020f021, 0x1010f081, 0x1010f0c1, 0x20c0e1, 0x1334, 0x2401c298, 0x0, 0x0, 0x0, 0x0, 0x0, 0x0, 0x0, 0x0, 0x0, 0x0
.long 0x1020c041, 0x1020c081, 0x1020c0a1, 0x20d0e1, 0x1354, 0x2401d298, 0x0, 0x0, 0x0, 0x0, 0x0, 0x0, 0x0, 0x0, 0x0, 0x0
.long 0x1020d041, 0x1020d081, 0x1020d0a1, 0x20e0e1, 0x1374, 0x2401e298, 0x0, 0x0, 0x0, 0x0, 0x0, 0x0, 0x0, 0x0, 0x0, 0x0
.long 0x1020e041, 0x1020e081, 0x1020e0a1, 0x20f0e1, 0x1394, 0x2401f298, 0x0, 0x0, 0x0, 0x0, 0x0, 0x0, 0x0, 0x0, 0x0, 0x0
.long 0x50f031, 0x1020f041, 0x1000f0a1, 0xc0e1, 0x11d4, 0x2401b298, 0x0, 0x0, 0x0, 0x0, 0x0, 0x0, 0x0, 0x0, 0x0, 0x0
.long 0xc3, 0x30034b, 0x20118b, 0x20c061, 0x44003007, 0x0, 0x0, 0x0, 0x0, 0x0, 0x0, 0x0, 0x0, 0x0, 0x0, 0x0
.long 0xd3, 0x30037b, 0x2011ab, 0x20d061, 0x44003017, 0x0, 0x0, 0x0, 0x0, 0x0, 0x0, 0x0, 0x0, 0x0, 0x0, 0x0
.long 0xe3, 0x3003ab, 0x2011cb, 0x20e061, 0x44003027, 0x0, 0x0, 0x0, 0x0, 0x0, 0x0, 0x0, 0x0, 0x0, 0x0, 0x0
.long 0xf3, 0x3003db, 0x2011eb, 0x20f061, 0x44003037, 0x0, 0x0, 0x0, 0x0, 0x0, 0x0, 0x0, 0x0, 0x0, 0x0, 0x0
.size task_table, 16384
```
